```python
import torch

def _softmax(x, axis=-1):
    return torch.softmax(x, dim=axis)
def _gelu(x):
    return torch.nn.functional.gelu(x, approximate="tanh")
def _silu(x):
    return torch.nn.functional.silu(x)
def _sigmoid(x):
    return torch.sigmoid(x)
def _layernorm(x, axis=-1, eps=1e-5):
    m = x.mean(dim=axis, keepdim=True)
    v = x.var(dim=axis, keepdim=True, unbiased=False)
    return (x - m) / torch.sqrt(v + eps)
def _scatter_add(tgt, idx, src, axis=0):
    return tgt.clone().index_add_(axis, idx, src)
def _segment_sum(src, seg, n):
    out = torch.zeros((n,) + src.shape[1:], dtype=src.dtype)
    return out.index_add_(0, seg, src)
def _pad(x, pw):
    flat = tuple(v for pair in reversed(pw) for v in pair)
    return torch.nn.functional.pad(x, flat)

kernel_name = 'parallel_sum__compressed_kv_cla__geglu_ffn__prompt'

def setup_inputs():

    _w = (lambda a: (lambda t: t.to(torch.bfloat16) if t.is_floating_point() else t)(torch.as_tensor(a)))
    def _A_setup():
        B, H, Sq, Sk, D, M = 1, 32, 2048, 2048, 128, 512
        Dc = 4 * D
        return {
            "x": _w((lambda *s: torch.randn(*s, dtype=torch.bfloat16) * 0.05)(B, Sq, M)),
            "c_kv": _w((lambda *s: torch.randn(*s, dtype=torch.bfloat16) * 1.6)(B, Sk, Dc)),
            "w_q": _w((lambda *s: torch.randn(*s, dtype=torch.bfloat16) * 0.8)(M, H, D) * (M ** -0.5)),
            "w_uk": _w((lambda *s: torch.randn(*s, dtype=torch.bfloat16) * 0.8)(Dc, H, D) * (Dc ** -0.5)),
            "w_uv": _w((lambda *s: torch.randn(*s, dtype=torch.bfloat16) * 1.6)(Dc, H, D) * (Dc ** -0.5)),
            "w_o": _w((lambda *s: torch.randn(*s, dtype=torch.bfloat16) * 1.6)(H, D, M) * ((H * D) ** -0.5)),
        }
    _A_in = _A_setup()

    def _B_setup():
        B, S, D, F = 1, 2048, 512, 1376
        return {
            "x": _w((lambda *s: torch.randn(*s, dtype=torch.bfloat16) * 0.05)(B, S, D)),
            "w_gate": _w((lambda *s: torch.randn(*s, dtype=torch.bfloat16) * 0.05)(D, F)),
            "w_up": _w((lambda *s: torch.randn(*s, dtype=torch.bfloat16) * 0.05)(D, F)),
            "w_down": _w((lambda *s: torch.randn(*s, dtype=torch.bfloat16) * 0.05)(F, D)),
        }
    _B_in = _B_setup()

    return {
        "A_x": _A_in["x"],
        "A_c_kv": _A_in["c_kv"],
        "A_w_q": _A_in["w_q"],
        "A_w_uk": _A_in["w_uk"],
        "A_w_uv": _A_in["w_uv"],
        "A_w_o": _A_in["w_o"],
        "B_x": _B_in["x"],
        "B_w_gate": _B_in["w_gate"],
        "B_w_up": _B_in["w_up"],
        "B_w_down": _B_in["w_down"],
    }

def reference(A_x, A_c_kv, A_w_q, A_w_uk, A_w_uv, A_w_o, B_x, B_w_gate, B_w_up, B_w_down):
    def _A_ref(x, c_kv, w_q, w_uk, w_uv, w_o):
        B, Sq, M = x.shape[0], x.shape[1], x.shape[2]
        Sk = c_kv.shape[1]
        H, D = w_q.shape[1], w_q.shape[2]
        q = torch.einsum("bqm,mhd->bhqd", x, w_q)
        k = torch.einsum("bkc,chd->bhkd", c_kv, w_uk)
        v = torch.einsum("bkc,chd->bhkd", c_kv, w_uv)
        scores = torch.einsum("bhqd,bhkd->bhqk", q, k) * (D ** -0.5)
        off = Sk - Sq
        qi = torch.arange(Sq)[:, None]
        kj = torch.arange(Sk)[None, :]
        cmask = kj <= (qi + off)
        scores = torch.where(cmask[None, None], scores, -1e9)
        p = _softmax(scores, axis=-1)
        ctx = torch.einsum("bhqk,bhkd->bhqd", p, v)
        return torch.einsum("bhqd,hdm->bqm", ctx, w_o)

    def _B_ref(x, w_gate, w_up, w_down):
        return (_gelu(x @ w_gate) * (x @ w_up)) @ w_down

    x = A_x
    xn = _layernorm(x, axis=-1)
    return x + _A_ref(xn, A_c_kv, A_w_q, A_w_uk, A_w_uv, A_w_o) + _B_ref(xn, B_w_gate, B_w_up, B_w_down)
```

```asm
; @launch grid=(256,1,1) block=(256,1,1) lds=163840
.amdgcn_target "amdgcn-amd-amdhsa--gfx950"
.text
.globl parallel_sum__compressed_kv_cla__geglu_ffn__prompt_kernel
.p2align 8
.type parallel_sum__compressed_kv_cla__geglu_ffn__prompt_kernel,@function
parallel_sum__compressed_kv_cla__geglu_ffn__prompt_kernel:
s_cmp_ge_u32 s2, 256
s_cbranch_scc1 KF_end
s_getpc_b64 s[78:79]
KF_top:
s_lshr_b32 s69, s2, 3
s_lshl_b32 s69, s69, 12
s_min_u32 s69, s69, KF_codeend-KF_top-4096
s_add_u32 s78, s78, s69
s_addc_u32 s79, s79, 0
v_lshrrev_b32 v11, 6, v0
v_and_b32 v12, 7, v0
v_lshl_add_u32 v11, v11, 3, v12
v_lshlrev_b32 v11, 7, v11
global_load_dword v12, v11, s[78:79]
s_load_dwordx4 s[84:87], s[0:1], 0
s_load_dwordx4 s[88:91], s[0:1], 24
s_load_dwordx4 s[92:95], s[0:1], 88
v_lshrrev_b32 v32, 6, v0
v_and_b32 v1, 63, v0
v_readfirstlane_b32 s40, v32
v_lshlrev_b32 v2, 4, v1
v_lshrrev_b32 v32, 3, v1
v_and_b32 v33, 7, v1
v_lshrrev_b32 v34, 1, v32
v_xor_b32 v35, v33, v34
v_lshlrev_b32 v36, 10, v32
v_lshl_add_u32 v240, v35, 4, v36
v_xor_b32 v37, 4, v35
v_lshl_add_u32 v241, v37, 4, v36
v_add_u32 v241, 7168, v241
v_lshl_add_u32 v242, v35, 4, v36
v_add_u32 v242, 14336, v242
v_xor_b32 v37, 4, v35
v_lshl_add_u32 v243, v37, 4, v36
v_add_u32 v243, 21504, v243
s_and_b32 s65, s2, 7
s_lshr_b32 s66, s2, 3
s_and_b32 s67, s66, 3
s_and_b32 s68, s65, 1
s_lshl_b32 s68, s68, 2
s_add_u32 s67, s68, s67
s_lshr_b32 s65, s65, 1
s_lshl_b32 s65, s65, 3
s_lshr_b32 s43, s66, 3
s_add_u32 s43, s43, s68
s_and_b32 s44, s66, 7
s_add_u32 s44, s44, s65
s_lshr_b32 s66, s66, 2
s_add_u32 s65, s65, s66
s_lshr_b32 s101, s65, 4
s_and_b32 s65, s65, 15
s_lshl_b32 s47, s65, 9
s_lshl_b32 s67, s67, 2
s_add_u32 s67, s67, s40
s_lshl_b32 s48, s67, 16
s_lshl_b32 s67, s67, 15
s_lshl_b32 s50, s65, 21
s_add_u32 s50, s50, s67
s_mul_i32 s49, s40, 24576
s_lshl_b32 s41, s40, 12
s_add_u32 s42, s41, 98304
s_lshl_b32 s82, s40, 11
s_add_u32 s82, s82, 98304
s_lshl_b32 s65, s43, 2
s_add_u32 s45, s65, s40
s_sub_u32 s46, 63, s45
v_and_b32 v34, 1, v34
v_lshlrev_b32 v34, 1, v34
v_xor_b32 v33, v33, v34
s_lshl_b32 s65, s40, 5
v_add_u32 v32, s65, v32
v_lshlrev_b32 v32, 13, v32
v_lshl_add_u32 v236, v33, 4, v32
v_xor_b32 v34, 4, v33
v_lshl_add_u32 v237, v34, 4, v32
v_add_u32 v237, 64512, v237
v_lshl_add_u32 v238, v33, 4, v32
v_add_u32 v238, 129024, v238
v_xor_b32 v34, 4, v33
v_lshl_add_u32 v239, v34, 4, v32
v_add_u32 v239, 193536, v239
s_waitcnt lgkmcnt(0)
s_mov_b32 s8, s86
s_mov_b32 s9, s87
s_mov_b32 s10, 0x200000
s_mov_b32 s11, 0x20000
s_cmp_eq_u32 s101, 0
s_cselect_b32 s12, s88, s90
s_cselect_b32 s13, s89, s91
s_mov_b32 s14, 0x400000
s_mov_b32 s15, 0x20000
s_lshr_b32 s68, s2, 3
s_lshl_b32 s68, s68, 2
s_add_u32 s68, s68, s40
s_and_b32 s69, s2, 1
s_lshl_b32 s69, s69, 20
s_lshl_b32 s68, s68, 13
s_add_u32 s67, s68, s69
s_bfe_u32 s69, s2, 0x10001
s_lshl_b32 s69, s69, 12
s_add_u32 s68, s68, s69
v_and_b32 v8, 7, v1
v_lshrrev_b32 v9, 3, v1
v_mov_b32 v10, 0x7ff00000
v_add_u32 v224, 0, v9
v_cmp_gt_u32 vcc, 2, v224
v_lshlrev_b32 v224, 7, v224
v_lshl_add_u32 v224, v8, 10, v224
v_cndmask_b32 v224, v10, v224, vcc
buffer_load_dword v220, v224, s[8:11], s67 offen
v_add_u32 v225, 0, v9
v_cmp_gt_u32 vcc, 1, v225
v_lshlrev_b32 v225, 20, v225
v_lshl_add_u32 v225, v8, 9, v225
v_cndmask_b32 v225, v10, v225, vcc
buffer_load_dword v221, v225, s[12:15], s68 offen
s_add_u32 m0, s49, 0
s_add_u32 s66, s48, 0
buffer_load_dwordx4 v240, s[8:11], s66 offen offset:0 lds
buffer_load_dwordx4 v241, s[8:11], s66 offen offset:1024 lds
buffer_load_dwordx4 v242, s[8:11], s66 offen offset:2048 lds
buffer_load_dwordx4 v243, s[8:11], s66 offen offset:3072 lds
s_add_u32 m0, s49, 4096
s_add_u32 s66, s48, 32768
buffer_load_dwordx4 v240, s[8:11], s66 offen offset:0 lds
buffer_load_dwordx4 v241, s[8:11], s66 offen offset:1024 lds
buffer_load_dwordx4 v242, s[8:11], s66 offen offset:2048 lds
buffer_load_dwordx4 v243, s[8:11], s66 offen offset:3072 lds
s_add_u32 m0, s42, 32768
s_add_u32 s65, s47, 0
buffer_load_dwordx4 v236, s[12:15], s65 offen offset:0 lds
buffer_load_dwordx4 v237, s[12:15], s65 offen offset:1024 lds
buffer_load_dwordx4 v238, s[12:15], s65 offen offset:2048 lds
buffer_load_dwordx4 v239, s[12:15], s65 offen offset:3072 lds
s_add_u32 m0, s49, 8192
s_add_u32 s66, s48, 128
buffer_load_dwordx4 v240, s[8:11], s66 offen offset:0 lds
buffer_load_dwordx4 v241, s[8:11], s66 offen offset:1024 lds
buffer_load_dwordx4 v242, s[8:11], s66 offen offset:2048 lds
buffer_load_dwordx4 v243, s[8:11], s66 offen offset:3072 lds
s_add_u32 m0, s49, 12288
s_add_u32 s66, s48, 32896
buffer_load_dwordx4 v240, s[8:11], s66 offen offset:0 lds
buffer_load_dwordx4 v241, s[8:11], s66 offen offset:1024 lds
buffer_load_dwordx4 v242, s[8:11], s66 offen offset:2048 lds
buffer_load_dwordx4 v243, s[8:11], s66 offen offset:3072 lds
s_mov_b32 s80, s94
s_mov_b32 s81, s95
s_add_u32 s32, s80, 0x4800000
s_addc_u32 s33, s81, 0
s_mov_b32 s34, 0xdc00
s_mov_b32 s35, 0x20000
v_mov_b32 v3, 0x7ff00000
v_mov_b32 v5, 0x7ff00000
v_mov_b32 v6, 1
v_cmp_eq_u32 vcc, 0, v0
s_nop 1
v_cndmask_b32_e64 v3, v3, 0, vcc
v_cmp_eq_u32 vcc, 0, v1
s_nop 1
v_cndmask_b32_e64 v5, v5, 0, vcc
v_lshlrev_b32 v13, 15, v0
v_cmp_gt_u32 vcc, 2, v0
s_nop 1
v_cndmask_b32 v13, v3, v13, vcc
v_mov_b32 v14, 0
s_lshl_b32 s62, s2, 7
s_mov_b32 s4, s84
s_mov_b32 s5, s85
s_mov_b32 s6, 0x200000
s_mov_b32 s7, 0x20000
s_lshl_b32 s63, s2, 2
s_add_u32 s63, s63, s40
s_lshl_b32 s63, s63, 11
s_mov_b32 s36, s92
s_mov_b32 s37, s93
s_mov_b32 s38, 0x100
s_mov_b32 s39, 0x20000
s_mov_b32 s16, s80
s_mov_b32 s17, s81
s_mov_b32 s18, 0x200000
s_mov_b32 s19, 0x20000
s_add_u32 s20, s80, 0x200000
s_addc_u32 s21, s81, 0
s_mov_b32 s22, 0x2000000
s_mov_b32 s23, 0x20000
s_mov_b32 s98, s84
s_mov_b32 s99, s85
s_load_dwordx2 s[84:85], s[0:1], 16
s_load_dwordx2 s[86:87], s[0:1], 40
s_load_dwordx4 s[88:91], s[0:1], 56
s_load_dwordx4 s[92:95], s[0:1], 72
v_lshrrev_b32 v32, 4, v1
v_bfe_u32 v33, v1, 2, 2
v_lshl_add_u32 v34, v32, 3, v33
v_lshlrev_b32 v34, 7, v34
v_and_b32 v32, 1, v32
v_lshlrev_b32 v32, 1, v32
v_lshrrev_b32 v33, 1, v33
v_or_b32 v32, v32, v33
v_and_b32 v33, 3, v1
v_lshl_add_u32 v34, v33, 3, v34
v_add_u32 v34, 98304, v34
v_xor_b32 v33, 0, v32
v_lshl_add_u32 v228, v33, 5, v34
v_xor_b32 v33, 1, v32
v_lshl_add_u32 v229, v33, 5, v34
v_xor_b32 v33, 2, v32
v_lshl_add_u32 v230, v33, 5, v34
v_xor_b32 v33, 3, v32
v_lshl_add_u32 v231, v33, 5, v34
v_and_b32 v32, 15, v1
v_lshrrev_b32 v33, 4, v1
v_lshrrev_b32 v34, 1, v32
v_xor_b32 v33, v33, v34
v_lshlrev_b32 v32, 7, v32
v_add_u32 v32, s49, v32
v_lshl_add_u32 v232, v33, 4, v32
v_xor_b32 v33, 4, v33
v_lshl_add_u32 v233, v33, 4, v32
s_waitcnt vmcnt(12)
ds_read_b128 a[0:3], v232 offset:0
ds_read_b128 a[4:7], v232 offset:2048
ds_read_b128 a[8:11], v232 offset:4096
ds_read_b128 a[12:15], v232 offset:6144
ds_read_b128 a[16:19], v233 offset:0
ds_read_b128 a[20:23], v233 offset:2048
ds_read_b128 a[24:27], v233 offset:4096
ds_read_b128 a[28:31], v233 offset:6144
s_waitcnt vmcnt(8)
s_barrier
ds_read_b64_tr_b16 v[200:201], v228 offset:32768
ds_read_b64_tr_b16 v[202:203], v228 offset:33280
ds_read_b64_tr_b16 v[204:205], v229 offset:32768
ds_read_b64_tr_b16 v[206:207], v229 offset:33280
ds_read_b64_tr_b16 v[208:209], v230 offset:32768
ds_read_b64_tr_b16 v[210:211], v230 offset:33280
s_waitcnt lgkmcnt(0)
s_cmp_eq_u32 s101, 0
s_cbranch_scc0 KF_vtype
v_mfma_f32_16x16x32_bf16 v[72:75], v[200:203], a[0:3], 0
ds_read_b64_tr_b16 v[212:213], v231 offset:32768
v_add_u32 v224, 2, v9
v_mfma_f32_16x16x32_bf16 v[76:79], v[200:203], a[4:7], 0
v_cmp_gt_u32 vcc, 8, v224
v_lshlrev_b32 v224, 7, v224
v_mfma_f32_16x16x32_bf16 v[80:83], v[200:203], a[8:11], 0
ds_read_b64_tr_b16 v[214:215], v231 offset:33280
v_lshl_add_u32 v224, v8, 10, v224
v_mfma_f32_16x16x32_bf16 v[84:87], v[200:203], a[12:15], 0
v_cndmask_b32 v224, v10, v224, vcc
v_mfma_f32_16x16x32_bf16 v[88:91], v[204:207], a[0:3], 0
ds_read_b64_tr_b16 v[200:201], v228 offset:36864
buffer_load_dword v222, v224, s[8:11], s67 offen
v_mfma_f32_16x16x32_bf16 v[92:95], v[204:207], a[4:7], 0
v_add_u32 v225, 1, v9
v_cmp_gt_u32 vcc, 4, v225
v_mfma_f32_16x16x32_bf16 v[96:99], v[204:207], a[8:11], 0
ds_read_b64_tr_b16 v[202:203], v228 offset:37376
v_lshlrev_b32 v225, 20, v225
v_mfma_f32_16x16x32_bf16 v[100:103], v[204:207], a[12:15], 0
v_lshl_add_u32 v225, v8, 9, v225
v_mfma_f32_16x16x32_bf16 v[104:107], v[208:211], a[0:3], 0
ds_read_b64_tr_b16 v[204:205], v229 offset:36864
v_cndmask_b32 v225, v10, v225, vcc
v_mfma_f32_16x16x32_bf16 v[108:111], v[208:211], a[4:7], 0
buffer_load_dword v223, v225, s[12:15], s68 offen
s_add_u32 m0, s42, 49152
v_mfma_f32_16x16x32_bf16 v[112:115], v[208:211], a[8:11], 0
ds_read_b64_tr_b16 v[206:207], v229 offset:37376
s_add_u32 s65, s47, 1048576
v_mfma_f32_16x16x32_bf16 v[116:119], v[208:211], a[12:15], 0
s_waitcnt lgkmcnt(4)
buffer_load_dwordx4 v236, s[12:15], s65 offen offset:0 lds
v_mfma_f32_16x16x32_bf16 v[120:123], v[212:215], a[0:3], 0
ds_read_b64_tr_b16 v[208:209], v230 offset:36864
buffer_load_dwordx4 v237, s[12:15], s65 offen offset:1024 lds
v_mfma_f32_16x16x32_bf16 v[124:127], v[212:215], a[4:7], 0
buffer_load_dwordx4 v238, s[12:15], s65 offen offset:2048 lds
v_mfma_f32_16x16x32_bf16 v[128:131], v[212:215], a[8:11], 0
ds_read_b64_tr_b16 v[210:211], v230 offset:37376
buffer_load_dwordx4 v239, s[12:15], s65 offen offset:3072 lds
v_mfma_f32_16x16x32_bf16 v[132:135], v[212:215], a[12:15], 0
s_waitcnt lgkmcnt(4)
buffer_store_dword v14, v13, s[32:35], s62 offen sc1
v_mfma_f32_16x16x32_bf16 v[72:75], v[200:203], a[16:19], v[72:75]
ds_read_b64_tr_b16 v[212:213], v231 offset:36864
buffer_load_dwordx4 v[24:27], v2, s[4:7], s63 offen
v_mfma_f32_16x16x32_bf16 v[76:79], v[200:203], a[20:23], v[76:79]
s_waitcnt vmcnt(8)
ds_read_b128 a[32:35], v232 offset:8192
buffer_load_dwordx4 v[28:31], v2, s[4:7], s63 offen offset:1024
v_mfma_f32_16x16x32_bf16 v[80:83], v[200:203], a[24:27], v[80:83]
ds_read_b64_tr_b16 v[214:215], v231 offset:37376
s_add_u32 m0, s49, 16384
v_mfma_f32_16x16x32_bf16 v[84:87], v[200:203], a[28:31], v[84:87]
ds_read_b128 a[36:39], v232 offset:10240
s_waitcnt lgkmcnt(6)
v_mfma_f32_16x16x32_bf16 v[88:91], v[204:207], a[16:19], v[88:91]
ds_read_b64_tr_b16 v[200:201], v228 offset:40960
s_add_u32 s66, s48, 256
v_mfma_f32_16x16x32_bf16 v[92:95], v[204:207], a[20:23], v[92:95]
ds_read_b128 a[40:43], v232 offset:12288
buffer_load_dwordx4 v240, s[8:11], s66 offen offset:0 lds
v_mfma_f32_16x16x32_bf16 v[96:99], v[204:207], a[24:27], v[96:99]
ds_read_b64_tr_b16 v[202:203], v228 offset:41472
buffer_load_dwordx4 v241, s[8:11], s66 offen offset:1024 lds
v_mfma_f32_16x16x32_bf16 v[100:103], v[204:207], a[28:31], v[100:103]
ds_read_b128 a[44:47], v232 offset:14336
s_waitcnt lgkmcnt(8)
v_mfma_f32_16x16x32_bf16 v[104:107], v[208:211], a[16:19], v[104:107]
ds_read_b64_tr_b16 v[204:205], v229 offset:40960
buffer_load_dwordx4 v242, s[8:11], s66 offen offset:2048 lds
v_mfma_f32_16x16x32_bf16 v[108:111], v[208:211], a[20:23], v[108:111]
ds_read_b128 a[48:51], v233 offset:8192
buffer_load_dwordx4 v243, s[8:11], s66 offen offset:3072 lds
v_mfma_f32_16x16x32_bf16 v[112:115], v[208:211], a[24:27], v[112:115]
ds_read_b64_tr_b16 v[206:207], v229 offset:41472
s_add_u32 m0, s49, 20480
v_mfma_f32_16x16x32_bf16 v[116:119], v[208:211], a[28:31], v[116:119]
ds_read_b128 a[52:55], v233 offset:10240
s_waitcnt lgkmcnt(9)
v_mfma_f32_16x16x32_bf16 v[120:123], v[212:215], a[16:19], v[120:123]
ds_read_b64_tr_b16 v[208:209], v230 offset:40960
s_add_u32 s66, s48, 33024
v_mfma_f32_16x16x32_bf16 v[124:127], v[212:215], a[20:23], v[124:127]
ds_read_b128 a[56:59], v233 offset:12288
buffer_load_dwordx4 v240, s[8:11], s66 offen offset:0 lds
v_mfma_f32_16x16x32_bf16 v[128:131], v[212:215], a[24:27], v[128:131]
ds_read_b64_tr_b16 v[210:211], v230 offset:41472
buffer_load_dwordx4 v241, s[8:11], s66 offen offset:1024 lds
v_mfma_f32_16x16x32_bf16 v[132:135], v[212:215], a[28:31], v[132:135]
ds_read_b128 a[60:63], v233 offset:14336
s_waitcnt lgkmcnt(9)
v_mfma_f32_16x16x32_bf16 v[72:75], v[200:203], a[32:35], v[72:75]
ds_read_b64_tr_b16 v[212:213], v231 offset:40960
buffer_load_dwordx4 v242, s[8:11], s66 offen offset:2048 lds
v_mfma_f32_16x16x32_bf16 v[76:79], v[200:203], a[36:39], v[76:79]
buffer_load_dwordx4 v243, s[8:11], s66 offen offset:3072 lds
s_add_u32 m0, s42, 0
v_mfma_f32_16x16x32_bf16 v[80:83], v[200:203], a[40:43], v[80:83]
ds_read_b64_tr_b16 v[214:215], v231 offset:41472
s_add_u32 s65, s47, 2097152
s_waitcnt lgkmcnt(10)
v_mfma_f32_16x16x32_bf16 v[84:87], v[200:203], a[44:47], v[84:87]
s_waitcnt lgkmcnt(7)
buffer_load_dwordx4 v236, s[12:15], s65 offen offset:0 lds
v_mfma_f32_16x16x32_bf16 v[88:91], v[204:207], a[32:35], v[88:91]
ds_read_b64_tr_b16 v[200:201], v228 offset:45056
buffer_load_dwordx4 v237, s[12:15], s65 offen offset:1024 lds
v_mfma_f32_16x16x32_bf16 v[92:95], v[204:207], a[36:39], v[92:95]
buffer_load_dwordx4 v238, s[12:15], s65 offen offset:2048 lds
v_mfma_f32_16x16x32_bf16 v[96:99], v[204:207], a[40:43], v[96:99]
ds_read_b64_tr_b16 v[202:203], v228 offset:45568
buffer_load_dwordx4 v239, s[12:15], s65 offen offset:3072 lds
v_mfma_f32_16x16x32_bf16 v[100:103], v[204:207], a[44:47], v[100:103]
s_waitcnt lgkmcnt(5)
s_add_u32 m0, s49, 0
v_mfma_f32_16x16x32_bf16 v[104:107], v[208:211], a[32:35], v[104:107]
ds_read_b64_tr_b16 v[204:205], v229 offset:45056
s_add_u32 s66, s48, 384
v_mfma_f32_16x16x32_bf16 v[108:111], v[208:211], a[36:39], v[108:111]
buffer_load_dwordx4 v240, s[8:11], s66 offen offset:0 lds
v_mfma_f32_16x16x32_bf16 v[112:115], v[208:211], a[40:43], v[112:115]
ds_read_b64_tr_b16 v[206:207], v229 offset:45568
buffer_load_dwordx4 v241, s[8:11], s66 offen offset:1024 lds
v_mfma_f32_16x16x32_bf16 v[116:119], v[208:211], a[44:47], v[116:119]
s_waitcnt lgkmcnt(4)
buffer_load_dwordx4 v242, s[8:11], s66 offen offset:2048 lds
v_mfma_f32_16x16x32_bf16 v[120:123], v[212:215], a[32:35], v[120:123]
ds_read_b64_tr_b16 v[208:209], v230 offset:45056
buffer_load_dwordx4 v243, s[8:11], s66 offen offset:3072 lds
v_mfma_f32_16x16x32_bf16 v[124:127], v[212:215], a[36:39], v[124:127]
s_add_u32 m0, s49, 4096
s_add_u32 s66, s48, 33152
v_mfma_f32_16x16x32_bf16 v[128:131], v[212:215], a[40:43], v[128:131]
ds_read_b64_tr_b16 v[210:211], v230 offset:45568
buffer_load_dwordx4 v240, s[8:11], s66 offen offset:0 lds
v_mfma_f32_16x16x32_bf16 v[132:135], v[212:215], a[44:47], v[132:135]
s_waitcnt lgkmcnt(4)
buffer_load_dwordx4 v241, s[8:11], s66 offen offset:1024 lds
v_mfma_f32_16x16x32_bf16 v[72:75], v[200:203], a[48:51], v[72:75]
ds_read_b64_tr_b16 v[212:213], v231 offset:45056
buffer_load_dwordx4 v242, s[8:11], s66 offen offset:2048 lds
v_mfma_f32_16x16x32_bf16 v[76:79], v[200:203], a[52:55], v[76:79]
s_waitcnt vmcnt(11)
ds_read_b128 a[64:67], v232 offset:16384
s_barrier
v_mfma_f32_16x16x32_bf16 v[80:83], v[200:203], a[56:59], v[80:83]
ds_read_b64_tr_b16 v[214:215], v231 offset:45568
buffer_load_dwordx4 v243, s[8:11], s66 offen offset:3072 lds
v_mfma_f32_16x16x32_bf16 v[84:87], v[200:203], a[60:63], v[84:87]
ds_read_b128 a[68:71], v232 offset:18432
s_waitcnt lgkmcnt(6)
v_mfma_f32_16x16x32_bf16 v[88:91], v[204:207], a[48:51], v[88:91]
ds_read_b64_tr_b16 v[200:201], v228 offset:49152
s_add_u32 m0, s49, 8192
s_add_u32 s66, s48, 512
buffer_load_dwordx4 v240, s[8:11], s66 offen offset:0 lds
buffer_load_dwordx4 v241, s[8:11], s66 offen offset:1024 lds
buffer_load_dwordx4 v242, s[8:11], s66 offen offset:2048 lds
buffer_load_dwordx4 v243, s[8:11], s66 offen offset:3072 lds
s_add_u32 m0, s49, 12288
s_add_u32 s66, s48, 33280
buffer_load_dwordx4 v240, s[8:11], s66 offen offset:0 lds
buffer_load_dwordx4 v241, s[8:11], s66 offen offset:1024 lds
buffer_load_dwordx4 v242, s[8:11], s66 offen offset:2048 lds
buffer_load_dwordx4 v243, s[8:11], s66 offen offset:3072 lds
v_mfma_f32_16x16x32_bf16 v[92:95], v[204:207], a[52:55], v[92:95]
ds_read_b128 a[72:75], v232 offset:20480
s_add_u32 m0, s42, 16384
s_add_u32 s65, s47, 3145728
v_mfma_f32_16x16x32_bf16 v[96:99], v[204:207], a[56:59], v[96:99]
ds_read_b64_tr_b16 v[202:203], v228 offset:49664
buffer_load_dwordx4 v236, s[12:15], s65 offen offset:0 lds
v_mfma_f32_16x16x32_bf16 v[100:103], v[204:207], a[60:63], v[100:103]
ds_read_b128 a[76:79], v232 offset:22528
s_waitcnt lgkmcnt(8)
buffer_load_dwordx4 v237, s[12:15], s65 offen offset:1024 lds
v_mfma_f32_16x16x32_bf16 v[104:107], v[208:211], a[48:51], v[104:107]
ds_read_b64_tr_b16 v[204:205], v229 offset:49152
buffer_load_dwordx4 v238, s[12:15], s65 offen offset:2048 lds
v_mfma_f32_16x16x32_bf16 v[108:111], v[208:211], a[52:55], v[108:111]
ds_read_b128 a[80:83], v233 offset:16384
buffer_load_dwordx4 v239, s[12:15], s65 offen offset:3072 lds
v_mfma_f32_16x16x32_bf16 v[112:115], v[208:211], a[56:59], v[112:115]
ds_read_b64_tr_b16 v[206:207], v229 offset:49664
s_mul_i32 s68, s40, 2080
v_mfma_f32_16x16x32_bf16 v[116:119], v[208:211], a[60:63], v[116:119]
ds_read_b128 a[84:87], v233 offset:18432
s_waitcnt lgkmcnt(9)
v_mfma_f32_16x16x32_bf16 v[120:123], v[212:215], a[48:51], v[120:123]
ds_read_b64_tr_b16 v[208:209], v230 offset:49152
v_add_u32 v60, s68, v2
v_mfma_f32_16x16x32_bf16 v[124:127], v[212:215], a[52:55], v[124:127]
ds_read_b128 a[88:91], v233 offset:20480
v_and_b32 v61, 7, v1
v_mfma_f32_16x16x32_bf16 v[128:131], v[212:215], a[56:59], v[128:131]
ds_read_b64_tr_b16 v[210:211], v230 offset:49664
v_mul_u32_u24 v62, 1040, v61
v_mfma_f32_16x16x32_bf16 v[132:135], v[212:215], a[60:63], v[132:135]
ds_read_b128 a[92:95], v233 offset:22528
s_waitcnt lgkmcnt(9)
v_mfma_f32_16x16x32_bf16 v[72:75], v[200:203], a[64:67], v[72:75]
ds_read_b64_tr_b16 v[212:213], v231 offset:49152
v_lshrrev_b32 v63, 3, v1
v_mfma_f32_16x16x32_bf16 v[76:79], v[200:203], a[68:71], v[76:79]
v_lshl_add_u32 v62, v63, 4, v62
s_lshl_b32 s68, s40, 8
v_mfma_f32_16x16x32_bf16 v[80:83], v[200:203], a[72:75], v[80:83]
ds_read_b64_tr_b16 v[214:215], v231 offset:49664
v_add_u32 v62, s68, v62
s_waitcnt lgkmcnt(10)
v_mfma_f32_16x16x32_bf16 v[84:87], v[200:203], a[76:79], v[84:87]
s_waitcnt lgkmcnt(7)
v_lshlrev_b32 v63, 8, v63
v_mfma_f32_16x16x32_bf16 v[88:91], v[204:207], a[64:67], v[88:91]
ds_read_b64_tr_b16 v[200:201], v228 offset:53248
s_waitcnt lgkmcnt(3)
v_mfma_f32_16x16x32_bf16 v[92:95], v[204:207], a[68:71], v[92:95]
s_add_u32 m0, s49, 16384
s_add_u32 s66, s48, 640
v_mfma_f32_16x16x32_bf16 v[96:99], v[204:207], a[72:75], v[96:99]
ds_read_b64_tr_b16 v[202:203], v228 offset:53760
buffer_load_dwordx4 v240, s[8:11], s66 offen offset:0 lds
v_mfma_f32_16x16x32_bf16 v[100:103], v[204:207], a[76:79], v[100:103]
buffer_load_dwordx4 v241, s[8:11], s66 offen offset:1024 lds
v_mfma_f32_16x16x32_bf16 v[104:107], v[208:211], a[64:67], v[104:107]
ds_read_b64_tr_b16 v[204:205], v229 offset:53248
buffer_load_dwordx4 v242, s[8:11], s66 offen offset:2048 lds
v_mfma_f32_16x16x32_bf16 v[108:111], v[208:211], a[68:71], v[108:111]
buffer_load_dwordx4 v243, s[8:11], s66 offen offset:3072 lds
s_add_u32 m0, s49, 20480
v_mfma_f32_16x16x32_bf16 v[112:115], v[208:211], a[72:75], v[112:115]
ds_read_b64_tr_b16 v[206:207], v229 offset:53760
s_add_u32 s66, s48, 33408
v_mfma_f32_16x16x32_bf16 v[116:119], v[208:211], a[76:79], v[116:119]
s_waitcnt lgkmcnt(4)
buffer_load_dwordx4 v240, s[8:11], s66 offen offset:0 lds
v_mfma_f32_16x16x32_bf16 v[120:123], v[212:215], a[64:67], v[120:123]
ds_read_b64_tr_b16 v[208:209], v230 offset:53248
buffer_load_dwordx4 v241, s[8:11], s66 offen offset:1024 lds
v_mfma_f32_16x16x32_bf16 v[124:127], v[212:215], a[68:71], v[124:127]
buffer_load_dwordx4 v242, s[8:11], s66 offen offset:2048 lds
buffer_load_dwordx4 v243, s[8:11], s66 offen offset:3072 lds
v_mfma_f32_16x16x32_bf16 v[128:131], v[212:215], a[72:75], v[128:131]
ds_read_b64_tr_b16 v[210:211], v230 offset:53760
v_lshl_add_u32 v63, v61, 4, v63
v_mfma_f32_16x16x32_bf16 v[132:135], v[212:215], a[76:79], v[132:135]
s_waitcnt lgkmcnt(4)
s_lshr_b32 s68, s2, 1
v_mfma_f32_16x16x32_bf16 v[72:75], v[200:203], a[80:83], v[72:75]
ds_read_b64_tr_b16 v[212:213], v231 offset:53248
s_lshl_b32 s68, s68, 14
v_mfma_f32_16x16x32_bf16 v[76:79], v[200:203], a[84:87], v[76:79]
s_waitcnt vmcnt(20)
ds_read_b128 a[96:99], v232 offset:0
v_add_u32 v63, s68, v63
v_mfma_f32_16x16x32_bf16 v[80:83], v[200:203], a[88:91], v[80:83]
ds_read_b64_tr_b16 v[214:215], v231 offset:53760
s_and_b32 s68, s2, 1
v_mfma_f32_16x16x32_bf16 v[84:87], v[200:203], a[92:95], v[84:87]
ds_read_b128 a[100:103], v232 offset:2048
s_waitcnt lgkmcnt(6)
v_mfma_f32_16x16x32_bf16 v[88:91], v[204:207], a[80:83], v[88:91]
ds_read_b64_tr_b16 v[200:201], v228 offset:57344
s_lshl_b32 s68, s68, 7
v_mfma_f32_16x16x32_bf16 v[92:95], v[204:207], a[84:87], v[92:95]
ds_read_b128 a[104:107], v232 offset:4096
s_add_u32 s68, s68, s41
v_mfma_f32_16x16x32_bf16 v[96:99], v[204:207], a[88:91], v[96:99]
ds_read_b64_tr_b16 v[202:203], v228 offset:57856
v_add_u32 v63, s68, v63
v_mfma_f32_16x16x32_bf16 v[100:103], v[204:207], a[92:95], v[100:103]
ds_read_b128 a[108:111], v232 offset:6144
s_waitcnt lgkmcnt(8)
v_mfma_f32_16x16x32_bf16 v[104:107], v[208:211], a[80:83], v[104:107]
ds_read_b64_tr_b16 v[204:205], v229 offset:57344
v_lshlrev_b32 v32, 16, v24
v_mfma_f32_16x16x32_bf16 v[108:111], v[208:211], a[84:87], v[108:111]
ds_read_b128 a[112:115], v233 offset:0
v_and_b32 v33, 0xffff0000, v24
v_mfma_f32_16x16x32_bf16 v[112:115], v[208:211], a[88:91], v[112:115]
ds_read_b64_tr_b16 v[206:207], v229 offset:57856
v_lshlrev_b32 v34, 16, v25
v_mfma_f32_16x16x32_bf16 v[116:119], v[208:211], a[92:95], v[116:119]
ds_read_b128 a[116:119], v233 offset:2048
s_waitcnt lgkmcnt(9)
v_mfma_f32_16x16x32_bf16 v[120:123], v[212:215], a[80:83], v[120:123]
ds_read_b64_tr_b16 v[208:209], v230 offset:57344
v_and_b32 v35, 0xffff0000, v25
v_mfma_f32_16x16x32_bf16 v[124:127], v[212:215], a[84:87], v[124:127]
ds_read_b128 a[120:123], v233 offset:4096
v_lshlrev_b32 v36, 16, v26
v_mfma_f32_16x16x32_bf16 v[128:131], v[212:215], a[88:91], v[128:131]
ds_read_b64_tr_b16 v[210:211], v230 offset:57856
v_and_b32 v37, 0xffff0000, v26
v_mfma_f32_16x16x32_bf16 v[132:135], v[212:215], a[92:95], v[132:135]
ds_read_b128 a[124:127], v233 offset:6144
s_waitcnt lgkmcnt(9)
v_mfma_f32_16x16x32_bf16 v[72:75], v[200:203], a[96:99], v[72:75]
ds_read_b64_tr_b16 v[212:213], v231 offset:57344
v_lshlrev_b32 v38, 16, v27
v_mfma_f32_16x16x32_bf16 v[76:79], v[200:203], a[100:103], v[76:79]
v_and_b32 v39, 0xffff0000, v27
v_lshlrev_b32 v40, 16, v28
v_mfma_f32_16x16x32_bf16 v[80:83], v[200:203], a[104:107], v[80:83]
ds_read_b64_tr_b16 v[214:215], v231 offset:57856
v_and_b32 v41, 0xffff0000, v28
s_waitcnt lgkmcnt(10)
v_mfma_f32_16x16x32_bf16 v[84:87], v[200:203], a[108:111], v[84:87]
s_waitcnt lgkmcnt(7)
v_lshlrev_b32 v42, 16, v29
v_mfma_f32_16x16x32_bf16 v[88:91], v[204:207], a[96:99], v[88:91]
ds_read_b64_tr_b16 v[200:201], v228 offset:61440
s_waitcnt lgkmcnt(3)
v_mfma_f32_16x16x32_bf16 v[92:95], v[204:207], a[100:103], v[92:95]
s_add_u32 m0, s49, 0
s_add_u32 s66, s48, 768
v_mfma_f32_16x16x32_bf16 v[96:99], v[204:207], a[104:107], v[96:99]
ds_read_b64_tr_b16 v[202:203], v228 offset:61952
buffer_load_dwordx4 v240, s[8:11], s66 offen offset:0 lds
v_mfma_f32_16x16x32_bf16 v[100:103], v[204:207], a[108:111], v[100:103]
buffer_load_dwordx4 v241, s[8:11], s66 offen offset:1024 lds
v_mfma_f32_16x16x32_bf16 v[104:107], v[208:211], a[96:99], v[104:107]
ds_read_b64_tr_b16 v[204:205], v229 offset:61440
buffer_load_dwordx4 v242, s[8:11], s66 offen offset:2048 lds
v_mfma_f32_16x16x32_bf16 v[108:111], v[208:211], a[100:103], v[108:111]
buffer_load_dwordx4 v243, s[8:11], s66 offen offset:3072 lds
s_add_u32 m0, s49, 4096
v_mfma_f32_16x16x32_bf16 v[112:115], v[208:211], a[104:107], v[112:115]
ds_read_b64_tr_b16 v[206:207], v229 offset:61952
s_add_u32 s66, s48, 33536
v_mfma_f32_16x16x32_bf16 v[116:119], v[208:211], a[108:111], v[116:119]
s_waitcnt lgkmcnt(4)
buffer_load_dwordx4 v240, s[8:11], s66 offen offset:0 lds
v_mfma_f32_16x16x32_bf16 v[120:123], v[212:215], a[96:99], v[120:123]
ds_read_b64_tr_b16 v[208:209], v230 offset:61440
buffer_load_dwordx4 v241, s[8:11], s66 offen offset:1024 lds
v_mfma_f32_16x16x32_bf16 v[124:127], v[212:215], a[100:103], v[124:127]
buffer_load_dwordx4 v242, s[8:11], s66 offen offset:2048 lds
buffer_load_dwordx4 v243, s[8:11], s66 offen offset:3072 lds
v_mfma_f32_16x16x32_bf16 v[128:131], v[212:215], a[104:107], v[128:131]
ds_read_b64_tr_b16 v[210:211], v230 offset:61952
v_and_b32 v43, 0xffff0000, v29
v_mfma_f32_16x16x32_bf16 v[132:135], v[212:215], a[108:111], v[132:135]
s_waitcnt lgkmcnt(4)
v_lshlrev_b32 v44, 16, v30
v_mfma_f32_16x16x32_bf16 v[72:75], v[200:203], a[112:115], v[72:75]
ds_read_b64_tr_b16 v[212:213], v231 offset:61440
v_and_b32 v45, 0xffff0000, v30
v_mfma_f32_16x16x32_bf16 v[76:79], v[200:203], a[116:119], v[76:79]
s_waitcnt vmcnt(20)
ds_read_b128 a[128:131], v232 offset:8192
s_barrier
v_mfma_f32_16x16x32_bf16 v[80:83], v[200:203], a[120:123], v[80:83]
ds_read_b64_tr_b16 v[214:215], v231 offset:61952
v_lshlrev_b32 v46, 16, v31
v_mfma_f32_16x16x32_bf16 v[84:87], v[200:203], a[124:127], v[84:87]
ds_read_b128 a[132:135], v232 offset:10240
s_waitcnt lgkmcnt(6)
v_mfma_f32_16x16x32_bf16 v[88:91], v[204:207], a[112:115], v[88:91]
ds_read_b64_tr_b16 v[200:201], v228 offset:0
v_and_b32 v47, 0xffff0000, v31
v_mfma_f32_16x16x32_bf16 v[92:95], v[204:207], a[116:119], v[92:95]
ds_read_b128 a[136:139], v232 offset:12288
s_add_u32 m0, s42, 32768
s_add_u32 s65, s47, 128
v_mfma_f32_16x16x32_bf16 v[96:99], v[204:207], a[120:123], v[96:99]
ds_read_b64_tr_b16 v[202:203], v228 offset:512
buffer_load_dwordx4 v236, s[12:15], s65 offen offset:0 lds
v_mfma_f32_16x16x32_bf16 v[100:103], v[204:207], a[124:127], v[100:103]
ds_read_b128 a[140:143], v232 offset:14336
s_waitcnt lgkmcnt(8)
buffer_load_dwordx4 v237, s[12:15], s65 offen offset:1024 lds
v_mfma_f32_16x16x32_bf16 v[104:107], v[208:211], a[112:115], v[104:107]
ds_read_b64_tr_b16 v[204:205], v229 offset:0
buffer_load_dwordx4 v238, s[12:15], s65 offen offset:2048 lds
v_mfma_f32_16x16x32_bf16 v[108:111], v[208:211], a[116:119], v[108:111]
ds_read_b128 a[144:147], v233 offset:8192
buffer_load_dwordx4 v239, s[12:15], s65 offen offset:3072 lds
v_mfma_f32_16x16x32_bf16 v[112:115], v[208:211], a[120:123], v[112:115]
ds_read_b64_tr_b16 v[206:207], v229 offset:512
v_add_f32 v52, v32, v36
v_mfma_f32_16x16x32_bf16 v[116:119], v[208:211], a[124:127], v[116:119]
ds_read_b128 a[148:151], v233 offset:10240
s_waitcnt lgkmcnt(9)
v_mfma_f32_16x16x32_bf16 v[120:123], v[212:215], a[112:115], v[120:123]
ds_read_b64_tr_b16 v[208:209], v230 offset:0
v_add_f32 v53, v33, v37
v_mfma_f32_16x16x32_bf16 v[124:127], v[212:215], a[116:119], v[124:127]
ds_read_b128 a[152:155], v233 offset:12288
v_add_f32 v54, v34, v38
v_mfma_f32_16x16x32_bf16 v[128:131], v[212:215], a[120:123], v[128:131]
ds_read_b64_tr_b16 v[210:211], v230 offset:512
v_add_f32 v55, v35, v39
v_mfma_f32_16x16x32_bf16 v[132:135], v[212:215], a[124:127], v[132:135]
ds_read_b128 a[156:159], v233 offset:14336
s_waitcnt lgkmcnt(9)
s_lshr_b32 s68, s2, 3
s_lshl_b32 s68, s68, 2
s_add_u32 s68, s68, s40
s_lshl_b32 s68, s68, 15
s_bfe_u32 s69, s2, 0x10001
s_lshl_b32 s69, s69, 12
s_add_u32 s68, s68, s69
v_bfe_u32 v224, v1, 3, 2
v_lshlrev_b32 v224, 13, v224
v_and_b32 v225, 7, v1
v_lshl_add_u32 v224, v225, 9, v224
buffer_load_dword v221, v224, s[12:15], s68 offen offset:128
v_mfma_f32_16x16x32_bf16 v[72:75], v[200:203], a[128:131], v[72:75]
ds_read_b64_tr_b16 v[212:213], v231 offset:0
v_add_f32 v56, v40, v44
v_mfma_f32_16x16x32_bf16 v[76:79], v[200:203], a[132:135], v[76:79]
v_add_f32 v57, v41, v45
v_add_f32 v58, v42, v46
v_mfma_f32_16x16x32_bf16 v[80:83], v[200:203], a[136:139], v[80:83]
ds_read_b64_tr_b16 v[214:215], v231 offset:512
v_add_f32 v59, v43, v47
s_waitcnt lgkmcnt(10)
v_mfma_f32_16x16x32_bf16 v[84:87], v[200:203], a[140:143], v[84:87]
s_waitcnt lgkmcnt(7)
v_add_f32 v52, v52, v53
v_mfma_f32_16x16x32_bf16 v[88:91], v[204:207], a[128:131], v[88:91]
ds_read_b64_tr_b16 v[200:201], v228 offset:4096
s_waitcnt lgkmcnt(3)
v_mfma_f32_16x16x32_bf16 v[92:95], v[204:207], a[132:135], v[92:95]
s_add_u32 m0, s49, 8192
s_add_u32 s66, s48, 896
v_mfma_f32_16x16x32_bf16 v[96:99], v[204:207], a[136:139], v[96:99]
ds_read_b64_tr_b16 v[202:203], v228 offset:4608
buffer_load_dwordx4 v240, s[8:11], s66 offen offset:0 lds
v_mfma_f32_16x16x32_bf16 v[100:103], v[204:207], a[140:143], v[100:103]
buffer_load_dwordx4 v241, s[8:11], s66 offen offset:1024 lds
v_mfma_f32_16x16x32_bf16 v[104:107], v[208:211], a[128:131], v[104:107]
ds_read_b64_tr_b16 v[204:205], v229 offset:4096
buffer_load_dwordx4 v242, s[8:11], s66 offen offset:2048 lds
v_mfma_f32_16x16x32_bf16 v[108:111], v[208:211], a[132:135], v[108:111]
buffer_load_dwordx4 v243, s[8:11], s66 offen offset:3072 lds
s_add_u32 m0, s49, 12288
v_mfma_f32_16x16x32_bf16 v[112:115], v[208:211], a[136:139], v[112:115]
ds_read_b64_tr_b16 v[206:207], v229 offset:4608
s_add_u32 s66, s48, 33664
v_mfma_f32_16x16x32_bf16 v[116:119], v[208:211], a[140:143], v[116:119]
s_waitcnt lgkmcnt(4)
buffer_load_dwordx4 v240, s[8:11], s66 offen offset:0 lds
v_mfma_f32_16x16x32_bf16 v[120:123], v[212:215], a[128:131], v[120:123]
ds_read_b64_tr_b16 v[208:209], v230 offset:4096
buffer_load_dwordx4 v241, s[8:11], s66 offen offset:1024 lds
v_mfma_f32_16x16x32_bf16 v[124:127], v[212:215], a[132:135], v[124:127]
buffer_load_dwordx4 v242, s[8:11], s66 offen offset:2048 lds
buffer_load_dwordx4 v243, s[8:11], s66 offen offset:3072 lds
v_mfma_f32_16x16x32_bf16 v[128:131], v[212:215], a[136:139], v[128:131]
ds_read_b64_tr_b16 v[210:211], v230 offset:4608
v_add_f32 v54, v54, v55
v_mfma_f32_16x16x32_bf16 v[132:135], v[212:215], a[140:143], v[132:135]
s_waitcnt lgkmcnt(4)
v_add_f32 v56, v56, v57
v_mfma_f32_16x16x32_bf16 v[72:75], v[200:203], a[144:147], v[72:75]
ds_read_b64_tr_b16 v[212:213], v231 offset:4096
v_add_f32 v58, v58, v59
v_mfma_f32_16x16x32_bf16 v[76:79], v[200:203], a[148:151], v[76:79]
s_waitcnt vmcnt(21)
ds_read_b128 a[160:163], v232 offset:16384
v_add_f32 v48, v52, v54
v_mfma_f32_16x16x32_bf16 v[80:83], v[200:203], a[152:155], v[80:83]
ds_read_b64_tr_b16 v[214:215], v231 offset:4608
v_add_f32 v49, v56, v58
v_mfma_f32_16x16x32_bf16 v[84:87], v[200:203], a[156:159], v[84:87]
ds_read_b128 a[164:167], v232 offset:18432
s_waitcnt lgkmcnt(6)
v_mfma_f32_16x16x32_bf16 v[88:91], v[204:207], a[144:147], v[88:91]
ds_read_b64_tr_b16 v[200:201], v228 offset:8192
v_add_f32_dpp v48, v48, v48 quad_perm:[1,0,3,2] row_mask:0xf bank_mask:0xf
v_mfma_f32_16x16x32_bf16 v[92:95], v[204:207], a[148:151], v[92:95]
ds_read_b128 a[168:171], v232 offset:20480
v_add_f32_dpp v49, v49, v49 quad_perm:[1,0,3,2] row_mask:0xf bank_mask:0xf
v_mfma_f32_16x16x32_bf16 v[96:99], v[204:207], a[152:155], v[96:99]
ds_read_b64_tr_b16 v[202:203], v228 offset:8704
v_add_f32_dpp v48, v48, v48 quad_perm:[2,3,0,1] row_mask:0xf bank_mask:0xf
v_mfma_f32_16x16x32_bf16 v[100:103], v[204:207], a[156:159], v[100:103]
ds_read_b128 a[172:175], v232 offset:22528
s_waitcnt lgkmcnt(8)
v_mfma_f32_16x16x32_bf16 v[104:107], v[208:211], a[144:147], v[104:107]
ds_read_b64_tr_b16 v[204:205], v229 offset:8192
v_add_f32_dpp v49, v49, v49 quad_perm:[2,3,0,1] row_mask:0xf bank_mask:0xf
v_mfma_f32_16x16x32_bf16 v[108:111], v[208:211], a[148:151], v[108:111]
ds_read_b128 a[176:179], v233 offset:16384
v_add_f32_dpp v48, v48, v48 row_half_mirror row_mask:0xf bank_mask:0xf
v_mfma_f32_16x16x32_bf16 v[112:115], v[208:211], a[152:155], v[112:115]
ds_read_b64_tr_b16 v[206:207], v229 offset:8704
v_add_f32_dpp v49, v49, v49 row_half_mirror row_mask:0xf bank_mask:0xf
v_mfma_f32_16x16x32_bf16 v[116:119], v[208:211], a[156:159], v[116:119]
ds_read_b128 a[180:183], v233 offset:18432
s_waitcnt lgkmcnt(9)
v_mfma_f32_16x16x32_bf16 v[120:123], v[212:215], a[144:147], v[120:123]
ds_read_b64_tr_b16 v[208:209], v230 offset:8192
v_add_f32_dpp v48, v48, v48 row_mirror row_mask:0xf bank_mask:0xf
v_mfma_f32_16x16x32_bf16 v[124:127], v[212:215], a[148:151], v[124:127]
ds_read_b128 a[184:187], v233 offset:20480
v_add_f32_dpp v49, v49, v49 row_mirror row_mask:0xf bank_mask:0xf
v_mfma_f32_16x16x32_bf16 v[128:131], v[212:215], a[152:155], v[128:131]
ds_read_b64_tr_b16 v[210:211], v230 offset:8704
v_mov_b32 v50, v48
v_mfma_f32_16x16x32_bf16 v[132:135], v[212:215], a[156:159], v[132:135]
ds_read_b128 a[188:191], v233 offset:22528
s_waitcnt lgkmcnt(9)
v_mfma_f32_16x16x32_bf16 v[72:75], v[200:203], a[160:163], v[72:75]
ds_read_b64_tr_b16 v[212:213], v231 offset:8192
v_mov_b32 v51, v49
v_mfma_f32_16x16x32_bf16 v[76:79], v[200:203], a[164:167], v[76:79]
v_permlane16_swap_b32 v48, v50
v_permlane16_swap_b32 v49, v51
v_mfma_f32_16x16x32_bf16 v[80:83], v[200:203], a[168:171], v[80:83]
ds_read_b64_tr_b16 v[214:215], v231 offset:8704
v_add_f32 v48, v48, v50
s_waitcnt lgkmcnt(10)
v_mfma_f32_16x16x32_bf16 v[84:87], v[200:203], a[172:175], v[84:87]
s_waitcnt lgkmcnt(7)
v_add_f32 v49, v49, v51
v_mfma_f32_16x16x32_bf16 v[88:91], v[204:207], a[160:163], v[88:91]
ds_read_b64_tr_b16 v[200:201], v228 offset:12288
v_mov_b32 v50, v48
v_mfma_f32_16x16x32_bf16 v[92:95], v[204:207], a[164:167], v[92:95]
v_mov_b32 v51, v49
v_permlane32_swap_b32 v48, v50
v_mfma_f32_16x16x32_bf16 v[96:99], v[204:207], a[168:171], v[96:99]
ds_read_b64_tr_b16 v[202:203], v228 offset:12800
v_permlane32_swap_b32 v49, v51
v_mfma_f32_16x16x32_bf16 v[100:103], v[204:207], a[172:175], v[100:103]
s_waitcnt lgkmcnt(5)
v_add_f32 v48, v48, v50
v_mfma_f32_16x16x32_bf16 v[104:107], v[208:211], a[160:163], v[104:107]
ds_read_b64_tr_b16 v[204:205], v229 offset:12288
v_add_f32 v49, v49, v51
s_and_b32 s69, s2, 3
s_lshl_b32 s69, s69, 6
buffer_atomic_add v6, v3, s[36:39], s69 offen sc1
v_mfma_f32_16x16x32_bf16 v[108:111], v[208:211], a[164:167], v[108:111]
v_mul_f32 v48, 0x3b000000, v48
v_mul_f32 v49, 0x3b000000, v49
v_mfma_f32_16x16x32_bf16 v[112:115], v[208:211], a[168:171], v[112:115]
ds_read_b64_tr_b16 v[206:207], v229 offset:12800
v_sub_f32 v32, v32, v48
v_mfma_f32_16x16x32_bf16 v[116:119], v[208:211], a[172:175], v[116:119]
s_waitcnt lgkmcnt(4)
v_sub_f32 v40, v40, v49
v_mfma_f32_16x16x32_bf16 v[120:123], v[212:215], a[160:163], v[120:123]
ds_read_b64_tr_b16 v[208:209], v230 offset:12288
v_sub_f32 v33, v33, v48
v_mfma_f32_16x16x32_bf16 v[124:127], v[212:215], a[164:167], v[124:127]
v_sub_f32 v41, v41, v49
v_sub_f32 v34, v34, v48
v_mfma_f32_16x16x32_bf16 v[128:131], v[212:215], a[168:171], v[128:131]
ds_read_b64_tr_b16 v[210:211], v230 offset:12800
v_sub_f32 v42, v42, v49
v_mfma_f32_16x16x32_bf16 v[132:135], v[212:215], a[172:175], v[132:135]
s_waitcnt lgkmcnt(4)
v_sub_f32 v35, v35, v48
v_mfma_f32_16x16x32_bf16 v[72:75], v[200:203], a[176:179], v[72:75]
ds_read_b64_tr_b16 v[212:213], v231 offset:12288
v_sub_f32 v43, v43, v49
v_mfma_f32_16x16x32_bf16 v[76:79], v[200:203], a[180:183], v[76:79]
s_waitcnt vmcnt(14)
ds_read_b128 a[192:195], v232 offset:0
s_barrier
v_mfma_f32_16x16x32_bf16 v[80:83], v[200:203], a[184:187], v[80:83]
ds_read_b64_tr_b16 v[214:215], v231 offset:12800
v_sub_f32 v36, v36, v48
v_mfma_f32_16x16x32_bf16 v[84:87], v[200:203], a[188:191], v[84:87]
ds_read_b128 a[196:199], v232 offset:2048
s_waitcnt lgkmcnt(6)
v_mfma_f32_16x16x32_bf16 v[88:91], v[204:207], a[176:179], v[88:91]
ds_read_b64_tr_b16 v[200:201], v228 offset:16384
v_sub_f32 v44, v44, v49
v_mfma_f32_16x16x32_bf16 v[92:95], v[204:207], a[180:183], v[92:95]
ds_read_b128 a[200:203], v232 offset:4096
s_add_u32 m0, s42, 49152
s_add_u32 s65, s47, 1048704
v_mfma_f32_16x16x32_bf16 v[96:99], v[204:207], a[184:187], v[96:99]
ds_read_b64_tr_b16 v[202:203], v228 offset:16896
buffer_load_dwordx4 v236, s[12:15], s65 offen offset:0 lds
v_mfma_f32_16x16x32_bf16 v[100:103], v[204:207], a[188:191], v[100:103]
ds_read_b128 a[204:207], v232 offset:6144
s_waitcnt lgkmcnt(8)
buffer_load_dwordx4 v237, s[12:15], s65 offen offset:1024 lds
v_mfma_f32_16x16x32_bf16 v[104:107], v[208:211], a[176:179], v[104:107]
ds_read_b64_tr_b16 v[204:205], v229 offset:16384
buffer_load_dwordx4 v238, s[12:15], s65 offen offset:2048 lds
v_mfma_f32_16x16x32_bf16 v[108:111], v[208:211], a[180:183], v[108:111]
ds_read_b128 a[208:211], v233 offset:0
buffer_load_dwordx4 v239, s[12:15], s65 offen offset:3072 lds
v_mfma_f32_16x16x32_bf16 v[112:115], v[208:211], a[184:187], v[112:115]
ds_read_b64_tr_b16 v[206:207], v229 offset:16896
v_sub_f32 v37, v37, v48
v_mfma_f32_16x16x32_bf16 v[116:119], v[208:211], a[188:191], v[116:119]
ds_read_b128 a[212:215], v233 offset:2048
s_waitcnt lgkmcnt(9)
v_mfma_f32_16x16x32_bf16 v[120:123], v[212:215], a[176:179], v[120:123]
ds_read_b64_tr_b16 v[208:209], v230 offset:16384
v_sub_f32 v45, v45, v49
v_mfma_f32_16x16x32_bf16 v[124:127], v[212:215], a[180:183], v[124:127]
ds_read_b128 a[216:219], v233 offset:4096
v_sub_f32 v38, v38, v48
v_mfma_f32_16x16x32_bf16 v[128:131], v[212:215], a[184:187], v[128:131]
ds_read_b64_tr_b16 v[210:211], v230 offset:16896
v_sub_f32 v46, v46, v49
v_mfma_f32_16x16x32_bf16 v[132:135], v[212:215], a[188:191], v[132:135]
ds_read_b128 a[220:223], v233 offset:6144
s_waitcnt lgkmcnt(9)
s_lshr_b32 s68, s2, 3
s_lshl_b32 s68, s68, 2
s_add_u32 s68, s68, s40
s_lshl_b32 s68, s68, 15
s_bfe_u32 s69, s2, 0x10001
s_lshl_b32 s69, s69, 12
s_add_u32 s68, s68, s69
v_bfe_u32 v224, v1, 3, 2
v_lshlrev_b32 v224, 13, v224
v_and_b32 v225, 7, v1
v_lshl_add_u32 v224, v225, 9, v224
buffer_load_dword v222, v224, s[12:15], s68 offen offset:256
v_mfma_f32_16x16x32_bf16 v[72:75], v[200:203], a[192:195], v[72:75]
ds_read_b64_tr_b16 v[212:213], v231 offset:16384
v_sub_f32 v39, v39, v48
v_mfma_f32_16x16x32_bf16 v[76:79], v[200:203], a[196:199], v[76:79]
v_sub_f32 v47, v47, v49
v_mul_f32 v52, v32, v32
v_mfma_f32_16x16x32_bf16 v[80:83], v[200:203], a[200:203], v[80:83]
ds_read_b64_tr_b16 v[214:215], v231 offset:16896
v_mul_f32 v53, v33, v33
s_waitcnt lgkmcnt(10)
v_mfma_f32_16x16x32_bf16 v[84:87], v[200:203], a[204:207], v[84:87]
s_waitcnt lgkmcnt(7)
v_mul_f32 v56, v40, v40
v_mfma_f32_16x16x32_bf16 v[88:91], v[204:207], a[192:195], v[88:91]
ds_read_b64_tr_b16 v[200:201], v228 offset:20480
v_mul_f32 v57, v41, v41
v_mfma_f32_16x16x32_bf16 v[92:95], v[204:207], a[196:199], v[92:95]
v_fmac_f32 v52, v34, v34
v_fmac_f32 v56, v42, v42
v_mfma_f32_16x16x32_bf16 v[96:99], v[204:207], a[200:203], v[96:99]
ds_read_b64_tr_b16 v[202:203], v228 offset:20992
v_fmac_f32 v53, v35, v35
v_mfma_f32_16x16x32_bf16 v[100:103], v[204:207], a[204:207], v[100:103]
s_waitcnt lgkmcnt(5)
v_fmac_f32 v57, v43, v43
v_mfma_f32_16x16x32_bf16 v[104:107], v[208:211], a[192:195], v[104:107]
ds_read_b64_tr_b16 v[204:205], v229 offset:20480
v_fmac_f32 v52, v36, v36
v_mfma_f32_16x16x32_bf16 v[108:111], v[208:211], a[196:199], v[108:111]
v_fmac_f32 v56, v44, v44
v_fmac_f32 v53, v37, v37
v_mfma_f32_16x16x32_bf16 v[112:115], v[208:211], a[200:203], v[112:115]
ds_read_b64_tr_b16 v[206:207], v229 offset:20992
v_fmac_f32 v57, v45, v45
v_mfma_f32_16x16x32_bf16 v[116:119], v[208:211], a[204:207], v[116:119]
s_waitcnt lgkmcnt(4)
v_fmac_f32 v52, v38, v38
v_mfma_f32_16x16x32_bf16 v[120:123], v[212:215], a[192:195], v[120:123]
ds_read_b64_tr_b16 v[208:209], v230 offset:20480
v_fmac_f32 v56, v46, v46
v_mfma_f32_16x16x32_bf16 v[124:127], v[212:215], a[196:199], v[124:127]
v_fmac_f32 v53, v39, v39
v_fmac_f32 v57, v47, v47
v_mfma_f32_16x16x32_bf16 v[128:131], v[212:215], a[200:203], v[128:131]
ds_read_b64_tr_b16 v[210:211], v230 offset:20992
v_add_f32 v48, v52, v53
v_mfma_f32_16x16x32_bf16 v[132:135], v[212:215], a[204:207], v[132:135]
s_waitcnt lgkmcnt(4)
v_add_f32 v49, v56, v57
v_mfma_f32_16x16x32_bf16 v[72:75], v[200:203], a[208:211], v[72:75]
ds_read_b64_tr_b16 v[212:213], v231 offset:20480
v_add_f32_dpp v48, v48, v48 quad_perm:[1,0,3,2] row_mask:0xf bank_mask:0xf
v_mfma_f32_16x16x32_bf16 v[76:79], v[200:203], a[212:215], v[76:79]
s_waitcnt vmcnt(6)
ds_read_b128 a[224:227], v232 offset:8192
v_add_f32_dpp v49, v49, v49 quad_perm:[1,0,3,2] row_mask:0xf bank_mask:0xf
v_mfma_f32_16x16x32_bf16 v[80:83], v[200:203], a[216:219], v[80:83]
ds_read_b64_tr_b16 v[214:215], v231 offset:20992
v_add_f32_dpp v48, v48, v48 quad_perm:[2,3,0,1] row_mask:0xf bank_mask:0xf
v_mfma_f32_16x16x32_bf16 v[84:87], v[200:203], a[220:223], v[84:87]
ds_read_b128 a[228:231], v232 offset:10240
s_waitcnt lgkmcnt(6)
v_mfma_f32_16x16x32_bf16 v[88:91], v[204:207], a[208:211], v[88:91]
ds_read_b64_tr_b16 v[200:201], v228 offset:24576
v_add_f32_dpp v49, v49, v49 quad_perm:[2,3,0,1] row_mask:0xf bank_mask:0xf
v_mfma_f32_16x16x32_bf16 v[92:95], v[204:207], a[212:215], v[92:95]
ds_read_b128 a[232:235], v232 offset:12288
v_add_f32_dpp v48, v48, v48 row_half_mirror row_mask:0xf bank_mask:0xf
v_mfma_f32_16x16x32_bf16 v[96:99], v[204:207], a[216:219], v[96:99]
ds_read_b64_tr_b16 v[202:203], v228 offset:25088
v_add_f32_dpp v49, v49, v49 row_half_mirror row_mask:0xf bank_mask:0xf
v_mfma_f32_16x16x32_bf16 v[100:103], v[204:207], a[220:223], v[100:103]
ds_read_b128 a[236:239], v232 offset:14336
s_waitcnt lgkmcnt(8)
v_mfma_f32_16x16x32_bf16 v[104:107], v[208:211], a[208:211], v[104:107]
ds_read_b64_tr_b16 v[204:205], v229 offset:24576
v_add_f32_dpp v48, v48, v48 row_mirror row_mask:0xf bank_mask:0xf
v_mfma_f32_16x16x32_bf16 v[108:111], v[208:211], a[212:215], v[108:111]
ds_read_b128 a[240:243], v233 offset:8192
v_add_f32_dpp v49, v49, v49 row_mirror row_mask:0xf bank_mask:0xf
v_mfma_f32_16x16x32_bf16 v[112:115], v[208:211], a[216:219], v[112:115]
ds_read_b64_tr_b16 v[206:207], v229 offset:25088
v_mov_b32 v50, v48
v_mfma_f32_16x16x32_bf16 v[116:119], v[208:211], a[220:223], v[116:119]
ds_read_b128 a[244:247], v233 offset:10240
s_waitcnt lgkmcnt(9)
v_mfma_f32_16x16x32_bf16 v[120:123], v[212:215], a[208:211], v[120:123]
ds_read_b64_tr_b16 v[208:209], v230 offset:24576
v_mov_b32 v51, v49
v_mfma_f32_16x16x32_bf16 v[124:127], v[212:215], a[212:215], v[124:127]
ds_read_b128 a[248:251], v233 offset:12288
v_permlane16_swap_b32 v48, v50
v_mfma_f32_16x16x32_bf16 v[128:131], v[212:215], a[216:219], v[128:131]
ds_read_b64_tr_b16 v[210:211], v230 offset:25088
v_permlane16_swap_b32 v49, v51
v_mfma_f32_16x16x32_bf16 v[132:135], v[212:215], a[220:223], v[132:135]
ds_read_b128 a[252:255], v233 offset:14336
s_waitcnt lgkmcnt(9)
v_mfma_f32_16x16x32_bf16 v[72:75], v[200:203], a[224:227], v[72:75]
ds_read_b64_tr_b16 v[212:213], v231 offset:24576
v_add_f32 v48, v48, v50
v_mfma_f32_16x16x32_bf16 v[76:79], v[200:203], a[228:231], v[76:79]
v_add_f32 v49, v49, v51
v_mov_b32 v50, v48
v_mfma_f32_16x16x32_bf16 v[80:83], v[200:203], a[232:235], v[80:83]
ds_read_b64_tr_b16 v[214:215], v231 offset:25088
v_mov_b32 v51, v49
s_waitcnt lgkmcnt(10)
v_mfma_f32_16x16x32_bf16 v[84:87], v[200:203], a[236:239], v[84:87]
s_waitcnt lgkmcnt(7)
v_permlane32_swap_b32 v48, v50
v_mfma_f32_16x16x32_bf16 v[88:91], v[204:207], a[224:227], v[88:91]
ds_read_b64_tr_b16 v[200:201], v228 offset:28672
v_permlane32_swap_b32 v49, v51
v_mfma_f32_16x16x32_bf16 v[92:95], v[204:207], a[228:231], v[92:95]
v_add_f32 v48, v48, v50
v_add_f32 v49, v49, v51
v_mfma_f32_16x16x32_bf16 v[96:99], v[204:207], a[232:235], v[96:99]
ds_read_b64_tr_b16 v[202:203], v228 offset:29184
v_mov_b32 v50, 0x3727c5ac
v_mfma_f32_16x16x32_bf16 v[100:103], v[204:207], a[236:239], v[100:103]
s_waitcnt lgkmcnt(5)
v_mov_b32 v51, 0x3727c5ac
v_mfma_f32_16x16x32_bf16 v[104:107], v[208:211], a[224:227], v[104:107]
ds_read_b64_tr_b16 v[204:205], v229 offset:28672
v_fmac_f32 v50, 0x3b000000, v48
v_mfma_f32_16x16x32_bf16 v[108:111], v[208:211], a[228:231], v[108:111]
v_fmac_f32 v51, 0x3b000000, v49
s_lshr_b32 s68, s2, 3
v_mfma_f32_16x16x32_bf16 v[112:115], v[208:211], a[232:235], v[112:115]
ds_read_b64_tr_b16 v[206:207], v229 offset:29184
s_lshl_b32 s68, s68, 2
v_mfma_f32_16x16x32_bf16 v[116:119], v[208:211], a[236:239], v[116:119]
s_waitcnt lgkmcnt(4)
s_add_u32 s68, s68, s40
v_mfma_f32_16x16x32_bf16 v[120:123], v[212:215], a[224:227], v[120:123]
ds_read_b64_tr_b16 v[208:209], v230 offset:28672
s_lshl_b32 s68, s68, 15
v_mfma_f32_16x16x32_bf16 v[124:127], v[212:215], a[228:231], v[124:127]
v_rsq_f32 v50, v50
v_mfma_f32_16x16x32_bf16 v[128:131], v[212:215], a[232:235], v[128:131]
ds_read_b64_tr_b16 v[210:211], v230 offset:29184
s_bfe_u32 s69, s2, 0x10001
v_mfma_f32_16x16x32_bf16 v[132:135], v[212:215], a[236:239], v[132:135]
s_waitcnt lgkmcnt(4)
s_lshl_b32 s69, s69, 12
v_mfma_f32_16x16x32_bf16 v[72:75], v[200:203], a[240:243], v[72:75]
ds_read_b64_tr_b16 v[212:213], v231 offset:28672
v_rsq_f32 v51, v51
v_mul_f32 v32, v32, v50
v_mul_f32 v40, v40, v51
v_mul_f32 v33, v33, v50
v_mul_f32 v41, v41, v51
v_mul_f32 v34, v34, v50
v_mul_f32 v42, v42, v51
v_mul_f32 v35, v35, v50
v_mul_f32 v43, v43, v51
v_mul_f32 v36, v36, v50
v_mul_f32 v44, v44, v51
v_mul_f32 v37, v37, v50
v_mul_f32 v45, v45, v51
v_mul_f32 v38, v38, v50
v_mul_f32 v46, v46, v51
v_mul_f32 v39, v39, v50
v_mul_f32 v47, v47, v51
v_cvt_pk_bf16_f32 v52, v32, v33
v_cvt_pk_bf16_f32 v53, v34, v35
v_cvt_pk_bf16_f32 v54, v36, v37
v_cvt_pk_bf16_f32 v55, v38, v39
v_cvt_pk_bf16_f32 v56, v40, v41
v_cvt_pk_bf16_f32 v57, v42, v43
v_cvt_pk_bf16_f32 v58, v44, v45
v_cvt_pk_bf16_f32 v59, v46, v47
v_mfma_f32_16x16x32_bf16 v[76:79], v[200:203], a[244:247], v[76:79]
s_barrier
v_mfma_f32_16x16x32_bf16 v[80:83], v[200:203], a[248:251], v[80:83]
ds_read_b64_tr_b16 v[214:215], v231 offset:29184
s_add_u32 m0, s42, 0
v_mfma_f32_16x16x32_bf16 v[84:87], v[200:203], a[252:255], v[84:87]
s_waitcnt lgkmcnt(4)
s_add_u32 s65, s47, 2097280
v_mfma_f32_16x16x32_bf16 v[88:91], v[204:207], a[240:243], v[88:91]
ds_read_b64_tr_b16 v[200:201], v228 offset:32768
ds_write_b128 v60, v[52:55]
v_mfma_f32_16x16x32_bf16 v[92:95], v[204:207], a[244:247], v[92:95]
buffer_load_dwordx4 v236, s[12:15], s65 offen offset:0 lds
ds_write_b128 v60, v[56:59] offset:1040
v_mfma_f32_16x16x32_bf16 v[96:99], v[204:207], a[248:251], v[96:99]
ds_read_b64_tr_b16 v[202:203], v228 offset:33280
s_add_u32 s68, s68, s69
v_mfma_f32_16x16x32_bf16 v[100:103], v[204:207], a[252:255], v[100:103]
s_waitcnt lgkmcnt(6)
v_bfe_u32 v224, v1, 3, 2
v_mfma_f32_16x16x32_bf16 v[104:107], v[208:211], a[240:243], v[104:107]
ds_read_b64_tr_b16 v[204:205], v229 offset:32768
v_lshlrev_b32 v224, 13, v224
v_mfma_f32_16x16x32_bf16 v[108:111], v[208:211], a[244:247], v[108:111]
v_and_b32 v225, 7, v1
v_lshl_add_u32 v224, v225, 9, v224
v_mfma_f32_16x16x32_bf16 v[112:115], v[208:211], a[248:251], v[112:115]
ds_read_b64_tr_b16 v[206:207], v229 offset:33280
v_mfma_f32_16x16x32_bf16 v[116:119], v[208:211], a[252:255], v[116:119]
s_waitcnt lgkmcnt(6)
v_mfma_f32_16x16x32_bf16 v[120:123], v[212:215], a[240:243], v[120:123]
ds_read_b64_tr_b16 v[208:209], v230 offset:32768
v_mfma_f32_16x16x32_bf16 v[124:127], v[212:215], a[244:247], v[124:127]
buffer_load_dword v223, v224, s[12:15], s68 offen offset:384
v_mfma_f32_16x16x32_bf16 v[128:131], v[212:215], a[248:251], v[128:131]
ds_read_b64_tr_b16 v[210:211], v230 offset:33280
v_mfma_f32_16x16x32_bf16 v[132:135], v[212:215], a[252:255], v[132:135]
s_waitcnt lgkmcnt(4)
v_mfma_f32_16x16x32_bf16 v[136:139], v[200:203], a[0:3], 0
ds_read_b64_tr_b16 v[212:213], v231 offset:32768
v_mfma_f32_16x16x32_bf16 v[140:143], v[200:203], a[4:7], 0
buffer_load_dwordx4 v237, s[12:15], s65 offen offset:1024 lds
v_mfma_f32_16x16x32_bf16 v[144:147], v[200:203], a[8:11], 0
ds_read_b64_tr_b16 v[214:215], v231 offset:33280
s_mov_b32 s4, s84
v_mfma_f32_16x16x32_bf16 v[148:151], v[200:203], a[12:15], 0
s_waitcnt lgkmcnt(4)
s_mov_b32 s5, s85
v_mfma_f32_16x16x32_bf16 v[152:155], v[204:207], a[0:3], 0
ds_read_b64_tr_b16 v[200:201], v228 offset:36864
s_mov_b32 s6, 0x400000
v_mfma_f32_16x16x32_bf16 v[156:159], v[204:207], a[4:7], 0
s_mov_b32 s7, 0x20000
s_mov_b32 s8, s88
v_mfma_f32_16x16x32_bf16 v[160:163], v[204:207], a[8:11], 0
ds_read_b64_tr_b16 v[202:203], v228 offset:37376
s_mov_b32 s9, s89
v_mfma_f32_16x16x32_bf16 v[164:167], v[204:207], a[12:15], 0
s_waitcnt lgkmcnt(4)
s_mov_b32 s10, 0x158000
v_mfma_f32_16x16x32_bf16 v[168:171], v[208:211], a[0:3], 0
ds_read_b64_tr_b16 v[204:205], v229 offset:36864
s_mov_b32 s11, 0x20000
v_mfma_f32_16x16x32_bf16 v[172:175], v[208:211], a[4:7], 0
s_mov_b32 s28, s90
s_mov_b32 s29, s91
v_mfma_f32_16x16x32_bf16 v[176:179], v[208:211], a[8:11], 0
ds_read_b64_tr_b16 v[206:207], v229 offset:37376
s_mov_b32 s30, 0x158000
v_mfma_f32_16x16x32_bf16 v[180:183], v[208:211], a[12:15], 0
s_waitcnt lgkmcnt(4)
s_mov_b32 s31, 0x20000
v_mfma_f32_16x16x32_bf16 v[184:187], v[212:215], a[0:3], 0
ds_read_b64_tr_b16 v[208:209], v230 offset:36864
s_add_u32 s67, s50, 0
v_mfma_f32_16x16x32_bf16 v[188:191], v[212:215], a[4:7], 0
v_mul_f32 v72, 0x3e0293ee, v72
v_mul_f32 v73, 0x3e0293ee, v73
v_mfma_f32_16x16x32_bf16 v[192:195], v[212:215], a[8:11], 0
ds_read_b64_tr_b16 v[210:211], v230 offset:37376
v_mul_f32 v74, 0x3e0293ee, v74
v_mfma_f32_16x16x32_bf16 v[196:199], v[212:215], a[12:15], 0
s_waitcnt lgkmcnt(4)
v_mul_f32 v75, 0x3e0293ee, v75
v_mfma_f32_16x16x32_bf16 v[136:139], v[200:203], a[16:19], v[136:139]
ds_read_b64_tr_b16 v[212:213], v231 offset:36864
v_mul_f32 v88, 0x3e0293ee, v88
v_mfma_f32_16x16x32_bf16 v[140:143], v[200:203], a[20:23], v[140:143]
buffer_load_dwordx4 v238, s[12:15], s65 offen offset:2048 lds
v_mul_f32 v89, 0x3e0293ee, v89
v_mfma_f32_16x16x32_bf16 v[144:147], v[200:203], a[24:27], v[144:147]
ds_read_b64_tr_b16 v[214:215], v231 offset:37376
v_mul_f32 v90, 0x3e0293ee, v90
v_mfma_f32_16x16x32_bf16 v[148:151], v[200:203], a[28:31], v[148:151]
s_waitcnt lgkmcnt(4)
v_mfma_f32_16x16x32_bf16 v[152:155], v[204:207], a[16:19], v[152:155]
ds_read_b64_tr_b16 v[200:201], v228 offset:40960
v_mul_f32 v91, 0x3e0293ee, v91
v_mfma_f32_16x16x32_bf16 v[156:159], v[204:207], a[20:23], v[156:159]
v_cvt_pk_bf16_f32 v8, v72, v73
v_mfma_f32_16x16x32_bf16 v[160:163], v[204:207], a[24:27], v[160:163]
ds_read_b64_tr_b16 v[202:203], v228 offset:41472
v_mfma_f32_16x16x32_bf16 v[164:167], v[204:207], a[28:31], v[164:167]
s_waitcnt lgkmcnt(4)
v_cvt_pk_bf16_f32 v9, v74, v75
v_mfma_f32_16x16x32_bf16 v[168:171], v[208:211], a[16:19], v[168:171]
ds_read_b64_tr_b16 v[204:205], v229 offset:40960
s_lshr_b32 s68, s2, 3
v_mfma_f32_16x16x32_bf16 v[172:175], v[208:211], a[20:23], v[172:175]
s_lshl_b32 s68, s68, 2
s_add_u32 s68, s68, s40
v_mfma_f32_16x16x32_bf16 v[176:179], v[208:211], a[24:27], v[176:179]
ds_read_b64_tr_b16 v[206:207], v229 offset:41472
s_bfe_u32 s69, s2, 0x20001
v_mfma_f32_16x16x32_bf16 v[180:183], v[208:211], a[28:31], v[180:183]
s_waitcnt lgkmcnt(4)
s_lshl_b32 s68, s68, 15
v_mfma_f32_16x16x32_bf16 v[184:187], v[212:215], a[16:19], v[184:187]
ds_read_b64_tr_b16 v[208:209], v230 offset:40960
s_lshl_b32 s69, s69, 11
v_cvt_pk_bf16_f32 v10, v88, v89
v_cvt_pk_bf16_f32 v11, v90, v91
v_mfma_f32_16x16x32_bf16 v[188:191], v[212:215], a[20:23], v[188:191]
s_add_u32 s68, s68, s69
v_bfe_u32 v224, v1, 3, 2
buffer_store_dwordx4 v[8:11], v2, s[20:23], s67 offen offset:0 sc1
v_mfma_f32_16x16x32_bf16 v[192:195], v[212:215], a[24:27], v[192:195]
ds_read_b64_tr_b16 v[210:211], v230 offset:41472
v_lshlrev_b32 v224, 13, v224
v_mfma_f32_16x16x32_bf16 v[196:199], v[212:215], a[28:31], v[196:199]
s_waitcnt lgkmcnt(4)
v_and_b32 v225, 7, v1
v_mfma_f32_16x16x32_bf16 v[136:139], v[200:203], a[32:35], v[136:139]
ds_read_b64_tr_b16 v[212:213], v231 offset:40960
v_lshl_add_u32 v224, v225, 7, v224
v_mfma_f32_16x16x32_bf16 v[140:143], v[200:203], a[36:39], v[140:143]
buffer_load_dwordx4 v239, s[12:15], s65 offen offset:3072 lds
v_mfma_f32_16x16x32_bf16 v[144:147], v[200:203], a[40:43], v[144:147]
ds_read_b64_tr_b16 v[214:215], v231 offset:41472
v_mul_f32 v104, 0x3e0293ee, v104
v_mfma_f32_16x16x32_bf16 v[148:151], v[200:203], a[44:47], v[148:151]
s_waitcnt lgkmcnt(4)
v_mul_f32 v105, 0x3e0293ee, v105
v_mfma_f32_16x16x32_bf16 v[152:155], v[204:207], a[32:35], v[152:155]
ds_read_b64_tr_b16 v[200:201], v228 offset:45056
v_mfma_f32_16x16x32_bf16 v[156:159], v[204:207], a[36:39], v[156:159]
buffer_load_dword v220, v224, s[4:7], s68 offen offset:0
v_mul_f32 v106, 0x3e0293ee, v106
v_mfma_f32_16x16x32_bf16 v[160:163], v[204:207], a[40:43], v[160:163]
ds_read_b64_tr_b16 v[202:203], v228 offset:45568
v_mfma_f32_16x16x32_bf16 v[164:167], v[204:207], a[44:47], v[164:167]
s_waitcnt lgkmcnt(4)
v_mul_f32 v107, 0x3e0293ee, v107
v_mfma_f32_16x16x32_bf16 v[168:171], v[208:211], a[32:35], v[168:171]
ds_read_b64_tr_b16 v[204:205], v229 offset:45056
v_mfma_f32_16x16x32_bf16 v[172:175], v[208:211], a[36:39], v[172:175]
v_mul_f32 v120, 0x3e0293ee, v120
v_mfma_f32_16x16x32_bf16 v[176:179], v[208:211], a[40:43], v[176:179]
ds_read_b64_tr_b16 v[206:207], v229 offset:45568
v_mfma_f32_16x16x32_bf16 v[180:183], v[208:211], a[44:47], v[180:183]
s_waitcnt lgkmcnt(4)
v_mul_f32 v121, 0x3e0293ee, v121
v_mfma_f32_16x16x32_bf16 v[184:187], v[212:215], a[32:35], v[184:187]
ds_read_b64_tr_b16 v[208:209], v230 offset:45056
v_mfma_f32_16x16x32_bf16 v[188:191], v[212:215], a[36:39], v[188:191]
v_mul_f32 v122, 0x3e0293ee, v122
v_mfma_f32_16x16x32_bf16 v[192:195], v[212:215], a[40:43], v[192:195]
ds_read_b64_tr_b16 v[210:211], v230 offset:45568
v_mfma_f32_16x16x32_bf16 v[196:199], v[212:215], a[44:47], v[196:199]
s_waitcnt lgkmcnt(4)
v_mul_f32 v123, 0x3e0293ee, v123
v_mfma_f32_16x16x32_bf16 v[136:139], v[200:203], a[48:51], v[136:139]
ds_read_b64_tr_b16 v[212:213], v231 offset:45056
v_mfma_f32_16x16x32_bf16 v[140:143], v[200:203], a[52:55], v[140:143]
s_waitcnt vmcnt(8)
s_barrier
v_mfma_f32_16x16x32_bf16 v[144:147], v[200:203], a[56:59], v[144:147]
ds_read_b64_tr_b16 v[214:215], v231 offset:45568
s_add_u32 m0, s42, 16384
v_mfma_f32_16x16x32_bf16 v[148:151], v[200:203], a[60:63], v[148:151]
s_waitcnt lgkmcnt(4)
s_add_u32 s65, s47, 3145856
v_mfma_f32_16x16x32_bf16 v[152:155], v[204:207], a[48:51], v[152:155]
ds_read_b64_tr_b16 v[200:201], v228 offset:49152
ds_read_b128 v[32:35], v62
v_mfma_f32_16x16x32_bf16 v[156:159], v[204:207], a[52:55], v[156:159]
buffer_load_dwordx4 v236, s[12:15], s65 offen offset:0 lds
ds_read_b128 v[36:39], v62 offset:128
v_mfma_f32_16x16x32_bf16 v[160:163], v[204:207], a[56:59], v[160:163]
ds_read_b64_tr_b16 v[202:203], v228 offset:49664
v_cvt_pk_bf16_f32 v12, v104, v105
v_mfma_f32_16x16x32_bf16 v[164:167], v[204:207], a[60:63], v[164:167]
s_waitcnt lgkmcnt(6)
v_cvt_pk_bf16_f32 v13, v106, v107
v_mfma_f32_16x16x32_bf16 v[168:171], v[208:211], a[48:51], v[168:171]
ds_read_b64_tr_b16 v[204:205], v229 offset:49152
v_cvt_pk_bf16_f32 v14, v120, v121
v_cvt_pk_bf16_f32 v15, v122, v123
v_mfma_f32_16x16x32_bf16 v[172:175], v[208:211], a[52:55], v[172:175]
buffer_store_dwordx4 v[12:15], v2, s[20:23], s67 offen offset:1024 sc1
v_mfma_f32_16x16x32_bf16 v[176:179], v[208:211], a[56:59], v[176:179]
ds_read_b64_tr_b16 v[206:207], v229 offset:49664
v_mfma_f32_16x16x32_bf16 v[180:183], v[208:211], a[60:63], v[180:183]
s_waitcnt lgkmcnt(6)
v_mfma_f32_16x16x32_bf16 v[184:187], v[212:215], a[48:51], v[184:187]
ds_read_b64_tr_b16 v[208:209], v230 offset:49152
v_mfma_f32_16x16x32_bf16 v[188:191], v[212:215], a[52:55], v[188:191]
v_mfma_f32_16x16x32_bf16 v[192:195], v[212:215], a[56:59], v[192:195]
ds_read_b64_tr_b16 v[210:211], v230 offset:49664
s_add_u32 s67, s50, 4096
v_mfma_f32_16x16x32_bf16 v[196:199], v[212:215], a[60:63], v[196:199]
s_waitcnt lgkmcnt(4)
v_mul_f32 v76, 0x3e0293ee, v76
v_mfma_f32_16x16x32_bf16 v[136:139], v[200:203], a[64:67], v[136:139]
ds_read_b64_tr_b16 v[212:213], v231 offset:49152
v_mfma_f32_16x16x32_bf16 v[140:143], v[200:203], a[68:71], v[140:143]
buffer_load_dwordx4 v237, s[12:15], s65 offen offset:1024 lds
v_mul_f32 v77, 0x3e0293ee, v77
v_mfma_f32_16x16x32_bf16 v[144:147], v[200:203], a[72:75], v[144:147]
ds_read_b64_tr_b16 v[214:215], v231 offset:49664
v_mfma_f32_16x16x32_bf16 v[148:151], v[200:203], a[76:79], v[148:151]
s_waitcnt lgkmcnt(4)
v_mul_f32 v78, 0x3e0293ee, v78
v_mfma_f32_16x16x32_bf16 v[152:155], v[204:207], a[64:67], v[152:155]
ds_read_b64_tr_b16 v[200:201], v228 offset:53248
v_mfma_f32_16x16x32_bf16 v[156:159], v[204:207], a[68:71], v[156:159]
v_mul_f32 v79, 0x3e0293ee, v79
v_mfma_f32_16x16x32_bf16 v[160:163], v[204:207], a[72:75], v[160:163]
ds_read_b64_tr_b16 v[202:203], v228 offset:53760
v_mul_f32 v92, 0x3e0293ee, v92
v_mfma_f32_16x16x32_bf16 v[164:167], v[204:207], a[76:79], v[164:167]
s_waitcnt lgkmcnt(4)
v_mfma_f32_16x16x32_bf16 v[168:171], v[208:211], a[64:67], v[168:171]
ds_read_b64_tr_b16 v[204:205], v229 offset:53248
v_mul_f32 v93, 0x3e0293ee, v93
v_mfma_f32_16x16x32_bf16 v[172:175], v[208:211], a[68:71], v[172:175]
v_mfma_f32_16x16x32_bf16 v[176:179], v[208:211], a[72:75], v[176:179]
ds_read_b64_tr_b16 v[206:207], v229 offset:53760
v_mul_f32 v94, 0x3e0293ee, v94
v_mfma_f32_16x16x32_bf16 v[180:183], v[208:211], a[76:79], v[180:183]
s_waitcnt lgkmcnt(4)
v_mfma_f32_16x16x32_bf16 v[184:187], v[212:215], a[64:67], v[184:187]
ds_read_b64_tr_b16 v[208:209], v230 offset:53248
v_mul_f32 v95, 0x3e0293ee, v95
v_mfma_f32_16x16x32_bf16 v[188:191], v[212:215], a[68:71], v[188:191]
buffer_store_dwordx4 v[32:35], v63, s[16:19], 0 offen sc1
v_cvt_pk_bf16_f32 v16, v76, v77
v_mfma_f32_16x16x32_bf16 v[192:195], v[212:215], a[72:75], v[192:195]
ds_read_b64_tr_b16 v[210:211], v230 offset:53760
v_mfma_f32_16x16x32_bf16 v[196:199], v[212:215], a[76:79], v[196:199]
s_waitcnt lgkmcnt(4)
v_cvt_pk_bf16_f32 v17, v78, v79
v_mfma_f32_16x16x32_bf16 v[136:139], v[200:203], a[80:83], v[136:139]
ds_read_b64_tr_b16 v[212:213], v231 offset:53248
v_mfma_f32_16x16x32_bf16 v[140:143], v[200:203], a[84:87], v[140:143]
buffer_load_dwordx4 v238, s[12:15], s65 offen offset:2048 lds
v_cvt_pk_bf16_f32 v18, v92, v93
v_mfma_f32_16x16x32_bf16 v[144:147], v[200:203], a[88:91], v[144:147]
ds_read_b64_tr_b16 v[214:215], v231 offset:53760
v_mfma_f32_16x16x32_bf16 v[148:151], v[200:203], a[92:95], v[148:151]
s_waitcnt lgkmcnt(4)
v_cvt_pk_bf16_f32 v19, v94, v95
v_mfma_f32_16x16x32_bf16 v[152:155], v[204:207], a[80:83], v[152:155]
ds_read_b64_tr_b16 v[200:201], v228 offset:57344
v_mfma_f32_16x16x32_bf16 v[156:159], v[204:207], a[84:87], v[156:159]
buffer_store_dwordx4 v[36:39], v63, s[16:19], 0 offen offset:2048 sc1
v_mfma_f32_16x16x32_bf16 v[160:163], v[204:207], a[88:91], v[160:163]
ds_read_b64_tr_b16 v[202:203], v228 offset:57856
v_mfma_f32_16x16x32_bf16 v[164:167], v[204:207], a[92:95], v[164:167]
s_waitcnt lgkmcnt(4)
v_mfma_f32_16x16x32_bf16 v[168:171], v[208:211], a[80:83], v[168:171]
ds_read_b64_tr_b16 v[204:205], v229 offset:57344
s_lshr_b32 s68, s2, 3
v_mfma_f32_16x16x32_bf16 v[172:175], v[208:211], a[84:87], v[172:175]
s_lshl_b32 s68, s68, 2
s_add_u32 s68, s68, s40
buffer_store_dwordx4 v[16:19], v2, s[20:23], s67 offen offset:0 sc1
v_mfma_f32_16x16x32_bf16 v[176:179], v[208:211], a[88:91], v[176:179]
ds_read_b64_tr_b16 v[206:207], v229 offset:57856
s_bfe_u32 s69, s2, 0x20001
v_mfma_f32_16x16x32_bf16 v[180:183], v[208:211], a[92:95], v[180:183]
s_waitcnt lgkmcnt(4)
s_lshl_b32 s68, s68, 15
v_mfma_f32_16x16x32_bf16 v[184:187], v[212:215], a[80:83], v[184:187]
ds_read_b64_tr_b16 v[208:209], v230 offset:57344
s_lshl_b32 s69, s69, 11
v_mfma_f32_16x16x32_bf16 v[188:191], v[212:215], a[84:87], v[188:191]
s_add_u32 s68, s68, s69
v_bfe_u32 v224, v1, 3, 2
v_mfma_f32_16x16x32_bf16 v[192:195], v[212:215], a[88:91], v[192:195]
ds_read_b64_tr_b16 v[210:211], v230 offset:57856
v_lshlrev_b32 v224, 13, v224
v_mfma_f32_16x16x32_bf16 v[196:199], v[212:215], a[92:95], v[196:199]
s_waitcnt lgkmcnt(4)
v_and_b32 v225, 7, v1
v_mfma_f32_16x16x32_bf16 v[136:139], v[200:203], a[96:99], v[136:139]
ds_read_b64_tr_b16 v[212:213], v231 offset:57344
v_lshl_add_u32 v224, v225, 7, v224
v_mfma_f32_16x16x32_bf16 v[140:143], v[200:203], a[100:103], v[140:143]
buffer_load_dwordx4 v239, s[12:15], s65 offen offset:3072 lds
v_mul_f32 v108, 0x3e0293ee, v108
v_mfma_f32_16x16x32_bf16 v[144:147], v[200:203], a[104:107], v[144:147]
ds_read_b64_tr_b16 v[214:215], v231 offset:57856
v_mul_f32 v109, 0x3e0293ee, v109
v_mfma_f32_16x16x32_bf16 v[148:151], v[200:203], a[108:111], v[148:151]
s_waitcnt lgkmcnt(4)
v_mul_f32 v110, 0x3e0293ee, v110
v_mfma_f32_16x16x32_bf16 v[152:155], v[204:207], a[96:99], v[152:155]
ds_read_b64_tr_b16 v[200:201], v228 offset:61440
v_mul_f32 v111, 0x3e0293ee, v111
v_mfma_f32_16x16x32_bf16 v[156:159], v[204:207], a[100:103], v[156:159]
buffer_load_dword v221, v224, s[4:7], s68 offen offset:1024
v_mul_f32 v124, 0x3e0293ee, v124
v_mfma_f32_16x16x32_bf16 v[160:163], v[204:207], a[104:107], v[160:163]
ds_read_b64_tr_b16 v[202:203], v228 offset:61952
v_mul_f32 v125, 0x3e0293ee, v125
v_mfma_f32_16x16x32_bf16 v[164:167], v[204:207], a[108:111], v[164:167]
s_waitcnt lgkmcnt(4)
v_mul_f32 v126, 0x3e0293ee, v126
v_mfma_f32_16x16x32_bf16 v[168:171], v[208:211], a[96:99], v[168:171]
ds_read_b64_tr_b16 v[204:205], v229 offset:61440
v_mul_f32 v127, 0x3e0293ee, v127
v_mfma_f32_16x16x32_bf16 v[172:175], v[208:211], a[100:103], v[172:175]
v_cvt_pk_bf16_f32 v20, v108, v109
v_mfma_f32_16x16x32_bf16 v[176:179], v[208:211], a[104:107], v[176:179]
ds_read_b64_tr_b16 v[206:207], v229 offset:61952
v_and_b32 v71, 3, v1
v_mfma_f32_16x16x32_bf16 v[180:183], v[208:211], a[108:111], v[180:183]
s_waitcnt lgkmcnt(4)
v_lshlrev_b32 v71, 6, v71
v_mfma_f32_16x16x32_bf16 v[184:187], v[212:215], a[96:99], v[184:187]
ds_read_b64_tr_b16 v[208:209], v230 offset:61440
buffer_load_dword v70, v71, s[36:39], 0 offen sc1
v_mfma_f32_16x16x32_bf16 v[188:191], v[212:215], a[100:103], v[188:191]
v_cvt_pk_bf16_f32 v21, v110, v111
v_cvt_pk_bf16_f32 v22, v124, v125
v_mfma_f32_16x16x32_bf16 v[192:195], v[212:215], a[104:107], v[192:195]
ds_read_b64_tr_b16 v[210:211], v230 offset:61952
v_mfma_f32_16x16x32_bf16 v[196:199], v[212:215], a[108:111], v[196:199]
s_waitcnt lgkmcnt(4)
v_cvt_pk_bf16_f32 v23, v126, v127
v_mfma_f32_16x16x32_bf16 v[136:139], v[200:203], a[112:115], v[136:139]
ds_read_b64_tr_b16 v[212:213], v231 offset:61440
v_mfma_f32_16x16x32_bf16 v[140:143], v[200:203], a[116:119], v[140:143]
s_waitcnt vmcnt(11)
s_barrier
v_mfma_f32_16x16x32_bf16 v[144:147], v[200:203], a[120:123], v[144:147]
ds_read_b64_tr_b16 v[214:215], v231 offset:61952
s_add_u32 m0, s42, 32768
v_mfma_f32_16x16x32_bf16 v[148:151], v[200:203], a[124:127], v[148:151]
s_waitcnt lgkmcnt(4)
s_add_u32 s65, s47, 256
v_mfma_f32_16x16x32_bf16 v[152:155], v[204:207], a[112:115], v[152:155]
ds_read_b64_tr_b16 v[200:201], v228 offset:0
v_mfma_f32_16x16x32_bf16 v[156:159], v[204:207], a[116:119], v[156:159]
buffer_load_dwordx4 v236, s[12:15], s65 offen offset:0 lds
v_mfma_f32_16x16x32_bf16 v[160:163], v[204:207], a[120:123], v[160:163]
ds_read_b64_tr_b16 v[202:203], v228 offset:512
v_mfma_f32_16x16x32_bf16 v[164:167], v[204:207], a[124:127], v[164:167]
s_waitcnt lgkmcnt(4)
v_mfma_f32_16x16x32_bf16 v[168:171], v[208:211], a[112:115], v[168:171]
ds_read_b64_tr_b16 v[204:205], v229 offset:0
v_mfma_f32_16x16x32_bf16 v[172:175], v[208:211], a[116:119], v[172:175]
buffer_store_dwordx4 v[20:23], v2, s[20:23], s67 offen offset:1024 sc1
s_add_u32 s67, s50, 16384
v_mfma_f32_16x16x32_bf16 v[176:179], v[208:211], a[120:123], v[176:179]
ds_read_b64_tr_b16 v[206:207], v229 offset:512
v_mul_f32 v80, 0x3e0293ee, v80
v_mfma_f32_16x16x32_bf16 v[180:183], v[208:211], a[124:127], v[180:183]
s_waitcnt lgkmcnt(4)
v_mfma_f32_16x16x32_bf16 v[184:187], v[212:215], a[112:115], v[184:187]
ds_read_b64_tr_b16 v[208:209], v230 offset:0
v_mul_f32 v81, 0x3e0293ee, v81
v_mfma_f32_16x16x32_bf16 v[188:191], v[212:215], a[116:119], v[188:191]
v_mfma_f32_16x16x32_bf16 v[192:195], v[212:215], a[120:123], v[192:195]
ds_read_b64_tr_b16 v[210:211], v230 offset:512
v_mul_f32 v82, 0x3e0293ee, v82
v_mfma_f32_16x16x32_bf16 v[196:199], v[212:215], a[124:127], v[196:199]
s_waitcnt lgkmcnt(4)
v_mfma_f32_16x16x32_bf16 v[136:139], v[200:203], a[128:131], v[136:139]
ds_read_b64_tr_b16 v[212:213], v231 offset:0
v_mul_f32 v83, 0x3e0293ee, v83
v_mfma_f32_16x16x32_bf16 v[140:143], v[200:203], a[132:135], v[140:143]
buffer_load_dwordx4 v237, s[12:15], s65 offen offset:1024 lds
v_mul_f32 v96, 0x3e0293ee, v96
v_mfma_f32_16x16x32_bf16 v[144:147], v[200:203], a[136:139], v[144:147]
ds_read_b64_tr_b16 v[214:215], v231 offset:512
v_mfma_f32_16x16x32_bf16 v[148:151], v[200:203], a[140:143], v[148:151]
s_waitcnt lgkmcnt(4)
v_mul_f32 v97, 0x3e0293ee, v97
v_mfma_f32_16x16x32_bf16 v[152:155], v[204:207], a[128:131], v[152:155]
ds_read_b64_tr_b16 v[200:201], v228 offset:4096
v_mfma_f32_16x16x32_bf16 v[156:159], v[204:207], a[132:135], v[156:159]
v_mul_f32 v98, 0x3e0293ee, v98
v_mfma_f32_16x16x32_bf16 v[160:163], v[204:207], a[136:139], v[160:163]
ds_read_b64_tr_b16 v[202:203], v228 offset:4608
v_mfma_f32_16x16x32_bf16 v[164:167], v[204:207], a[140:143], v[164:167]
s_waitcnt lgkmcnt(4)
v_mul_f32 v99, 0x3e0293ee, v99
v_mfma_f32_16x16x32_bf16 v[168:171], v[208:211], a[128:131], v[168:171]
ds_read_b64_tr_b16 v[204:205], v229 offset:4096
v_cvt_pk_bf16_f32 v8, v80, v81
v_mfma_f32_16x16x32_bf16 v[172:175], v[208:211], a[132:135], v[172:175]
v_mfma_f32_16x16x32_bf16 v[176:179], v[208:211], a[136:139], v[176:179]
ds_read_b64_tr_b16 v[206:207], v229 offset:4608
v_cvt_pk_bf16_f32 v9, v82, v83
v_mfma_f32_16x16x32_bf16 v[180:183], v[208:211], a[140:143], v[180:183]
s_waitcnt lgkmcnt(4)
v_mfma_f32_16x16x32_bf16 v[184:187], v[212:215], a[128:131], v[184:187]
ds_read_b64_tr_b16 v[208:209], v230 offset:4096
v_cvt_pk_bf16_f32 v10, v96, v97
v_mfma_f32_16x16x32_bf16 v[188:191], v[212:215], a[132:135], v[188:191]
v_mfma_f32_16x16x32_bf16 v[192:195], v[212:215], a[136:139], v[192:195]
ds_read_b64_tr_b16 v[210:211], v230 offset:4608
v_cvt_pk_bf16_f32 v11, v98, v99
v_mfma_f32_16x16x32_bf16 v[196:199], v[212:215], a[140:143], v[196:199]
s_waitcnt lgkmcnt(4)
v_mfma_f32_16x16x32_bf16 v[136:139], v[200:203], a[144:147], v[136:139]
ds_read_b64_tr_b16 v[212:213], v231 offset:4096
v_mfma_f32_16x16x32_bf16 v[140:143], v[200:203], a[148:151], v[140:143]
buffer_load_dwordx4 v238, s[12:15], s65 offen offset:2048 lds
v_mfma_f32_16x16x32_bf16 v[144:147], v[200:203], a[152:155], v[144:147]
ds_read_b64_tr_b16 v[214:215], v231 offset:4608
v_mfma_f32_16x16x32_bf16 v[148:151], v[200:203], a[156:159], v[148:151]
s_waitcnt lgkmcnt(4)
v_mfma_f32_16x16x32_bf16 v[152:155], v[204:207], a[144:147], v[152:155]
ds_read_b64_tr_b16 v[200:201], v228 offset:8192
v_mfma_f32_16x16x32_bf16 v[156:159], v[204:207], a[148:151], v[156:159]
buffer_store_dwordx4 v[8:11], v2, s[20:23], s67 offen offset:0 sc1
v_mul_f32 v112, 0x3e0293ee, v112
v_mfma_f32_16x16x32_bf16 v[160:163], v[204:207], a[152:155], v[160:163]
ds_read_b64_tr_b16 v[202:203], v228 offset:8704
v_mul_f32 v113, 0x3e0293ee, v113
v_mfma_f32_16x16x32_bf16 v[164:167], v[204:207], a[156:159], v[164:167]
s_waitcnt lgkmcnt(4)
v_mfma_f32_16x16x32_bf16 v[168:171], v[208:211], a[144:147], v[168:171]
ds_read_b64_tr_b16 v[204:205], v229 offset:8192
s_lshr_b32 s68, s2, 3
v_mfma_f32_16x16x32_bf16 v[172:175], v[208:211], a[148:151], v[172:175]
s_lshl_b32 s68, s68, 2
s_add_u32 s68, s68, s40
v_mfma_f32_16x16x32_bf16 v[176:179], v[208:211], a[152:155], v[176:179]
ds_read_b64_tr_b16 v[206:207], v229 offset:8704
s_bfe_u32 s69, s2, 0x20001
v_mfma_f32_16x16x32_bf16 v[180:183], v[208:211], a[156:159], v[180:183]
s_waitcnt lgkmcnt(4)
s_mul_i32 s68, s68, 11008
v_mfma_f32_16x16x32_bf16 v[184:187], v[212:215], a[144:147], v[184:187]
ds_read_b64_tr_b16 v[208:209], v230 offset:8192
v_bfe_u32 v224, v1, 3, 2
v_mfma_f32_16x16x32_bf16 v[188:191], v[212:215], a[148:151], v[188:191]
v_mul_u32_u24 v224, 2752, v224
v_and_b32 v225, 7, v1
v_mfma_f32_16x16x32_bf16 v[192:195], v[212:215], a[152:155], v[192:195]
ds_read_b64_tr_b16 v[210:211], v230 offset:8704
v_cmp_gt_u32 vcc, 5, v225
v_mfma_f32_16x16x32_bf16 v[196:199], v[212:215], a[156:159], v[196:199]
s_waitcnt lgkmcnt(4)
v_lshlrev_b32 v223, 7, v225
v_mfma_f32_16x16x32_bf16 v[136:139], v[200:203], a[160:163], v[136:139]
ds_read_b64_tr_b16 v[212:213], v231 offset:8192
v_subrev_u32 v225, 640, v223
v_mfma_f32_16x16x32_bf16 v[140:143], v[200:203], a[164:167], v[140:143]
buffer_load_dwordx4 v239, s[12:15], s65 offen offset:3072 lds
v_min_u32 v223, 508, v223
v_mfma_f32_16x16x32_bf16 v[144:147], v[200:203], a[168:171], v[144:147]
ds_read_b64_tr_b16 v[214:215], v231 offset:8704
v_min_u32 v225, 252, v225
v_mfma_f32_16x16x32_bf16 v[148:151], v[200:203], a[172:175], v[148:151]
s_waitcnt lgkmcnt(4)
s_mul_i32 s69, s69, 256
v_mfma_f32_16x16x32_bf16 v[152:155], v[204:207], a[160:163], v[152:155]
ds_read_b64_tr_b16 v[200:201], v228 offset:12288
v_add_u32 v225, 2048, v225
v_mfma_f32_16x16x32_bf16 v[156:159], v[204:207], a[164:167], v[156:159]
v_add_u32 v223, s69, v223
v_cndmask_b32 v223, v225, v223, vcc
v_mfma_f32_16x16x32_bf16 v[160:163], v[204:207], a[168:171], v[160:163]
ds_read_b64_tr_b16 v[202:203], v228 offset:12800
v_add_u32 v223, s69, v223
v_mfma_f32_16x16x32_bf16 v[164:167], v[204:207], a[172:175], v[164:167]
s_waitcnt lgkmcnt(4)
v_add_u32 v224, v224, v223
v_mfma_f32_16x16x32_bf16 v[168:171], v[208:211], a[160:163], v[168:171]
ds_read_b64_tr_b16 v[204:205], v229 offset:12288
v_mul_f32 v114, 0x3e0293ee, v114
v_mfma_f32_16x16x32_bf16 v[172:175], v[208:211], a[164:167], v[172:175]
buffer_load_dword v222, v224, s[8:11], s68 offen
v_mul_f32 v115, 0x3e0293ee, v115
v_mfma_f32_16x16x32_bf16 v[176:179], v[208:211], a[168:171], v[176:179]
ds_read_b64_tr_b16 v[206:207], v229 offset:12800
v_mul_f32 v128, 0x3e0293ee, v128
v_mfma_f32_16x16x32_bf16 v[180:183], v[208:211], a[172:175], v[180:183]
s_waitcnt lgkmcnt(4)
v_mul_f32 v129, 0x3e0293ee, v129
v_mul_f32 v130, 0x3e0293ee, v130
v_mul_f32 v131, 0x3e0293ee, v131
v_cvt_pk_bf16_f32 v12, v112, v113
v_cvt_pk_bf16_f32 v13, v114, v115
v_cvt_pk_bf16_f32 v14, v128, v129
v_cvt_pk_bf16_f32 v15, v130, v131
v_mfma_f32_16x16x32_bf16 v[184:187], v[212:215], a[160:163], v[184:187]
ds_read_b64_tr_b16 v[208:209], v230 offset:12288
v_mfma_f32_16x16x32_bf16 v[188:191], v[212:215], a[164:167], v[188:191]
s_waitcnt vmcnt(7)
v_cmp_le_u32 vcc, 64, v70
s_cmp_eq_u64 vcc, exec
s_cbranch_scc0 KF_g0_spin
KF_g0_back:
buffer_store_dwordx4 v[12:15], v2, s[20:23], s67 offen offset:1024 sc1
v_mfma_f32_16x16x32_bf16 v[192:195], v[212:215], a[168:171], v[192:195]
ds_read_b64_tr_b16 v[210:211], v230 offset:12800
s_add_u32 s67, s50, 20480
v_mfma_f32_16x16x32_bf16 v[196:199], v[212:215], a[172:175], v[196:199]
s_waitcnt lgkmcnt(4)
v_mul_f32 v84, 0x3e0293ee, v84
v_mfma_f32_16x16x32_bf16 v[136:139], v[200:203], a[176:179], v[136:139]
ds_read_b64_tr_b16 v[212:213], v231 offset:12288
v_mfma_f32_16x16x32_bf16 v[140:143], v[200:203], a[180:183], v[140:143]
s_barrier
v_mfma_f32_16x16x32_bf16 v[144:147], v[200:203], a[184:187], v[144:147]
ds_read_b64_tr_b16 v[214:215], v231 offset:12800
s_add_u32 m0, s42, 49152
v_mfma_f32_16x16x32_bf16 v[148:151], v[200:203], a[188:191], v[148:151]
s_waitcnt lgkmcnt(4)
s_add_u32 s65, s47, 1048832
v_mfma_f32_16x16x32_bf16 v[152:155], v[204:207], a[176:179], v[152:155]
ds_read_b64_tr_b16 v[200:201], v228 offset:16384
s_lshr_b32 s69, s2, 4
v_mfma_f32_16x16x32_bf16 v[156:159], v[204:207], a[180:183], v[156:159]
buffer_load_dwordx4 v236, s[12:15], s65 offen offset:0 lds
s_sub_u32 s68, 15, s69
v_mfma_f32_16x16x32_bf16 v[160:163], v[204:207], a[184:187], v[160:163]
ds_read_b64_tr_b16 v[202:203], v228 offset:16896
s_min_u32 s69, s69, s68
v_mfma_f32_16x16x32_bf16 v[164:167], v[204:207], a[188:191], v[164:167]
s_waitcnt lgkmcnt(4)
s_add_u32 s69, s69, 256
v_mfma_f32_16x16x32_bf16 v[168:171], v[208:211], a[176:179], v[168:171]
ds_read_b64_tr_b16 v[204:205], v229 offset:16384
s_lshl_b32 s69, s69, 7
v_mfma_f32_16x16x32_bf16 v[172:175], v[208:211], a[180:183], v[172:175]
buffer_atomic_add v6, v3, s[32:35], s69 offen sc1
v_mul_f32 v85, 0x3e0293ee, v85
v_mfma_f32_16x16x32_bf16 v[176:179], v[208:211], a[184:187], v[176:179]
ds_read_b64_tr_b16 v[206:207], v229 offset:16896
v_mul_f32 v86, 0x3e0293ee, v86
v_mfma_f32_16x16x32_bf16 v[180:183], v[208:211], a[188:191], v[180:183]
s_waitcnt lgkmcnt(4)
v_mul_f32 v87, 0x3e0293ee, v87
v_mfma_f32_16x16x32_bf16 v[184:187], v[212:215], a[176:179], v[184:187]
ds_read_b64_tr_b16 v[208:209], v230 offset:16384
v_mul_f32 v100, 0x3e0293ee, v100
v_mfma_f32_16x16x32_bf16 v[188:191], v[212:215], a[180:183], v[188:191]
v_mul_f32 v101, 0x3e0293ee, v101
v_mul_f32 v102, 0x3e0293ee, v102
v_mfma_f32_16x16x32_bf16 v[192:195], v[212:215], a[184:187], v[192:195]
ds_read_b64_tr_b16 v[210:211], v230 offset:16896
v_mul_f32 v103, 0x3e0293ee, v103
v_mfma_f32_16x16x32_bf16 v[196:199], v[212:215], a[188:191], v[196:199]
s_waitcnt lgkmcnt(4)
v_cvt_pk_bf16_f32 v16, v84, v85
v_mfma_f32_16x16x32_bf16 v[136:139], v[200:203], a[192:195], v[136:139]
ds_read_b64_tr_b16 v[212:213], v231 offset:16384
v_cvt_pk_bf16_f32 v17, v86, v87
v_mfma_f32_16x16x32_bf16 v[140:143], v[200:203], a[196:199], v[140:143]
buffer_load_dwordx4 v237, s[12:15], s65 offen offset:1024 lds
v_cvt_pk_bf16_f32 v18, v100, v101
v_mfma_f32_16x16x32_bf16 v[144:147], v[200:203], a[200:203], v[144:147]
ds_read_b64_tr_b16 v[214:215], v231 offset:16896
v_mfma_f32_16x16x32_bf16 v[148:151], v[200:203], a[204:207], v[148:151]
s_waitcnt lgkmcnt(4)
v_cvt_pk_bf16_f32 v19, v102, v103
v_mfma_f32_16x16x32_bf16 v[152:155], v[204:207], a[192:195], v[152:155]
ds_read_b64_tr_b16 v[200:201], v228 offset:20480
v_mfma_f32_16x16x32_bf16 v[156:159], v[204:207], a[196:199], v[156:159]
buffer_store_dwordx4 v[16:19], v2, s[20:23], s67 offen offset:0 sc1
v_mfma_f32_16x16x32_bf16 v[160:163], v[204:207], a[200:203], v[160:163]
ds_read_b64_tr_b16 v[202:203], v228 offset:20992
v_mfma_f32_16x16x32_bf16 v[164:167], v[204:207], a[204:207], v[164:167]
s_waitcnt lgkmcnt(4)
v_mfma_f32_16x16x32_bf16 v[168:171], v[208:211], a[192:195], v[168:171]
ds_read_b64_tr_b16 v[204:205], v229 offset:20480
v_mfma_f32_16x16x32_bf16 v[172:175], v[208:211], a[196:199], v[172:175]
v_mfma_f32_16x16x32_bf16 v[176:179], v[208:211], a[200:203], v[176:179]
ds_read_b64_tr_b16 v[206:207], v229 offset:20992
v_mul_f32 v116, 0x3e0293ee, v116
v_mfma_f32_16x16x32_bf16 v[180:183], v[208:211], a[204:207], v[180:183]
s_waitcnt lgkmcnt(4)
v_mul_f32 v117, 0x3e0293ee, v117
v_mfma_f32_16x16x32_bf16 v[184:187], v[212:215], a[192:195], v[184:187]
ds_read_b64_tr_b16 v[208:209], v230 offset:20480
v_mfma_f32_16x16x32_bf16 v[188:191], v[212:215], a[196:199], v[188:191]
v_mul_f32 v118, 0x3e0293ee, v118
v_mfma_f32_16x16x32_bf16 v[192:195], v[212:215], a[200:203], v[192:195]
ds_read_b64_tr_b16 v[210:211], v230 offset:20992
v_mfma_f32_16x16x32_bf16 v[196:199], v[212:215], a[204:207], v[196:199]
s_waitcnt lgkmcnt(4)
v_mul_f32 v119, 0x3e0293ee, v119
v_mfma_f32_16x16x32_bf16 v[136:139], v[200:203], a[208:211], v[136:139]
ds_read_b64_tr_b16 v[212:213], v231 offset:20480
v_mfma_f32_16x16x32_bf16 v[140:143], v[200:203], a[212:215], v[140:143]
buffer_load_dwordx4 v238, s[12:15], s65 offen offset:2048 lds
v_mul_f32 v132, 0x3e0293ee, v132
v_mfma_f32_16x16x32_bf16 v[144:147], v[200:203], a[216:219], v[144:147]
ds_read_b64_tr_b16 v[214:215], v231 offset:20992
v_mfma_f32_16x16x32_bf16 v[148:151], v[200:203], a[220:223], v[148:151]
s_waitcnt lgkmcnt(4)
v_mul_f32 v133, 0x3e0293ee, v133
v_mfma_f32_16x16x32_bf16 v[152:155], v[204:207], a[208:211], v[152:155]
ds_read_b64_tr_b16 v[200:201], v228 offset:24576
v_mfma_f32_16x16x32_bf16 v[156:159], v[204:207], a[212:215], v[156:159]
v_mul_f32 v134, 0x3e0293ee, v134
v_mfma_f32_16x16x32_bf16 v[160:163], v[204:207], a[216:219], v[160:163]
ds_read_b64_tr_b16 v[202:203], v228 offset:25088
v_mfma_f32_16x16x32_bf16 v[164:167], v[204:207], a[220:223], v[164:167]
s_waitcnt lgkmcnt(4)
v_mul_f32 v135, 0x3e0293ee, v135
v_mfma_f32_16x16x32_bf16 v[168:171], v[208:211], a[208:211], v[168:171]
ds_read_b64_tr_b16 v[204:205], v229 offset:24576
s_lshr_b32 s68, s2, 3
v_mfma_f32_16x16x32_bf16 v[172:175], v[208:211], a[212:215], v[172:175]
s_lshl_b32 s68, s68, 2
s_add_u32 s68, s68, s40
v_mfma_f32_16x16x32_bf16 v[176:179], v[208:211], a[216:219], v[176:179]
ds_read_b64_tr_b16 v[206:207], v229 offset:25088
s_bfe_u32 s69, s2, 0x20001
v_mfma_f32_16x16x32_bf16 v[180:183], v[208:211], a[220:223], v[180:183]
s_waitcnt lgkmcnt(4)
s_mul_i32 s68, s68, 11008
v_mfma_f32_16x16x32_bf16 v[184:187], v[212:215], a[208:211], v[184:187]
ds_read_b64_tr_b16 v[208:209], v230 offset:24576
v_bfe_u32 v224, v1, 3, 2
v_mfma_f32_16x16x32_bf16 v[188:191], v[212:215], a[212:215], v[188:191]
v_mul_u32_u24 v224, 2752, v224
v_and_b32 v225, 7, v1
v_mfma_f32_16x16x32_bf16 v[192:195], v[212:215], a[216:219], v[192:195]
ds_read_b64_tr_b16 v[210:211], v230 offset:25088
v_cmp_gt_u32 vcc, 5, v225
v_mfma_f32_16x16x32_bf16 v[196:199], v[212:215], a[220:223], v[196:199]
s_waitcnt lgkmcnt(4)
v_lshlrev_b32 v223, 7, v225
v_mfma_f32_16x16x32_bf16 v[136:139], v[200:203], a[224:227], v[136:139]
ds_read_b64_tr_b16 v[212:213], v231 offset:24576
v_subrev_u32 v225, 640, v223
v_cvt_pk_bf16_f32 v20, v116, v117
v_cvt_pk_bf16_f32 v21, v118, v119
v_cvt_pk_bf16_f32 v22, v132, v133
v_cvt_pk_bf16_f32 v23, v134, v135
v_mfma_f32_16x16x32_bf16 v[140:143], v[200:203], a[228:231], v[140:143]
buffer_load_dwordx4 v239, s[12:15], s65 offen offset:3072 lds
v_min_u32 v223, 508, v223
v_mfma_f32_16x16x32_bf16 v[144:147], v[200:203], a[232:235], v[144:147]
ds_read_b64_tr_b16 v[214:215], v231 offset:25088
v_min_u32 v225, 252, v225
v_mfma_f32_16x16x32_bf16 v[148:151], v[200:203], a[236:239], v[148:151]
s_waitcnt lgkmcnt(4)
s_mul_i32 s69, s69, 256
v_mfma_f32_16x16x32_bf16 v[152:155], v[204:207], a[224:227], v[152:155]
ds_read_b64_tr_b16 v[200:201], v228 offset:28672
v_add_u32 v225, 2048, v225
v_mfma_f32_16x16x32_bf16 v[156:159], v[204:207], a[228:231], v[156:159]
v_add_u32 v223, s69, v223
v_cndmask_b32 v223, v225, v223, vcc
buffer_store_dwordx4 v[20:23], v2, s[20:23], s67 offen offset:1024 sc1
v_mfma_f32_16x16x32_bf16 v[160:163], v[204:207], a[232:235], v[160:163]
ds_read_b64_tr_b16 v[202:203], v228 offset:29184
v_add_u32 v223, s69, v223
v_mfma_f32_16x16x32_bf16 v[164:167], v[204:207], a[236:239], v[164:167]
s_waitcnt lgkmcnt(4)
v_add_u32 v224, v224, v223
v_mfma_f32_16x16x32_bf16 v[168:171], v[208:211], a[224:227], v[168:171]
ds_read_b64_tr_b16 v[204:205], v229 offset:28672
v_mfma_f32_16x16x32_bf16 v[172:175], v[208:211], a[228:231], v[172:175]
buffer_load_dword v221, v224, s[28:31], s68 offen
v_mfma_f32_16x16x32_bf16 v[176:179], v[208:211], a[232:235], v[176:179]
ds_read_b64_tr_b16 v[206:207], v229 offset:29184
v_mfma_f32_16x16x32_bf16 v[180:183], v[208:211], a[236:239], v[180:183]
s_waitcnt lgkmcnt(4)
v_mfma_f32_16x16x32_bf16 v[184:187], v[212:215], a[224:227], v[184:187]
ds_read_b64_tr_b16 v[208:209], v230 offset:28672
v_mfma_f32_16x16x32_bf16 v[188:191], v[212:215], a[228:231], v[188:191]
v_mfma_f32_16x16x32_bf16 v[192:195], v[212:215], a[232:235], v[192:195]
ds_read_b64_tr_b16 v[210:211], v230 offset:29184
v_mfma_f32_16x16x32_bf16 v[196:199], v[212:215], a[236:239], v[196:199]
s_waitcnt lgkmcnt(4)
v_mfma_f32_16x16x32_bf16 v[136:139], v[200:203], a[240:243], v[136:139]
ds_read_b64_tr_b16 v[212:213], v231 offset:28672
v_mfma_f32_16x16x32_bf16 v[140:143], v[200:203], a[244:247], v[140:143]
s_waitcnt vmcnt(10)
s_barrier
v_mfma_f32_16x16x32_bf16 v[144:147], v[200:203], a[248:251], v[144:147]
ds_read_b64_tr_b16 v[214:215], v231 offset:29184
s_add_u32 m0, s42, 0
v_mfma_f32_16x16x32_bf16 v[148:151], v[200:203], a[252:255], v[148:151]
s_waitcnt lgkmcnt(4)
s_add_u32 s65, s47, 2097408
v_mfma_f32_16x16x32_bf16 v[152:155], v[204:207], a[240:243], v[152:155]
ds_read_b64_tr_b16 v[200:201], v228 offset:32768
v_mfma_f32_16x16x32_bf16 v[156:159], v[204:207], a[244:247], v[156:159]
buffer_load_dwordx4 v236, s[12:15], s65 offen offset:0 lds
v_mfma_f32_16x16x32_bf16 v[160:163], v[204:207], a[248:251], v[160:163]
ds_read_b64_tr_b16 v[202:203], v228 offset:33280
v_mfma_f32_16x16x32_bf16 v[164:167], v[204:207], a[252:255], v[164:167]
s_waitcnt lgkmcnt(4)
v_mfma_f32_16x16x32_bf16 v[168:171], v[208:211], a[240:243], v[168:171]
ds_read_b64_tr_b16 v[204:205], v229 offset:32768
v_mfma_f32_16x16x32_bf16 v[172:175], v[208:211], a[244:247], v[172:175]
v_mfma_f32_16x16x32_bf16 v[176:179], v[208:211], a[248:251], v[176:179]
ds_read_b64_tr_b16 v[206:207], v229 offset:33280
v_mfma_f32_16x16x32_bf16 v[180:183], v[208:211], a[252:255], v[180:183]
s_waitcnt lgkmcnt(4)
v_mfma_f32_16x16x32_bf16 v[184:187], v[212:215], a[240:243], v[184:187]
ds_read_b64_tr_b16 v[208:209], v230 offset:32768
v_mfma_f32_16x16x32_bf16 v[188:191], v[212:215], a[244:247], v[188:191]
v_mfma_f32_16x16x32_bf16 v[192:195], v[212:215], a[248:251], v[192:195]
ds_read_b64_tr_b16 v[210:211], v230 offset:33280
v_mfma_f32_16x16x32_bf16 v[196:199], v[212:215], a[252:255], v[196:199]
s_waitcnt lgkmcnt(4)
v_mfma_f32_16x16x32_bf16 v[72:75], v[200:203], a[0:3], 0
ds_read_b64_tr_b16 v[212:213], v231 offset:32768
v_mfma_f32_16x16x32_bf16 v[76:79], v[200:203], a[4:7], 0
buffer_load_dwordx4 v237, s[12:15], s65 offen offset:1024 lds
v_mfma_f32_16x16x32_bf16 v[80:83], v[200:203], a[8:11], 0
ds_read_b64_tr_b16 v[214:215], v231 offset:33280
v_lshrrev_b32 v216, 4, v1
v_mfma_f32_16x16x32_bf16 v[84:87], v[200:203], a[12:15], 0
s_waitcnt lgkmcnt(4)
v_bfe_u32 v217, v1, 2, 2
v_mfma_f32_16x16x32_bf16 v[88:91], v[204:207], a[0:3], 0
ds_read_b64_tr_b16 v[200:201], v228 offset:36864
v_lshl_add_u32 v217, v216, 3, v217
v_mfma_f32_16x16x32_bf16 v[92:95], v[204:207], a[4:7], 0
v_and_b32 v216, 1, v216
v_and_b32 v218, 3, v1
v_mfma_f32_16x16x32_bf16 v[96:99], v[204:207], a[8:11], 0
ds_read_b64_tr_b16 v[202:203], v228 offset:37376
v_lshlrev_b32 v218, 3, v218
v_mfma_f32_16x16x32_bf16 v[100:103], v[204:207], a[12:15], 0
s_waitcnt lgkmcnt(4)
v_add_u32 v218, 98304, v218
v_mfma_f32_16x16x32_bf16 v[104:107], v[208:211], a[0:3], 0
ds_read_b64_tr_b16 v[204:205], v229 offset:36864
v_lshl_add_u32 v219, v217, 6, v218
v_mfma_f32_16x16x32_bf16 v[108:111], v[208:211], a[4:7], 0
v_lshl_add_u32 v232, v216, 5, v219
v_xor_b32 v233, 32, v232
v_mfma_f32_16x16x32_bf16 v[112:115], v[208:211], a[8:11], 0
ds_read_b64_tr_b16 v[206:207], v229 offset:37376
v_lshl_add_u32 v219, v217, 5, v218
v_mfma_f32_16x16x32_bf16 v[116:119], v[208:211], a[12:15], 0
s_waitcnt lgkmcnt(4)
v_lshl_add_u32 v234, v216, 7, v219
v_mfma_f32_16x16x32_bf16 v[120:123], v[212:215], a[0:3], 0
ds_read_b64_tr_b16 v[208:209], v230 offset:36864
v_subrev_u32 v234, 0, v234
v_mfma_f32_16x16x32_bf16 v[124:127], v[212:215], a[4:7], 0
v_xor_b32 v235, 128, v234
s_movk_i32 s69, 2752
v_mfma_f32_16x16x32_bf16 v[128:131], v[212:215], a[8:11], 0
ds_read_b64_tr_b16 v[210:211], v230 offset:37376
s_lshl_b32 s68, s40, 5
v_mfma_f32_16x16x32_bf16 v[132:135], v[212:215], a[12:15], 0
s_waitcnt lgkmcnt(4)
v_lshrrev_b32 v216, 2, v1
v_mfma_f32_16x16x32_bf16 v[72:75], v[200:203], a[16:19], v[72:75]
ds_read_b64_tr_b16 v[212:213], v231 offset:36864
v_add_u32 v216, s68, v216
v_mfma_f32_16x16x32_bf16 v[76:79], v[200:203], a[20:23], v[76:79]
buffer_load_dwordx4 v238, s[12:15], s65 offen offset:2048 lds
v_mul_lo_u32 v216, v216, s69
v_mfma_f32_16x16x32_bf16 v[80:83], v[200:203], a[24:27], v[80:83]
ds_read_b64_tr_b16 v[214:215], v231 offset:37376
v_and_b32 v217, 3, v1
v_mfma_f32_16x16x32_bf16 v[84:87], v[200:203], a[28:31], v[84:87]
s_waitcnt lgkmcnt(4)
v_lshrrev_b32 v218, 5, v1
v_mfma_f32_16x16x32_bf16 v[88:91], v[204:207], a[16:19], v[88:91]
ds_read_b64_tr_b16 v[200:201], v228 offset:40960
v_lshlrev_b32 v218, 1, v218
v_mfma_f32_16x16x32_bf16 v[92:95], v[204:207], a[20:23], v[92:95]
v_xor_b32 v217, v217, v218
v_lshl_add_u32 v240, v217, 4, v216
v_mfma_f32_16x16x32_bf16 v[96:99], v[204:207], a[24:27], v[96:99]
ds_read_b64_tr_b16 v[202:203], v228 offset:41472
v_add_u32 v241, 43008, v240
v_mfma_f32_16x16x32_bf16 v[100:103], v[204:207], a[28:31], v[100:103]
s_waitcnt lgkmcnt(4)
s_lshl_b32 s68, s40, 6
v_mfma_f32_16x16x32_bf16 v[104:107], v[208:211], a[16:19], v[104:107]
ds_read_b64_tr_b16 v[204:205], v229 offset:40960
v_lshrrev_b32 v216, 1, v1
v_mfma_f32_16x16x32_bf16 v[108:111], v[208:211], a[20:23], v[108:111]
v_bfe_u32 v217, v1, 4, 1
v_lshlrev_b32 v217, 2, v217
v_mfma_f32_16x16x32_bf16 v[112:115], v[208:211], a[24:27], v[112:115]
ds_read_b64_tr_b16 v[206:207], v229 offset:41472
v_xor_b32 v216, v216, v217
v_mfma_f32_16x16x32_bf16 v[116:119], v[208:211], a[28:31], v[116:119]
s_waitcnt lgkmcnt(4)
v_add_u32 v216, s68, v216
v_mfma_f32_16x16x32_bf16 v[120:123], v[212:215], a[16:19], v[120:123]
ds_read_b64_tr_b16 v[208:209], v230 offset:40960
v_mul_lo_u32 v216, v216, s69
s_add_u32 s67, s50, 0
v_mul_f32 v136, 0x3e0293ee, v136
v_mul_f32 v137, 0x3e0293ee, v137
v_mul_f32 v138, 0x3e0293ee, v138
v_mul_f32 v139, 0x3e0293ee, v139
v_mul_f32 v152, 0x3e0293ee, v152
v_mul_f32 v153, 0x3e0293ee, v153
v_mul_f32 v154, 0x3e0293ee, v154
v_mul_f32 v155, 0x3e0293ee, v155
v_cvt_pk_bf16_f32 v8, v136, v137
v_cvt_pk_bf16_f32 v9, v138, v139
v_cvt_pk_bf16_f32 v10, v152, v153
v_cvt_pk_bf16_f32 v11, v154, v155
v_mfma_f32_16x16x32_bf16 v[124:127], v[212:215], a[20:23], v[124:127]
v_and_b32 v217, 1, v1
v_lshl_add_u32 v242, v217, 4, v216
buffer_store_dwordx4 v[8:11], v2, s[20:23], s67 offen offset:2048 sc1
v_mfma_f32_16x16x32_bf16 v[128:131], v[212:215], a[24:27], v[128:131]
ds_read_b64_tr_b16 v[210:211], v230 offset:41472
v_add_u32 v243, 87040, v242
v_mfma_f32_16x16x32_bf16 v[132:135], v[212:215], a[28:31], v[132:135]
s_waitcnt lgkmcnt(4)
v_lshlrev_b32 v216, 3, v1
v_mfma_f32_16x16x32_bf16 v[72:75], v[200:203], a[32:35], v[72:75]
ds_read_b64_tr_b16 v[212:213], v231 offset:40960
s_mul_i32 s68, s45, 90112
v_mfma_f32_16x16x32_bf16 v[76:79], v[200:203], a[36:39], v[76:79]
buffer_load_dwordx4 v239, s[12:15], s65 offen offset:3072 lds
v_add_u32 v248, s68, v216
v_mfma_f32_16x16x32_bf16 v[80:83], v[200:203], a[40:43], v[80:83]
ds_read_b64_tr_b16 v[214:215], v231 offset:41472
v_add_u32 v249, 45056, v248
v_mfma_f32_16x16x32_bf16 v[84:87], v[200:203], a[44:47], v[84:87]
s_waitcnt lgkmcnt(4)
s_mul_i32 s68, s46, 90112
v_mfma_f32_16x16x32_bf16 v[88:91], v[204:207], a[32:35], v[88:91]
ds_read_b64_tr_b16 v[200:201], v228 offset:45056
v_add_u32 v250, s68, v216
v_mfma_f32_16x16x32_bf16 v[92:95], v[204:207], a[36:39], v[92:95]
v_add_u32 v251, 45056, v250
s_lshl_b32 s68, s45, 15
v_mfma_f32_16x16x32_bf16 v[96:99], v[204:207], a[40:43], v[96:99]
ds_read_b64_tr_b16 v[202:203], v228 offset:45568
v_add_u32 v244, s68, v2
v_mfma_f32_16x16x32_bf16 v[100:103], v[204:207], a[44:47], v[100:103]
s_waitcnt lgkmcnt(4)
v_add_u32 v245, 16384, v244
v_mfma_f32_16x16x32_bf16 v[104:107], v[208:211], a[32:35], v[104:107]
ds_read_b64_tr_b16 v[204:205], v229 offset:45056
s_lshl_b32 s68, s46, 15
v_mfma_f32_16x16x32_bf16 v[108:111], v[208:211], a[36:39], v[108:111]
v_add_u32 v246, s68, v2
v_add_u32 v247, 16384, v246
v_mfma_f32_16x16x32_bf16 v[112:115], v[208:211], a[40:43], v[112:115]
ds_read_b64_tr_b16 v[206:207], v229 offset:45568
v_mov_b32 v4, 0xc0135761
v_mfma_f32_16x16x32_bf16 v[116:119], v[208:211], a[44:47], v[116:119]
s_waitcnt lgkmcnt(4)
v_mov_b32 v252, v2
v_mfma_f32_16x16x32_bf16 v[120:123], v[212:215], a[32:35], v[120:123]
ds_read_b64_tr_b16 v[208:209], v230 offset:45056
v_add_u32 v253, 16384, v2
v_mfma_f32_16x16x32_bf16 v[124:127], v[212:215], a[36:39], v[124:127]
s_movk_i32 s56, 0x1000
s_movk_i32 s57, 0x2000
v_mfma_f32_16x16x32_bf16 v[128:131], v[212:215], a[40:43], v[128:131]
ds_read_b64_tr_b16 v[210:211], v230 offset:45568
s_movk_i32 s58, 0x3000
v_mfma_f32_16x16x32_bf16 v[132:135], v[212:215], a[44:47], v[132:135]
s_waitcnt lgkmcnt(4)
s_lshl_b32 s51, s44, 8
v_mfma_f32_16x16x32_bf16 v[72:75], v[200:203], a[48:51], v[72:75]
ds_read_b64_tr_b16 v[212:213], v231 offset:45056
s_lshl_b32 s52, s44, 6
v_mfma_f32_16x16x32_bf16 v[76:79], v[200:203], a[52:55], v[76:79]
s_waitcnt vmcnt(7)
s_barrier
v_mfma_f32_16x16x32_bf16 v[80:83], v[200:203], a[56:59], v[80:83]
ds_read_b64_tr_b16 v[214:215], v231 offset:45568
s_add_u32 m0, s42, 16384
v_mfma_f32_16x16x32_bf16 v[84:87], v[200:203], a[60:63], v[84:87]
s_waitcnt lgkmcnt(4)
s_add_u32 s65, s47, 3145984
v_mfma_f32_16x16x32_bf16 v[88:91], v[204:207], a[48:51], v[88:91]
ds_read_b64_tr_b16 v[200:201], v228 offset:49152
s_lshl_b32 s54, s44, 10
v_mfma_f32_16x16x32_bf16 v[92:95], v[204:207], a[52:55], v[92:95]
buffer_load_dwordx4 v236, s[12:15], s65 offen offset:0 lds
s_add_u32 s68, s44, 64
v_mfma_f32_16x16x32_bf16 v[96:99], v[204:207], a[56:59], v[96:99]
ds_read_b64_tr_b16 v[202:203], v228 offset:49664
s_lshl_b32 s53, s68, 5
v_mfma_f32_16x16x32_bf16 v[100:103], v[204:207], a[60:63], v[100:103]
s_waitcnt lgkmcnt(4)
s_lshl_b32 s55, s68, 9
v_mfma_f32_16x16x32_bf16 v[104:107], v[208:211], a[48:51], v[104:107]
ds_read_b64_tr_b16 v[204:205], v229 offset:49152
s_lshl_b32 s68, s44, 12
v_mul_f32 v168, 0x3e0293ee, v168
v_mul_f32 v169, 0x3e0293ee, v169
v_mul_f32 v170, 0x3e0293ee, v170
v_mul_f32 v171, 0x3e0293ee, v171
v_mul_f32 v184, 0x3e0293ee, v184
v_mul_f32 v185, 0x3e0293ee, v185
v_mul_f32 v186, 0x3e0293ee, v186
v_mul_f32 v187, 0x3e0293ee, v187
v_cvt_pk_bf16_f32 v12, v168, v169
v_cvt_pk_bf16_f32 v13, v170, v171
v_cvt_pk_bf16_f32 v14, v184, v185
v_cvt_pk_bf16_f32 v15, v186, v187
v_mfma_f32_16x16x32_bf16 v[108:111], v[208:211], a[52:55], v[108:111]
s_lshl_b32 s62, s45, 18
s_add_u32 s62, s62, s68
buffer_store_dwordx4 v[12:15], v2, s[20:23], s67 offen offset:3072 sc1
v_mfma_f32_16x16x32_bf16 v[112:115], v[208:211], a[56:59], v[112:115]
ds_read_b64_tr_b16 v[206:207], v229 offset:49664
s_lshl_b32 s63, s46, 18
v_mfma_f32_16x16x32_bf16 v[116:119], v[208:211], a[60:63], v[116:119]
s_waitcnt lgkmcnt(4)
s_add_u32 s63, s63, s68
v_mfma_f32_16x16x32_bf16 v[120:123], v[212:215], a[48:51], v[120:123]
ds_read_b64_tr_b16 v[208:209], v230 offset:49152
s_lshr_b32 s68, s40, 1
v_mfma_f32_16x16x32_bf16 v[124:127], v[212:215], a[52:55], v[124:127]
s_lshl_b32 s68, s68, 15
s_sub_u32 s83, s41, s68
v_mfma_f32_16x16x32_bf16 v[128:131], v[212:215], a[56:59], v[128:131]
ds_read_b64_tr_b16 v[210:211], v230 offset:49664
s_add_u32 s59, s83, 114688
v_mfma_f32_16x16x32_bf16 v[132:135], v[212:215], a[60:63], v[132:135]
s_waitcnt lgkmcnt(4)
s_lshl_b32 s68, s45, 14
v_mfma_f32_16x16x32_bf16 v[72:75], v[200:203], a[64:67], v[72:75]
ds_read_b64_tr_b16 v[212:213], v231 offset:49152
s_add_u32 s60, s68, s59
v_mfma_f32_16x16x32_bf16 v[76:79], v[200:203], a[68:71], v[76:79]
buffer_load_dwordx4 v237, s[12:15], s65 offen offset:1024 lds
s_lshl_b32 s68, s43, 16
v_mfma_f32_16x16x32_bf16 v[80:83], v[200:203], a[72:75], v[80:83]
ds_read_b64_tr_b16 v[214:215], v231 offset:49664
s_sub_u32 s61, 983040, s68
v_mfma_f32_16x16x32_bf16 v[84:87], v[200:203], a[76:79], v[84:87]
s_waitcnt lgkmcnt(4)
s_add_u32 s61, s61, s59
v_mfma_f32_16x16x32_bf16 v[88:91], v[204:207], a[64:67], v[88:91]
ds_read_b64_tr_b16 v[200:201], v228 offset:53248
s_mov_b32 s64, 0
v_mfma_f32_16x16x32_bf16 v[92:95], v[204:207], a[68:71], v[92:95]
v_and_b32 v216, 15, v1
v_lshrrev_b32 v217, 4, v1
v_mfma_f32_16x16x32_bf16 v[96:99], v[204:207], a[72:75], v[96:99]
ds_read_b64_tr_b16 v[202:203], v228 offset:53760
v_lshlrev_b32 v217, 2, v217
v_mfma_f32_16x16x32_bf16 v[100:103], v[204:207], a[76:79], v[100:103]
s_waitcnt lgkmcnt(4)
v_cmp_le_u32 s[70:71], v217, v216
v_mfma_f32_16x16x32_bf16 v[104:107], v[208:211], a[64:67], v[104:107]
ds_read_b64_tr_b16 v[204:205], v229 offset:53248
v_add_u32 v217, 1, v217
v_mfma_f32_16x16x32_bf16 v[108:111], v[208:211], a[68:71], v[108:111]
v_cmp_le_u32 s[72:73], v217, v216
v_add_u32 v217, 1, v217
v_mfma_f32_16x16x32_bf16 v[112:115], v[208:211], a[72:75], v[112:115]
ds_read_b64_tr_b16 v[206:207], v229 offset:53760
v_cmp_le_u32 s[74:75], v217, v216
v_mfma_f32_16x16x32_bf16 v[116:119], v[208:211], a[76:79], v[116:119]
s_waitcnt lgkmcnt(4)
v_add_u32 v217, 1, v217
v_mfma_f32_16x16x32_bf16 v[120:123], v[212:215], a[64:67], v[120:123]
ds_read_b64_tr_b16 v[208:209], v230 offset:53248
v_cmp_le_u32 s[76:77], v217, v216
v_mfma_f32_16x16x32_bf16 v[124:127], v[212:215], a[68:71], v[124:127]
s_add_u32 s67, s50, 4096
v_mul_f32 v140, 0x3e0293ee, v140
v_mfma_f32_16x16x32_bf16 v[128:131], v[212:215], a[72:75], v[128:131]
ds_read_b64_tr_b16 v[210:211], v230 offset:53760
v_mul_f32 v141, 0x3e0293ee, v141
v_mfma_f32_16x16x32_bf16 v[132:135], v[212:215], a[76:79], v[132:135]
s_waitcnt lgkmcnt(4)
v_mul_f32 v142, 0x3e0293ee, v142
v_mfma_f32_16x16x32_bf16 v[72:75], v[200:203], a[80:83], v[72:75]
ds_read_b64_tr_b16 v[212:213], v231 offset:53248
s_cmp_ge_u32 s44, 22
s_cselect_b32 s53, 0x40000000, s53
v_mfma_f32_16x16x32_bf16 v[76:79], v[200:203], a[84:87], v[76:79]
buffer_load_dwordx4 v238, s[12:15], s65 offen offset:2048 lds
v_mul_f32 v143, 0x3e0293ee, v143
v_mfma_f32_16x16x32_bf16 v[80:83], v[200:203], a[88:91], v[80:83]
ds_read_b64_tr_b16 v[214:215], v231 offset:53760
v_mul_f32 v156, 0x3e0293ee, v156
v_mfma_f32_16x16x32_bf16 v[84:87], v[200:203], a[92:95], v[84:87]
s_waitcnt lgkmcnt(4)
v_mul_f32 v157, 0x3e0293ee, v157
v_mfma_f32_16x16x32_bf16 v[88:91], v[204:207], a[80:83], v[88:91]
ds_read_b64_tr_b16 v[200:201], v228 offset:57344
s_cmp_ge_u32 s44, 24
s_cselect_b32 s55, 0x40000000, s55
v_mul_f32 v158, 0x3e0293ee, v158
v_mul_f32 v159, 0x3e0293ee, v159
v_cvt_pk_bf16_f32 v16, v140, v141
v_cvt_pk_bf16_f32 v17, v142, v143
v_cvt_pk_bf16_f32 v18, v156, v157
v_cvt_pk_bf16_f32 v19, v158, v159
v_mfma_f32_16x16x32_bf16 v[92:95], v[204:207], a[84:87], v[92:95]
v_mov_b32 v71, 0
s_add_u32 s69, s43, 256
buffer_store_dwordx4 v[16:19], v2, s[20:23], s67 offen offset:2048 sc1
v_mfma_f32_16x16x32_bf16 v[96:99], v[204:207], a[88:91], v[96:99]
ds_read_b64_tr_b16 v[202:203], v228 offset:57856
s_lshl_b32 s69, s69, 7
v_mfma_f32_16x16x32_bf16 v[100:103], v[204:207], a[92:95], v[100:103]
s_waitcnt lgkmcnt(4)
buffer_load_dword v70, v71, s[32:35], s69 offen sc1
v_mfma_f32_16x16x32_bf16 v[104:107], v[208:211], a[80:83], v[104:107]
ds_read_b64_tr_b16 v[204:205], v229 offset:57344
v_mfma_f32_16x16x32_bf16 v[108:111], v[208:211], a[84:87], v[108:111]
s_add_u32 s24, s80, 0x3200000
s_addc_u32 s25, s81, 0
v_mfma_f32_16x16x32_bf16 v[112:115], v[208:211], a[88:91], v[112:115]
ds_read_b64_tr_b16 v[206:207], v229 offset:57856
s_mov_b32 s26, 0x580000
v_mfma_f32_16x16x32_bf16 v[116:119], v[208:211], a[92:95], v[116:119]
s_waitcnt lgkmcnt(4)
s_mov_b32 s27, 0x20000
v_mfma_f32_16x16x32_bf16 v[120:123], v[212:215], a[80:83], v[120:123]
ds_read_b64_tr_b16 v[208:209], v230 offset:57344
v_mul_f32 v172, 0x3e0293ee, v172
v_mfma_f32_16x16x32_bf16 v[124:127], v[212:215], a[84:87], v[124:127]
s_add_u32 s28, s80, 0x2200000
s_addc_u32 s29, s81, 0
v_mfma_f32_16x16x32_bf16 v[128:131], v[212:215], a[88:91], v[128:131]
ds_read_b64_tr_b16 v[210:211], v230 offset:57856
s_mov_b32 s30, 0x1000000
v_mfma_f32_16x16x32_bf16 v[132:135], v[212:215], a[92:95], v[132:135]
s_waitcnt lgkmcnt(4)
s_mov_b32 s31, 0x20000
v_mfma_f32_16x16x32_bf16 v[72:75], v[200:203], a[96:99], v[72:75]
ds_read_b64_tr_b16 v[212:213], v231 offset:57344
v_mul_f32 v173, 0x3e0293ee, v173
v_mfma_f32_16x16x32_bf16 v[76:79], v[200:203], a[100:103], v[76:79]
buffer_load_dwordx4 v239, s[12:15], s65 offen offset:3072 lds
v_mul_f32 v174, 0x3e0293ee, v174
v_mfma_f32_16x16x32_bf16 v[80:83], v[200:203], a[104:107], v[80:83]
ds_read_b64_tr_b16 v[214:215], v231 offset:57856
v_mul_f32 v175, 0x3e0293ee, v175
v_mfma_f32_16x16x32_bf16 v[84:87], v[200:203], a[108:111], v[84:87]
s_waitcnt lgkmcnt(4)
v_mul_f32 v188, 0x3e0293ee, v188
v_mfma_f32_16x16x32_bf16 v[88:91], v[204:207], a[96:99], v[88:91]
ds_read_b64_tr_b16 v[200:201], v228 offset:61440
v_mul_f32 v189, 0x3e0293ee, v189
v_mfma_f32_16x16x32_bf16 v[92:95], v[204:207], a[100:103], v[92:95]
v_mul_f32 v190, 0x3e0293ee, v190
v_mfma_f32_16x16x32_bf16 v[96:99], v[204:207], a[104:107], v[96:99]
ds_read_b64_tr_b16 v[202:203], v228 offset:61952
v_mfma_f32_16x16x32_bf16 v[100:103], v[204:207], a[108:111], v[100:103]
s_waitcnt lgkmcnt(4)
v_mul_f32 v191, 0x3e0293ee, v191
v_mfma_f32_16x16x32_bf16 v[104:107], v[208:211], a[96:99], v[104:107]
ds_read_b64_tr_b16 v[204:205], v229 offset:61440
v_mfma_f32_16x16x32_bf16 v[108:111], v[208:211], a[100:103], v[108:111]
v_cvt_pk_bf16_f32 v20, v172, v173
v_mfma_f32_16x16x32_bf16 v[112:115], v[208:211], a[104:107], v[112:115]
ds_read_b64_tr_b16 v[206:207], v229 offset:61952
v_mfma_f32_16x16x32_bf16 v[116:119], v[208:211], a[108:111], v[116:119]
s_waitcnt lgkmcnt(4)
v_cvt_pk_bf16_f32 v21, v174, v175
v_mfma_f32_16x16x32_bf16 v[120:123], v[212:215], a[96:99], v[120:123]
ds_read_b64_tr_b16 v[208:209], v230 offset:61440
v_mfma_f32_16x16x32_bf16 v[124:127], v[212:215], a[100:103], v[124:127]
v_cvt_pk_bf16_f32 v22, v188, v189
v_mfma_f32_16x16x32_bf16 v[128:131], v[212:215], a[104:107], v[128:131]
ds_read_b64_tr_b16 v[210:211], v230 offset:61952
v_mfma_f32_16x16x32_bf16 v[132:135], v[212:215], a[108:111], v[132:135]
s_waitcnt lgkmcnt(4)
v_cvt_pk_bf16_f32 v23, v190, v191
v_mfma_f32_16x16x32_bf16 v[72:75], v[200:203], a[112:115], v[72:75]
ds_read_b64_tr_b16 v[212:213], v231 offset:61440
v_mfma_f32_16x16x32_bf16 v[76:79], v[200:203], a[116:119], v[76:79]
s_waitcnt vmcnt(7)
s_barrier
v_mfma_f32_16x16x32_bf16 v[80:83], v[200:203], a[120:123], v[80:83]
ds_read_b64_tr_b16 v[214:215], v231 offset:61952
s_add_u32 m0, s42, 32768
v_mfma_f32_16x16x32_bf16 v[84:87], v[200:203], a[124:127], v[84:87]
s_waitcnt lgkmcnt(4)
s_add_u32 s65, s47, 384
v_mfma_f32_16x16x32_bf16 v[88:91], v[204:207], a[112:115], v[88:91]
ds_read_b64_tr_b16 v[200:201], v228 offset:0
v_mfma_f32_16x16x32_bf16 v[92:95], v[204:207], a[116:119], v[92:95]
buffer_load_dwordx4 v236, s[12:15], s65 offen offset:0 lds
v_mfma_f32_16x16x32_bf16 v[96:99], v[204:207], a[120:123], v[96:99]
ds_read_b64_tr_b16 v[202:203], v228 offset:512
v_mfma_f32_16x16x32_bf16 v[100:103], v[204:207], a[124:127], v[100:103]
s_waitcnt lgkmcnt(4)
v_mfma_f32_16x16x32_bf16 v[104:107], v[208:211], a[112:115], v[104:107]
ds_read_b64_tr_b16 v[204:205], v229 offset:0
v_mfma_f32_16x16x32_bf16 v[108:111], v[208:211], a[116:119], v[108:111]
buffer_store_dwordx4 v[20:23], v2, s[20:23], s67 offen offset:3072 sc1
s_add_u32 s67, s50, 16384
v_mfma_f32_16x16x32_bf16 v[112:115], v[208:211], a[120:123], v[112:115]
ds_read_b64_tr_b16 v[206:207], v229 offset:512
v_mul_f32 v144, 0x3e0293ee, v144
v_mfma_f32_16x16x32_bf16 v[116:119], v[208:211], a[124:127], v[116:119]
s_waitcnt lgkmcnt(4)
v_mfma_f32_16x16x32_bf16 v[120:123], v[212:215], a[112:115], v[120:123]
ds_read_b64_tr_b16 v[208:209], v230 offset:0
v_mul_f32 v145, 0x3e0293ee, v145
v_mfma_f32_16x16x32_bf16 v[124:127], v[212:215], a[116:119], v[124:127]
v_mfma_f32_16x16x32_bf16 v[128:131], v[212:215], a[120:123], v[128:131]
ds_read_b64_tr_b16 v[210:211], v230 offset:512
v_mul_f32 v146, 0x3e0293ee, v146
v_mfma_f32_16x16x32_bf16 v[132:135], v[212:215], a[124:127], v[132:135]
s_waitcnt lgkmcnt(4)
v_mfma_f32_16x16x32_bf16 v[72:75], v[200:203], a[128:131], v[72:75]
ds_read_b64_tr_b16 v[212:213], v231 offset:0
v_mul_f32 v147, 0x3e0293ee, v147
v_mfma_f32_16x16x32_bf16 v[76:79], v[200:203], a[132:135], v[76:79]
buffer_load_dwordx4 v237, s[12:15], s65 offen offset:1024 lds
v_mul_f32 v160, 0x3e0293ee, v160
v_mfma_f32_16x16x32_bf16 v[80:83], v[200:203], a[136:139], v[80:83]
ds_read_b64_tr_b16 v[214:215], v231 offset:512
v_mfma_f32_16x16x32_bf16 v[84:87], v[200:203], a[140:143], v[84:87]
s_waitcnt lgkmcnt(4)
v_mul_f32 v161, 0x3e0293ee, v161
v_mfma_f32_16x16x32_bf16 v[88:91], v[204:207], a[128:131], v[88:91]
ds_read_b64_tr_b16 v[200:201], v228 offset:4096
v_mfma_f32_16x16x32_bf16 v[92:95], v[204:207], a[132:135], v[92:95]
v_mul_f32 v162, 0x3e0293ee, v162
v_mfma_f32_16x16x32_bf16 v[96:99], v[204:207], a[136:139], v[96:99]
ds_read_b64_tr_b16 v[202:203], v228 offset:4608
v_mfma_f32_16x16x32_bf16 v[100:103], v[204:207], a[140:143], v[100:103]
s_waitcnt lgkmcnt(4)
v_mul_f32 v163, 0x3e0293ee, v163
v_mfma_f32_16x16x32_bf16 v[104:107], v[208:211], a[128:131], v[104:107]
ds_read_b64_tr_b16 v[204:205], v229 offset:4096
v_cvt_pk_bf16_f32 v8, v144, v145
v_mfma_f32_16x16x32_bf16 v[108:111], v[208:211], a[132:135], v[108:111]
v_mfma_f32_16x16x32_bf16 v[112:115], v[208:211], a[136:139], v[112:115]
ds_read_b64_tr_b16 v[206:207], v229 offset:4608
v_cvt_pk_bf16_f32 v9, v146, v147
v_mfma_f32_16x16x32_bf16 v[116:119], v[208:211], a[140:143], v[116:119]
s_waitcnt lgkmcnt(4)
v_mfma_f32_16x16x32_bf16 v[120:123], v[212:215], a[128:131], v[120:123]
ds_read_b64_tr_b16 v[208:209], v230 offset:4096
v_cvt_pk_bf16_f32 v10, v160, v161
v_mfma_f32_16x16x32_bf16 v[124:127], v[212:215], a[132:135], v[124:127]
v_mfma_f32_16x16x32_bf16 v[128:131], v[212:215], a[136:139], v[128:131]
ds_read_b64_tr_b16 v[210:211], v230 offset:4608
v_cvt_pk_bf16_f32 v11, v162, v163
v_mfma_f32_16x16x32_bf16 v[132:135], v[212:215], a[140:143], v[132:135]
s_waitcnt lgkmcnt(4)
v_mfma_f32_16x16x32_bf16 v[72:75], v[200:203], a[144:147], v[72:75]
ds_read_b64_tr_b16 v[212:213], v231 offset:4096
v_mfma_f32_16x16x32_bf16 v[76:79], v[200:203], a[148:151], v[76:79]
buffer_load_dwordx4 v238, s[12:15], s65 offen offset:2048 lds
v_mfma_f32_16x16x32_bf16 v[80:83], v[200:203], a[152:155], v[80:83]
ds_read_b64_tr_b16 v[214:215], v231 offset:4608
v_mfma_f32_16x16x32_bf16 v[84:87], v[200:203], a[156:159], v[84:87]
s_waitcnt lgkmcnt(4)
v_mfma_f32_16x16x32_bf16 v[88:91], v[204:207], a[144:147], v[88:91]
ds_read_b64_tr_b16 v[200:201], v228 offset:8192
v_mfma_f32_16x16x32_bf16 v[92:95], v[204:207], a[148:151], v[92:95]
s_waitcnt vmcnt(5)
v_cmp_le_u32 vcc, 32, v70
s_cmp_eq_u64 vcc, exec
s_cbranch_scc0 KF_x0_spin
KF_x0_back:
buffer_store_dwordx4 v[8:11], v2, s[20:23], s67 offen offset:2048 sc1
v_mfma_f32_16x16x32_bf16 v[96:99], v[204:207], a[152:155], v[96:99]
ds_read_b64_tr_b16 v[202:203], v228 offset:8704
v_mul_f32 v176, 0x3e0293ee, v176
v_mfma_f32_16x16x32_bf16 v[100:103], v[204:207], a[156:159], v[100:103]
s_waitcnt lgkmcnt(4)
v_mul_f32 v177, 0x3e0293ee, v177
v_mfma_f32_16x16x32_bf16 v[104:107], v[208:211], a[144:147], v[104:107]
ds_read_b64_tr_b16 v[204:205], v229 offset:8192
v_mul_f32 v178, 0x3e0293ee, v178
v_mfma_f32_16x16x32_bf16 v[108:111], v[208:211], a[148:151], v[108:111]
v_mfma_f32_16x16x32_bf16 v[112:115], v[208:211], a[152:155], v[112:115]
ds_read_b64_tr_b16 v[206:207], v229 offset:8704
v_mul_f32 v179, 0x3e0293ee, v179
v_mfma_f32_16x16x32_bf16 v[116:119], v[208:211], a[156:159], v[116:119]
s_waitcnt lgkmcnt(4)
v_mfma_f32_16x16x32_bf16 v[120:123], v[212:215], a[144:147], v[120:123]
ds_read_b64_tr_b16 v[208:209], v230 offset:8192
v_mul_f32 v192, 0x3e0293ee, v192
v_mfma_f32_16x16x32_bf16 v[124:127], v[212:215], a[148:151], v[124:127]
v_mfma_f32_16x16x32_bf16 v[128:131], v[212:215], a[152:155], v[128:131]
ds_read_b64_tr_b16 v[210:211], v230 offset:8704
v_mul_f32 v193, 0x3e0293ee, v193
v_mfma_f32_16x16x32_bf16 v[132:135], v[212:215], a[156:159], v[132:135]
s_waitcnt lgkmcnt(4)
v_mfma_f32_16x16x32_bf16 v[72:75], v[200:203], a[160:163], v[72:75]
ds_read_b64_tr_b16 v[212:213], v231 offset:8192
v_mul_f32 v194, 0x3e0293ee, v194
v_mfma_f32_16x16x32_bf16 v[76:79], v[200:203], a[164:167], v[76:79]
buffer_load_dwordx4 v239, s[12:15], s65 offen offset:3072 lds
v_mfma_f32_16x16x32_bf16 v[80:83], v[200:203], a[168:171], v[80:83]
ds_read_b64_tr_b16 v[214:215], v231 offset:8704
v_mul_f32 v195, 0x3e0293ee, v195
v_mfma_f32_16x16x32_bf16 v[84:87], v[200:203], a[172:175], v[84:87]
s_waitcnt lgkmcnt(4)
v_mfma_f32_16x16x32_bf16 v[88:91], v[204:207], a[160:163], v[88:91]
ds_read_b64_tr_b16 v[200:201], v228 offset:12288
v_cvt_pk_bf16_f32 v12, v176, v177
v_mfma_f32_16x16x32_bf16 v[92:95], v[204:207], a[164:167], v[92:95]
v_mfma_f32_16x16x32_bf16 v[96:99], v[204:207], a[168:171], v[96:99]
ds_read_b64_tr_b16 v[202:203], v228 offset:12800
v_cvt_pk_bf16_f32 v13, v178, v179
v_mfma_f32_16x16x32_bf16 v[100:103], v[204:207], a[172:175], v[100:103]
s_waitcnt lgkmcnt(4)
v_mfma_f32_16x16x32_bf16 v[104:107], v[208:211], a[160:163], v[104:107]
ds_read_b64_tr_b16 v[204:205], v229 offset:12288
v_cvt_pk_bf16_f32 v14, v192, v193
v_mfma_f32_16x16x32_bf16 v[108:111], v[208:211], a[164:167], v[108:111]
v_mfma_f32_16x16x32_bf16 v[112:115], v[208:211], a[168:171], v[112:115]
ds_read_b64_tr_b16 v[206:207], v229 offset:12800
v_cvt_pk_bf16_f32 v15, v194, v195
v_mfma_f32_16x16x32_bf16 v[116:119], v[208:211], a[172:175], v[116:119]
s_waitcnt lgkmcnt(4)
v_mfma_f32_16x16x32_bf16 v[120:123], v[212:215], a[160:163], v[120:123]
ds_read_b64_tr_b16 v[208:209], v230 offset:12288
v_mfma_f32_16x16x32_bf16 v[124:127], v[212:215], a[164:167], v[124:127]
buffer_store_dwordx4 v[12:15], v2, s[20:23], s67 offen offset:3072 sc1
v_mfma_f32_16x16x32_bf16 v[128:131], v[212:215], a[168:171], v[128:131]
ds_read_b64_tr_b16 v[210:211], v230 offset:12800
s_add_u32 s67, s50, 20480
v_mfma_f32_16x16x32_bf16 v[132:135], v[212:215], a[172:175], v[132:135]
s_waitcnt lgkmcnt(4)
v_mul_f32 v148, 0x3e0293ee, v148
v_mfma_f32_16x16x32_bf16 v[72:75], v[200:203], a[176:179], v[72:75]
ds_read_b64_tr_b16 v[212:213], v231 offset:12288
v_mfma_f32_16x16x32_bf16 v[76:79], v[200:203], a[180:183], v[76:79]
s_waitcnt vmcnt(7)
s_barrier
v_mfma_f32_16x16x32_bf16 v[80:83], v[200:203], a[184:187], v[80:83]
ds_read_b64_tr_b16 v[214:215], v231 offset:12800
s_add_u32 m0, s42, 49152
v_mfma_f32_16x16x32_bf16 v[84:87], v[200:203], a[188:191], v[84:87]
s_waitcnt lgkmcnt(4)
s_add_u32 s65, s47, 1048960
v_mfma_f32_16x16x32_bf16 v[88:91], v[204:207], a[176:179], v[88:91]
ds_read_b64_tr_b16 v[200:201], v228 offset:16384
v_mul_f32 v149, 0x3e0293ee, v149
v_mfma_f32_16x16x32_bf16 v[92:95], v[204:207], a[180:183], v[92:95]
buffer_load_dwordx4 v236, s[12:15], s65 offen offset:0 lds
v_mul_f32 v150, 0x3e0293ee, v150
v_mfma_f32_16x16x32_bf16 v[96:99], v[204:207], a[184:187], v[96:99]
ds_read_b64_tr_b16 v[202:203], v228 offset:16896
v_mul_f32 v151, 0x3e0293ee, v151
v_mfma_f32_16x16x32_bf16 v[100:103], v[204:207], a[188:191], v[100:103]
s_waitcnt lgkmcnt(4)
v_mul_f32 v164, 0x3e0293ee, v164
v_mfma_f32_16x16x32_bf16 v[104:107], v[208:211], a[176:179], v[104:107]
ds_read_b64_tr_b16 v[204:205], v229 offset:16384
v_mul_f32 v165, 0x3e0293ee, v165
v_mfma_f32_16x16x32_bf16 v[108:111], v[208:211], a[180:183], v[108:111]
v_mfma_f32_16x16x32_bf16 v[112:115], v[208:211], a[184:187], v[112:115]
ds_read_b64_tr_b16 v[206:207], v229 offset:16896
v_mul_f32 v166, 0x3e0293ee, v166
v_mfma_f32_16x16x32_bf16 v[116:119], v[208:211], a[188:191], v[116:119]
s_waitcnt lgkmcnt(4)
v_mfma_f32_16x16x32_bf16 v[120:123], v[212:215], a[176:179], v[120:123]
ds_read_b64_tr_b16 v[208:209], v230 offset:16384
v_mul_f32 v167, 0x3e0293ee, v167
v_mfma_f32_16x16x32_bf16 v[124:127], v[212:215], a[180:183], v[124:127]
v_cvt_pk_bf16_f32 v16, v148, v149
v_mfma_f32_16x16x32_bf16 v[128:131], v[212:215], a[184:187], v[128:131]
ds_read_b64_tr_b16 v[210:211], v230 offset:16896
v_mfma_f32_16x16x32_bf16 v[132:135], v[212:215], a[188:191], v[132:135]
s_waitcnt lgkmcnt(4)
v_cvt_pk_bf16_f32 v17, v150, v151
v_mfma_f32_16x16x32_bf16 v[72:75], v[200:203], a[192:195], v[72:75]
ds_read_b64_tr_b16 v[212:213], v231 offset:16384
v_mfma_f32_16x16x32_bf16 v[76:79], v[200:203], a[196:199], v[76:79]
buffer_load_dwordx4 v237, s[12:15], s65 offen offset:1024 lds
v_cvt_pk_bf16_f32 v18, v164, v165
v_mfma_f32_16x16x32_bf16 v[80:83], v[200:203], a[200:203], v[80:83]
ds_read_b64_tr_b16 v[214:215], v231 offset:16896
v_mfma_f32_16x16x32_bf16 v[84:87], v[200:203], a[204:207], v[84:87]
s_waitcnt lgkmcnt(4)
v_cvt_pk_bf16_f32 v19, v166, v167
v_mfma_f32_16x16x32_bf16 v[88:91], v[204:207], a[192:195], v[88:91]
ds_read_b64_tr_b16 v[200:201], v228 offset:20480
v_mfma_f32_16x16x32_bf16 v[92:95], v[204:207], a[196:199], v[92:95]
buffer_store_dwordx4 v[16:19], v2, s[20:23], s67 offen offset:2048 sc1
v_mfma_f32_16x16x32_bf16 v[96:99], v[204:207], a[200:203], v[96:99]
ds_read_b64_tr_b16 v[202:203], v228 offset:20992
v_mfma_f32_16x16x32_bf16 v[100:103], v[204:207], a[204:207], v[100:103]
s_waitcnt lgkmcnt(4)
v_mfma_f32_16x16x32_bf16 v[104:107], v[208:211], a[192:195], v[104:107]
ds_read_b64_tr_b16 v[204:205], v229 offset:20480
v_mfma_f32_16x16x32_bf16 v[108:111], v[208:211], a[196:199], v[108:111]
v_mfma_f32_16x16x32_bf16 v[112:115], v[208:211], a[200:203], v[112:115]
ds_read_b64_tr_b16 v[206:207], v229 offset:20992
v_mul_f32 v180, 0x3e0293ee, v180
v_mfma_f32_16x16x32_bf16 v[116:119], v[208:211], a[204:207], v[116:119]
s_waitcnt lgkmcnt(4)
v_mul_f32 v181, 0x3e0293ee, v181
v_mfma_f32_16x16x32_bf16 v[120:123], v[212:215], a[192:195], v[120:123]
ds_read_b64_tr_b16 v[208:209], v230 offset:20480
v_mfma_f32_16x16x32_bf16 v[124:127], v[212:215], a[196:199], v[124:127]
v_mul_f32 v182, 0x3e0293ee, v182
v_mfma_f32_16x16x32_bf16 v[128:131], v[212:215], a[200:203], v[128:131]
ds_read_b64_tr_b16 v[210:211], v230 offset:20992
v_mfma_f32_16x16x32_bf16 v[132:135], v[212:215], a[204:207], v[132:135]
s_waitcnt lgkmcnt(4)
v_mul_f32 v183, 0x3e0293ee, v183
v_mfma_f32_16x16x32_bf16 v[72:75], v[200:203], a[208:211], v[72:75]
ds_read_b64_tr_b16 v[212:213], v231 offset:20480
v_mfma_f32_16x16x32_bf16 v[76:79], v[200:203], a[212:215], v[76:79]
buffer_load_dwordx4 v238, s[12:15], s65 offen offset:2048 lds
v_mul_f32 v196, 0x3e0293ee, v196
v_mfma_f32_16x16x32_bf16 v[80:83], v[200:203], a[216:219], v[80:83]
ds_read_b64_tr_b16 v[214:215], v231 offset:20992
v_mfma_f32_16x16x32_bf16 v[84:87], v[200:203], a[220:223], v[84:87]
s_waitcnt lgkmcnt(4)
v_mul_f32 v197, 0x3e0293ee, v197
v_mfma_f32_16x16x32_bf16 v[88:91], v[204:207], a[208:211], v[88:91]
ds_read_b64_tr_b16 v[200:201], v228 offset:24576
v_mfma_f32_16x16x32_bf16 v[92:95], v[204:207], a[212:215], v[92:95]
v_mul_f32 v198, 0x3e0293ee, v198
v_mfma_f32_16x16x32_bf16 v[96:99], v[204:207], a[216:219], v[96:99]
ds_read_b64_tr_b16 v[202:203], v228 offset:25088
v_mfma_f32_16x16x32_bf16 v[100:103], v[204:207], a[220:223], v[100:103]
s_waitcnt lgkmcnt(4)
v_mul_f32 v199, 0x3e0293ee, v199
v_mfma_f32_16x16x32_bf16 v[104:107], v[208:211], a[208:211], v[104:107]
ds_read_b64_tr_b16 v[204:205], v229 offset:24576
v_mfma_f32_16x16x32_bf16 v[108:111], v[208:211], a[212:215], v[108:111]
v_cvt_pk_bf16_f32 v20, v180, v181
v_mfma_f32_16x16x32_bf16 v[112:115], v[208:211], a[216:219], v[112:115]
ds_read_b64_tr_b16 v[206:207], v229 offset:25088
v_mfma_f32_16x16x32_bf16 v[116:119], v[208:211], a[220:223], v[116:119]
s_waitcnt lgkmcnt(4)
v_cvt_pk_bf16_f32 v21, v182, v183
v_mfma_f32_16x16x32_bf16 v[120:123], v[212:215], a[208:211], v[120:123]
ds_read_b64_tr_b16 v[208:209], v230 offset:24576
v_mfma_f32_16x16x32_bf16 v[124:127], v[212:215], a[212:215], v[124:127]
v_cvt_pk_bf16_f32 v22, v196, v197
v_mfma_f32_16x16x32_bf16 v[128:131], v[212:215], a[216:219], v[128:131]
ds_read_b64_tr_b16 v[210:211], v230 offset:25088
v_mfma_f32_16x16x32_bf16 v[132:135], v[212:215], a[220:223], v[132:135]
s_waitcnt lgkmcnt(4)
v_cvt_pk_bf16_f32 v23, v198, v199
v_mfma_f32_16x16x32_bf16 v[72:75], v[200:203], a[224:227], v[72:75]
ds_read_b64_tr_b16 v[212:213], v231 offset:24576
v_mfma_f32_16x16x32_bf16 v[76:79], v[200:203], a[228:231], v[76:79]
buffer_load_dwordx4 v239, s[12:15], s65 offen offset:3072 lds
v_mfma_f32_16x16x32_bf16 v[80:83], v[200:203], a[232:235], v[80:83]
ds_read_b64_tr_b16 v[214:215], v231 offset:25088
v_mfma_f32_16x16x32_bf16 v[84:87], v[200:203], a[236:239], v[84:87]
s_waitcnt lgkmcnt(4)
v_mfma_f32_16x16x32_bf16 v[88:91], v[204:207], a[224:227], v[88:91]
ds_read_b64_tr_b16 v[200:201], v228 offset:28672
v_mfma_f32_16x16x32_bf16 v[92:95], v[204:207], a[228:231], v[92:95]
buffer_store_dwordx4 v[20:23], v2, s[20:23], s67 offen offset:3072 sc1
v_mfma_f32_16x16x32_bf16 v[96:99], v[204:207], a[232:235], v[96:99]
ds_read_b64_tr_b16 v[202:203], v228 offset:29184
v_mfma_f32_16x16x32_bf16 v[100:103], v[204:207], a[236:239], v[100:103]
s_waitcnt lgkmcnt(4)
v_mfma_f32_16x16x32_bf16 v[104:107], v[208:211], a[224:227], v[104:107]
ds_read_b64_tr_b16 v[204:205], v229 offset:28672
v_mfma_f32_16x16x32_bf16 v[108:111], v[208:211], a[228:231], v[108:111]
v_mfma_f32_16x16x32_bf16 v[112:115], v[208:211], a[232:235], v[112:115]
ds_read_b64_tr_b16 v[206:207], v229 offset:29184
v_mfma_f32_16x16x32_bf16 v[116:119], v[208:211], a[236:239], v[116:119]
s_waitcnt lgkmcnt(4)
v_mfma_f32_16x16x32_bf16 v[120:123], v[212:215], a[224:227], v[120:123]
ds_read_b64_tr_b16 v[208:209], v230 offset:28672
v_mfma_f32_16x16x32_bf16 v[124:127], v[212:215], a[228:231], v[124:127]
v_mfma_f32_16x16x32_bf16 v[128:131], v[212:215], a[232:235], v[128:131]
ds_read_b64_tr_b16 v[210:211], v230 offset:29184
v_mfma_f32_16x16x32_bf16 v[132:135], v[212:215], a[236:239], v[132:135]
s_waitcnt lgkmcnt(4)
v_mfma_f32_16x16x32_bf16 v[72:75], v[200:203], a[240:243], v[72:75]
ds_read_b64_tr_b16 v[212:213], v231 offset:28672
v_mfma_f32_16x16x32_bf16 v[76:79], v[200:203], a[244:247], v[76:79]
s_waitcnt vmcnt(7)
s_barrier
v_mfma_f32_16x16x32_bf16 v[80:83], v[200:203], a[248:251], v[80:83]
ds_read_b64_tr_b16 v[214:215], v231 offset:29184
s_add_u32 m0, s42, 0
v_mfma_f32_16x16x32_bf16 v[84:87], v[200:203], a[252:255], v[84:87]
s_waitcnt lgkmcnt(4)
s_add_u32 s65, s47, 2097536
v_mfma_f32_16x16x32_bf16 v[88:91], v[204:207], a[240:243], v[88:91]
ds_read_b64_tr_b16 v[200:201], v228 offset:32768
v_mfma_f32_16x16x32_bf16 v[92:95], v[204:207], a[244:247], v[92:95]
buffer_load_dwordx4 v236, s[12:15], s65 offen offset:0 lds
v_mfma_f32_16x16x32_bf16 v[96:99], v[204:207], a[248:251], v[96:99]
ds_read_b64_tr_b16 v[202:203], v228 offset:33280
v_mfma_f32_16x16x32_bf16 v[100:103], v[204:207], a[252:255], v[100:103]
s_waitcnt lgkmcnt(4)
v_mfma_f32_16x16x32_bf16 v[104:107], v[208:211], a[240:243], v[104:107]
ds_read_b64_tr_b16 v[204:205], v229 offset:32768
v_mfma_f32_16x16x32_bf16 v[108:111], v[208:211], a[244:247], v[108:111]
v_mfma_f32_16x16x32_bf16 v[112:115], v[208:211], a[248:251], v[112:115]
ds_read_b64_tr_b16 v[206:207], v229 offset:33280
v_mfma_f32_16x16x32_bf16 v[116:119], v[208:211], a[252:255], v[116:119]
s_waitcnt lgkmcnt(4)
v_mfma_f32_16x16x32_bf16 v[120:123], v[212:215], a[240:243], v[120:123]
ds_read_b64_tr_b16 v[208:209], v230 offset:32768
v_mfma_f32_16x16x32_bf16 v[124:127], v[212:215], a[244:247], v[124:127]
v_mfma_f32_16x16x32_bf16 v[128:131], v[212:215], a[248:251], v[128:131]
ds_read_b64_tr_b16 v[210:211], v230 offset:33280
v_mfma_f32_16x16x32_bf16 v[132:135], v[212:215], a[252:255], v[132:135]
s_waitcnt lgkmcnt(4)
v_mfma_f32_16x16x32_bf16 v[136:139], v[200:203], a[0:3], 0
ds_read_b64_tr_b16 v[212:213], v231 offset:32768
v_mfma_f32_16x16x32_bf16 v[140:143], v[200:203], a[4:7], 0
buffer_load_dwordx4 v237, s[12:15], s65 offen offset:1024 lds
v_mfma_f32_16x16x32_bf16 v[144:147], v[200:203], a[8:11], 0
ds_read_b64_tr_b16 v[214:215], v231 offset:33280
v_mfma_f32_16x16x32_bf16 v[148:151], v[200:203], a[12:15], 0
s_waitcnt lgkmcnt(4)
v_mfma_f32_16x16x32_bf16 v[152:155], v[204:207], a[0:3], 0
ds_read_b64_tr_b16 v[200:201], v228 offset:36864
v_mfma_f32_16x16x32_bf16 v[156:159], v[204:207], a[4:7], 0
v_mfma_f32_16x16x32_bf16 v[160:163], v[204:207], a[8:11], 0
ds_read_b64_tr_b16 v[202:203], v228 offset:37376
s_add_u32 s67, s50, 1048576
v_mfma_f32_16x16x32_bf16 v[164:167], v[204:207], a[12:15], 0
s_waitcnt lgkmcnt(4)
v_mul_f32 v72, 0x3e0293ee, v72
v_mfma_f32_16x16x32_bf16 v[168:171], v[208:211], a[0:3], 0
ds_read_b64_tr_b16 v[204:205], v229 offset:36864
v_mfma_f32_16x16x32_bf16 v[172:175], v[208:211], a[4:7], 0
v_mul_f32 v73, 0x3e0293ee, v73
v_mfma_f32_16x16x32_bf16 v[176:179], v[208:211], a[8:11], 0
ds_read_b64_tr_b16 v[206:207], v229 offset:37376
v_mfma_f32_16x16x32_bf16 v[180:183], v[208:211], a[12:15], 0
s_waitcnt lgkmcnt(4)
v_mul_f32 v74, 0x3e0293ee, v74
v_mfma_f32_16x16x32_bf16 v[184:187], v[212:215], a[0:3], 0
ds_read_b64_tr_b16 v[208:209], v230 offset:36864
v_mfma_f32_16x16x32_bf16 v[188:191], v[212:215], a[4:7], 0
v_mul_f32 v75, 0x3e0293ee, v75
v_mfma_f32_16x16x32_bf16 v[192:195], v[212:215], a[8:11], 0
ds_read_b64_tr_b16 v[210:211], v230 offset:37376
v_mul_f32 v88, 0x3e0293ee, v88
v_mfma_f32_16x16x32_bf16 v[196:199], v[212:215], a[12:15], 0
s_waitcnt lgkmcnt(4)
v_mfma_f32_16x16x32_bf16 v[136:139], v[200:203], a[16:19], v[136:139]
ds_read_b64_tr_b16 v[212:213], v231 offset:36864
v_mul_f32 v89, 0x3e0293ee, v89
v_mfma_f32_16x16x32_bf16 v[140:143], v[200:203], a[20:23], v[140:143]
buffer_load_dwordx4 v238, s[12:15], s65 offen offset:2048 lds
v_mfma_f32_16x16x32_bf16 v[144:147], v[200:203], a[24:27], v[144:147]
ds_read_b64_tr_b16 v[214:215], v231 offset:37376
v_mul_f32 v90, 0x3e0293ee, v90
v_mfma_f32_16x16x32_bf16 v[148:151], v[200:203], a[28:31], v[148:151]
s_waitcnt lgkmcnt(4)
v_mfma_f32_16x16x32_bf16 v[152:155], v[204:207], a[16:19], v[152:155]
ds_read_b64_tr_b16 v[200:201], v228 offset:40960
v_mul_f32 v91, 0x3e0293ee, v91
v_mfma_f32_16x16x32_bf16 v[156:159], v[204:207], a[20:23], v[156:159]
v_cvt_pk_bf16_f32 v8, v72, v73
buffer_load_dwordx4 a[0:3], v244, s[16:19], 0 offen offset:0 sc1
v_mfma_f32_16x16x32_bf16 v[160:163], v[204:207], a[24:27], v[160:163]
ds_read_b64_tr_b16 v[202:203], v228 offset:41472
v_mfma_f32_16x16x32_bf16 v[164:167], v[204:207], a[28:31], v[164:167]
s_waitcnt lgkmcnt(4)
v_cvt_pk_bf16_f32 v9, v74, v75
v_mfma_f32_16x16x32_bf16 v[168:171], v[208:211], a[16:19], v[168:171]
ds_read_b64_tr_b16 v[204:205], v229 offset:40960
v_mfma_f32_16x16x32_bf16 v[172:175], v[208:211], a[20:23], v[172:175]
v_cvt_pk_bf16_f32 v10, v88, v89
buffer_load_dwordx4 a[4:7], v245, s[16:19], 0 offen offset:0 sc1
v_mfma_f32_16x16x32_bf16 v[176:179], v[208:211], a[24:27], v[176:179]
ds_read_b64_tr_b16 v[206:207], v229 offset:41472
v_mfma_f32_16x16x32_bf16 v[180:183], v[208:211], a[28:31], v[180:183]
s_waitcnt lgkmcnt(4)
v_cvt_pk_bf16_f32 v11, v90, v91
v_mfma_f32_16x16x32_bf16 v[184:187], v[212:215], a[16:19], v[184:187]
ds_read_b64_tr_b16 v[208:209], v230 offset:40960
v_mfma_f32_16x16x32_bf16 v[188:191], v[212:215], a[20:23], v[188:191]
buffer_store_dwordx4 v[8:11], v2, s[20:23], s67 offen offset:0 sc1
v_mfma_f32_16x16x32_bf16 v[192:195], v[212:215], a[24:27], v[192:195]
ds_read_b64_tr_b16 v[210:211], v230 offset:41472
v_mfma_f32_16x16x32_bf16 v[196:199], v[212:215], a[28:31], v[196:199]
s_waitcnt lgkmcnt(4)
v_mfma_f32_16x16x32_bf16 v[136:139], v[200:203], a[32:35], v[136:139]
ds_read_b64_tr_b16 v[212:213], v231 offset:40960
v_mfma_f32_16x16x32_bf16 v[140:143], v[200:203], a[36:39], v[140:143]
buffer_load_dwordx4 v239, s[12:15], s65 offen offset:3072 lds
v_mfma_f32_16x16x32_bf16 v[144:147], v[200:203], a[40:43], v[144:147]
ds_read_b64_tr_b16 v[214:215], v231 offset:41472
v_mul_f32 v104, 0x3e0293ee, v104
v_mfma_f32_16x16x32_bf16 v[148:151], v[200:203], a[44:47], v[148:151]
s_waitcnt lgkmcnt(4)
v_mul_f32 v105, 0x3e0293ee, v105
v_mfma_f32_16x16x32_bf16 v[152:155], v[204:207], a[32:35], v[152:155]
ds_read_b64_tr_b16 v[200:201], v228 offset:45056
v_mfma_f32_16x16x32_bf16 v[156:159], v[204:207], a[36:39], v[156:159]
v_mul_f32 v106, 0x3e0293ee, v106
buffer_load_dwordx4 a[8:11], v246, s[16:19], 0 offen offset:0 sc1
v_mfma_f32_16x16x32_bf16 v[160:163], v[204:207], a[40:43], v[160:163]
ds_read_b64_tr_b16 v[202:203], v228 offset:45568
v_mfma_f32_16x16x32_bf16 v[164:167], v[204:207], a[44:47], v[164:167]
s_waitcnt lgkmcnt(4)
v_mul_f32 v107, 0x3e0293ee, v107
v_mfma_f32_16x16x32_bf16 v[168:171], v[208:211], a[32:35], v[168:171]
ds_read_b64_tr_b16 v[204:205], v229 offset:45056
v_mfma_f32_16x16x32_bf16 v[172:175], v[208:211], a[36:39], v[172:175]
v_mul_f32 v120, 0x3e0293ee, v120
buffer_load_dwordx4 a[12:15], v247, s[16:19], 0 offen offset:0 sc1
v_mfma_f32_16x16x32_bf16 v[176:179], v[208:211], a[40:43], v[176:179]
ds_read_b64_tr_b16 v[206:207], v229 offset:45568
v_mfma_f32_16x16x32_bf16 v[180:183], v[208:211], a[44:47], v[180:183]
s_waitcnt lgkmcnt(4)
v_mul_f32 v121, 0x3e0293ee, v121
v_mfma_f32_16x16x32_bf16 v[184:187], v[212:215], a[32:35], v[184:187]
ds_read_b64_tr_b16 v[208:209], v230 offset:45056
v_mfma_f32_16x16x32_bf16 v[188:191], v[212:215], a[36:39], v[188:191]
v_mul_f32 v122, 0x3e0293ee, v122
buffer_load_dwordx4 a[16:19], v244, s[16:19], 0 offen offset:1024 sc1
v_mfma_f32_16x16x32_bf16 v[192:195], v[212:215], a[40:43], v[192:195]
ds_read_b64_tr_b16 v[210:211], v230 offset:45568
v_mfma_f32_16x16x32_bf16 v[196:199], v[212:215], a[44:47], v[196:199]
s_waitcnt lgkmcnt(4)
v_mul_f32 v123, 0x3e0293ee, v123
v_mfma_f32_16x16x32_bf16 v[136:139], v[200:203], a[48:51], v[136:139]
ds_read_b64_tr_b16 v[212:213], v231 offset:45056
v_mfma_f32_16x16x32_bf16 v[140:143], v[200:203], a[52:55], v[140:143]
s_waitcnt vmcnt(11)
s_barrier
v_mfma_f32_16x16x32_bf16 v[144:147], v[200:203], a[56:59], v[144:147]
ds_read_b64_tr_b16 v[214:215], v231 offset:45568
s_add_u32 m0, s42, 16384
v_mfma_f32_16x16x32_bf16 v[148:151], v[200:203], a[60:63], v[148:151]
s_waitcnt lgkmcnt(4)
s_add_u32 s65, s47, 3146112
v_mfma_f32_16x16x32_bf16 v[152:155], v[204:207], a[48:51], v[152:155]
ds_read_b64_tr_b16 v[200:201], v228 offset:49152
v_cvt_pk_bf16_f32 v12, v104, v105
v_mfma_f32_16x16x32_bf16 v[156:159], v[204:207], a[52:55], v[156:159]
buffer_load_dwordx4 v236, s[12:15], s65 offen offset:0 lds
v_cvt_pk_bf16_f32 v13, v106, v107
v_mfma_f32_16x16x32_bf16 v[160:163], v[204:207], a[56:59], v[160:163]
ds_read_b64_tr_b16 v[202:203], v228 offset:49664
v_cvt_pk_bf16_f32 v14, v120, v121
v_mfma_f32_16x16x32_bf16 v[164:167], v[204:207], a[60:63], v[164:167]
s_waitcnt lgkmcnt(4)
v_cvt_pk_bf16_f32 v15, v122, v123
v_mfma_f32_16x16x32_bf16 v[168:171], v[208:211], a[48:51], v[168:171]
ds_read_b64_tr_b16 v[204:205], v229 offset:49152
v_mfma_f32_16x16x32_bf16 v[172:175], v[208:211], a[52:55], v[172:175]
buffer_store_dwordx4 v[12:15], v2, s[20:23], s67 offen offset:1024 sc1
v_mfma_f32_16x16x32_bf16 v[176:179], v[208:211], a[56:59], v[176:179]
ds_read_b64_tr_b16 v[206:207], v229 offset:49664
v_mfma_f32_16x16x32_bf16 v[180:183], v[208:211], a[60:63], v[180:183]
s_waitcnt lgkmcnt(4)
v_mfma_f32_16x16x32_bf16 v[184:187], v[212:215], a[48:51], v[184:187]
ds_read_b64_tr_b16 v[208:209], v230 offset:49152
v_mfma_f32_16x16x32_bf16 v[188:191], v[212:215], a[52:55], v[188:191]
buffer_load_dwordx4 a[20:23], v245, s[16:19], 0 offen offset:1024 sc1
v_mfma_f32_16x16x32_bf16 v[192:195], v[212:215], a[56:59], v[192:195]
ds_read_b64_tr_b16 v[210:211], v230 offset:49664
s_add_u32 s67, s50, 1052672
v_mfma_f32_16x16x32_bf16 v[196:199], v[212:215], a[60:63], v[196:199]
s_waitcnt lgkmcnt(4)
v_mul_f32 v76, 0x3e0293ee, v76
v_mfma_f32_16x16x32_bf16 v[136:139], v[200:203], a[64:67], v[136:139]
ds_read_b64_tr_b16 v[212:213], v231 offset:49152
v_mfma_f32_16x16x32_bf16 v[140:143], v[200:203], a[68:71], v[140:143]
buffer_load_dwordx4 v237, s[12:15], s65 offen offset:1024 lds
v_mul_f32 v77, 0x3e0293ee, v77
v_mfma_f32_16x16x32_bf16 v[144:147], v[200:203], a[72:75], v[144:147]
ds_read_b64_tr_b16 v[214:215], v231 offset:49664
v_mfma_f32_16x16x32_bf16 v[148:151], v[200:203], a[76:79], v[148:151]
s_waitcnt lgkmcnt(4)
v_mul_f32 v78, 0x3e0293ee, v78
v_mfma_f32_16x16x32_bf16 v[152:155], v[204:207], a[64:67], v[152:155]
ds_read_b64_tr_b16 v[200:201], v228 offset:53248
v_mfma_f32_16x16x32_bf16 v[156:159], v[204:207], a[68:71], v[156:159]
v_mul_f32 v79, 0x3e0293ee, v79
buffer_load_dwordx4 a[24:27], v246, s[16:19], 0 offen offset:1024 sc1
v_mfma_f32_16x16x32_bf16 v[160:163], v[204:207], a[72:75], v[160:163]
ds_read_b64_tr_b16 v[202:203], v228 offset:53760
v_mul_f32 v92, 0x3e0293ee, v92
v_mfma_f32_16x16x32_bf16 v[164:167], v[204:207], a[76:79], v[164:167]
s_waitcnt lgkmcnt(4)
v_mfma_f32_16x16x32_bf16 v[168:171], v[208:211], a[64:67], v[168:171]
ds_read_b64_tr_b16 v[204:205], v229 offset:53248
v_mul_f32 v93, 0x3e0293ee, v93
v_mfma_f32_16x16x32_bf16 v[172:175], v[208:211], a[68:71], v[172:175]
buffer_load_dwordx4 a[28:31], v247, s[16:19], 0 offen offset:1024 sc1
v_mfma_f32_16x16x32_bf16 v[176:179], v[208:211], a[72:75], v[176:179]
ds_read_b64_tr_b16 v[206:207], v229 offset:53760
v_mul_f32 v94, 0x3e0293ee, v94
v_mfma_f32_16x16x32_bf16 v[180:183], v[208:211], a[76:79], v[180:183]
s_waitcnt lgkmcnt(4)
v_mfma_f32_16x16x32_bf16 v[184:187], v[212:215], a[64:67], v[184:187]
ds_read_b64_tr_b16 v[208:209], v230 offset:53248
v_mul_f32 v95, 0x3e0293ee, v95
v_mfma_f32_16x16x32_bf16 v[188:191], v[212:215], a[68:71], v[188:191]
v_cvt_pk_bf16_f32 v16, v76, v77
buffer_load_dwordx4 a[32:35], v244, s[16:19], 0 offen offset:2048 sc1
v_mfma_f32_16x16x32_bf16 v[192:195], v[212:215], a[72:75], v[192:195]
ds_read_b64_tr_b16 v[210:211], v230 offset:53760
v_mfma_f32_16x16x32_bf16 v[196:199], v[212:215], a[76:79], v[196:199]
s_waitcnt lgkmcnt(4)
v_cvt_pk_bf16_f32 v17, v78, v79
v_mfma_f32_16x16x32_bf16 v[136:139], v[200:203], a[80:83], v[136:139]
ds_read_b64_tr_b16 v[212:213], v231 offset:53248
v_mfma_f32_16x16x32_bf16 v[140:143], v[200:203], a[84:87], v[140:143]
buffer_load_dwordx4 v238, s[12:15], s65 offen offset:2048 lds
v_cvt_pk_bf16_f32 v18, v92, v93
v_mfma_f32_16x16x32_bf16 v[144:147], v[200:203], a[88:91], v[144:147]
ds_read_b64_tr_b16 v[214:215], v231 offset:53760
v_mfma_f32_16x16x32_bf16 v[148:151], v[200:203], a[92:95], v[148:151]
s_waitcnt lgkmcnt(4)
v_cvt_pk_bf16_f32 v19, v94, v95
v_mfma_f32_16x16x32_bf16 v[152:155], v[204:207], a[80:83], v[152:155]
ds_read_b64_tr_b16 v[200:201], v228 offset:57344
v_mfma_f32_16x16x32_bf16 v[156:159], v[204:207], a[84:87], v[156:159]
buffer_store_dwordx4 v[16:19], v2, s[20:23], s67 offen offset:0 sc1
v_mfma_f32_16x16x32_bf16 v[160:163], v[204:207], a[88:91], v[160:163]
ds_read_b64_tr_b16 v[202:203], v228 offset:57856
v_mfma_f32_16x16x32_bf16 v[164:167], v[204:207], a[92:95], v[164:167]
s_waitcnt lgkmcnt(4)
v_mfma_f32_16x16x32_bf16 v[168:171], v[208:211], a[80:83], v[168:171]
ds_read_b64_tr_b16 v[204:205], v229 offset:57344
v_mfma_f32_16x16x32_bf16 v[172:175], v[208:211], a[84:87], v[172:175]
buffer_load_dwordx4 a[36:39], v245, s[16:19], 0 offen offset:2048 sc1
v_mfma_f32_16x16x32_bf16 v[176:179], v[208:211], a[88:91], v[176:179]
ds_read_b64_tr_b16 v[206:207], v229 offset:57856
v_mul_f32 v108, 0x3e0293ee, v108
v_mfma_f32_16x16x32_bf16 v[180:183], v[208:211], a[92:95], v[180:183]
s_waitcnt lgkmcnt(4)
v_mul_f32 v109, 0x3e0293ee, v109
v_mfma_f32_16x16x32_bf16 v[184:187], v[212:215], a[80:83], v[184:187]
ds_read_b64_tr_b16 v[208:209], v230 offset:57344
v_mfma_f32_16x16x32_bf16 v[188:191], v[212:215], a[84:87], v[188:191]
v_mul_f32 v110, 0x3e0293ee, v110
buffer_load_dwordx4 a[40:43], v246, s[16:19], 0 offen offset:2048 sc1
v_mfma_f32_16x16x32_bf16 v[192:195], v[212:215], a[88:91], v[192:195]
ds_read_b64_tr_b16 v[210:211], v230 offset:57856
v_mfma_f32_16x16x32_bf16 v[196:199], v[212:215], a[92:95], v[196:199]
s_waitcnt lgkmcnt(4)
v_mul_f32 v111, 0x3e0293ee, v111
v_mfma_f32_16x16x32_bf16 v[136:139], v[200:203], a[96:99], v[136:139]
ds_read_b64_tr_b16 v[212:213], v231 offset:57344
v_mfma_f32_16x16x32_bf16 v[140:143], v[200:203], a[100:103], v[140:143]
buffer_load_dwordx4 v239, s[12:15], s65 offen offset:3072 lds
v_mul_f32 v124, 0x3e0293ee, v124
v_mfma_f32_16x16x32_bf16 v[144:147], v[200:203], a[104:107], v[144:147]
ds_read_b64_tr_b16 v[214:215], v231 offset:57856
v_mfma_f32_16x16x32_bf16 v[148:151], v[200:203], a[108:111], v[148:151]
s_waitcnt lgkmcnt(4)
v_mul_f32 v125, 0x3e0293ee, v125
v_mfma_f32_16x16x32_bf16 v[152:155], v[204:207], a[96:99], v[152:155]
ds_read_b64_tr_b16 v[200:201], v228 offset:61440
v_mfma_f32_16x16x32_bf16 v[156:159], v[204:207], a[100:103], v[156:159]
v_mul_f32 v126, 0x3e0293ee, v126
buffer_load_dwordx4 a[44:47], v247, s[16:19], 0 offen offset:2048 sc1
v_mfma_f32_16x16x32_bf16 v[160:163], v[204:207], a[104:107], v[160:163]
ds_read_b64_tr_b16 v[202:203], v228 offset:61952
v_mfma_f32_16x16x32_bf16 v[164:167], v[204:207], a[108:111], v[164:167]
s_waitcnt lgkmcnt(4)
v_mul_f32 v127, 0x3e0293ee, v127
v_mfma_f32_16x16x32_bf16 v[168:171], v[208:211], a[96:99], v[168:171]
ds_read_b64_tr_b16 v[204:205], v229 offset:61440
v_mfma_f32_16x16x32_bf16 v[172:175], v[208:211], a[100:103], v[172:175]
v_cvt_pk_bf16_f32 v20, v108, v109
buffer_load_dwordx4 a[48:51], v244, s[16:19], 0 offen offset:3072 sc1
v_mfma_f32_16x16x32_bf16 v[176:179], v[208:211], a[104:107], v[176:179]
ds_read_b64_tr_b16 v[206:207], v229 offset:61952
v_mfma_f32_16x16x32_bf16 v[180:183], v[208:211], a[108:111], v[180:183]
s_waitcnt lgkmcnt(4)
v_cvt_pk_bf16_f32 v21, v110, v111
v_mfma_f32_16x16x32_bf16 v[184:187], v[212:215], a[96:99], v[184:187]
ds_read_b64_tr_b16 v[208:209], v230 offset:61440
v_mfma_f32_16x16x32_bf16 v[188:191], v[212:215], a[100:103], v[188:191]
v_cvt_pk_bf16_f32 v22, v124, v125
buffer_load_dwordx4 a[52:55], v245, s[16:19], 0 offen offset:3072 sc1
v_mfma_f32_16x16x32_bf16 v[192:195], v[212:215], a[104:107], v[192:195]
ds_read_b64_tr_b16 v[210:211], v230 offset:61952
v_mfma_f32_16x16x32_bf16 v[196:199], v[212:215], a[108:111], v[196:199]
s_waitcnt lgkmcnt(4)
v_cvt_pk_bf16_f32 v23, v126, v127
v_mfma_f32_16x16x32_bf16 v[136:139], v[200:203], a[112:115], v[136:139]
ds_read_b64_tr_b16 v[212:213], v231 offset:61440
v_mfma_f32_16x16x32_bf16 v[140:143], v[200:203], a[116:119], v[140:143]
s_waitcnt vmcnt(18)
s_barrier
v_mfma_f32_16x16x32_bf16 v[144:147], v[200:203], a[120:123], v[144:147]
ds_read_b64_tr_b16 v[214:215], v231 offset:61952
s_add_u32 m0, s42, 32768
v_mfma_f32_16x16x32_bf16 v[148:151], v[200:203], a[124:127], v[148:151]
s_waitcnt lgkmcnt(4)
s_add_u32 s65, s51, 0
v_mfma_f32_16x16x32_bf16 v[152:155], v[204:207], a[112:115], v[152:155]
ds_read_b64_tr_b16 v[200:201], v228 offset:0
v_mfma_f32_16x16x32_bf16 v[156:159], v[204:207], a[116:119], v[156:159]
buffer_load_dwordx4 v236, s[4:7], s65 offen offset:0 lds
v_mfma_f32_16x16x32_bf16 v[160:163], v[204:207], a[120:123], v[160:163]
ds_read_b64_tr_b16 v[202:203], v228 offset:512
v_mfma_f32_16x16x32_bf16 v[164:167], v[204:207], a[124:127], v[164:167]
s_waitcnt lgkmcnt(4)
v_mfma_f32_16x16x32_bf16 v[168:171], v[208:211], a[112:115], v[168:171]
ds_read_b64_tr_b16 v[204:205], v229 offset:0
v_mfma_f32_16x16x32_bf16 v[172:175], v[208:211], a[116:119], v[172:175]
buffer_store_dwordx4 v[20:23], v2, s[20:23], s67 offen offset:1024 sc1
s_add_u32 s67, s50, 1064960
v_mfma_f32_16x16x32_bf16 v[176:179], v[208:211], a[120:123], v[176:179]
ds_read_b64_tr_b16 v[206:207], v229 offset:512
v_mul_f32 v80, 0x3e0293ee, v80
v_mfma_f32_16x16x32_bf16 v[180:183], v[208:211], a[124:127], v[180:183]
s_waitcnt lgkmcnt(4)
v_mfma_f32_16x16x32_bf16 v[184:187], v[212:215], a[112:115], v[184:187]
ds_read_b64_tr_b16 v[208:209], v230 offset:0
v_mul_f32 v81, 0x3e0293ee, v81
v_mfma_f32_16x16x32_bf16 v[188:191], v[212:215], a[116:119], v[188:191]
buffer_load_dwordx4 a[56:59], v246, s[16:19], 0 offen offset:3072 sc1
v_mfma_f32_16x16x32_bf16 v[192:195], v[212:215], a[120:123], v[192:195]
ds_read_b64_tr_b16 v[210:211], v230 offset:512
v_mul_f32 v82, 0x3e0293ee, v82
v_mfma_f32_16x16x32_bf16 v[196:199], v[212:215], a[124:127], v[196:199]
s_waitcnt lgkmcnt(4)
v_mfma_f32_16x16x32_bf16 v[136:139], v[200:203], a[128:131], v[136:139]
ds_read_b64_tr_b16 v[212:213], v231 offset:0
v_mul_f32 v83, 0x3e0293ee, v83
v_mfma_f32_16x16x32_bf16 v[140:143], v[200:203], a[132:135], v[140:143]
buffer_load_dwordx4 v237, s[4:7], s65 offen offset:1024 lds
v_mul_f32 v96, 0x3e0293ee, v96
v_mfma_f32_16x16x32_bf16 v[144:147], v[200:203], a[136:139], v[144:147]
ds_read_b64_tr_b16 v[214:215], v231 offset:512
v_mfma_f32_16x16x32_bf16 v[148:151], v[200:203], a[140:143], v[148:151]
s_waitcnt lgkmcnt(4)
v_mul_f32 v97, 0x3e0293ee, v97
v_mfma_f32_16x16x32_bf16 v[152:155], v[204:207], a[128:131], v[152:155]
ds_read_b64_tr_b16 v[200:201], v228 offset:4096
v_mfma_f32_16x16x32_bf16 v[156:159], v[204:207], a[132:135], v[156:159]
v_mul_f32 v98, 0x3e0293ee, v98
buffer_load_dwordx4 a[60:63], v247, s[16:19], 0 offen offset:3072 sc1
v_mfma_f32_16x16x32_bf16 v[160:163], v[204:207], a[136:139], v[160:163]
ds_read_b64_tr_b16 v[202:203], v228 offset:4608
v_mfma_f32_16x16x32_bf16 v[164:167], v[204:207], a[140:143], v[164:167]
s_waitcnt lgkmcnt(4)
v_mul_f32 v99, 0x3e0293ee, v99
v_mfma_f32_16x16x32_bf16 v[168:171], v[208:211], a[128:131], v[168:171]
ds_read_b64_tr_b16 v[204:205], v229 offset:4096
s_mov_b32 s12, s90
v_mfma_f32_16x16x32_bf16 v[172:175], v[208:211], a[132:135], v[172:175]
s_mov_b32 s13, s91
s_mov_b32 s14, 0x158000
buffer_load_dwordx4 a[64:67], v244, s[16:19], s56 offen offset:0 sc1
v_mfma_f32_16x16x32_bf16 v[176:179], v[208:211], a[136:139], v[176:179]
ds_read_b64_tr_b16 v[206:207], v229 offset:4608
s_mov_b32 s15, 0x20000
v_mfma_f32_16x16x32_bf16 v[180:183], v[208:211], a[140:143], v[180:183]
s_waitcnt lgkmcnt(4)
v_cvt_pk_bf16_f32 v8, v80, v81
v_mfma_f32_16x16x32_bf16 v[184:187], v[212:215], a[128:131], v[184:187]
ds_read_b64_tr_b16 v[208:209], v230 offset:4096
v_cvt_pk_bf16_f32 v9, v82, v83
v_mfma_f32_16x16x32_bf16 v[188:191], v[212:215], a[132:135], v[188:191]
v_cvt_pk_bf16_f32 v10, v96, v97
buffer_load_dwordx4 a[68:71], v245, s[16:19], s56 offen offset:0 sc1
v_mfma_f32_16x16x32_bf16 v[192:195], v[212:215], a[136:139], v[192:195]
ds_read_b64_tr_b16 v[210:211], v230 offset:4608
v_cvt_pk_bf16_f32 v11, v98, v99
v_mfma_f32_16x16x32_bf16 v[196:199], v[212:215], a[140:143], v[196:199]
s_waitcnt lgkmcnt(4)
v_mfma_f32_16x16x32_bf16 v[136:139], v[200:203], a[144:147], v[136:139]
ds_read_b64_tr_b16 v[212:213], v231 offset:4096
v_mfma_f32_16x16x32_bf16 v[140:143], v[200:203], a[148:151], v[140:143]
buffer_load_dwordx4 v238, s[4:7], s65 offen offset:2048 lds
v_mfma_f32_16x16x32_bf16 v[144:147], v[200:203], a[152:155], v[144:147]
ds_read_b64_tr_b16 v[214:215], v231 offset:4608
v_mfma_f32_16x16x32_bf16 v[148:151], v[200:203], a[156:159], v[148:151]
s_waitcnt lgkmcnt(4)
v_mfma_f32_16x16x32_bf16 v[152:155], v[204:207], a[144:147], v[152:155]
ds_read_b64_tr_b16 v[200:201], v228 offset:8192
v_mfma_f32_16x16x32_bf16 v[156:159], v[204:207], a[148:151], v[156:159]
buffer_store_dwordx4 v[8:11], v2, s[20:23], s67 offen offset:0 sc1
v_mul_f32 v112, 0x3e0293ee, v112
v_mfma_f32_16x16x32_bf16 v[160:163], v[204:207], a[152:155], v[160:163]
ds_read_b64_tr_b16 v[202:203], v228 offset:8704
v_mul_f32 v113, 0x3e0293ee, v113
v_mfma_f32_16x16x32_bf16 v[164:167], v[204:207], a[156:159], v[164:167]
s_waitcnt lgkmcnt(4)
v_mfma_f32_16x16x32_bf16 v[168:171], v[208:211], a[144:147], v[168:171]
ds_read_b64_tr_b16 v[204:205], v229 offset:8192
v_mul_f32 v114, 0x3e0293ee, v114
v_mfma_f32_16x16x32_bf16 v[172:175], v[208:211], a[148:151], v[172:175]
buffer_load_dwordx4 a[72:75], v246, s[16:19], s56 offen offset:0 sc1
v_mfma_f32_16x16x32_bf16 v[176:179], v[208:211], a[152:155], v[176:179]
ds_read_b64_tr_b16 v[206:207], v229 offset:8704
v_mul_f32 v115, 0x3e0293ee, v115
v_mfma_f32_16x16x32_bf16 v[180:183], v[208:211], a[156:159], v[180:183]
s_waitcnt lgkmcnt(4)
v_mfma_f32_16x16x32_bf16 v[184:187], v[212:215], a[144:147], v[184:187]
ds_read_b64_tr_b16 v[208:209], v230 offset:8192
v_mul_f32 v128, 0x3e0293ee, v128
v_mfma_f32_16x16x32_bf16 v[188:191], v[212:215], a[148:151], v[188:191]
buffer_load_dwordx4 a[76:79], v247, s[16:19], s56 offen offset:0 sc1
v_mfma_f32_16x16x32_bf16 v[192:195], v[212:215], a[152:155], v[192:195]
ds_read_b64_tr_b16 v[210:211], v230 offset:8704
v_mul_f32 v129, 0x3e0293ee, v129
v_mfma_f32_16x16x32_bf16 v[196:199], v[212:215], a[156:159], v[196:199]
s_waitcnt lgkmcnt(4)
v_mfma_f32_16x16x32_bf16 v[136:139], v[200:203], a[160:163], v[136:139]
ds_read_b64_tr_b16 v[212:213], v231 offset:8192
v_mul_f32 v130, 0x3e0293ee, v130
v_mfma_f32_16x16x32_bf16 v[140:143], v[200:203], a[164:167], v[140:143]
buffer_load_dwordx4 v239, s[4:7], s65 offen offset:3072 lds
v_mfma_f32_16x16x32_bf16 v[144:147], v[200:203], a[168:171], v[144:147]
ds_read_b64_tr_b16 v[214:215], v231 offset:8704
v_mul_f32 v131, 0x3e0293ee, v131
v_mfma_f32_16x16x32_bf16 v[148:151], v[200:203], a[172:175], v[148:151]
s_waitcnt lgkmcnt(4)
v_mfma_f32_16x16x32_bf16 v[152:155], v[204:207], a[160:163], v[152:155]
ds_read_b64_tr_b16 v[200:201], v228 offset:12288
v_cvt_pk_bf16_f32 v12, v112, v113
v_mfma_f32_16x16x32_bf16 v[156:159], v[204:207], a[164:167], v[156:159]
buffer_load_dwordx4 a[80:83], v244, s[16:19], s56 offen offset:1024 sc1
v_mfma_f32_16x16x32_bf16 v[160:163], v[204:207], a[168:171], v[160:163]
ds_read_b64_tr_b16 v[202:203], v228 offset:12800
v_cvt_pk_bf16_f32 v13, v114, v115
v_mfma_f32_16x16x32_bf16 v[164:167], v[204:207], a[172:175], v[164:167]
s_waitcnt lgkmcnt(4)
v_mfma_f32_16x16x32_bf16 v[168:171], v[208:211], a[160:163], v[168:171]
ds_read_b64_tr_b16 v[204:205], v229 offset:12288
v_cvt_pk_bf16_f32 v14, v128, v129
v_mfma_f32_16x16x32_bf16 v[172:175], v[208:211], a[164:167], v[172:175]
buffer_load_dwordx4 a[84:87], v245, s[16:19], s56 offen offset:1024 sc1
v_mfma_f32_16x16x32_bf16 v[176:179], v[208:211], a[168:171], v[176:179]
ds_read_b64_tr_b16 v[206:207], v229 offset:12800
v_cvt_pk_bf16_f32 v15, v130, v131
v_mfma_f32_16x16x32_bf16 v[180:183], v[208:211], a[172:175], v[180:183]
s_waitcnt lgkmcnt(4)
v_mfma_f32_16x16x32_bf16 v[184:187], v[212:215], a[160:163], v[184:187]
ds_read_b64_tr_b16 v[208:209], v230 offset:12288
v_mfma_f32_16x16x32_bf16 v[188:191], v[212:215], a[164:167], v[188:191]
buffer_store_dwordx4 v[12:15], v2, s[20:23], s67 offen offset:1024 sc1
v_mfma_f32_16x16x32_bf16 v[192:195], v[212:215], a[168:171], v[192:195]
ds_read_b64_tr_b16 v[210:211], v230 offset:12800
s_add_u32 s67, s50, 1069056
v_mfma_f32_16x16x32_bf16 v[196:199], v[212:215], a[172:175], v[196:199]
s_waitcnt lgkmcnt(4)
v_mul_f32 v84, 0x3e0293ee, v84
v_mfma_f32_16x16x32_bf16 v[136:139], v[200:203], a[176:179], v[136:139]
ds_read_b64_tr_b16 v[212:213], v231 offset:12288
v_mfma_f32_16x16x32_bf16 v[140:143], v[200:203], a[180:183], v[140:143]
s_waitcnt vmcnt(18)
s_barrier
v_mfma_f32_16x16x32_bf16 v[144:147], v[200:203], a[184:187], v[144:147]
ds_read_b64_tr_b16 v[214:215], v231 offset:12800
s_add_u32 m0, s42, 49152
v_mfma_f32_16x16x32_bf16 v[148:151], v[200:203], a[188:191], v[148:151]
s_waitcnt lgkmcnt(4)
s_add_u32 s65, s51, 1048576
v_mfma_f32_16x16x32_bf16 v[152:155], v[204:207], a[176:179], v[152:155]
ds_read_b64_tr_b16 v[200:201], v228 offset:16384
v_mul_f32 v85, 0x3e0293ee, v85
v_mfma_f32_16x16x32_bf16 v[156:159], v[204:207], a[180:183], v[156:159]
buffer_load_dwordx4 v236, s[4:7], s65 offen offset:0 lds
v_mul_f32 v86, 0x3e0293ee, v86
v_mfma_f32_16x16x32_bf16 v[160:163], v[204:207], a[184:187], v[160:163]
ds_read_b64_tr_b16 v[202:203], v228 offset:16896
v_mul_f32 v87, 0x3e0293ee, v87
v_mfma_f32_16x16x32_bf16 v[164:167], v[204:207], a[188:191], v[164:167]
s_waitcnt lgkmcnt(4)
v_mul_f32 v100, 0x3e0293ee, v100
v_mfma_f32_16x16x32_bf16 v[168:171], v[208:211], a[176:179], v[168:171]
ds_read_b64_tr_b16 v[204:205], v229 offset:16384
v_mul_f32 v101, 0x3e0293ee, v101
v_mfma_f32_16x16x32_bf16 v[172:175], v[208:211], a[180:183], v[172:175]
buffer_load_dwordx4 a[88:91], v246, s[16:19], s56 offen offset:1024 sc1
v_mfma_f32_16x16x32_bf16 v[176:179], v[208:211], a[184:187], v[176:179]
ds_read_b64_tr_b16 v[206:207], v229 offset:16896
v_mul_f32 v102, 0x3e0293ee, v102
v_mfma_f32_16x16x32_bf16 v[180:183], v[208:211], a[188:191], v[180:183]
s_waitcnt lgkmcnt(4)
v_mfma_f32_16x16x32_bf16 v[184:187], v[212:215], a[176:179], v[184:187]
ds_read_b64_tr_b16 v[208:209], v230 offset:16384
v_mul_f32 v103, 0x3e0293ee, v103
v_mfma_f32_16x16x32_bf16 v[188:191], v[212:215], a[180:183], v[188:191]
v_cvt_pk_bf16_f32 v16, v84, v85
buffer_load_dwordx4 a[92:95], v247, s[16:19], s56 offen offset:1024 sc1
v_mfma_f32_16x16x32_bf16 v[192:195], v[212:215], a[184:187], v[192:195]
ds_read_b64_tr_b16 v[210:211], v230 offset:16896
v_mfma_f32_16x16x32_bf16 v[196:199], v[212:215], a[188:191], v[196:199]
s_waitcnt lgkmcnt(4)
v_cvt_pk_bf16_f32 v17, v86, v87
v_mfma_f32_16x16x32_bf16 v[136:139], v[200:203], a[192:195], v[136:139]
ds_read_b64_tr_b16 v[212:213], v231 offset:16384
v_mfma_f32_16x16x32_bf16 v[140:143], v[200:203], a[196:199], v[140:143]
buffer_load_dwordx4 v237, s[4:7], s65 offen offset:1024 lds
v_cvt_pk_bf16_f32 v18, v100, v101
v_mfma_f32_16x16x32_bf16 v[144:147], v[200:203], a[200:203], v[144:147]
ds_read_b64_tr_b16 v[214:215], v231 offset:16896
v_mfma_f32_16x16x32_bf16 v[148:151], v[200:203], a[204:207], v[148:151]
s_waitcnt lgkmcnt(4)
v_cvt_pk_bf16_f32 v19, v102, v103
v_mfma_f32_16x16x32_bf16 v[152:155], v[204:207], a[192:195], v[152:155]
ds_read_b64_tr_b16 v[200:201], v228 offset:20480
v_mfma_f32_16x16x32_bf16 v[156:159], v[204:207], a[196:199], v[156:159]
buffer_store_dwordx4 v[16:19], v2, s[20:23], s67 offen offset:0 sc1
v_mfma_f32_16x16x32_bf16 v[160:163], v[204:207], a[200:203], v[160:163]
ds_read_b64_tr_b16 v[202:203], v228 offset:20992
v_mfma_f32_16x16x32_bf16 v[164:167], v[204:207], a[204:207], v[164:167]
s_waitcnt lgkmcnt(4)
v_mfma_f32_16x16x32_bf16 v[168:171], v[208:211], a[192:195], v[168:171]
ds_read_b64_tr_b16 v[204:205], v229 offset:20480
v_mfma_f32_16x16x32_bf16 v[172:175], v[208:211], a[196:199], v[172:175]
buffer_load_dwordx4 a[96:99], v244, s[16:19], s56 offen offset:2048 sc1
v_mfma_f32_16x16x32_bf16 v[176:179], v[208:211], a[200:203], v[176:179]
ds_read_b64_tr_b16 v[206:207], v229 offset:20992
v_mul_f32 v116, 0x3e0293ee, v116
v_mfma_f32_16x16x32_bf16 v[180:183], v[208:211], a[204:207], v[180:183]
s_waitcnt lgkmcnt(4)
v_mul_f32 v117, 0x3e0293ee, v117
v_mfma_f32_16x16x32_bf16 v[184:187], v[212:215], a[192:195], v[184:187]
ds_read_b64_tr_b16 v[208:209], v230 offset:20480
v_mfma_f32_16x16x32_bf16 v[188:191], v[212:215], a[196:199], v[188:191]
v_mul_f32 v118, 0x3e0293ee, v118
buffer_load_dwordx4 a[100:103], v245, s[16:19], s56 offen offset:2048 sc1
v_mfma_f32_16x16x32_bf16 v[192:195], v[212:215], a[200:203], v[192:195]
ds_read_b64_tr_b16 v[210:211], v230 offset:20992
v_mfma_f32_16x16x32_bf16 v[196:199], v[212:215], a[204:207], v[196:199]
s_waitcnt lgkmcnt(4)
v_mul_f32 v119, 0x3e0293ee, v119
v_mfma_f32_16x16x32_bf16 v[136:139], v[200:203], a[208:211], v[136:139]
ds_read_b64_tr_b16 v[212:213], v231 offset:20480
v_mfma_f32_16x16x32_bf16 v[140:143], v[200:203], a[212:215], v[140:143]
buffer_load_dwordx4 v238, s[4:7], s65 offen offset:2048 lds
v_mul_f32 v132, 0x3e0293ee, v132
v_mfma_f32_16x16x32_bf16 v[144:147], v[200:203], a[216:219], v[144:147]
ds_read_b64_tr_b16 v[214:215], v231 offset:20992
v_mfma_f32_16x16x32_bf16 v[148:151], v[200:203], a[220:223], v[148:151]
s_waitcnt lgkmcnt(4)
v_mul_f32 v133, 0x3e0293ee, v133
v_mfma_f32_16x16x32_bf16 v[152:155], v[204:207], a[208:211], v[152:155]
ds_read_b64_tr_b16 v[200:201], v228 offset:24576
v_mfma_f32_16x16x32_bf16 v[156:159], v[204:207], a[212:215], v[156:159]
v_mul_f32 v134, 0x3e0293ee, v134
buffer_load_dwordx4 a[104:107], v246, s[16:19], s56 offen offset:2048 sc1
v_mfma_f32_16x16x32_bf16 v[160:163], v[204:207], a[216:219], v[160:163]
ds_read_b64_tr_b16 v[202:203], v228 offset:25088
v_mfma_f32_16x16x32_bf16 v[164:167], v[204:207], a[220:223], v[164:167]
s_waitcnt lgkmcnt(4)
v_mul_f32 v135, 0x3e0293ee, v135
v_mfma_f32_16x16x32_bf16 v[168:171], v[208:211], a[208:211], v[168:171]
ds_read_b64_tr_b16 v[204:205], v229 offset:24576
v_mfma_f32_16x16x32_bf16 v[172:175], v[208:211], a[212:215], v[172:175]
v_cvt_pk_bf16_f32 v20, v116, v117
buffer_load_dwordx4 a[108:111], v247, s[16:19], s56 offen offset:2048 sc1
v_mfma_f32_16x16x32_bf16 v[176:179], v[208:211], a[216:219], v[176:179]
ds_read_b64_tr_b16 v[206:207], v229 offset:25088
v_mfma_f32_16x16x32_bf16 v[180:183], v[208:211], a[220:223], v[180:183]
s_waitcnt lgkmcnt(4)
v_cvt_pk_bf16_f32 v21, v118, v119
v_mfma_f32_16x16x32_bf16 v[184:187], v[212:215], a[208:211], v[184:187]
ds_read_b64_tr_b16 v[208:209], v230 offset:24576
v_mfma_f32_16x16x32_bf16 v[188:191], v[212:215], a[212:215], v[188:191]
v_cvt_pk_bf16_f32 v22, v132, v133
buffer_load_dwordx4 a[112:115], v244, s[16:19], s56 offen offset:3072 sc1
v_mfma_f32_16x16x32_bf16 v[192:195], v[212:215], a[216:219], v[192:195]
ds_read_b64_tr_b16 v[210:211], v230 offset:25088
v_mfma_f32_16x16x32_bf16 v[196:199], v[212:215], a[220:223], v[196:199]
s_waitcnt lgkmcnt(4)
v_cvt_pk_bf16_f32 v23, v134, v135
v_mfma_f32_16x16x32_bf16 v[136:139], v[200:203], a[224:227], v[136:139]
ds_read_b64_tr_b16 v[212:213], v231 offset:24576
v_mfma_f32_16x16x32_bf16 v[140:143], v[200:203], a[228:231], v[140:143]
buffer_load_dwordx4 v239, s[4:7], s65 offen offset:3072 lds
v_mfma_f32_16x16x32_bf16 v[144:147], v[200:203], a[232:235], v[144:147]
ds_read_b64_tr_b16 v[214:215], v231 offset:25088
v_mfma_f32_16x16x32_bf16 v[148:151], v[200:203], a[236:239], v[148:151]
s_waitcnt lgkmcnt(4)
v_mfma_f32_16x16x32_bf16 v[152:155], v[204:207], a[224:227], v[152:155]
ds_read_b64_tr_b16 v[200:201], v228 offset:28672
v_mfma_f32_16x16x32_bf16 v[156:159], v[204:207], a[228:231], v[156:159]
buffer_store_dwordx4 v[20:23], v2, s[20:23], s67 offen offset:1024 sc1
v_mfma_f32_16x16x32_bf16 v[160:163], v[204:207], a[232:235], v[160:163]
ds_read_b64_tr_b16 v[202:203], v228 offset:29184
v_mfma_f32_16x16x32_bf16 v[164:167], v[204:207], a[236:239], v[164:167]
s_waitcnt lgkmcnt(4)
v_mfma_f32_16x16x32_bf16 v[168:171], v[208:211], a[224:227], v[168:171]
ds_read_b64_tr_b16 v[204:205], v229 offset:28672
v_mfma_f32_16x16x32_bf16 v[172:175], v[208:211], a[228:231], v[172:175]
buffer_load_dwordx4 a[116:119], v245, s[16:19], s56 offen offset:3072 sc1
v_mfma_f32_16x16x32_bf16 v[176:179], v[208:211], a[232:235], v[176:179]
ds_read_b64_tr_b16 v[206:207], v229 offset:29184
v_mfma_f32_16x16x32_bf16 v[180:183], v[208:211], a[236:239], v[180:183]
s_waitcnt lgkmcnt(4)
v_mfma_f32_16x16x32_bf16 v[184:187], v[212:215], a[224:227], v[184:187]
ds_read_b64_tr_b16 v[208:209], v230 offset:28672
v_mfma_f32_16x16x32_bf16 v[188:191], v[212:215], a[228:231], v[188:191]
buffer_load_dwordx4 a[120:123], v246, s[16:19], s56 offen offset:3072 sc1
v_mfma_f32_16x16x32_bf16 v[192:195], v[212:215], a[232:235], v[192:195]
ds_read_b64_tr_b16 v[210:211], v230 offset:29184
v_mfma_f32_16x16x32_bf16 v[196:199], v[212:215], a[236:239], v[196:199]
s_waitcnt lgkmcnt(4)
v_mfma_f32_16x16x32_bf16 v[136:139], v[200:203], a[240:243], v[136:139]
ds_read_b64_tr_b16 v[212:213], v231 offset:28672
v_mfma_f32_16x16x32_bf16 v[140:143], v[200:203], a[244:247], v[140:143]
s_waitcnt vmcnt(18)
s_barrier
v_mfma_f32_16x16x32_bf16 v[144:147], v[200:203], a[248:251], v[144:147]
ds_read_b64_tr_b16 v[214:215], v231 offset:29184
s_add_u32 m0, s42, 0
v_mfma_f32_16x16x32_bf16 v[148:151], v[200:203], a[252:255], v[148:151]
s_waitcnt lgkmcnt(4)
s_add_u32 s65, s51, 2097152
v_mfma_f32_16x16x32_bf16 v[152:155], v[204:207], a[240:243], v[152:155]
ds_read_b64_tr_b16 v[200:201], v228 offset:32768
v_mfma_f32_16x16x32_bf16 v[156:159], v[204:207], a[244:247], v[156:159]
buffer_load_dwordx4 v236, s[4:7], s65 offen offset:0 lds
v_mfma_f32_16x16x32_bf16 v[160:163], v[204:207], a[248:251], v[160:163]
ds_read_b64_tr_b16 v[202:203], v228 offset:33280
v_mfma_f32_16x16x32_bf16 v[164:167], v[204:207], a[252:255], v[164:167]
s_waitcnt lgkmcnt(4)
v_mfma_f32_16x16x32_bf16 v[168:171], v[208:211], a[240:243], v[168:171]
ds_read_b64_tr_b16 v[204:205], v229 offset:32768
v_mfma_f32_16x16x32_bf16 v[172:175], v[208:211], a[244:247], v[172:175]
buffer_load_dwordx4 a[124:127], v247, s[16:19], s56 offen offset:3072 sc1
v_mfma_f32_16x16x32_bf16 v[176:179], v[208:211], a[248:251], v[176:179]
ds_read_b64_tr_b16 v[206:207], v229 offset:33280
v_mfma_f32_16x16x32_bf16 v[180:183], v[208:211], a[252:255], v[180:183]
s_waitcnt lgkmcnt(4)
v_mfma_f32_16x16x32_bf16 v[184:187], v[212:215], a[240:243], v[184:187]
ds_read_b64_tr_b16 v[208:209], v230 offset:32768
v_mfma_f32_16x16x32_bf16 v[188:191], v[212:215], a[244:247], v[188:191]
buffer_load_dwordx4 a[128:131], v244, s[16:19], s57 offen offset:0 sc1
v_mfma_f32_16x16x32_bf16 v[192:195], v[212:215], a[248:251], v[192:195]
ds_read_b64_tr_b16 v[210:211], v230 offset:33280
v_mfma_f32_16x16x32_bf16 v[196:199], v[212:215], a[252:255], v[196:199]
s_waitcnt lgkmcnt(4)
v_mfma_f32_16x16x32_bf16 v[72:75], v[200:203], a[0:3], 0
ds_read_b64_tr_b16 v[212:213], v231 offset:32768
v_mfma_f32_16x16x32_bf16 v[76:79], v[200:203], a[4:7], 0
buffer_load_dwordx4 v237, s[4:7], s65 offen offset:1024 lds
v_mfma_f32_16x16x32_bf16 v[80:83], v[200:203], a[8:11], 0
ds_read_b64_tr_b16 v[214:215], v231 offset:33280
v_mfma_f32_16x16x32_bf16 v[84:87], v[200:203], a[12:15], 0
s_waitcnt lgkmcnt(4)
v_mfma_f32_16x16x32_bf16 v[88:91], v[204:207], a[0:3], 0
ds_read_b64_tr_b16 v[200:201], v228 offset:36864
v_mfma_f32_16x16x32_bf16 v[92:95], v[204:207], a[4:7], 0
buffer_load_dwordx4 a[132:135], v245, s[16:19], s57 offen offset:0 sc1
v_mfma_f32_16x16x32_bf16 v[96:99], v[204:207], a[8:11], 0
ds_read_b64_tr_b16 v[202:203], v228 offset:37376
s_add_u32 s67, s50, 1048576
v_mfma_f32_16x16x32_bf16 v[100:103], v[204:207], a[12:15], 0
s_waitcnt lgkmcnt(4)
v_mul_f32 v136, 0x3e0293ee, v136
v_mfma_f32_16x16x32_bf16 v[104:107], v[208:211], a[0:3], 0
ds_read_b64_tr_b16 v[204:205], v229 offset:36864
v_mfma_f32_16x16x32_bf16 v[108:111], v[208:211], a[4:7], 0
v_mul_f32 v137, 0x3e0293ee, v137
buffer_load_dwordx4 a[136:139], v246, s[16:19], s57 offen offset:0 sc1
v_mfma_f32_16x16x32_bf16 v[112:115], v[208:211], a[8:11], 0
ds_read_b64_tr_b16 v[206:207], v229 offset:37376
v_mfma_f32_16x16x32_bf16 v[116:119], v[208:211], a[12:15], 0
s_waitcnt lgkmcnt(4)
v_mul_f32 v138, 0x3e0293ee, v138
v_mfma_f32_16x16x32_bf16 v[120:123], v[212:215], a[0:3], 0
ds_read_b64_tr_b16 v[208:209], v230 offset:36864
v_mfma_f32_16x16x32_bf16 v[124:127], v[212:215], a[4:7], 0
v_mul_f32 v139, 0x3e0293ee, v139
buffer_load_dwordx4 a[140:143], v247, s[16:19], s57 offen offset:0 sc1
v_mfma_f32_16x16x32_bf16 v[128:131], v[212:215], a[8:11], 0
ds_read_b64_tr_b16 v[210:211], v230 offset:37376
v_mul_f32 v152, 0x3e0293ee, v152
v_mfma_f32_16x16x32_bf16 v[132:135], v[212:215], a[12:15], 0
s_waitcnt lgkmcnt(4)
v_mfma_f32_16x16x32_bf16 v[72:75], v[200:203], a[16:19], v[72:75]
ds_read_b64_tr_b16 v[212:213], v231 offset:36864
v_mul_f32 v153, 0x3e0293ee, v153
v_mfma_f32_16x16x32_bf16 v[76:79], v[200:203], a[20:23], v[76:79]
buffer_load_dwordx4 v238, s[4:7], s65 offen offset:2048 lds
v_mfma_f32_16x16x32_bf16 v[80:83], v[200:203], a[24:27], v[80:83]
ds_read_b64_tr_b16 v[214:215], v231 offset:37376
v_mul_f32 v154, 0x3e0293ee, v154
v_mfma_f32_16x16x32_bf16 v[84:87], v[200:203], a[28:31], v[84:87]
s_waitcnt lgkmcnt(4)
v_mfma_f32_16x16x32_bf16 v[88:91], v[204:207], a[16:19], v[88:91]
ds_read_b64_tr_b16 v[200:201], v228 offset:40960
v_mul_f32 v155, 0x3e0293ee, v155
v_mfma_f32_16x16x32_bf16 v[92:95], v[204:207], a[20:23], v[92:95]
v_cvt_pk_bf16_f32 v8, v136, v137
buffer_load_dwordx4 a[144:147], v244, s[16:19], s57 offen offset:1024 sc1
v_mfma_f32_16x16x32_bf16 v[96:99], v[204:207], a[24:27], v[96:99]
ds_read_b64_tr_b16 v[202:203], v228 offset:41472
v_mfma_f32_16x16x32_bf16 v[100:103], v[204:207], a[28:31], v[100:103]
s_waitcnt lgkmcnt(4)
v_cvt_pk_bf16_f32 v9, v138, v139
v_mfma_f32_16x16x32_bf16 v[104:107], v[208:211], a[16:19], v[104:107]
ds_read_b64_tr_b16 v[204:205], v229 offset:40960
v_mfma_f32_16x16x32_bf16 v[108:111], v[208:211], a[20:23], v[108:111]
v_cvt_pk_bf16_f32 v10, v152, v153
buffer_load_dwordx4 a[148:151], v245, s[16:19], s57 offen offset:1024 sc1
v_mfma_f32_16x16x32_bf16 v[112:115], v[208:211], a[24:27], v[112:115]
ds_read_b64_tr_b16 v[206:207], v229 offset:41472
v_mfma_f32_16x16x32_bf16 v[116:119], v[208:211], a[28:31], v[116:119]
s_waitcnt lgkmcnt(4)
v_cvt_pk_bf16_f32 v11, v154, v155
v_mfma_f32_16x16x32_bf16 v[120:123], v[212:215], a[16:19], v[120:123]
ds_read_b64_tr_b16 v[208:209], v230 offset:40960
v_mfma_f32_16x16x32_bf16 v[124:127], v[212:215], a[20:23], v[124:127]
buffer_store_dwordx4 v[8:11], v2, s[20:23], s67 offen offset:2048 sc1
v_mfma_f32_16x16x32_bf16 v[128:131], v[212:215], a[24:27], v[128:131]
ds_read_b64_tr_b16 v[210:211], v230 offset:41472
v_mfma_f32_16x16x32_bf16 v[132:135], v[212:215], a[28:31], v[132:135]
s_waitcnt lgkmcnt(4)
v_mfma_f32_16x16x32_bf16 v[72:75], v[200:203], a[32:35], v[72:75]
ds_read_b64_tr_b16 v[212:213], v231 offset:40960
v_mfma_f32_16x16x32_bf16 v[76:79], v[200:203], a[36:39], v[76:79]
buffer_load_dwordx4 v239, s[4:7], s65 offen offset:3072 lds
v_mfma_f32_16x16x32_bf16 v[80:83], v[200:203], a[40:43], v[80:83]
ds_read_b64_tr_b16 v[214:215], v231 offset:41472
v_mul_f32 v168, 0x3e0293ee, v168
v_mfma_f32_16x16x32_bf16 v[84:87], v[200:203], a[44:47], v[84:87]
s_waitcnt lgkmcnt(4)
v_mul_f32 v169, 0x3e0293ee, v169
v_mfma_f32_16x16x32_bf16 v[88:91], v[204:207], a[32:35], v[88:91]
ds_read_b64_tr_b16 v[200:201], v228 offset:45056
v_mfma_f32_16x16x32_bf16 v[92:95], v[204:207], a[36:39], v[92:95]
v_mul_f32 v170, 0x3e0293ee, v170
buffer_load_dwordx4 a[152:155], v246, s[16:19], s57 offen offset:1024 sc1
v_mfma_f32_16x16x32_bf16 v[96:99], v[204:207], a[40:43], v[96:99]
ds_read_b64_tr_b16 v[202:203], v228 offset:45568
v_mfma_f32_16x16x32_bf16 v[100:103], v[204:207], a[44:47], v[100:103]
s_waitcnt lgkmcnt(4)
v_mul_f32 v171, 0x3e0293ee, v171
v_mfma_f32_16x16x32_bf16 v[104:107], v[208:211], a[32:35], v[104:107]
ds_read_b64_tr_b16 v[204:205], v229 offset:45056
v_mfma_f32_16x16x32_bf16 v[108:111], v[208:211], a[36:39], v[108:111]
v_mul_f32 v184, 0x3e0293ee, v184
buffer_load_dwordx4 a[156:159], v247, s[16:19], s57 offen offset:1024 sc1
v_mfma_f32_16x16x32_bf16 v[112:115], v[208:211], a[40:43], v[112:115]
ds_read_b64_tr_b16 v[206:207], v229 offset:45568
v_mfma_f32_16x16x32_bf16 v[116:119], v[208:211], a[44:47], v[116:119]
s_waitcnt lgkmcnt(4)
v_mul_f32 v185, 0x3e0293ee, v185
v_mfma_f32_16x16x32_bf16 v[120:123], v[212:215], a[32:35], v[120:123]
ds_read_b64_tr_b16 v[208:209], v230 offset:45056
v_mfma_f32_16x16x32_bf16 v[124:127], v[212:215], a[36:39], v[124:127]
v_mul_f32 v186, 0x3e0293ee, v186
buffer_load_dwordx4 a[160:163], v244, s[16:19], s57 offen offset:2048 sc1
v_mfma_f32_16x16x32_bf16 v[128:131], v[212:215], a[40:43], v[128:131]
ds_read_b64_tr_b16 v[210:211], v230 offset:45568
v_mfma_f32_16x16x32_bf16 v[132:135], v[212:215], a[44:47], v[132:135]
s_waitcnt lgkmcnt(4)
v_mul_f32 v187, 0x3e0293ee, v187
v_mfma_f32_16x16x32_bf16 v[72:75], v[200:203], a[48:51], v[72:75]
ds_read_b64_tr_b16 v[212:213], v231 offset:45056
v_mfma_f32_16x16x32_bf16 v[76:79], v[200:203], a[52:55], v[76:79]
s_waitcnt vmcnt(18)
s_barrier
v_mfma_f32_16x16x32_bf16 v[80:83], v[200:203], a[56:59], v[80:83]
ds_read_b64_tr_b16 v[214:215], v231 offset:45568
s_add_u32 m0, s42, 16384
v_mfma_f32_16x16x32_bf16 v[84:87], v[200:203], a[60:63], v[84:87]
s_waitcnt lgkmcnt(4)
s_add_u32 s65, s51, 3145728
v_mfma_f32_16x16x32_bf16 v[88:91], v[204:207], a[48:51], v[88:91]
ds_read_b64_tr_b16 v[200:201], v228 offset:49152
v_cvt_pk_bf16_f32 v12, v168, v169
v_mfma_f32_16x16x32_bf16 v[92:95], v[204:207], a[52:55], v[92:95]
buffer_load_dwordx4 v236, s[4:7], s65 offen offset:0 lds
v_cvt_pk_bf16_f32 v13, v170, v171
v_mfma_f32_16x16x32_bf16 v[96:99], v[204:207], a[56:59], v[96:99]
ds_read_b64_tr_b16 v[202:203], v228 offset:49664
v_cvt_pk_bf16_f32 v14, v184, v185
v_mfma_f32_16x16x32_bf16 v[100:103], v[204:207], a[60:63], v[100:103]
s_waitcnt lgkmcnt(4)
v_cvt_pk_bf16_f32 v15, v186, v187
v_mfma_f32_16x16x32_bf16 v[104:107], v[208:211], a[48:51], v[104:107]
ds_read_b64_tr_b16 v[204:205], v229 offset:49152
v_mfma_f32_16x16x32_bf16 v[108:111], v[208:211], a[52:55], v[108:111]
buffer_store_dwordx4 v[12:15], v2, s[20:23], s67 offen offset:3072 sc1
v_mfma_f32_16x16x32_bf16 v[112:115], v[208:211], a[56:59], v[112:115]
ds_read_b64_tr_b16 v[206:207], v229 offset:49664
v_mfma_f32_16x16x32_bf16 v[116:119], v[208:211], a[60:63], v[116:119]
s_waitcnt lgkmcnt(4)
v_mfma_f32_16x16x32_bf16 v[120:123], v[212:215], a[48:51], v[120:123]
ds_read_b64_tr_b16 v[208:209], v230 offset:49152
v_mfma_f32_16x16x32_bf16 v[124:127], v[212:215], a[52:55], v[124:127]
buffer_load_dwordx4 a[164:167], v245, s[16:19], s57 offen offset:2048 sc1
v_mfma_f32_16x16x32_bf16 v[128:131], v[212:215], a[56:59], v[128:131]
ds_read_b64_tr_b16 v[210:211], v230 offset:49664
s_add_u32 s67, s50, 1052672
v_mfma_f32_16x16x32_bf16 v[132:135], v[212:215], a[60:63], v[132:135]
s_waitcnt lgkmcnt(4)
v_mul_f32 v140, 0x3e0293ee, v140
v_mfma_f32_16x16x32_bf16 v[72:75], v[200:203], a[64:67], v[72:75]
ds_read_b64_tr_b16 v[212:213], v231 offset:49152
v_mfma_f32_16x16x32_bf16 v[76:79], v[200:203], a[68:71], v[76:79]
buffer_load_dwordx4 v237, s[4:7], s65 offen offset:1024 lds
v_mul_f32 v141, 0x3e0293ee, v141
v_mfma_f32_16x16x32_bf16 v[80:83], v[200:203], a[72:75], v[80:83]
ds_read_b64_tr_b16 v[214:215], v231 offset:49664
v_mfma_f32_16x16x32_bf16 v[84:87], v[200:203], a[76:79], v[84:87]
s_waitcnt lgkmcnt(4)
v_mul_f32 v142, 0x3e0293ee, v142
v_mfma_f32_16x16x32_bf16 v[88:91], v[204:207], a[64:67], v[88:91]
ds_read_b64_tr_b16 v[200:201], v228 offset:53248
v_mfma_f32_16x16x32_bf16 v[92:95], v[204:207], a[68:71], v[92:95]
v_mul_f32 v143, 0x3e0293ee, v143
buffer_load_dwordx4 a[168:171], v246, s[16:19], s57 offen offset:2048 sc1
v_mfma_f32_16x16x32_bf16 v[96:99], v[204:207], a[72:75], v[96:99]
ds_read_b64_tr_b16 v[202:203], v228 offset:53760
v_mul_f32 v156, 0x3e0293ee, v156
v_mfma_f32_16x16x32_bf16 v[100:103], v[204:207], a[76:79], v[100:103]
s_waitcnt lgkmcnt(4)
v_mfma_f32_16x16x32_bf16 v[104:107], v[208:211], a[64:67], v[104:107]
ds_read_b64_tr_b16 v[204:205], v229 offset:53248
v_mul_f32 v157, 0x3e0293ee, v157
v_mfma_f32_16x16x32_bf16 v[108:111], v[208:211], a[68:71], v[108:111]
buffer_load_dwordx4 a[172:175], v247, s[16:19], s57 offen offset:2048 sc1
v_mfma_f32_16x16x32_bf16 v[112:115], v[208:211], a[72:75], v[112:115]
ds_read_b64_tr_b16 v[206:207], v229 offset:53760
v_mul_f32 v158, 0x3e0293ee, v158
v_mfma_f32_16x16x32_bf16 v[116:119], v[208:211], a[76:79], v[116:119]
s_waitcnt lgkmcnt(4)
v_mfma_f32_16x16x32_bf16 v[120:123], v[212:215], a[64:67], v[120:123]
ds_read_b64_tr_b16 v[208:209], v230 offset:53248
v_mul_f32 v159, 0x3e0293ee, v159
v_mfma_f32_16x16x32_bf16 v[124:127], v[212:215], a[68:71], v[124:127]
v_cvt_pk_bf16_f32 v16, v140, v141
buffer_load_dwordx4 a[176:179], v244, s[16:19], s57 offen offset:3072 sc1
v_mfma_f32_16x16x32_bf16 v[128:131], v[212:215], a[72:75], v[128:131]
ds_read_b64_tr_b16 v[210:211], v230 offset:53760
v_mfma_f32_16x16x32_bf16 v[132:135], v[212:215], a[76:79], v[132:135]
s_waitcnt lgkmcnt(4)
v_cvt_pk_bf16_f32 v17, v142, v143
v_mfma_f32_16x16x32_bf16 v[72:75], v[200:203], a[80:83], v[72:75]
ds_read_b64_tr_b16 v[212:213], v231 offset:53248
v_mfma_f32_16x16x32_bf16 v[76:79], v[200:203], a[84:87], v[76:79]
buffer_load_dwordx4 v238, s[4:7], s65 offen offset:2048 lds
v_cvt_pk_bf16_f32 v18, v156, v157
v_mfma_f32_16x16x32_bf16 v[80:83], v[200:203], a[88:91], v[80:83]
ds_read_b64_tr_b16 v[214:215], v231 offset:53760
v_mfma_f32_16x16x32_bf16 v[84:87], v[200:203], a[92:95], v[84:87]
s_waitcnt lgkmcnt(4)
v_cvt_pk_bf16_f32 v19, v158, v159
v_mfma_f32_16x16x32_bf16 v[88:91], v[204:207], a[80:83], v[88:91]
ds_read_b64_tr_b16 v[200:201], v228 offset:57344
v_mfma_f32_16x16x32_bf16 v[92:95], v[204:207], a[84:87], v[92:95]
buffer_store_dwordx4 v[16:19], v2, s[20:23], s67 offen offset:2048 sc1
v_mfma_f32_16x16x32_bf16 v[96:99], v[204:207], a[88:91], v[96:99]
ds_read_b64_tr_b16 v[202:203], v228 offset:57856
v_mfma_f32_16x16x32_bf16 v[100:103], v[204:207], a[92:95], v[100:103]
s_waitcnt lgkmcnt(4)
v_mfma_f32_16x16x32_bf16 v[104:107], v[208:211], a[80:83], v[104:107]
ds_read_b64_tr_b16 v[204:205], v229 offset:57344
v_mfma_f32_16x16x32_bf16 v[108:111], v[208:211], a[84:87], v[108:111]
buffer_load_dwordx4 a[180:183], v245, s[16:19], s57 offen offset:3072 sc1
v_mfma_f32_16x16x32_bf16 v[112:115], v[208:211], a[88:91], v[112:115]
ds_read_b64_tr_b16 v[206:207], v229 offset:57856
v_mul_f32 v172, 0x3e0293ee, v172
v_mfma_f32_16x16x32_bf16 v[116:119], v[208:211], a[92:95], v[116:119]
s_waitcnt lgkmcnt(4)
v_mul_f32 v173, 0x3e0293ee, v173
v_mfma_f32_16x16x32_bf16 v[120:123], v[212:215], a[80:83], v[120:123]
ds_read_b64_tr_b16 v[208:209], v230 offset:57344
v_mfma_f32_16x16x32_bf16 v[124:127], v[212:215], a[84:87], v[124:127]
v_mul_f32 v174, 0x3e0293ee, v174
buffer_load_dwordx4 a[184:187], v246, s[16:19], s57 offen offset:3072 sc1
v_mfma_f32_16x16x32_bf16 v[128:131], v[212:215], a[88:91], v[128:131]
ds_read_b64_tr_b16 v[210:211], v230 offset:57856
v_mfma_f32_16x16x32_bf16 v[132:135], v[212:215], a[92:95], v[132:135]
s_waitcnt lgkmcnt(4)
v_mul_f32 v175, 0x3e0293ee, v175
v_mfma_f32_16x16x32_bf16 v[72:75], v[200:203], a[96:99], v[72:75]
ds_read_b64_tr_b16 v[212:213], v231 offset:57344
v_mfma_f32_16x16x32_bf16 v[76:79], v[200:203], a[100:103], v[76:79]
buffer_load_dwordx4 v239, s[4:7], s65 offen offset:3072 lds
v_mul_f32 v188, 0x3e0293ee, v188
v_mfma_f32_16x16x32_bf16 v[80:83], v[200:203], a[104:107], v[80:83]
ds_read_b64_tr_b16 v[214:215], v231 offset:57856
v_mfma_f32_16x16x32_bf16 v[84:87], v[200:203], a[108:111], v[84:87]
s_waitcnt lgkmcnt(4)
v_mul_f32 v189, 0x3e0293ee, v189
v_mfma_f32_16x16x32_bf16 v[88:91], v[204:207], a[96:99], v[88:91]
ds_read_b64_tr_b16 v[200:201], v228 offset:61440
v_mfma_f32_16x16x32_bf16 v[92:95], v[204:207], a[100:103], v[92:95]
v_mul_f32 v190, 0x3e0293ee, v190
buffer_load_dwordx4 a[188:191], v247, s[16:19], s57 offen offset:3072 sc1
v_mfma_f32_16x16x32_bf16 v[96:99], v[204:207], a[104:107], v[96:99]
ds_read_b64_tr_b16 v[202:203], v228 offset:61952
v_mfma_f32_16x16x32_bf16 v[100:103], v[204:207], a[108:111], v[100:103]
s_waitcnt lgkmcnt(4)
v_mul_f32 v191, 0x3e0293ee, v191
v_mfma_f32_16x16x32_bf16 v[104:107], v[208:211], a[96:99], v[104:107]
ds_read_b64_tr_b16 v[204:205], v229 offset:61440
v_mfma_f32_16x16x32_bf16 v[108:111], v[208:211], a[100:103], v[108:111]
v_cvt_pk_bf16_f32 v20, v172, v173
buffer_load_dwordx4 a[192:195], v244, s[16:19], s58 offen offset:0 sc1
v_mfma_f32_16x16x32_bf16 v[112:115], v[208:211], a[104:107], v[112:115]
ds_read_b64_tr_b16 v[206:207], v229 offset:61952
v_mfma_f32_16x16x32_bf16 v[116:119], v[208:211], a[108:111], v[116:119]
s_waitcnt lgkmcnt(4)
v_cvt_pk_bf16_f32 v21, v174, v175
v_mfma_f32_16x16x32_bf16 v[120:123], v[212:215], a[96:99], v[120:123]
ds_read_b64_tr_b16 v[208:209], v230 offset:61440
v_mfma_f32_16x16x32_bf16 v[124:127], v[212:215], a[100:103], v[124:127]
v_cvt_pk_bf16_f32 v22, v188, v189
buffer_load_dwordx4 a[196:199], v245, s[16:19], s58 offen offset:0 sc1
v_mfma_f32_16x16x32_bf16 v[128:131], v[212:215], a[104:107], v[128:131]
ds_read_b64_tr_b16 v[210:211], v230 offset:61952
v_mfma_f32_16x16x32_bf16 v[132:135], v[212:215], a[108:111], v[132:135]
s_waitcnt lgkmcnt(4)
v_cvt_pk_bf16_f32 v23, v190, v191
v_mfma_f32_16x16x32_bf16 v[72:75], v[200:203], a[112:115], v[72:75]
ds_read_b64_tr_b16 v[212:213], v231 offset:61440
s_waitcnt vmcnt(31)
v_mfma_f32_16x16x32_bf16 v[76:79], v[200:203], a[116:119], v[76:79]
s_waitcnt vmcnt(18)
s_barrier
v_mfma_f32_16x16x32_bf16 v[80:83], v[200:203], a[120:123], v[80:83]
ds_read_b64_tr_b16 v[214:215], v231 offset:61952
s_add_u32 m0, s82, 32768
v_mfma_f32_16x16x32_bf16 v[84:87], v[200:203], a[124:127], v[84:87]
s_waitcnt lgkmcnt(4)
s_add_u32 s65, s52, 0
v_mfma_f32_16x16x32_bf16 v[88:91], v[204:207], a[112:115], v[88:91]
ds_read_b64_tr_b16 v[200:201], v228 offset:0
v_mfma_f32_16x16x32_bf16 v[92:95], v[204:207], a[116:119], v[92:95]
buffer_load_dwordx4 v240, s[8:11], s65 offen offset:0 lds
v_mfma_f32_16x16x32_bf16 v[96:99], v[204:207], a[120:123], v[96:99]
ds_read_b64_tr_b16 v[202:203], v228 offset:512
v_mfma_f32_16x16x32_bf16 v[100:103], v[204:207], a[124:127], v[100:103]
s_waitcnt lgkmcnt(4)
v_mfma_f32_16x16x32_bf16 v[104:107], v[208:211], a[112:115], v[104:107]
ds_read_b64_tr_b16 v[204:205], v229 offset:0
v_mfma_f32_16x16x32_bf16 v[108:111], v[208:211], a[116:119], v[108:111]
buffer_store_dwordx4 v[20:23], v2, s[20:23], s67 offen offset:3072 sc1
s_add_u32 s67, s50, 1064960
v_mfma_f32_16x16x32_bf16 v[112:115], v[208:211], a[120:123], v[112:115]
ds_read_b64_tr_b16 v[206:207], v229 offset:512
v_mul_f32 v144, 0x3e0293ee, v144
v_mfma_f32_16x16x32_bf16 v[116:119], v[208:211], a[124:127], v[116:119]
s_waitcnt lgkmcnt(4)
v_mfma_f32_16x16x32_bf16 v[120:123], v[212:215], a[112:115], v[120:123]
ds_read_b64_tr_b16 v[208:209], v230 offset:0
v_mul_f32 v145, 0x3e0293ee, v145
v_mfma_f32_16x16x32_bf16 v[124:127], v[212:215], a[116:119], v[124:127]
buffer_load_dwordx4 a[200:203], v246, s[16:19], s58 offen offset:0 sc1
v_mfma_f32_16x16x32_bf16 v[128:131], v[212:215], a[120:123], v[128:131]
ds_read_b64_tr_b16 v[210:211], v230 offset:512
v_mul_f32 v146, 0x3e0293ee, v146
v_mfma_f32_16x16x32_bf16 v[132:135], v[212:215], a[124:127], v[132:135]
s_waitcnt lgkmcnt(4)
v_mfma_f32_16x16x32_bf16 v[72:75], v[200:203], a[128:131], v[72:75]
ds_read_b64_tr_b16 v[212:213], v231 offset:0
v_mul_f32 v147, 0x3e0293ee, v147
v_mfma_f32_16x16x32_bf16 v[76:79], v[200:203], a[132:135], v[76:79]
buffer_load_dwordx4 v241, s[8:11], s65 offen offset:1024 lds
s_add_u32 m0, s82, 40960
v_mfma_f32_16x16x32_bf16 v[80:83], v[200:203], a[136:139], v[80:83]
ds_read_b64_tr_b16 v[214:215], v231 offset:512
v_mul_f32 v160, 0x3e0293ee, v160
v_mfma_f32_16x16x32_bf16 v[84:87], v[200:203], a[140:143], v[84:87]
s_waitcnt lgkmcnt(4)
v_mul_f32 v161, 0x3e0293ee, v161
v_mfma_f32_16x16x32_bf16 v[88:91], v[204:207], a[128:131], v[88:91]
ds_read_b64_tr_b16 v[200:201], v228 offset:4096
v_mfma_f32_16x16x32_bf16 v[92:95], v[204:207], a[132:135], v[92:95]
v_mul_f32 v162, 0x3e0293ee, v162
buffer_load_dwordx4 a[204:207], v247, s[16:19], s58 offen offset:0 sc1
v_mfma_f32_16x16x32_bf16 v[96:99], v[204:207], a[136:139], v[96:99]
ds_read_b64_tr_b16 v[202:203], v228 offset:4608
v_mfma_f32_16x16x32_bf16 v[100:103], v[204:207], a[140:143], v[100:103]
s_waitcnt lgkmcnt(4)
v_mul_f32 v163, 0x3e0293ee, v163
v_mfma_f32_16x16x32_bf16 v[104:107], v[208:211], a[128:131], v[104:107]
ds_read_b64_tr_b16 v[204:205], v229 offset:4096
v_cvt_pk_bf16_f32 v8, v144, v145
v_mfma_f32_16x16x32_bf16 v[108:111], v[208:211], a[132:135], v[108:111]
buffer_load_dwordx4 a[208:211], v244, s[16:19], s58 offen offset:1024 sc1
v_mfma_f32_16x16x32_bf16 v[112:115], v[208:211], a[136:139], v[112:115]
ds_read_b64_tr_b16 v[206:207], v229 offset:4608
v_cvt_pk_bf16_f32 v9, v146, v147
v_mfma_f32_16x16x32_bf16 v[116:119], v[208:211], a[140:143], v[116:119]
s_waitcnt lgkmcnt(4)
v_mfma_f32_16x16x32_bf16 v[120:123], v[212:215], a[128:131], v[120:123]
ds_read_b64_tr_b16 v[208:209], v230 offset:4096
v_cvt_pk_bf16_f32 v10, v160, v161
v_mfma_f32_16x16x32_bf16 v[124:127], v[212:215], a[132:135], v[124:127]
buffer_load_dwordx4 a[212:215], v245, s[16:19], s58 offen offset:1024 sc1
v_mfma_f32_16x16x32_bf16 v[128:131], v[212:215], a[136:139], v[128:131]
ds_read_b64_tr_b16 v[210:211], v230 offset:4608
v_cvt_pk_bf16_f32 v11, v162, v163
v_mfma_f32_16x16x32_bf16 v[132:135], v[212:215], a[140:143], v[132:135]
s_waitcnt lgkmcnt(4)
v_mfma_f32_16x16x32_bf16 v[72:75], v[200:203], a[144:147], v[72:75]
ds_read_b64_tr_b16 v[212:213], v231 offset:4096
v_mfma_f32_16x16x32_bf16 v[76:79], v[200:203], a[148:151], v[76:79]
buffer_load_dwordx4 v240, s[12:15], s65 offen offset:0 lds
s_waitcnt vmcnt(25)
v_mfma_f32_16x16x32_bf16 v[80:83], v[200:203], a[152:155], v[80:83]
ds_read_b64_tr_b16 v[214:215], v231 offset:4608
s_waitcnt vmcnt(24)
v_mfma_f32_16x16x32_bf16 v[84:87], v[200:203], a[156:159], v[84:87]
s_waitcnt lgkmcnt(4)
v_mfma_f32_16x16x32_bf16 v[88:91], v[204:207], a[144:147], v[88:91]
ds_read_b64_tr_b16 v[200:201], v228 offset:8192
v_mfma_f32_16x16x32_bf16 v[92:95], v[204:207], a[148:151], v[92:95]
buffer_store_dwordx4 v[8:11], v2, s[20:23], s67 offen offset:2048 sc1
v_mul_f32 v176, 0x3e0293ee, v176
v_mfma_f32_16x16x32_bf16 v[96:99], v[204:207], a[152:155], v[96:99]
ds_read_b64_tr_b16 v[202:203], v228 offset:8704
v_mul_f32 v177, 0x3e0293ee, v177
v_mfma_f32_16x16x32_bf16 v[100:103], v[204:207], a[156:159], v[100:103]
s_waitcnt lgkmcnt(4)
v_mfma_f32_16x16x32_bf16 v[104:107], v[208:211], a[144:147], v[104:107]
ds_read_b64_tr_b16 v[204:205], v229 offset:8192
v_mul_f32 v178, 0x3e0293ee, v178
v_mfma_f32_16x16x32_bf16 v[108:111], v[208:211], a[148:151], v[108:111]
buffer_load_dwordx4 a[216:219], v246, s[16:19], s58 offen offset:1024 sc1
v_mfma_f32_16x16x32_bf16 v[112:115], v[208:211], a[152:155], v[112:115]
ds_read_b64_tr_b16 v[206:207], v229 offset:8704
v_mul_f32 v179, 0x3e0293ee, v179
v_mfma_f32_16x16x32_bf16 v[116:119], v[208:211], a[156:159], v[116:119]
s_waitcnt lgkmcnt(4)
v_mfma_f32_16x16x32_bf16 v[120:123], v[212:215], a[144:147], v[120:123]
ds_read_b64_tr_b16 v[208:209], v230 offset:8192
v_mul_f32 v192, 0x3e0293ee, v192
v_mfma_f32_16x16x32_bf16 v[124:127], v[212:215], a[148:151], v[124:127]
buffer_load_dwordx4 a[220:223], v247, s[16:19], s58 offen offset:1024 sc1
v_mfma_f32_16x16x32_bf16 v[128:131], v[212:215], a[152:155], v[128:131]
ds_read_b64_tr_b16 v[210:211], v230 offset:8704
v_mul_f32 v193, 0x3e0293ee, v193
v_mfma_f32_16x16x32_bf16 v[132:135], v[212:215], a[156:159], v[132:135]
s_waitcnt lgkmcnt(4)
s_waitcnt vmcnt(26)
v_mfma_f32_16x16x32_bf16 v[72:75], v[200:203], a[160:163], v[72:75]
ds_read_b64_tr_b16 v[212:213], v231 offset:8192
v_mul_f32 v194, 0x3e0293ee, v194
s_waitcnt vmcnt(23)
v_mfma_f32_16x16x32_bf16 v[76:79], v[200:203], a[164:167], v[76:79]
buffer_load_dwordx4 v241, s[12:15], s65 offen offset:1024 lds
s_waitcnt vmcnt(22)
v_mfma_f32_16x16x32_bf16 v[80:83], v[200:203], a[168:171], v[80:83]
ds_read_b64_tr_b16 v[214:215], v231 offset:8704
v_mul_f32 v195, 0x3e0293ee, v195
s_waitcnt vmcnt(21)
v_mfma_f32_16x16x32_bf16 v[84:87], v[200:203], a[172:175], v[84:87]
s_waitcnt lgkmcnt(4)
v_mfma_f32_16x16x32_bf16 v[88:91], v[204:207], a[160:163], v[88:91]
ds_read_b64_tr_b16 v[200:201], v228 offset:12288
v_cvt_pk_bf16_f32 v12, v176, v177
v_mfma_f32_16x16x32_bf16 v[92:95], v[204:207], a[164:167], v[92:95]
buffer_load_dwordx4 a[224:227], v244, s[16:19], s58 offen offset:2048 sc1
v_mfma_f32_16x16x32_bf16 v[96:99], v[204:207], a[168:171], v[96:99]
ds_read_b64_tr_b16 v[202:203], v228 offset:12800
v_cvt_pk_bf16_f32 v13, v178, v179
v_mfma_f32_16x16x32_bf16 v[100:103], v[204:207], a[172:175], v[100:103]
s_waitcnt lgkmcnt(4)
v_mfma_f32_16x16x32_bf16 v[104:107], v[208:211], a[160:163], v[104:107]
ds_read_b64_tr_b16 v[204:205], v229 offset:12288
v_cvt_pk_bf16_f32 v14, v192, v193
v_mfma_f32_16x16x32_bf16 v[108:111], v[208:211], a[164:167], v[108:111]
buffer_load_dwordx4 a[228:231], v245, s[16:19], s58 offen offset:2048 sc1
v_mfma_f32_16x16x32_bf16 v[112:115], v[208:211], a[168:171], v[112:115]
ds_read_b64_tr_b16 v[206:207], v229 offset:12800
v_cvt_pk_bf16_f32 v15, v194, v195
v_mfma_f32_16x16x32_bf16 v[116:119], v[208:211], a[172:175], v[116:119]
s_waitcnt lgkmcnt(4)
v_mfma_f32_16x16x32_bf16 v[120:123], v[212:215], a[160:163], v[120:123]
ds_read_b64_tr_b16 v[208:209], v230 offset:12288
v_mfma_f32_16x16x32_bf16 v[124:127], v[212:215], a[164:167], v[124:127]
buffer_store_dwordx4 v[12:15], v2, s[20:23], s67 offen offset:3072 sc1
v_mfma_f32_16x16x32_bf16 v[128:131], v[212:215], a[168:171], v[128:131]
ds_read_b64_tr_b16 v[210:211], v230 offset:12800
s_add_u32 s67, s50, 1069056
v_mfma_f32_16x16x32_bf16 v[132:135], v[212:215], a[172:175], v[132:135]
s_waitcnt lgkmcnt(4)
v_mul_f32 v148, 0x3e0293ee, v148
s_waitcnt vmcnt(23)
v_mfma_f32_16x16x32_bf16 v[72:75], v[200:203], a[176:179], v[72:75]
ds_read_b64_tr_b16 v[212:213], v231 offset:12288
s_waitcnt vmcnt(20)
v_mfma_f32_16x16x32_bf16 v[76:79], v[200:203], a[180:183], v[76:79]
s_waitcnt vmcnt(18)
s_barrier
v_mfma_f32_16x16x32_bf16 v[80:83], v[200:203], a[184:187], v[80:83]
ds_read_b64_tr_b16 v[214:215], v231 offset:12800
s_add_u32 m0, s82, 49152
s_waitcnt vmcnt(17)
v_mfma_f32_16x16x32_bf16 v[84:87], v[200:203], a[188:191], v[84:87]
s_waitcnt lgkmcnt(4)
s_add_u32 s65, s52, 352256
v_mfma_f32_16x16x32_bf16 v[88:91], v[204:207], a[176:179], v[88:91]
ds_read_b64_tr_b16 v[200:201], v228 offset:16384
v_mul_f32 v149, 0x3e0293ee, v149
v_mfma_f32_16x16x32_bf16 v[92:95], v[204:207], a[180:183], v[92:95]
buffer_load_dwordx4 v240, s[8:11], s65 offen offset:0 lds
v_mul_f32 v150, 0x3e0293ee, v150
v_mfma_f32_16x16x32_bf16 v[96:99], v[204:207], a[184:187], v[96:99]
ds_read_b64_tr_b16 v[202:203], v228 offset:16896
v_mul_f32 v151, 0x3e0293ee, v151
v_mfma_f32_16x16x32_bf16 v[100:103], v[204:207], a[188:191], v[100:103]
s_waitcnt lgkmcnt(4)
v_mul_f32 v164, 0x3e0293ee, v164
v_mfma_f32_16x16x32_bf16 v[104:107], v[208:211], a[176:179], v[104:107]
ds_read_b64_tr_b16 v[204:205], v229 offset:16384
v_mul_f32 v165, 0x3e0293ee, v165
v_mfma_f32_16x16x32_bf16 v[108:111], v[208:211], a[180:183], v[108:111]
buffer_load_dwordx4 a[232:235], v246, s[16:19], s58 offen offset:2048 sc1
v_mfma_f32_16x16x32_bf16 v[112:115], v[208:211], a[184:187], v[112:115]
ds_read_b64_tr_b16 v[206:207], v229 offset:16896
v_mul_f32 v166, 0x3e0293ee, v166
v_mfma_f32_16x16x32_bf16 v[116:119], v[208:211], a[188:191], v[116:119]
s_waitcnt lgkmcnt(4)
v_mfma_f32_16x16x32_bf16 v[120:123], v[212:215], a[176:179], v[120:123]
ds_read_b64_tr_b16 v[208:209], v230 offset:16384
v_mul_f32 v167, 0x3e0293ee, v167
v_mfma_f32_16x16x32_bf16 v[124:127], v[212:215], a[180:183], v[124:127]
v_cvt_pk_bf16_f32 v16, v148, v149
buffer_load_dwordx4 a[236:239], v247, s[16:19], s58 offen offset:2048 sc1
v_mfma_f32_16x16x32_bf16 v[128:131], v[212:215], a[184:187], v[128:131]
ds_read_b64_tr_b16 v[210:211], v230 offset:16896
v_mfma_f32_16x16x32_bf16 v[132:135], v[212:215], a[188:191], v[132:135]
s_waitcnt lgkmcnt(4)
v_cvt_pk_bf16_f32 v17, v150, v151
s_waitcnt vmcnt(19)
v_mfma_f32_16x16x32_bf16 v[72:75], v[200:203], a[192:195], v[72:75]
ds_read_b64_tr_b16 v[212:213], v231 offset:16384
s_waitcnt vmcnt(18)
v_mfma_f32_16x16x32_bf16 v[76:79], v[200:203], a[196:199], v[76:79]
buffer_load_dwordx4 v241, s[8:11], s65 offen offset:1024 lds
s_add_u32 m0, s82, 57344
s_waitcnt vmcnt(16)
v_mfma_f32_16x16x32_bf16 v[80:83], v[200:203], a[200:203], v[80:83]
ds_read_b64_tr_b16 v[214:215], v231 offset:16896
v_cvt_pk_bf16_f32 v18, v164, v165
s_waitcnt vmcnt(14)
v_mfma_f32_16x16x32_bf16 v[84:87], v[200:203], a[204:207], v[84:87]
s_waitcnt lgkmcnt(4)
v_cvt_pk_bf16_f32 v19, v166, v167
v_mfma_f32_16x16x32_bf16 v[88:91], v[204:207], a[192:195], v[88:91]
ds_read_b64_tr_b16 v[200:201], v228 offset:20480
v_mfma_f32_16x16x32_bf16 v[92:95], v[204:207], a[196:199], v[92:95]
buffer_store_dwordx4 v[16:19], v2, s[20:23], s67 offen offset:2048 sc1
v_mfma_f32_16x16x32_bf16 v[96:99], v[204:207], a[200:203], v[96:99]
ds_read_b64_tr_b16 v[202:203], v228 offset:20992
v_mfma_f32_16x16x32_bf16 v[100:103], v[204:207], a[204:207], v[100:103]
s_waitcnt lgkmcnt(4)
v_mfma_f32_16x16x32_bf16 v[104:107], v[208:211], a[192:195], v[104:107]
ds_read_b64_tr_b16 v[204:205], v229 offset:20480
v_mfma_f32_16x16x32_bf16 v[108:111], v[208:211], a[196:199], v[108:111]
buffer_load_dwordx4 a[240:243], v244, s[16:19], s58 offen offset:3072 sc1
v_mfma_f32_16x16x32_bf16 v[112:115], v[208:211], a[200:203], v[112:115]
ds_read_b64_tr_b16 v[206:207], v229 offset:20992
v_mul_f32 v180, 0x3e0293ee, v180
v_mfma_f32_16x16x32_bf16 v[116:119], v[208:211], a[204:207], v[116:119]
s_waitcnt lgkmcnt(4)
v_mul_f32 v181, 0x3e0293ee, v181
v_mfma_f32_16x16x32_bf16 v[120:123], v[212:215], a[192:195], v[120:123]
ds_read_b64_tr_b16 v[208:209], v230 offset:20480
v_mfma_f32_16x16x32_bf16 v[124:127], v[212:215], a[196:199], v[124:127]
v_mul_f32 v182, 0x3e0293ee, v182
buffer_load_dwordx4 a[244:247], v245, s[16:19], s58 offen offset:3072 sc1
v_mfma_f32_16x16x32_bf16 v[128:131], v[212:215], a[200:203], v[128:131]
ds_read_b64_tr_b16 v[210:211], v230 offset:20992
v_mfma_f32_16x16x32_bf16 v[132:135], v[212:215], a[204:207], v[132:135]
s_waitcnt lgkmcnt(4)
v_mul_f32 v183, 0x3e0293ee, v183
s_waitcnt vmcnt(16)
v_mfma_f32_16x16x32_bf16 v[72:75], v[200:203], a[208:211], v[72:75]
ds_read_b64_tr_b16 v[212:213], v231 offset:20480
s_waitcnt vmcnt(15)
v_mfma_f32_16x16x32_bf16 v[76:79], v[200:203], a[212:215], v[76:79]
buffer_load_dwordx4 v240, s[12:15], s65 offen offset:0 lds
v_mul_f32 v196, 0x3e0293ee, v196
s_waitcnt vmcnt(13)
v_mfma_f32_16x16x32_bf16 v[80:83], v[200:203], a[216:219], v[80:83]
ds_read_b64_tr_b16 v[214:215], v231 offset:20992
s_waitcnt vmcnt(12)
v_mfma_f32_16x16x32_bf16 v[84:87], v[200:203], a[220:223], v[84:87]
s_waitcnt lgkmcnt(4)
v_mul_f32 v197, 0x3e0293ee, v197
v_mfma_f32_16x16x32_bf16 v[88:91], v[204:207], a[208:211], v[88:91]
ds_read_b64_tr_b16 v[200:201], v228 offset:24576
v_mfma_f32_16x16x32_bf16 v[92:95], v[204:207], a[212:215], v[92:95]
v_mul_f32 v198, 0x3e0293ee, v198
buffer_load_dwordx4 a[248:251], v246, s[16:19], s58 offen offset:3072 sc1
v_mfma_f32_16x16x32_bf16 v[96:99], v[204:207], a[216:219], v[96:99]
ds_read_b64_tr_b16 v[202:203], v228 offset:25088
v_mfma_f32_16x16x32_bf16 v[100:103], v[204:207], a[220:223], v[100:103]
s_waitcnt lgkmcnt(4)
v_mul_f32 v199, 0x3e0293ee, v199
v_mfma_f32_16x16x32_bf16 v[104:107], v[208:211], a[208:211], v[104:107]
ds_read_b64_tr_b16 v[204:205], v229 offset:24576
v_mfma_f32_16x16x32_bf16 v[108:111], v[208:211], a[212:215], v[108:111]
v_cvt_pk_bf16_f32 v20, v180, v181
buffer_load_dwordx4 a[252:255], v247, s[16:19], s58 offen offset:3072 sc1
v_mfma_f32_16x16x32_bf16 v[112:115], v[208:211], a[216:219], v[112:115]
ds_read_b64_tr_b16 v[206:207], v229 offset:25088
v_mfma_f32_16x16x32_bf16 v[116:119], v[208:211], a[220:223], v[116:119]
s_waitcnt lgkmcnt(4)
v_cvt_pk_bf16_f32 v21, v182, v183
v_mfma_f32_16x16x32_bf16 v[120:123], v[212:215], a[208:211], v[120:123]
ds_read_b64_tr_b16 v[208:209], v230 offset:24576
v_mfma_f32_16x16x32_bf16 v[124:127], v[212:215], a[212:215], v[124:127]
v_cvt_pk_bf16_f32 v22, v196, v197
v_mfma_f32_16x16x32_bf16 v[128:131], v[212:215], a[216:219], v[128:131]
ds_read_b64_tr_b16 v[210:211], v230 offset:25088
v_mfma_f32_16x16x32_bf16 v[132:135], v[212:215], a[220:223], v[132:135]
s_waitcnt lgkmcnt(4)
v_cvt_pk_bf16_f32 v23, v198, v199
s_waitcnt vmcnt(12)
v_mfma_f32_16x16x32_bf16 v[72:75], v[200:203], a[224:227], v[72:75]
ds_read_b64_tr_b16 v[212:213], v231 offset:24576
s_waitcnt vmcnt(11)
v_mfma_f32_16x16x32_bf16 v[76:79], v[200:203], a[228:231], v[76:79]
buffer_load_dwordx4 v241, s[12:15], s65 offen offset:1024 lds
s_waitcnt vmcnt(9)
v_mfma_f32_16x16x32_bf16 v[80:83], v[200:203], a[232:235], v[80:83]
ds_read_b64_tr_b16 v[214:215], v231 offset:25088
s_waitcnt vmcnt(8)
v_mfma_f32_16x16x32_bf16 v[84:87], v[200:203], a[236:239], v[84:87]
s_waitcnt lgkmcnt(4)
v_mfma_f32_16x16x32_bf16 v[88:91], v[204:207], a[224:227], v[88:91]
ds_read_b64_tr_b16 v[200:201], v228 offset:28672
v_mfma_f32_16x16x32_bf16 v[92:95], v[204:207], a[228:231], v[92:95]
buffer_store_dwordx4 v[20:23], v2, s[20:23], s67 offen offset:3072 sc1
v_mfma_f32_16x16x32_bf16 v[96:99], v[204:207], a[232:235], v[96:99]
ds_read_b64_tr_b16 v[202:203], v228 offset:29184
v_mfma_f32_16x16x32_bf16 v[100:103], v[204:207], a[236:239], v[100:103]
s_waitcnt lgkmcnt(4)
v_mfma_f32_16x16x32_bf16 v[104:107], v[208:211], a[224:227], v[104:107]
ds_read_b64_tr_b16 v[204:205], v229 offset:28672
v_mfma_f32_16x16x32_bf16 v[108:111], v[208:211], a[228:231], v[108:111]
v_mfma_f32_16x16x32_bf16 v[112:115], v[208:211], a[232:235], v[112:115]
ds_read_b64_tr_b16 v[206:207], v229 offset:29184
v_mfma_f32_16x16x32_bf16 v[116:119], v[208:211], a[236:239], v[116:119]
s_waitcnt lgkmcnt(4)
v_mfma_f32_16x16x32_bf16 v[120:123], v[212:215], a[224:227], v[120:123]
ds_read_b64_tr_b16 v[208:209], v230 offset:28672
v_mfma_f32_16x16x32_bf16 v[124:127], v[212:215], a[228:231], v[124:127]
v_mfma_f32_16x16x32_bf16 v[128:131], v[212:215], a[232:235], v[128:131]
ds_read_b64_tr_b16 v[210:211], v230 offset:29184
v_mfma_f32_16x16x32_bf16 v[132:135], v[212:215], a[236:239], v[132:135]
s_waitcnt lgkmcnt(4)
s_waitcnt vmcnt(6)
v_mfma_f32_16x16x32_bf16 v[72:75], v[200:203], a[240:243], v[72:75]
ds_read_b64_tr_b16 v[212:213], v231 offset:28672
s_waitcnt vmcnt(5)
v_mfma_f32_16x16x32_bf16 v[76:79], v[200:203], a[244:247], v[76:79]
s_barrier
s_waitcnt vmcnt(3)
v_mfma_f32_16x16x32_bf16 v[80:83], v[200:203], a[248:251], v[80:83]
ds_read_b64_tr_b16 v[214:215], v231 offset:29184
s_waitcnt vmcnt(2)
v_mfma_f32_16x16x32_bf16 v[84:87], v[200:203], a[252:255], v[84:87]
s_waitcnt lgkmcnt(4)
v_mfma_f32_16x16x32_bf16 v[88:91], v[204:207], a[240:243], v[88:91]
ds_read_b64_tr_b16 v[200:201], v232 offset:32768
v_mfma_f32_16x16x32_bf16 v[92:95], v[204:207], a[244:247], v[92:95]
s_add_u32 m0, s82, 0
s_add_u32 s65, s52, 704512
v_mfma_f32_16x16x32_bf16 v[96:99], v[204:207], a[248:251], v[96:99]
ds_read_b64_tr_b16 v[202:203], v232 offset:33024
buffer_load_dwordx4 v240, s[8:11], s65 offen offset:0 lds
v_mfma_f32_16x16x32_bf16 v[100:103], v[204:207], a[252:255], v[100:103]
s_waitcnt lgkmcnt(4)
buffer_load_dwordx4 v241, s[8:11], s65 offen offset:1024 lds
v_mfma_f32_16x16x32_bf16 v[104:107], v[208:211], a[240:243], v[104:107]
ds_read_b64_tr_b16 v[204:205], v233 offset:32768
s_add_u32 m0, s82, 8192
v_mfma_f32_16x16x32_bf16 v[108:111], v[208:211], a[244:247], v[108:111]
buffer_load_dwordx4 v240, s[12:15], s65 offen offset:0 lds
buffer_load_dwordx4 v241, s[12:15], s65 offen offset:1024 lds
v_mfma_f32_16x16x32_bf16 v[112:115], v[208:211], a[248:251], v[112:115]
ds_read_b64_tr_b16 v[206:207], v233 offset:33024
v_mfma_f32_16x16x32_bf16 v[116:119], v[208:211], a[252:255], v[116:119]
s_waitcnt lgkmcnt(4)
v_mfma_f32_16x16x32_bf16 v[120:123], v[212:215], a[240:243], v[120:123]
ds_read_b64_tr_b16 v[208:209], v232 offset:40960
v_mfma_f32_16x16x32_bf16 v[124:127], v[212:215], a[244:247], v[124:127]
v_mfma_f32_16x16x32_bf16 v[128:131], v[212:215], a[248:251], v[128:131]
ds_read_b64_tr_b16 v[210:211], v232 offset:41216
v_mfma_f32_16x16x32_bf16 v[132:135], v[212:215], a[252:255], v[132:135]
s_waitcnt lgkmcnt(4)
s_branch KF_common
KF_vtype:
v_mfma_f32_16x16x32_bf16 v[72:75], a[0:3], v[200:203], 0
ds_read_b64_tr_b16 v[212:213], v231 offset:32768
v_add_u32 v224, 2, v9
v_mfma_f32_16x16x32_bf16 v[76:79], a[4:7], v[200:203], 0
v_cmp_gt_u32 vcc, 8, v224
v_lshlrev_b32 v224, 7, v224
v_mfma_f32_16x16x32_bf16 v[80:83], a[8:11], v[200:203], 0
ds_read_b64_tr_b16 v[214:215], v231 offset:33280
v_lshl_add_u32 v224, v8, 10, v224
v_mfma_f32_16x16x32_bf16 v[84:87], a[12:15], v[200:203], 0
v_cndmask_b32 v224, v10, v224, vcc
v_mfma_f32_16x16x32_bf16 v[88:91], a[0:3], v[204:207], 0
ds_read_b64_tr_b16 v[200:201], v228 offset:36864
buffer_load_dword v222, v224, s[8:11], s67 offen
v_mfma_f32_16x16x32_bf16 v[92:95], a[4:7], v[204:207], 0
v_add_u32 v225, 1, v9
v_cmp_gt_u32 vcc, 4, v225
v_mfma_f32_16x16x32_bf16 v[96:99], a[8:11], v[204:207], 0
ds_read_b64_tr_b16 v[202:203], v228 offset:37376
v_lshlrev_b32 v225, 20, v225
v_mfma_f32_16x16x32_bf16 v[100:103], a[12:15], v[204:207], 0
v_lshl_add_u32 v225, v8, 9, v225
v_mfma_f32_16x16x32_bf16 v[104:107], a[0:3], v[208:211], 0
ds_read_b64_tr_b16 v[204:205], v229 offset:36864
v_cndmask_b32 v225, v10, v225, vcc
v_mfma_f32_16x16x32_bf16 v[108:111], a[4:7], v[208:211], 0
buffer_load_dword v223, v225, s[12:15], s68 offen
s_add_u32 m0, s42, 49152
v_mfma_f32_16x16x32_bf16 v[112:115], a[8:11], v[208:211], 0
ds_read_b64_tr_b16 v[206:207], v229 offset:37376
s_add_u32 s65, s47, 1048576
v_mfma_f32_16x16x32_bf16 v[116:119], a[12:15], v[208:211], 0
s_waitcnt lgkmcnt(4)
buffer_load_dwordx4 v236, s[12:15], s65 offen offset:0 lds
v_mfma_f32_16x16x32_bf16 v[120:123], a[0:3], v[212:215], 0
ds_read_b64_tr_b16 v[208:209], v230 offset:36864
buffer_load_dwordx4 v237, s[12:15], s65 offen offset:1024 lds
v_mfma_f32_16x16x32_bf16 v[124:127], a[4:7], v[212:215], 0
buffer_load_dwordx4 v238, s[12:15], s65 offen offset:2048 lds
v_mfma_f32_16x16x32_bf16 v[128:131], a[8:11], v[212:215], 0
ds_read_b64_tr_b16 v[210:211], v230 offset:37376
buffer_load_dwordx4 v239, s[12:15], s65 offen offset:3072 lds
v_mfma_f32_16x16x32_bf16 v[132:135], a[12:15], v[212:215], 0
s_waitcnt lgkmcnt(4)
buffer_store_dword v14, v13, s[32:35], s62 offen sc1
v_mfma_f32_16x16x32_bf16 v[72:75], a[16:19], v[200:203], v[72:75]
ds_read_b64_tr_b16 v[212:213], v231 offset:36864
buffer_load_dwordx4 v[24:27], v2, s[4:7], s63 offen
v_mfma_f32_16x16x32_bf16 v[76:79], a[20:23], v[200:203], v[76:79]
s_waitcnt vmcnt(8)
ds_read_b128 a[32:35], v232 offset:8192
buffer_load_dwordx4 v[28:31], v2, s[4:7], s63 offen offset:1024
v_mfma_f32_16x16x32_bf16 v[80:83], a[24:27], v[200:203], v[80:83]
ds_read_b64_tr_b16 v[214:215], v231 offset:37376
s_add_u32 m0, s49, 16384
v_mfma_f32_16x16x32_bf16 v[84:87], a[28:31], v[200:203], v[84:87]
ds_read_b128 a[36:39], v232 offset:10240
s_waitcnt lgkmcnt(6)
v_mfma_f32_16x16x32_bf16 v[88:91], a[16:19], v[204:207], v[88:91]
ds_read_b64_tr_b16 v[200:201], v228 offset:40960
s_add_u32 s66, s48, 256
v_mfma_f32_16x16x32_bf16 v[92:95], a[20:23], v[204:207], v[92:95]
ds_read_b128 a[40:43], v232 offset:12288
buffer_load_dwordx4 v240, s[8:11], s66 offen offset:0 lds
v_mfma_f32_16x16x32_bf16 v[96:99], a[24:27], v[204:207], v[96:99]
ds_read_b64_tr_b16 v[202:203], v228 offset:41472
buffer_load_dwordx4 v241, s[8:11], s66 offen offset:1024 lds
v_mfma_f32_16x16x32_bf16 v[100:103], a[28:31], v[204:207], v[100:103]
ds_read_b128 a[44:47], v232 offset:14336
s_waitcnt lgkmcnt(8)
v_mfma_f32_16x16x32_bf16 v[104:107], a[16:19], v[208:211], v[104:107]
ds_read_b64_tr_b16 v[204:205], v229 offset:40960
buffer_load_dwordx4 v242, s[8:11], s66 offen offset:2048 lds
v_mfma_f32_16x16x32_bf16 v[108:111], a[20:23], v[208:211], v[108:111]
ds_read_b128 a[48:51], v233 offset:8192
buffer_load_dwordx4 v243, s[8:11], s66 offen offset:3072 lds
v_mfma_f32_16x16x32_bf16 v[112:115], a[24:27], v[208:211], v[112:115]
ds_read_b64_tr_b16 v[206:207], v229 offset:41472
s_add_u32 m0, s49, 20480
v_mfma_f32_16x16x32_bf16 v[116:119], a[28:31], v[208:211], v[116:119]
ds_read_b128 a[52:55], v233 offset:10240
s_waitcnt lgkmcnt(9)
v_mfma_f32_16x16x32_bf16 v[120:123], a[16:19], v[212:215], v[120:123]
ds_read_b64_tr_b16 v[208:209], v230 offset:40960
s_add_u32 s66, s48, 33024
v_mfma_f32_16x16x32_bf16 v[124:127], a[20:23], v[212:215], v[124:127]
ds_read_b128 a[56:59], v233 offset:12288
buffer_load_dwordx4 v240, s[8:11], s66 offen offset:0 lds
v_mfma_f32_16x16x32_bf16 v[128:131], a[24:27], v[212:215], v[128:131]
ds_read_b64_tr_b16 v[210:211], v230 offset:41472
buffer_load_dwordx4 v241, s[8:11], s66 offen offset:1024 lds
v_mfma_f32_16x16x32_bf16 v[132:135], a[28:31], v[212:215], v[132:135]
ds_read_b128 a[60:63], v233 offset:14336
s_waitcnt lgkmcnt(9)
v_mfma_f32_16x16x32_bf16 v[72:75], a[32:35], v[200:203], v[72:75]
ds_read_b64_tr_b16 v[212:213], v231 offset:40960
buffer_load_dwordx4 v242, s[8:11], s66 offen offset:2048 lds
v_mfma_f32_16x16x32_bf16 v[76:79], a[36:39], v[200:203], v[76:79]
buffer_load_dwordx4 v243, s[8:11], s66 offen offset:3072 lds
s_add_u32 m0, s42, 0
v_mfma_f32_16x16x32_bf16 v[80:83], a[40:43], v[200:203], v[80:83]
ds_read_b64_tr_b16 v[214:215], v231 offset:41472
s_add_u32 s65, s47, 2097152
s_waitcnt lgkmcnt(10)
v_mfma_f32_16x16x32_bf16 v[84:87], a[44:47], v[200:203], v[84:87]
s_waitcnt lgkmcnt(7)
buffer_load_dwordx4 v236, s[12:15], s65 offen offset:0 lds
v_mfma_f32_16x16x32_bf16 v[88:91], a[32:35], v[204:207], v[88:91]
ds_read_b64_tr_b16 v[200:201], v228 offset:45056
buffer_load_dwordx4 v237, s[12:15], s65 offen offset:1024 lds
v_mfma_f32_16x16x32_bf16 v[92:95], a[36:39], v[204:207], v[92:95]
buffer_load_dwordx4 v238, s[12:15], s65 offen offset:2048 lds
v_mfma_f32_16x16x32_bf16 v[96:99], a[40:43], v[204:207], v[96:99]
ds_read_b64_tr_b16 v[202:203], v228 offset:45568
buffer_load_dwordx4 v239, s[12:15], s65 offen offset:3072 lds
v_mfma_f32_16x16x32_bf16 v[100:103], a[44:47], v[204:207], v[100:103]
s_waitcnt lgkmcnt(5)
s_add_u32 m0, s49, 0
v_mfma_f32_16x16x32_bf16 v[104:107], a[32:35], v[208:211], v[104:107]
ds_read_b64_tr_b16 v[204:205], v229 offset:45056
s_add_u32 s66, s48, 384
v_mfma_f32_16x16x32_bf16 v[108:111], a[36:39], v[208:211], v[108:111]
buffer_load_dwordx4 v240, s[8:11], s66 offen offset:0 lds
v_mfma_f32_16x16x32_bf16 v[112:115], a[40:43], v[208:211], v[112:115]
ds_read_b64_tr_b16 v[206:207], v229 offset:45568
buffer_load_dwordx4 v241, s[8:11], s66 offen offset:1024 lds
v_mfma_f32_16x16x32_bf16 v[116:119], a[44:47], v[208:211], v[116:119]
s_waitcnt lgkmcnt(4)
buffer_load_dwordx4 v242, s[8:11], s66 offen offset:2048 lds
v_mfma_f32_16x16x32_bf16 v[120:123], a[32:35], v[212:215], v[120:123]
ds_read_b64_tr_b16 v[208:209], v230 offset:45056
buffer_load_dwordx4 v243, s[8:11], s66 offen offset:3072 lds
v_mfma_f32_16x16x32_bf16 v[124:127], a[36:39], v[212:215], v[124:127]
s_add_u32 m0, s49, 4096
s_add_u32 s66, s48, 33152
v_mfma_f32_16x16x32_bf16 v[128:131], a[40:43], v[212:215], v[128:131]
ds_read_b64_tr_b16 v[210:211], v230 offset:45568
buffer_load_dwordx4 v240, s[8:11], s66 offen offset:0 lds
v_mfma_f32_16x16x32_bf16 v[132:135], a[44:47], v[212:215], v[132:135]
s_waitcnt lgkmcnt(4)
buffer_load_dwordx4 v241, s[8:11], s66 offen offset:1024 lds
v_mfma_f32_16x16x32_bf16 v[72:75], a[48:51], v[200:203], v[72:75]
ds_read_b64_tr_b16 v[212:213], v231 offset:45056
buffer_load_dwordx4 v242, s[8:11], s66 offen offset:2048 lds
v_mfma_f32_16x16x32_bf16 v[76:79], a[52:55], v[200:203], v[76:79]
s_waitcnt vmcnt(11)
ds_read_b128 a[64:67], v232 offset:16384
s_barrier
v_mfma_f32_16x16x32_bf16 v[80:83], a[56:59], v[200:203], v[80:83]
ds_read_b64_tr_b16 v[214:215], v231 offset:45568
buffer_load_dwordx4 v243, s[8:11], s66 offen offset:3072 lds
v_mfma_f32_16x16x32_bf16 v[84:87], a[60:63], v[200:203], v[84:87]
ds_read_b128 a[68:71], v232 offset:18432
s_waitcnt lgkmcnt(6)
v_mfma_f32_16x16x32_bf16 v[88:91], a[48:51], v[204:207], v[88:91]
ds_read_b64_tr_b16 v[200:201], v228 offset:49152
s_add_u32 m0, s49, 8192
s_add_u32 s66, s48, 512
buffer_load_dwordx4 v240, s[8:11], s66 offen offset:0 lds
buffer_load_dwordx4 v241, s[8:11], s66 offen offset:1024 lds
buffer_load_dwordx4 v242, s[8:11], s66 offen offset:2048 lds
buffer_load_dwordx4 v243, s[8:11], s66 offen offset:3072 lds
s_add_u32 m0, s49, 12288
s_add_u32 s66, s48, 33280
buffer_load_dwordx4 v240, s[8:11], s66 offen offset:0 lds
buffer_load_dwordx4 v241, s[8:11], s66 offen offset:1024 lds
buffer_load_dwordx4 v242, s[8:11], s66 offen offset:2048 lds
buffer_load_dwordx4 v243, s[8:11], s66 offen offset:3072 lds
v_mfma_f32_16x16x32_bf16 v[92:95], a[52:55], v[204:207], v[92:95]
ds_read_b128 a[72:75], v232 offset:20480
s_add_u32 m0, s42, 16384
s_add_u32 s65, s47, 3145728
v_mfma_f32_16x16x32_bf16 v[96:99], a[56:59], v[204:207], v[96:99]
ds_read_b64_tr_b16 v[202:203], v228 offset:49664
buffer_load_dwordx4 v236, s[12:15], s65 offen offset:0 lds
v_mfma_f32_16x16x32_bf16 v[100:103], a[60:63], v[204:207], v[100:103]
ds_read_b128 a[76:79], v232 offset:22528
s_waitcnt lgkmcnt(8)
buffer_load_dwordx4 v237, s[12:15], s65 offen offset:1024 lds
v_mfma_f32_16x16x32_bf16 v[104:107], a[48:51], v[208:211], v[104:107]
ds_read_b64_tr_b16 v[204:205], v229 offset:49152
buffer_load_dwordx4 v238, s[12:15], s65 offen offset:2048 lds
v_mfma_f32_16x16x32_bf16 v[108:111], a[52:55], v[208:211], v[108:111]
ds_read_b128 a[80:83], v233 offset:16384
buffer_load_dwordx4 v239, s[12:15], s65 offen offset:3072 lds
v_mfma_f32_16x16x32_bf16 v[112:115], a[56:59], v[208:211], v[112:115]
ds_read_b64_tr_b16 v[206:207], v229 offset:49664
s_mul_i32 s68, s40, 2080
v_mfma_f32_16x16x32_bf16 v[116:119], a[60:63], v[208:211], v[116:119]
ds_read_b128 a[84:87], v233 offset:18432
s_waitcnt lgkmcnt(9)
v_mfma_f32_16x16x32_bf16 v[120:123], a[48:51], v[212:215], v[120:123]
ds_read_b64_tr_b16 v[208:209], v230 offset:49152
v_add_u32 v60, s68, v2
v_mfma_f32_16x16x32_bf16 v[124:127], a[52:55], v[212:215], v[124:127]
ds_read_b128 a[88:91], v233 offset:20480
v_and_b32 v61, 7, v1
v_mfma_f32_16x16x32_bf16 v[128:131], a[56:59], v[212:215], v[128:131]
ds_read_b64_tr_b16 v[210:211], v230 offset:49664
v_mul_u32_u24 v62, 1040, v61
v_mfma_f32_16x16x32_bf16 v[132:135], a[60:63], v[212:215], v[132:135]
ds_read_b128 a[92:95], v233 offset:22528
s_waitcnt lgkmcnt(9)
v_mfma_f32_16x16x32_bf16 v[72:75], a[64:67], v[200:203], v[72:75]
ds_read_b64_tr_b16 v[212:213], v231 offset:49152
v_lshrrev_b32 v63, 3, v1
v_mfma_f32_16x16x32_bf16 v[76:79], a[68:71], v[200:203], v[76:79]
v_lshl_add_u32 v62, v63, 4, v62
s_lshl_b32 s68, s40, 8
v_mfma_f32_16x16x32_bf16 v[80:83], a[72:75], v[200:203], v[80:83]
ds_read_b64_tr_b16 v[214:215], v231 offset:49664
v_add_u32 v62, s68, v62
s_waitcnt lgkmcnt(10)
v_mfma_f32_16x16x32_bf16 v[84:87], a[76:79], v[200:203], v[84:87]
s_waitcnt lgkmcnt(7)
v_lshlrev_b32 v63, 8, v63
v_mfma_f32_16x16x32_bf16 v[88:91], a[64:67], v[204:207], v[88:91]
ds_read_b64_tr_b16 v[200:201], v228 offset:53248
s_waitcnt lgkmcnt(3)
v_mfma_f32_16x16x32_bf16 v[92:95], a[68:71], v[204:207], v[92:95]
s_add_u32 m0, s49, 16384
s_add_u32 s66, s48, 640
v_mfma_f32_16x16x32_bf16 v[96:99], a[72:75], v[204:207], v[96:99]
ds_read_b64_tr_b16 v[202:203], v228 offset:53760
buffer_load_dwordx4 v240, s[8:11], s66 offen offset:0 lds
v_mfma_f32_16x16x32_bf16 v[100:103], a[76:79], v[204:207], v[100:103]
buffer_load_dwordx4 v241, s[8:11], s66 offen offset:1024 lds
v_mfma_f32_16x16x32_bf16 v[104:107], a[64:67], v[208:211], v[104:107]
ds_read_b64_tr_b16 v[204:205], v229 offset:53248
buffer_load_dwordx4 v242, s[8:11], s66 offen offset:2048 lds
v_mfma_f32_16x16x32_bf16 v[108:111], a[68:71], v[208:211], v[108:111]
buffer_load_dwordx4 v243, s[8:11], s66 offen offset:3072 lds
s_add_u32 m0, s49, 20480
v_mfma_f32_16x16x32_bf16 v[112:115], a[72:75], v[208:211], v[112:115]
ds_read_b64_tr_b16 v[206:207], v229 offset:53760
s_add_u32 s66, s48, 33408
v_mfma_f32_16x16x32_bf16 v[116:119], a[76:79], v[208:211], v[116:119]
s_waitcnt lgkmcnt(4)
buffer_load_dwordx4 v240, s[8:11], s66 offen offset:0 lds
v_mfma_f32_16x16x32_bf16 v[120:123], a[64:67], v[212:215], v[120:123]
ds_read_b64_tr_b16 v[208:209], v230 offset:53248
buffer_load_dwordx4 v241, s[8:11], s66 offen offset:1024 lds
v_mfma_f32_16x16x32_bf16 v[124:127], a[68:71], v[212:215], v[124:127]
buffer_load_dwordx4 v242, s[8:11], s66 offen offset:2048 lds
buffer_load_dwordx4 v243, s[8:11], s66 offen offset:3072 lds
v_mfma_f32_16x16x32_bf16 v[128:131], a[72:75], v[212:215], v[128:131]
ds_read_b64_tr_b16 v[210:211], v230 offset:53760
v_lshl_add_u32 v63, v61, 4, v63
v_mfma_f32_16x16x32_bf16 v[132:135], a[76:79], v[212:215], v[132:135]
s_waitcnt lgkmcnt(4)
s_lshr_b32 s68, s2, 1
v_mfma_f32_16x16x32_bf16 v[72:75], a[80:83], v[200:203], v[72:75]
ds_read_b64_tr_b16 v[212:213], v231 offset:53248
s_lshl_b32 s68, s68, 14
v_mfma_f32_16x16x32_bf16 v[76:79], a[84:87], v[200:203], v[76:79]
s_waitcnt vmcnt(20)
ds_read_b128 a[96:99], v232 offset:0
v_add_u32 v63, s68, v63
v_mfma_f32_16x16x32_bf16 v[80:83], a[88:91], v[200:203], v[80:83]
ds_read_b64_tr_b16 v[214:215], v231 offset:53760
s_and_b32 s68, s2, 1
v_mfma_f32_16x16x32_bf16 v[84:87], a[92:95], v[200:203], v[84:87]
ds_read_b128 a[100:103], v232 offset:2048
s_waitcnt lgkmcnt(6)
v_mfma_f32_16x16x32_bf16 v[88:91], a[80:83], v[204:207], v[88:91]
ds_read_b64_tr_b16 v[200:201], v228 offset:57344
s_lshl_b32 s68, s68, 7
v_mfma_f32_16x16x32_bf16 v[92:95], a[84:87], v[204:207], v[92:95]
ds_read_b128 a[104:107], v232 offset:4096
s_add_u32 s68, s68, s41
v_mfma_f32_16x16x32_bf16 v[96:99], a[88:91], v[204:207], v[96:99]
ds_read_b64_tr_b16 v[202:203], v228 offset:57856
v_add_u32 v63, s68, v63
v_mfma_f32_16x16x32_bf16 v[100:103], a[92:95], v[204:207], v[100:103]
ds_read_b128 a[108:111], v232 offset:6144
s_waitcnt lgkmcnt(8)
v_mfma_f32_16x16x32_bf16 v[104:107], a[80:83], v[208:211], v[104:107]
ds_read_b64_tr_b16 v[204:205], v229 offset:57344
v_lshlrev_b32 v32, 16, v24
v_mfma_f32_16x16x32_bf16 v[108:111], a[84:87], v[208:211], v[108:111]
ds_read_b128 a[112:115], v233 offset:0
v_and_b32 v33, 0xffff0000, v24
v_mfma_f32_16x16x32_bf16 v[112:115], a[88:91], v[208:211], v[112:115]
ds_read_b64_tr_b16 v[206:207], v229 offset:57856
v_lshlrev_b32 v34, 16, v25
v_mfma_f32_16x16x32_bf16 v[116:119], a[92:95], v[208:211], v[116:119]
ds_read_b128 a[116:119], v233 offset:2048
s_waitcnt lgkmcnt(9)
v_mfma_f32_16x16x32_bf16 v[120:123], a[80:83], v[212:215], v[120:123]
ds_read_b64_tr_b16 v[208:209], v230 offset:57344
v_and_b32 v35, 0xffff0000, v25
v_mfma_f32_16x16x32_bf16 v[124:127], a[84:87], v[212:215], v[124:127]
ds_read_b128 a[120:123], v233 offset:4096
v_lshlrev_b32 v36, 16, v26
v_mfma_f32_16x16x32_bf16 v[128:131], a[88:91], v[212:215], v[128:131]
ds_read_b64_tr_b16 v[210:211], v230 offset:57856
v_and_b32 v37, 0xffff0000, v26
v_mfma_f32_16x16x32_bf16 v[132:135], a[92:95], v[212:215], v[132:135]
ds_read_b128 a[124:127], v233 offset:6144
s_waitcnt lgkmcnt(9)
v_mfma_f32_16x16x32_bf16 v[72:75], a[96:99], v[200:203], v[72:75]
ds_read_b64_tr_b16 v[212:213], v231 offset:57344
v_lshlrev_b32 v38, 16, v27
v_mfma_f32_16x16x32_bf16 v[76:79], a[100:103], v[200:203], v[76:79]
v_and_b32 v39, 0xffff0000, v27
v_lshlrev_b32 v40, 16, v28
v_mfma_f32_16x16x32_bf16 v[80:83], a[104:107], v[200:203], v[80:83]
ds_read_b64_tr_b16 v[214:215], v231 offset:57856
v_and_b32 v41, 0xffff0000, v28
s_waitcnt lgkmcnt(10)
v_mfma_f32_16x16x32_bf16 v[84:87], a[108:111], v[200:203], v[84:87]
s_waitcnt lgkmcnt(7)
v_lshlrev_b32 v42, 16, v29
v_mfma_f32_16x16x32_bf16 v[88:91], a[96:99], v[204:207], v[88:91]
ds_read_b64_tr_b16 v[200:201], v228 offset:61440
s_waitcnt lgkmcnt(3)
v_mfma_f32_16x16x32_bf16 v[92:95], a[100:103], v[204:207], v[92:95]
s_add_u32 m0, s49, 0
s_add_u32 s66, s48, 768
v_mfma_f32_16x16x32_bf16 v[96:99], a[104:107], v[204:207], v[96:99]
ds_read_b64_tr_b16 v[202:203], v228 offset:61952
buffer_load_dwordx4 v240, s[8:11], s66 offen offset:0 lds
v_mfma_f32_16x16x32_bf16 v[100:103], a[108:111], v[204:207], v[100:103]
buffer_load_dwordx4 v241, s[8:11], s66 offen offset:1024 lds
v_mfma_f32_16x16x32_bf16 v[104:107], a[96:99], v[208:211], v[104:107]
ds_read_b64_tr_b16 v[204:205], v229 offset:61440
buffer_load_dwordx4 v242, s[8:11], s66 offen offset:2048 lds
v_mfma_f32_16x16x32_bf16 v[108:111], a[100:103], v[208:211], v[108:111]
buffer_load_dwordx4 v243, s[8:11], s66 offen offset:3072 lds
s_add_u32 m0, s49, 4096
v_mfma_f32_16x16x32_bf16 v[112:115], a[104:107], v[208:211], v[112:115]
ds_read_b64_tr_b16 v[206:207], v229 offset:61952
s_add_u32 s66, s48, 33536
v_mfma_f32_16x16x32_bf16 v[116:119], a[108:111], v[208:211], v[116:119]
s_waitcnt lgkmcnt(4)
buffer_load_dwordx4 v240, s[8:11], s66 offen offset:0 lds
v_mfma_f32_16x16x32_bf16 v[120:123], a[96:99], v[212:215], v[120:123]
ds_read_b64_tr_b16 v[208:209], v230 offset:61440
buffer_load_dwordx4 v241, s[8:11], s66 offen offset:1024 lds
v_mfma_f32_16x16x32_bf16 v[124:127], a[100:103], v[212:215], v[124:127]
buffer_load_dwordx4 v242, s[8:11], s66 offen offset:2048 lds
buffer_load_dwordx4 v243, s[8:11], s66 offen offset:3072 lds
v_mfma_f32_16x16x32_bf16 v[128:131], a[104:107], v[212:215], v[128:131]
ds_read_b64_tr_b16 v[210:211], v230 offset:61952
v_and_b32 v43, 0xffff0000, v29
v_mfma_f32_16x16x32_bf16 v[132:135], a[108:111], v[212:215], v[132:135]
s_waitcnt lgkmcnt(4)
v_lshlrev_b32 v44, 16, v30
v_mfma_f32_16x16x32_bf16 v[72:75], a[112:115], v[200:203], v[72:75]
ds_read_b64_tr_b16 v[212:213], v231 offset:61440
v_and_b32 v45, 0xffff0000, v30
v_mfma_f32_16x16x32_bf16 v[76:79], a[116:119], v[200:203], v[76:79]
s_waitcnt vmcnt(20)
ds_read_b128 a[128:131], v232 offset:8192
s_barrier
v_mfma_f32_16x16x32_bf16 v[80:83], a[120:123], v[200:203], v[80:83]
ds_read_b64_tr_b16 v[214:215], v231 offset:61952
v_lshlrev_b32 v46, 16, v31
v_mfma_f32_16x16x32_bf16 v[84:87], a[124:127], v[200:203], v[84:87]
ds_read_b128 a[132:135], v232 offset:10240
s_waitcnt lgkmcnt(6)
v_mfma_f32_16x16x32_bf16 v[88:91], a[112:115], v[204:207], v[88:91]
ds_read_b64_tr_b16 v[200:201], v228 offset:0
v_and_b32 v47, 0xffff0000, v31
v_mfma_f32_16x16x32_bf16 v[92:95], a[116:119], v[204:207], v[92:95]
ds_read_b128 a[136:139], v232 offset:12288
s_add_u32 m0, s42, 32768
s_add_u32 s65, s47, 128
v_mfma_f32_16x16x32_bf16 v[96:99], a[120:123], v[204:207], v[96:99]
ds_read_b64_tr_b16 v[202:203], v228 offset:512
buffer_load_dwordx4 v236, s[12:15], s65 offen offset:0 lds
v_mfma_f32_16x16x32_bf16 v[100:103], a[124:127], v[204:207], v[100:103]
ds_read_b128 a[140:143], v232 offset:14336
s_waitcnt lgkmcnt(8)
buffer_load_dwordx4 v237, s[12:15], s65 offen offset:1024 lds
v_mfma_f32_16x16x32_bf16 v[104:107], a[112:115], v[208:211], v[104:107]
ds_read_b64_tr_b16 v[204:205], v229 offset:0
buffer_load_dwordx4 v238, s[12:15], s65 offen offset:2048 lds
v_mfma_f32_16x16x32_bf16 v[108:111], a[116:119], v[208:211], v[108:111]
ds_read_b128 a[144:147], v233 offset:8192
buffer_load_dwordx4 v239, s[12:15], s65 offen offset:3072 lds
v_mfma_f32_16x16x32_bf16 v[112:115], a[120:123], v[208:211], v[112:115]
ds_read_b64_tr_b16 v[206:207], v229 offset:512
v_add_f32 v52, v32, v36
v_mfma_f32_16x16x32_bf16 v[116:119], a[124:127], v[208:211], v[116:119]
ds_read_b128 a[148:151], v233 offset:10240
s_waitcnt lgkmcnt(9)
v_mfma_f32_16x16x32_bf16 v[120:123], a[112:115], v[212:215], v[120:123]
ds_read_b64_tr_b16 v[208:209], v230 offset:0
v_add_f32 v53, v33, v37
v_mfma_f32_16x16x32_bf16 v[124:127], a[116:119], v[212:215], v[124:127]
ds_read_b128 a[152:155], v233 offset:12288
v_add_f32 v54, v34, v38
v_mfma_f32_16x16x32_bf16 v[128:131], a[120:123], v[212:215], v[128:131]
ds_read_b64_tr_b16 v[210:211], v230 offset:512
v_add_f32 v55, v35, v39
v_mfma_f32_16x16x32_bf16 v[132:135], a[124:127], v[212:215], v[132:135]
ds_read_b128 a[156:159], v233 offset:14336
s_waitcnt lgkmcnt(9)
s_lshr_b32 s68, s2, 3
s_lshl_b32 s68, s68, 2
s_add_u32 s68, s68, s40
s_lshl_b32 s68, s68, 15
s_bfe_u32 s69, s2, 0x10001
s_lshl_b32 s69, s69, 12
s_add_u32 s68, s68, s69
v_bfe_u32 v224, v1, 3, 2
v_lshlrev_b32 v224, 13, v224
v_and_b32 v225, 7, v1
v_lshl_add_u32 v224, v225, 9, v224
buffer_load_dword v221, v224, s[12:15], s68 offen offset:128
v_mfma_f32_16x16x32_bf16 v[72:75], a[128:131], v[200:203], v[72:75]
ds_read_b64_tr_b16 v[212:213], v231 offset:0
v_add_f32 v56, v40, v44
v_mfma_f32_16x16x32_bf16 v[76:79], a[132:135], v[200:203], v[76:79]
v_add_f32 v57, v41, v45
v_add_f32 v58, v42, v46
v_mfma_f32_16x16x32_bf16 v[80:83], a[136:139], v[200:203], v[80:83]
ds_read_b64_tr_b16 v[214:215], v231 offset:512
v_add_f32 v59, v43, v47
s_waitcnt lgkmcnt(10)
v_mfma_f32_16x16x32_bf16 v[84:87], a[140:143], v[200:203], v[84:87]
s_waitcnt lgkmcnt(7)
v_add_f32 v52, v52, v53
v_mfma_f32_16x16x32_bf16 v[88:91], a[128:131], v[204:207], v[88:91]
ds_read_b64_tr_b16 v[200:201], v228 offset:4096
s_waitcnt lgkmcnt(3)
v_mfma_f32_16x16x32_bf16 v[92:95], a[132:135], v[204:207], v[92:95]
s_add_u32 m0, s49, 8192
s_add_u32 s66, s48, 896
v_mfma_f32_16x16x32_bf16 v[96:99], a[136:139], v[204:207], v[96:99]
ds_read_b64_tr_b16 v[202:203], v228 offset:4608
buffer_load_dwordx4 v240, s[8:11], s66 offen offset:0 lds
v_mfma_f32_16x16x32_bf16 v[100:103], a[140:143], v[204:207], v[100:103]
buffer_load_dwordx4 v241, s[8:11], s66 offen offset:1024 lds
v_mfma_f32_16x16x32_bf16 v[104:107], a[128:131], v[208:211], v[104:107]
ds_read_b64_tr_b16 v[204:205], v229 offset:4096
buffer_load_dwordx4 v242, s[8:11], s66 offen offset:2048 lds
v_mfma_f32_16x16x32_bf16 v[108:111], a[132:135], v[208:211], v[108:111]
buffer_load_dwordx4 v243, s[8:11], s66 offen offset:3072 lds
s_add_u32 m0, s49, 12288
v_mfma_f32_16x16x32_bf16 v[112:115], a[136:139], v[208:211], v[112:115]
ds_read_b64_tr_b16 v[206:207], v229 offset:4608
s_add_u32 s66, s48, 33664
v_mfma_f32_16x16x32_bf16 v[116:119], a[140:143], v[208:211], v[116:119]
s_waitcnt lgkmcnt(4)
buffer_load_dwordx4 v240, s[8:11], s66 offen offset:0 lds
v_mfma_f32_16x16x32_bf16 v[120:123], a[128:131], v[212:215], v[120:123]
ds_read_b64_tr_b16 v[208:209], v230 offset:4096
buffer_load_dwordx4 v241, s[8:11], s66 offen offset:1024 lds
v_mfma_f32_16x16x32_bf16 v[124:127], a[132:135], v[212:215], v[124:127]
buffer_load_dwordx4 v242, s[8:11], s66 offen offset:2048 lds
buffer_load_dwordx4 v243, s[8:11], s66 offen offset:3072 lds
v_mfma_f32_16x16x32_bf16 v[128:131], a[136:139], v[212:215], v[128:131]
ds_read_b64_tr_b16 v[210:211], v230 offset:4608
v_add_f32 v54, v54, v55
v_mfma_f32_16x16x32_bf16 v[132:135], a[140:143], v[212:215], v[132:135]
s_waitcnt lgkmcnt(4)
v_add_f32 v56, v56, v57
v_mfma_f32_16x16x32_bf16 v[72:75], a[144:147], v[200:203], v[72:75]
ds_read_b64_tr_b16 v[212:213], v231 offset:4096
v_add_f32 v58, v58, v59
v_mfma_f32_16x16x32_bf16 v[76:79], a[148:151], v[200:203], v[76:79]
s_waitcnt vmcnt(21)
ds_read_b128 a[160:163], v232 offset:16384
v_add_f32 v48, v52, v54
v_mfma_f32_16x16x32_bf16 v[80:83], a[152:155], v[200:203], v[80:83]
ds_read_b64_tr_b16 v[214:215], v231 offset:4608
v_add_f32 v49, v56, v58
v_mfma_f32_16x16x32_bf16 v[84:87], a[156:159], v[200:203], v[84:87]
ds_read_b128 a[164:167], v232 offset:18432
s_waitcnt lgkmcnt(6)
v_mfma_f32_16x16x32_bf16 v[88:91], a[144:147], v[204:207], v[88:91]
ds_read_b64_tr_b16 v[200:201], v228 offset:8192
v_add_f32_dpp v48, v48, v48 quad_perm:[1,0,3,2] row_mask:0xf bank_mask:0xf
v_mfma_f32_16x16x32_bf16 v[92:95], a[148:151], v[204:207], v[92:95]
ds_read_b128 a[168:171], v232 offset:20480
v_add_f32_dpp v49, v49, v49 quad_perm:[1,0,3,2] row_mask:0xf bank_mask:0xf
v_mfma_f32_16x16x32_bf16 v[96:99], a[152:155], v[204:207], v[96:99]
ds_read_b64_tr_b16 v[202:203], v228 offset:8704
v_add_f32_dpp v48, v48, v48 quad_perm:[2,3,0,1] row_mask:0xf bank_mask:0xf
v_mfma_f32_16x16x32_bf16 v[100:103], a[156:159], v[204:207], v[100:103]
ds_read_b128 a[172:175], v232 offset:22528
s_waitcnt lgkmcnt(8)
v_mfma_f32_16x16x32_bf16 v[104:107], a[144:147], v[208:211], v[104:107]
ds_read_b64_tr_b16 v[204:205], v229 offset:8192
v_add_f32_dpp v49, v49, v49 quad_perm:[2,3,0,1] row_mask:0xf bank_mask:0xf
v_mfma_f32_16x16x32_bf16 v[108:111], a[148:151], v[208:211], v[108:111]
ds_read_b128 a[176:179], v233 offset:16384
v_add_f32_dpp v48, v48, v48 row_half_mirror row_mask:0xf bank_mask:0xf
v_mfma_f32_16x16x32_bf16 v[112:115], a[152:155], v[208:211], v[112:115]
ds_read_b64_tr_b16 v[206:207], v229 offset:8704
v_add_f32_dpp v49, v49, v49 row_half_mirror row_mask:0xf bank_mask:0xf
v_mfma_f32_16x16x32_bf16 v[116:119], a[156:159], v[208:211], v[116:119]
ds_read_b128 a[180:183], v233 offset:18432
s_waitcnt lgkmcnt(9)
v_mfma_f32_16x16x32_bf16 v[120:123], a[144:147], v[212:215], v[120:123]
ds_read_b64_tr_b16 v[208:209], v230 offset:8192
v_add_f32_dpp v48, v48, v48 row_mirror row_mask:0xf bank_mask:0xf
v_mfma_f32_16x16x32_bf16 v[124:127], a[148:151], v[212:215], v[124:127]
ds_read_b128 a[184:187], v233 offset:20480
v_add_f32_dpp v49, v49, v49 row_mirror row_mask:0xf bank_mask:0xf
v_mfma_f32_16x16x32_bf16 v[128:131], a[152:155], v[212:215], v[128:131]
ds_read_b64_tr_b16 v[210:211], v230 offset:8704
v_mov_b32 v50, v48
v_mfma_f32_16x16x32_bf16 v[132:135], a[156:159], v[212:215], v[132:135]
ds_read_b128 a[188:191], v233 offset:22528
s_waitcnt lgkmcnt(9)
v_mfma_f32_16x16x32_bf16 v[72:75], a[160:163], v[200:203], v[72:75]
ds_read_b64_tr_b16 v[212:213], v231 offset:8192
v_mov_b32 v51, v49
v_mfma_f32_16x16x32_bf16 v[76:79], a[164:167], v[200:203], v[76:79]
v_permlane16_swap_b32 v48, v50
v_permlane16_swap_b32 v49, v51
v_mfma_f32_16x16x32_bf16 v[80:83], a[168:171], v[200:203], v[80:83]
ds_read_b64_tr_b16 v[214:215], v231 offset:8704
v_add_f32 v48, v48, v50
s_waitcnt lgkmcnt(10)
v_mfma_f32_16x16x32_bf16 v[84:87], a[172:175], v[200:203], v[84:87]
s_waitcnt lgkmcnt(7)
v_add_f32 v49, v49, v51
v_mfma_f32_16x16x32_bf16 v[88:91], a[160:163], v[204:207], v[88:91]
ds_read_b64_tr_b16 v[200:201], v228 offset:12288
v_mov_b32 v50, v48
v_mfma_f32_16x16x32_bf16 v[92:95], a[164:167], v[204:207], v[92:95]
v_mov_b32 v51, v49
v_permlane32_swap_b32 v48, v50
v_mfma_f32_16x16x32_bf16 v[96:99], a[168:171], v[204:207], v[96:99]
ds_read_b64_tr_b16 v[202:203], v228 offset:12800
v_permlane32_swap_b32 v49, v51
v_mfma_f32_16x16x32_bf16 v[100:103], a[172:175], v[204:207], v[100:103]
s_waitcnt lgkmcnt(5)
v_add_f32 v48, v48, v50
v_mfma_f32_16x16x32_bf16 v[104:107], a[160:163], v[208:211], v[104:107]
ds_read_b64_tr_b16 v[204:205], v229 offset:12288
v_add_f32 v49, v49, v51
s_and_b32 s69, s2, 3
s_lshl_b32 s69, s69, 6
buffer_atomic_add v6, v3, s[36:39], s69 offen sc1
v_mfma_f32_16x16x32_bf16 v[108:111], a[164:167], v[208:211], v[108:111]
v_mul_f32 v48, 0x3b000000, v48
v_mul_f32 v49, 0x3b000000, v49
v_mfma_f32_16x16x32_bf16 v[112:115], a[168:171], v[208:211], v[112:115]
ds_read_b64_tr_b16 v[206:207], v229 offset:12800
v_sub_f32 v32, v32, v48
v_mfma_f32_16x16x32_bf16 v[116:119], a[172:175], v[208:211], v[116:119]
s_waitcnt lgkmcnt(4)
v_sub_f32 v40, v40, v49
v_mfma_f32_16x16x32_bf16 v[120:123], a[160:163], v[212:215], v[120:123]
ds_read_b64_tr_b16 v[208:209], v230 offset:12288
v_sub_f32 v33, v33, v48
v_mfma_f32_16x16x32_bf16 v[124:127], a[164:167], v[212:215], v[124:127]
v_sub_f32 v41, v41, v49
v_sub_f32 v34, v34, v48
v_mfma_f32_16x16x32_bf16 v[128:131], a[168:171], v[212:215], v[128:131]
ds_read_b64_tr_b16 v[210:211], v230 offset:12800
v_sub_f32 v42, v42, v49
v_mfma_f32_16x16x32_bf16 v[132:135], a[172:175], v[212:215], v[132:135]
s_waitcnt lgkmcnt(4)
v_sub_f32 v35, v35, v48
v_mfma_f32_16x16x32_bf16 v[72:75], a[176:179], v[200:203], v[72:75]
ds_read_b64_tr_b16 v[212:213], v231 offset:12288
v_sub_f32 v43, v43, v49
v_mfma_f32_16x16x32_bf16 v[76:79], a[180:183], v[200:203], v[76:79]
s_waitcnt vmcnt(14)
ds_read_b128 a[192:195], v232 offset:0
s_barrier
v_mfma_f32_16x16x32_bf16 v[80:83], a[184:187], v[200:203], v[80:83]
ds_read_b64_tr_b16 v[214:215], v231 offset:12800
v_sub_f32 v36, v36, v48
v_mfma_f32_16x16x32_bf16 v[84:87], a[188:191], v[200:203], v[84:87]
ds_read_b128 a[196:199], v232 offset:2048
s_waitcnt lgkmcnt(6)
v_mfma_f32_16x16x32_bf16 v[88:91], a[176:179], v[204:207], v[88:91]
ds_read_b64_tr_b16 v[200:201], v228 offset:16384
v_sub_f32 v44, v44, v49
v_mfma_f32_16x16x32_bf16 v[92:95], a[180:183], v[204:207], v[92:95]
ds_read_b128 a[200:203], v232 offset:4096
s_add_u32 m0, s42, 49152
s_add_u32 s65, s47, 1048704
v_mfma_f32_16x16x32_bf16 v[96:99], a[184:187], v[204:207], v[96:99]
ds_read_b64_tr_b16 v[202:203], v228 offset:16896
buffer_load_dwordx4 v236, s[12:15], s65 offen offset:0 lds
v_mfma_f32_16x16x32_bf16 v[100:103], a[188:191], v[204:207], v[100:103]
ds_read_b128 a[204:207], v232 offset:6144
s_waitcnt lgkmcnt(8)
buffer_load_dwordx4 v237, s[12:15], s65 offen offset:1024 lds
v_mfma_f32_16x16x32_bf16 v[104:107], a[176:179], v[208:211], v[104:107]
ds_read_b64_tr_b16 v[204:205], v229 offset:16384
buffer_load_dwordx4 v238, s[12:15], s65 offen offset:2048 lds
v_mfma_f32_16x16x32_bf16 v[108:111], a[180:183], v[208:211], v[108:111]
ds_read_b128 a[208:211], v233 offset:0
buffer_load_dwordx4 v239, s[12:15], s65 offen offset:3072 lds
v_mfma_f32_16x16x32_bf16 v[112:115], a[184:187], v[208:211], v[112:115]
ds_read_b64_tr_b16 v[206:207], v229 offset:16896
v_sub_f32 v37, v37, v48
v_mfma_f32_16x16x32_bf16 v[116:119], a[188:191], v[208:211], v[116:119]
ds_read_b128 a[212:215], v233 offset:2048
s_waitcnt lgkmcnt(9)
v_mfma_f32_16x16x32_bf16 v[120:123], a[176:179], v[212:215], v[120:123]
ds_read_b64_tr_b16 v[208:209], v230 offset:16384
v_sub_f32 v45, v45, v49
v_mfma_f32_16x16x32_bf16 v[124:127], a[180:183], v[212:215], v[124:127]
ds_read_b128 a[216:219], v233 offset:4096
v_sub_f32 v38, v38, v48
v_mfma_f32_16x16x32_bf16 v[128:131], a[184:187], v[212:215], v[128:131]
ds_read_b64_tr_b16 v[210:211], v230 offset:16896
v_sub_f32 v46, v46, v49
v_mfma_f32_16x16x32_bf16 v[132:135], a[188:191], v[212:215], v[132:135]
ds_read_b128 a[220:223], v233 offset:6144
s_waitcnt lgkmcnt(9)
s_lshr_b32 s68, s2, 3
s_lshl_b32 s68, s68, 2
s_add_u32 s68, s68, s40
s_lshl_b32 s68, s68, 15
s_bfe_u32 s69, s2, 0x10001
s_lshl_b32 s69, s69, 12
s_add_u32 s68, s68, s69
v_bfe_u32 v224, v1, 3, 2
v_lshlrev_b32 v224, 13, v224
v_and_b32 v225, 7, v1
v_lshl_add_u32 v224, v225, 9, v224
buffer_load_dword v222, v224, s[12:15], s68 offen offset:256
v_mfma_f32_16x16x32_bf16 v[72:75], a[192:195], v[200:203], v[72:75]
ds_read_b64_tr_b16 v[212:213], v231 offset:16384
v_sub_f32 v39, v39, v48
v_mfma_f32_16x16x32_bf16 v[76:79], a[196:199], v[200:203], v[76:79]
v_sub_f32 v47, v47, v49
v_mul_f32 v52, v32, v32
v_mfma_f32_16x16x32_bf16 v[80:83], a[200:203], v[200:203], v[80:83]
ds_read_b64_tr_b16 v[214:215], v231 offset:16896
v_mul_f32 v53, v33, v33
s_waitcnt lgkmcnt(10)
v_mfma_f32_16x16x32_bf16 v[84:87], a[204:207], v[200:203], v[84:87]
s_waitcnt lgkmcnt(7)
v_mul_f32 v56, v40, v40
v_mfma_f32_16x16x32_bf16 v[88:91], a[192:195], v[204:207], v[88:91]
ds_read_b64_tr_b16 v[200:201], v228 offset:20480
v_mul_f32 v57, v41, v41
v_mfma_f32_16x16x32_bf16 v[92:95], a[196:199], v[204:207], v[92:95]
v_fmac_f32 v52, v34, v34
v_fmac_f32 v56, v42, v42
v_mfma_f32_16x16x32_bf16 v[96:99], a[200:203], v[204:207], v[96:99]
ds_read_b64_tr_b16 v[202:203], v228 offset:20992
v_fmac_f32 v53, v35, v35
v_mfma_f32_16x16x32_bf16 v[100:103], a[204:207], v[204:207], v[100:103]
s_waitcnt lgkmcnt(5)
v_fmac_f32 v57, v43, v43
v_mfma_f32_16x16x32_bf16 v[104:107], a[192:195], v[208:211], v[104:107]
ds_read_b64_tr_b16 v[204:205], v229 offset:20480
v_fmac_f32 v52, v36, v36
v_mfma_f32_16x16x32_bf16 v[108:111], a[196:199], v[208:211], v[108:111]
v_fmac_f32 v56, v44, v44
v_fmac_f32 v53, v37, v37
v_mfma_f32_16x16x32_bf16 v[112:115], a[200:203], v[208:211], v[112:115]
ds_read_b64_tr_b16 v[206:207], v229 offset:20992
v_fmac_f32 v57, v45, v45
v_mfma_f32_16x16x32_bf16 v[116:119], a[204:207], v[208:211], v[116:119]
s_waitcnt lgkmcnt(4)
v_fmac_f32 v52, v38, v38
v_mfma_f32_16x16x32_bf16 v[120:123], a[192:195], v[212:215], v[120:123]
ds_read_b64_tr_b16 v[208:209], v230 offset:20480
v_fmac_f32 v56, v46, v46
v_mfma_f32_16x16x32_bf16 v[124:127], a[196:199], v[212:215], v[124:127]
v_fmac_f32 v53, v39, v39
v_fmac_f32 v57, v47, v47
v_mfma_f32_16x16x32_bf16 v[128:131], a[200:203], v[212:215], v[128:131]
ds_read_b64_tr_b16 v[210:211], v230 offset:20992
v_add_f32 v48, v52, v53
v_mfma_f32_16x16x32_bf16 v[132:135], a[204:207], v[212:215], v[132:135]
s_waitcnt lgkmcnt(4)
v_add_f32 v49, v56, v57
v_mfma_f32_16x16x32_bf16 v[72:75], a[208:211], v[200:203], v[72:75]
ds_read_b64_tr_b16 v[212:213], v231 offset:20480
v_add_f32_dpp v48, v48, v48 quad_perm:[1,0,3,2] row_mask:0xf bank_mask:0xf
v_mfma_f32_16x16x32_bf16 v[76:79], a[212:215], v[200:203], v[76:79]
s_waitcnt vmcnt(6)
ds_read_b128 a[224:227], v232 offset:8192
v_add_f32_dpp v49, v49, v49 quad_perm:[1,0,3,2] row_mask:0xf bank_mask:0xf
v_mfma_f32_16x16x32_bf16 v[80:83], a[216:219], v[200:203], v[80:83]
ds_read_b64_tr_b16 v[214:215], v231 offset:20992
v_add_f32_dpp v48, v48, v48 quad_perm:[2,3,0,1] row_mask:0xf bank_mask:0xf
v_mfma_f32_16x16x32_bf16 v[84:87], a[220:223], v[200:203], v[84:87]
ds_read_b128 a[228:231], v232 offset:10240
s_waitcnt lgkmcnt(6)
v_mfma_f32_16x16x32_bf16 v[88:91], a[208:211], v[204:207], v[88:91]
ds_read_b64_tr_b16 v[200:201], v228 offset:24576
v_add_f32_dpp v49, v49, v49 quad_perm:[2,3,0,1] row_mask:0xf bank_mask:0xf
v_mfma_f32_16x16x32_bf16 v[92:95], a[212:215], v[204:207], v[92:95]
ds_read_b128 a[232:235], v232 offset:12288
v_add_f32_dpp v48, v48, v48 row_half_mirror row_mask:0xf bank_mask:0xf
v_mfma_f32_16x16x32_bf16 v[96:99], a[216:219], v[204:207], v[96:99]
ds_read_b64_tr_b16 v[202:203], v228 offset:25088
v_add_f32_dpp v49, v49, v49 row_half_mirror row_mask:0xf bank_mask:0xf
v_mfma_f32_16x16x32_bf16 v[100:103], a[220:223], v[204:207], v[100:103]
ds_read_b128 a[236:239], v232 offset:14336
s_waitcnt lgkmcnt(8)
v_mfma_f32_16x16x32_bf16 v[104:107], a[208:211], v[208:211], v[104:107]
ds_read_b64_tr_b16 v[204:205], v229 offset:24576
v_add_f32_dpp v48, v48, v48 row_mirror row_mask:0xf bank_mask:0xf
v_mfma_f32_16x16x32_bf16 v[108:111], a[212:215], v[208:211], v[108:111]
ds_read_b128 a[240:243], v233 offset:8192
v_add_f32_dpp v49, v49, v49 row_mirror row_mask:0xf bank_mask:0xf
v_mfma_f32_16x16x32_bf16 v[112:115], a[216:219], v[208:211], v[112:115]
ds_read_b64_tr_b16 v[206:207], v229 offset:25088
v_mov_b32 v50, v48
v_mfma_f32_16x16x32_bf16 v[116:119], a[220:223], v[208:211], v[116:119]
ds_read_b128 a[244:247], v233 offset:10240
s_waitcnt lgkmcnt(9)
v_mfma_f32_16x16x32_bf16 v[120:123], a[208:211], v[212:215], v[120:123]
ds_read_b64_tr_b16 v[208:209], v230 offset:24576
v_mov_b32 v51, v49
v_mfma_f32_16x16x32_bf16 v[124:127], a[212:215], v[212:215], v[124:127]
ds_read_b128 a[248:251], v233 offset:12288
v_permlane16_swap_b32 v48, v50
v_mfma_f32_16x16x32_bf16 v[128:131], a[216:219], v[212:215], v[128:131]
ds_read_b64_tr_b16 v[210:211], v230 offset:25088
v_permlane16_swap_b32 v49, v51
v_mfma_f32_16x16x32_bf16 v[132:135], a[220:223], v[212:215], v[132:135]
ds_read_b128 a[252:255], v233 offset:14336
s_waitcnt lgkmcnt(9)
v_mfma_f32_16x16x32_bf16 v[72:75], a[224:227], v[200:203], v[72:75]
ds_read_b64_tr_b16 v[212:213], v231 offset:24576
v_add_f32 v48, v48, v50
v_mfma_f32_16x16x32_bf16 v[76:79], a[228:231], v[200:203], v[76:79]
v_add_f32 v49, v49, v51
v_mov_b32 v50, v48
v_mfma_f32_16x16x32_bf16 v[80:83], a[232:235], v[200:203], v[80:83]
ds_read_b64_tr_b16 v[214:215], v231 offset:25088
v_mov_b32 v51, v49
s_waitcnt lgkmcnt(10)
v_mfma_f32_16x16x32_bf16 v[84:87], a[236:239], v[200:203], v[84:87]
s_waitcnt lgkmcnt(7)
v_permlane32_swap_b32 v48, v50
v_mfma_f32_16x16x32_bf16 v[88:91], a[224:227], v[204:207], v[88:91]
ds_read_b64_tr_b16 v[200:201], v228 offset:28672
v_permlane32_swap_b32 v49, v51
v_mfma_f32_16x16x32_bf16 v[92:95], a[228:231], v[204:207], v[92:95]
v_add_f32 v48, v48, v50
v_add_f32 v49, v49, v51
v_mfma_f32_16x16x32_bf16 v[96:99], a[232:235], v[204:207], v[96:99]
ds_read_b64_tr_b16 v[202:203], v228 offset:29184
v_mov_b32 v50, 0x3727c5ac
v_mfma_f32_16x16x32_bf16 v[100:103], a[236:239], v[204:207], v[100:103]
s_waitcnt lgkmcnt(5)
v_mov_b32 v51, 0x3727c5ac
v_mfma_f32_16x16x32_bf16 v[104:107], a[224:227], v[208:211], v[104:107]
ds_read_b64_tr_b16 v[204:205], v229 offset:28672
v_fmac_f32 v50, 0x3b000000, v48
v_mfma_f32_16x16x32_bf16 v[108:111], a[228:231], v[208:211], v[108:111]
v_fmac_f32 v51, 0x3b000000, v49
s_lshr_b32 s68, s2, 3
v_mfma_f32_16x16x32_bf16 v[112:115], a[232:235], v[208:211], v[112:115]
ds_read_b64_tr_b16 v[206:207], v229 offset:29184
s_lshl_b32 s68, s68, 2
v_mfma_f32_16x16x32_bf16 v[116:119], a[236:239], v[208:211], v[116:119]
s_waitcnt lgkmcnt(4)
s_add_u32 s68, s68, s40
v_mfma_f32_16x16x32_bf16 v[120:123], a[224:227], v[212:215], v[120:123]
ds_read_b64_tr_b16 v[208:209], v230 offset:28672
s_lshl_b32 s68, s68, 15
v_mfma_f32_16x16x32_bf16 v[124:127], a[228:231], v[212:215], v[124:127]
v_rsq_f32 v50, v50
v_mfma_f32_16x16x32_bf16 v[128:131], a[232:235], v[212:215], v[128:131]
ds_read_b64_tr_b16 v[210:211], v230 offset:29184
s_bfe_u32 s69, s2, 0x10001
v_mfma_f32_16x16x32_bf16 v[132:135], a[236:239], v[212:215], v[132:135]
s_waitcnt lgkmcnt(4)
s_lshl_b32 s69, s69, 12
v_mfma_f32_16x16x32_bf16 v[72:75], a[240:243], v[200:203], v[72:75]
ds_read_b64_tr_b16 v[212:213], v231 offset:28672
v_rsq_f32 v51, v51
v_mul_f32 v32, v32, v50
v_mul_f32 v40, v40, v51
v_mul_f32 v33, v33, v50
v_mul_f32 v41, v41, v51
v_mul_f32 v34, v34, v50
v_mul_f32 v42, v42, v51
v_mul_f32 v35, v35, v50
v_mul_f32 v43, v43, v51
v_mul_f32 v36, v36, v50
v_mul_f32 v44, v44, v51
v_mul_f32 v37, v37, v50
v_mul_f32 v45, v45, v51
v_mul_f32 v38, v38, v50
v_mul_f32 v46, v46, v51
v_mul_f32 v39, v39, v50
v_mul_f32 v47, v47, v51
v_cvt_pk_bf16_f32 v52, v32, v33
v_cvt_pk_bf16_f32 v53, v34, v35
v_cvt_pk_bf16_f32 v54, v36, v37
v_cvt_pk_bf16_f32 v55, v38, v39
v_cvt_pk_bf16_f32 v56, v40, v41
v_cvt_pk_bf16_f32 v57, v42, v43
v_cvt_pk_bf16_f32 v58, v44, v45
v_cvt_pk_bf16_f32 v59, v46, v47
v_mfma_f32_16x16x32_bf16 v[76:79], a[244:247], v[200:203], v[76:79]
s_barrier
v_mfma_f32_16x16x32_bf16 v[80:83], a[248:251], v[200:203], v[80:83]
ds_read_b64_tr_b16 v[214:215], v231 offset:29184
s_add_u32 m0, s42, 0
v_mfma_f32_16x16x32_bf16 v[84:87], a[252:255], v[200:203], v[84:87]
s_waitcnt lgkmcnt(4)
s_add_u32 s65, s47, 2097280
v_mfma_f32_16x16x32_bf16 v[88:91], a[240:243], v[204:207], v[88:91]
ds_read_b64_tr_b16 v[200:201], v228 offset:32768
ds_write_b128 v60, v[52:55]
v_mfma_f32_16x16x32_bf16 v[92:95], a[244:247], v[204:207], v[92:95]
buffer_load_dwordx4 v236, s[12:15], s65 offen offset:0 lds
ds_write_b128 v60, v[56:59] offset:1040
v_mfma_f32_16x16x32_bf16 v[96:99], a[248:251], v[204:207], v[96:99]
ds_read_b64_tr_b16 v[202:203], v228 offset:33280
s_add_u32 s68, s68, s69
v_mfma_f32_16x16x32_bf16 v[100:103], a[252:255], v[204:207], v[100:103]
s_waitcnt lgkmcnt(6)
v_bfe_u32 v224, v1, 3, 2
v_mfma_f32_16x16x32_bf16 v[104:107], a[240:243], v[208:211], v[104:107]
ds_read_b64_tr_b16 v[204:205], v229 offset:32768
v_lshlrev_b32 v224, 13, v224
v_mfma_f32_16x16x32_bf16 v[108:111], a[244:247], v[208:211], v[108:111]
v_and_b32 v225, 7, v1
v_lshl_add_u32 v224, v225, 9, v224
v_mfma_f32_16x16x32_bf16 v[112:115], a[248:251], v[208:211], v[112:115]
ds_read_b64_tr_b16 v[206:207], v229 offset:33280
v_mfma_f32_16x16x32_bf16 v[116:119], a[252:255], v[208:211], v[116:119]
s_waitcnt lgkmcnt(6)
v_mfma_f32_16x16x32_bf16 v[120:123], a[240:243], v[212:215], v[120:123]
ds_read_b64_tr_b16 v[208:209], v230 offset:32768
v_mfma_f32_16x16x32_bf16 v[124:127], a[244:247], v[212:215], v[124:127]
buffer_load_dword v223, v224, s[12:15], s68 offen offset:384
v_mfma_f32_16x16x32_bf16 v[128:131], a[248:251], v[212:215], v[128:131]
ds_read_b64_tr_b16 v[210:211], v230 offset:33280
v_mfma_f32_16x16x32_bf16 v[132:135], a[252:255], v[212:215], v[132:135]
s_waitcnt lgkmcnt(4)
v_mfma_f32_16x16x32_bf16 v[136:139], a[0:3], v[200:203], 0
ds_read_b64_tr_b16 v[212:213], v231 offset:32768
v_mfma_f32_16x16x32_bf16 v[140:143], a[4:7], v[200:203], 0
buffer_load_dwordx4 v237, s[12:15], s65 offen offset:1024 lds
v_mfma_f32_16x16x32_bf16 v[144:147], a[8:11], v[200:203], 0
ds_read_b64_tr_b16 v[214:215], v231 offset:33280
s_mov_b32 s4, s84
v_mfma_f32_16x16x32_bf16 v[148:151], a[12:15], v[200:203], 0
s_waitcnt lgkmcnt(4)
s_mov_b32 s5, s85
v_mfma_f32_16x16x32_bf16 v[152:155], a[0:3], v[204:207], 0
ds_read_b64_tr_b16 v[200:201], v228 offset:36864
s_mov_b32 s6, 0x400000
v_mfma_f32_16x16x32_bf16 v[156:159], a[4:7], v[204:207], 0
s_mov_b32 s7, 0x20000
s_mov_b32 s8, s88
v_mfma_f32_16x16x32_bf16 v[160:163], a[8:11], v[204:207], 0
ds_read_b64_tr_b16 v[202:203], v228 offset:37376
s_mov_b32 s9, s89
v_mfma_f32_16x16x32_bf16 v[164:167], a[12:15], v[204:207], 0
s_waitcnt lgkmcnt(4)
s_mov_b32 s10, 0x158000
v_mfma_f32_16x16x32_bf16 v[168:171], a[0:3], v[208:211], 0
ds_read_b64_tr_b16 v[204:205], v229 offset:36864
s_mov_b32 s11, 0x20000
v_mfma_f32_16x16x32_bf16 v[172:175], a[4:7], v[208:211], 0
s_mov_b32 s28, s90
s_mov_b32 s29, s91
v_mfma_f32_16x16x32_bf16 v[176:179], a[8:11], v[208:211], 0
ds_read_b64_tr_b16 v[206:207], v229 offset:37376
s_mov_b32 s30, 0x158000
v_mfma_f32_16x16x32_bf16 v[180:183], a[12:15], v[208:211], 0
s_waitcnt lgkmcnt(4)
s_mov_b32 s31, 0x20000
v_mfma_f32_16x16x32_bf16 v[184:187], a[0:3], v[212:215], 0
ds_read_b64_tr_b16 v[208:209], v230 offset:36864
s_add_u32 s67, s50, 8192
v_mfma_f32_16x16x32_bf16 v[188:191], a[4:7], v[212:215], 0
v_cvt_pk_bf16_f32 v8, v72, v73
v_mfma_f32_16x16x32_bf16 v[192:195], a[8:11], v[212:215], 0
ds_read_b64_tr_b16 v[210:211], v230 offset:37376
v_mfma_f32_16x16x32_bf16 v[196:199], a[12:15], v[212:215], 0
s_waitcnt lgkmcnt(4)
v_cvt_pk_bf16_f32 v9, v74, v75
v_mfma_f32_16x16x32_bf16 v[136:139], a[16:19], v[200:203], v[136:139]
ds_read_b64_tr_b16 v[212:213], v231 offset:36864
v_mfma_f32_16x16x32_bf16 v[140:143], a[20:23], v[200:203], v[140:143]
buffer_load_dwordx4 v238, s[12:15], s65 offen offset:2048 lds
v_mfma_f32_16x16x32_bf16 v[144:147], a[24:27], v[200:203], v[144:147]
ds_read_b64_tr_b16 v[214:215], v231 offset:37376
v_mfma_f32_16x16x32_bf16 v[148:151], a[28:31], v[200:203], v[148:151]
s_waitcnt lgkmcnt(4)
v_cvt_pk_bf16_f32 v10, v76, v77
v_mfma_f32_16x16x32_bf16 v[152:155], a[16:19], v[204:207], v[152:155]
ds_read_b64_tr_b16 v[200:201], v228 offset:40960
v_mfma_f32_16x16x32_bf16 v[156:159], a[20:23], v[204:207], v[156:159]
v_mfma_f32_16x16x32_bf16 v[160:163], a[24:27], v[204:207], v[160:163]
ds_read_b64_tr_b16 v[202:203], v228 offset:41472
v_mfma_f32_16x16x32_bf16 v[164:167], a[28:31], v[204:207], v[164:167]
s_waitcnt lgkmcnt(4)
v_mfma_f32_16x16x32_bf16 v[168:171], a[16:19], v[208:211], v[168:171]
ds_read_b64_tr_b16 v[204:205], v229 offset:40960
s_lshr_b32 s68, s2, 3
v_mfma_f32_16x16x32_bf16 v[172:175], a[20:23], v[208:211], v[172:175]
s_lshl_b32 s68, s68, 2
s_add_u32 s68, s68, s40
v_mfma_f32_16x16x32_bf16 v[176:179], a[24:27], v[208:211], v[176:179]
ds_read_b64_tr_b16 v[206:207], v229 offset:41472
s_bfe_u32 s69, s2, 0x20001
v_mfma_f32_16x16x32_bf16 v[180:183], a[28:31], v[208:211], v[180:183]
s_waitcnt lgkmcnt(4)
s_lshl_b32 s68, s68, 15
v_mfma_f32_16x16x32_bf16 v[184:187], a[16:19], v[212:215], v[184:187]
ds_read_b64_tr_b16 v[208:209], v230 offset:40960
s_lshl_b32 s69, s69, 11
v_cvt_pk_bf16_f32 v11, v78, v79
v_mfma_f32_16x16x32_bf16 v[188:191], a[20:23], v[212:215], v[188:191]
s_add_u32 s68, s68, s69
v_bfe_u32 v224, v1, 3, 2
buffer_store_dwordx4 v[8:11], v2, s[20:23], s67 offen offset:0 sc1
v_mfma_f32_16x16x32_bf16 v[192:195], a[24:27], v[212:215], v[192:195]
ds_read_b64_tr_b16 v[210:211], v230 offset:41472
v_lshlrev_b32 v224, 13, v224
v_mfma_f32_16x16x32_bf16 v[196:199], a[28:31], v[212:215], v[196:199]
s_waitcnt lgkmcnt(4)
v_and_b32 v225, 7, v1
v_mfma_f32_16x16x32_bf16 v[136:139], a[32:35], v[200:203], v[136:139]
ds_read_b64_tr_b16 v[212:213], v231 offset:40960
v_lshl_add_u32 v224, v225, 7, v224
v_mfma_f32_16x16x32_bf16 v[140:143], a[36:39], v[200:203], v[140:143]
buffer_load_dwordx4 v239, s[12:15], s65 offen offset:3072 lds
v_mfma_f32_16x16x32_bf16 v[144:147], a[40:43], v[200:203], v[144:147]
ds_read_b64_tr_b16 v[214:215], v231 offset:41472
v_cvt_pk_bf16_f32 v12, v88, v89
v_mfma_f32_16x16x32_bf16 v[148:151], a[44:47], v[200:203], v[148:151]
s_waitcnt lgkmcnt(4)
v_mfma_f32_16x16x32_bf16 v[152:155], a[32:35], v[204:207], v[152:155]
ds_read_b64_tr_b16 v[200:201], v228 offset:45056
v_mfma_f32_16x16x32_bf16 v[156:159], a[36:39], v[204:207], v[156:159]
buffer_load_dword v220, v224, s[4:7], s68 offen offset:0
v_mfma_f32_16x16x32_bf16 v[160:163], a[40:43], v[204:207], v[160:163]
ds_read_b64_tr_b16 v[202:203], v228 offset:45568
v_mfma_f32_16x16x32_bf16 v[164:167], a[44:47], v[204:207], v[164:167]
s_waitcnt lgkmcnt(4)
v_cvt_pk_bf16_f32 v13, v90, v91
v_mfma_f32_16x16x32_bf16 v[168:171], a[32:35], v[208:211], v[168:171]
ds_read_b64_tr_b16 v[204:205], v229 offset:45056
v_mfma_f32_16x16x32_bf16 v[172:175], a[36:39], v[208:211], v[172:175]
v_mfma_f32_16x16x32_bf16 v[176:179], a[40:43], v[208:211], v[176:179]
ds_read_b64_tr_b16 v[206:207], v229 offset:45568
v_mfma_f32_16x16x32_bf16 v[180:183], a[44:47], v[208:211], v[180:183]
s_waitcnt lgkmcnt(4)
v_mfma_f32_16x16x32_bf16 v[184:187], a[32:35], v[212:215], v[184:187]
ds_read_b64_tr_b16 v[208:209], v230 offset:45056
v_mfma_f32_16x16x32_bf16 v[188:191], a[36:39], v[212:215], v[188:191]
v_cvt_pk_bf16_f32 v14, v92, v93
v_mfma_f32_16x16x32_bf16 v[192:195], a[40:43], v[212:215], v[192:195]
ds_read_b64_tr_b16 v[210:211], v230 offset:45568
v_mfma_f32_16x16x32_bf16 v[196:199], a[44:47], v[212:215], v[196:199]
s_waitcnt lgkmcnt(4)
v_mfma_f32_16x16x32_bf16 v[136:139], a[48:51], v[200:203], v[136:139]
ds_read_b64_tr_b16 v[212:213], v231 offset:45056
v_mfma_f32_16x16x32_bf16 v[140:143], a[52:55], v[200:203], v[140:143]
s_waitcnt vmcnt(8)
s_barrier
v_mfma_f32_16x16x32_bf16 v[144:147], a[56:59], v[200:203], v[144:147]
ds_read_b64_tr_b16 v[214:215], v231 offset:45568
s_add_u32 m0, s42, 16384
v_mfma_f32_16x16x32_bf16 v[148:151], a[60:63], v[200:203], v[148:151]
s_waitcnt lgkmcnt(4)
s_add_u32 s65, s47, 3145856
v_mfma_f32_16x16x32_bf16 v[152:155], a[48:51], v[204:207], v[152:155]
ds_read_b64_tr_b16 v[200:201], v228 offset:49152
ds_read_b128 v[32:35], v62
v_mfma_f32_16x16x32_bf16 v[156:159], a[52:55], v[204:207], v[156:159]
buffer_load_dwordx4 v236, s[12:15], s65 offen offset:0 lds
ds_read_b128 v[36:39], v62 offset:128
v_mfma_f32_16x16x32_bf16 v[160:163], a[56:59], v[204:207], v[160:163]
ds_read_b64_tr_b16 v[202:203], v228 offset:49664
v_cvt_pk_bf16_f32 v15, v94, v95
v_mfma_f32_16x16x32_bf16 v[164:167], a[60:63], v[204:207], v[164:167]
s_waitcnt lgkmcnt(6)
v_mfma_f32_16x16x32_bf16 v[168:171], a[48:51], v[208:211], v[168:171]
ds_read_b64_tr_b16 v[204:205], v229 offset:49152
v_mfma_f32_16x16x32_bf16 v[172:175], a[52:55], v[208:211], v[172:175]
buffer_store_dwordx4 v[12:15], v2, s[20:23], s67 offen offset:1024 sc1
v_mfma_f32_16x16x32_bf16 v[176:179], a[56:59], v[208:211], v[176:179]
ds_read_b64_tr_b16 v[206:207], v229 offset:49664
v_mfma_f32_16x16x32_bf16 v[180:183], a[60:63], v[208:211], v[180:183]
s_waitcnt lgkmcnt(6)
v_mfma_f32_16x16x32_bf16 v[184:187], a[48:51], v[212:215], v[184:187]
ds_read_b64_tr_b16 v[208:209], v230 offset:49152
v_mfma_f32_16x16x32_bf16 v[188:191], a[52:55], v[212:215], v[188:191]
v_mfma_f32_16x16x32_bf16 v[192:195], a[56:59], v[212:215], v[192:195]
ds_read_b64_tr_b16 v[210:211], v230 offset:49664
v_cvt_pk_bf16_f32 v16, v104, v105
v_mfma_f32_16x16x32_bf16 v[196:199], a[60:63], v[212:215], v[196:199]
s_waitcnt lgkmcnt(4)
v_mfma_f32_16x16x32_bf16 v[136:139], a[64:67], v[200:203], v[136:139]
ds_read_b64_tr_b16 v[212:213], v231 offset:49152
v_mfma_f32_16x16x32_bf16 v[140:143], a[68:71], v[200:203], v[140:143]
buffer_load_dwordx4 v237, s[12:15], s65 offen offset:1024 lds
v_mfma_f32_16x16x32_bf16 v[144:147], a[72:75], v[200:203], v[144:147]
ds_read_b64_tr_b16 v[214:215], v231 offset:49664
v_mfma_f32_16x16x32_bf16 v[148:151], a[76:79], v[200:203], v[148:151]
s_waitcnt lgkmcnt(4)
v_cvt_pk_bf16_f32 v17, v106, v107
v_mfma_f32_16x16x32_bf16 v[152:155], a[64:67], v[204:207], v[152:155]
ds_read_b64_tr_b16 v[200:201], v228 offset:53248
v_mfma_f32_16x16x32_bf16 v[156:159], a[68:71], v[204:207], v[156:159]
v_mfma_f32_16x16x32_bf16 v[160:163], a[72:75], v[204:207], v[160:163]
ds_read_b64_tr_b16 v[202:203], v228 offset:53760
v_mfma_f32_16x16x32_bf16 v[164:167], a[76:79], v[204:207], v[164:167]
s_waitcnt lgkmcnt(4)
v_mfma_f32_16x16x32_bf16 v[168:171], a[64:67], v[208:211], v[168:171]
ds_read_b64_tr_b16 v[204:205], v229 offset:53248
v_mfma_f32_16x16x32_bf16 v[172:175], a[68:71], v[208:211], v[172:175]
v_cvt_pk_bf16_f32 v18, v108, v109
v_mfma_f32_16x16x32_bf16 v[176:179], a[72:75], v[208:211], v[176:179]
ds_read_b64_tr_b16 v[206:207], v229 offset:53760
v_mfma_f32_16x16x32_bf16 v[180:183], a[76:79], v[208:211], v[180:183]
s_waitcnt lgkmcnt(4)
v_mfma_f32_16x16x32_bf16 v[184:187], a[64:67], v[212:215], v[184:187]
ds_read_b64_tr_b16 v[208:209], v230 offset:53248
v_mfma_f32_16x16x32_bf16 v[188:191], a[68:71], v[212:215], v[188:191]
buffer_store_dwordx4 v[32:35], v63, s[16:19], 0 offen sc1
v_mfma_f32_16x16x32_bf16 v[192:195], a[72:75], v[212:215], v[192:195]
ds_read_b64_tr_b16 v[210:211], v230 offset:53760
v_mfma_f32_16x16x32_bf16 v[196:199], a[76:79], v[212:215], v[196:199]
s_waitcnt lgkmcnt(4)
v_cvt_pk_bf16_f32 v19, v110, v111
v_mfma_f32_16x16x32_bf16 v[136:139], a[80:83], v[200:203], v[136:139]
ds_read_b64_tr_b16 v[212:213], v231 offset:53248
v_mfma_f32_16x16x32_bf16 v[140:143], a[84:87], v[200:203], v[140:143]
buffer_load_dwordx4 v238, s[12:15], s65 offen offset:2048 lds
v_mfma_f32_16x16x32_bf16 v[144:147], a[88:91], v[200:203], v[144:147]
ds_read_b64_tr_b16 v[214:215], v231 offset:53760
v_mfma_f32_16x16x32_bf16 v[148:151], a[92:95], v[200:203], v[148:151]
s_waitcnt lgkmcnt(4)
v_mfma_f32_16x16x32_bf16 v[152:155], a[80:83], v[204:207], v[152:155]
ds_read_b64_tr_b16 v[200:201], v228 offset:57344
v_mfma_f32_16x16x32_bf16 v[156:159], a[84:87], v[204:207], v[156:159]
buffer_store_dwordx4 v[36:39], v63, s[16:19], 0 offen offset:2048 sc1
v_mfma_f32_16x16x32_bf16 v[160:163], a[88:91], v[204:207], v[160:163]
ds_read_b64_tr_b16 v[202:203], v228 offset:57856
v_mfma_f32_16x16x32_bf16 v[164:167], a[92:95], v[204:207], v[164:167]
s_waitcnt lgkmcnt(4)
v_mfma_f32_16x16x32_bf16 v[168:171], a[80:83], v[208:211], v[168:171]
ds_read_b64_tr_b16 v[204:205], v229 offset:57344
s_lshr_b32 s68, s2, 3
v_mfma_f32_16x16x32_bf16 v[172:175], a[84:87], v[208:211], v[172:175]
s_lshl_b32 s68, s68, 2
s_add_u32 s68, s68, s40
buffer_store_dwordx4 v[16:19], v2, s[20:23], s67 offen offset:2048 sc1
v_mfma_f32_16x16x32_bf16 v[176:179], a[88:91], v[208:211], v[176:179]
ds_read_b64_tr_b16 v[206:207], v229 offset:57856
s_bfe_u32 s69, s2, 0x20001
v_mfma_f32_16x16x32_bf16 v[180:183], a[92:95], v[208:211], v[180:183]
s_waitcnt lgkmcnt(4)
s_lshl_b32 s68, s68, 15
v_mfma_f32_16x16x32_bf16 v[184:187], a[80:83], v[212:215], v[184:187]
ds_read_b64_tr_b16 v[208:209], v230 offset:57344
s_lshl_b32 s69, s69, 11
v_mfma_f32_16x16x32_bf16 v[188:191], a[84:87], v[212:215], v[188:191]
s_add_u32 s68, s68, s69
v_bfe_u32 v224, v1, 3, 2
v_mfma_f32_16x16x32_bf16 v[192:195], a[88:91], v[212:215], v[192:195]
ds_read_b64_tr_b16 v[210:211], v230 offset:57856
v_lshlrev_b32 v224, 13, v224
v_mfma_f32_16x16x32_bf16 v[196:199], a[92:95], v[212:215], v[196:199]
s_waitcnt lgkmcnt(4)
v_and_b32 v225, 7, v1
v_mfma_f32_16x16x32_bf16 v[136:139], a[96:99], v[200:203], v[136:139]
ds_read_b64_tr_b16 v[212:213], v231 offset:57344
v_lshl_add_u32 v224, v225, 7, v224
v_mfma_f32_16x16x32_bf16 v[140:143], a[100:103], v[200:203], v[140:143]
buffer_load_dwordx4 v239, s[12:15], s65 offen offset:3072 lds
v_cvt_pk_bf16_f32 v20, v120, v121
v_mfma_f32_16x16x32_bf16 v[144:147], a[104:107], v[200:203], v[144:147]
ds_read_b64_tr_b16 v[214:215], v231 offset:57856
v_cvt_pk_bf16_f32 v21, v122, v123
v_mfma_f32_16x16x32_bf16 v[148:151], a[108:111], v[200:203], v[148:151]
s_waitcnt lgkmcnt(4)
v_mfma_f32_16x16x32_bf16 v[152:155], a[96:99], v[204:207], v[152:155]
ds_read_b64_tr_b16 v[200:201], v228 offset:61440
v_mfma_f32_16x16x32_bf16 v[156:159], a[100:103], v[204:207], v[156:159]
buffer_load_dword v221, v224, s[4:7], s68 offen offset:1024
v_cvt_pk_bf16_f32 v22, v124, v125
v_mfma_f32_16x16x32_bf16 v[160:163], a[104:107], v[204:207], v[160:163]
ds_read_b64_tr_b16 v[202:203], v228 offset:61952
v_mfma_f32_16x16x32_bf16 v[164:167], a[108:111], v[204:207], v[164:167]
s_waitcnt lgkmcnt(4)
v_mfma_f32_16x16x32_bf16 v[168:171], a[96:99], v[208:211], v[168:171]
ds_read_b64_tr_b16 v[204:205], v229 offset:61440
v_mfma_f32_16x16x32_bf16 v[172:175], a[100:103], v[208:211], v[172:175]
v_mfma_f32_16x16x32_bf16 v[176:179], a[104:107], v[208:211], v[176:179]
ds_read_b64_tr_b16 v[206:207], v229 offset:61952
v_and_b32 v71, 3, v1
v_mfma_f32_16x16x32_bf16 v[180:183], a[108:111], v[208:211], v[180:183]
s_waitcnt lgkmcnt(4)
v_lshlrev_b32 v71, 6, v71
v_mfma_f32_16x16x32_bf16 v[184:187], a[96:99], v[212:215], v[184:187]
ds_read_b64_tr_b16 v[208:209], v230 offset:61440
buffer_load_dword v70, v71, s[36:39], 0 offen sc1
v_mfma_f32_16x16x32_bf16 v[188:191], a[100:103], v[212:215], v[188:191]
v_cvt_pk_bf16_f32 v23, v126, v127
v_mfma_f32_16x16x32_bf16 v[192:195], a[104:107], v[212:215], v[192:195]
ds_read_b64_tr_b16 v[210:211], v230 offset:61952
v_mfma_f32_16x16x32_bf16 v[196:199], a[108:111], v[212:215], v[196:199]
s_waitcnt lgkmcnt(4)
v_mfma_f32_16x16x32_bf16 v[136:139], a[112:115], v[200:203], v[136:139]
ds_read_b64_tr_b16 v[212:213], v231 offset:61440
v_mfma_f32_16x16x32_bf16 v[140:143], a[116:119], v[200:203], v[140:143]
s_waitcnt vmcnt(11)
s_barrier
v_mfma_f32_16x16x32_bf16 v[144:147], a[120:123], v[200:203], v[144:147]
ds_read_b64_tr_b16 v[214:215], v231 offset:61952
s_add_u32 m0, s42, 32768
v_mfma_f32_16x16x32_bf16 v[148:151], a[124:127], v[200:203], v[148:151]
s_waitcnt lgkmcnt(4)
s_add_u32 s65, s47, 256
v_mfma_f32_16x16x32_bf16 v[152:155], a[112:115], v[204:207], v[152:155]
ds_read_b64_tr_b16 v[200:201], v228 offset:0
v_mfma_f32_16x16x32_bf16 v[156:159], a[116:119], v[204:207], v[156:159]
buffer_load_dwordx4 v236, s[12:15], s65 offen offset:0 lds
v_mfma_f32_16x16x32_bf16 v[160:163], a[120:123], v[204:207], v[160:163]
ds_read_b64_tr_b16 v[202:203], v228 offset:512
v_mfma_f32_16x16x32_bf16 v[164:167], a[124:127], v[204:207], v[164:167]
s_waitcnt lgkmcnt(4)
v_mfma_f32_16x16x32_bf16 v[168:171], a[112:115], v[208:211], v[168:171]
ds_read_b64_tr_b16 v[204:205], v229 offset:0
v_mfma_f32_16x16x32_bf16 v[172:175], a[116:119], v[208:211], v[172:175]
buffer_store_dwordx4 v[20:23], v2, s[20:23], s67 offen offset:3072 sc1
s_add_u32 s67, s50, 24576
v_mfma_f32_16x16x32_bf16 v[176:179], a[120:123], v[208:211], v[176:179]
ds_read_b64_tr_b16 v[206:207], v229 offset:512
v_mfma_f32_16x16x32_bf16 v[180:183], a[124:127], v[208:211], v[180:183]
s_waitcnt lgkmcnt(4)
v_mfma_f32_16x16x32_bf16 v[184:187], a[112:115], v[212:215], v[184:187]
ds_read_b64_tr_b16 v[208:209], v230 offset:0
v_mfma_f32_16x16x32_bf16 v[188:191], a[116:119], v[212:215], v[188:191]
v_cvt_pk_bf16_f32 v8, v80, v81
v_mfma_f32_16x16x32_bf16 v[192:195], a[120:123], v[212:215], v[192:195]
ds_read_b64_tr_b16 v[210:211], v230 offset:512
v_mfma_f32_16x16x32_bf16 v[196:199], a[124:127], v[212:215], v[196:199]
s_waitcnt lgkmcnt(4)
v_mfma_f32_16x16x32_bf16 v[136:139], a[128:131], v[200:203], v[136:139]
ds_read_b64_tr_b16 v[212:213], v231 offset:0
v_mfma_f32_16x16x32_bf16 v[140:143], a[132:135], v[200:203], v[140:143]
buffer_load_dwordx4 v237, s[12:15], s65 offen offset:1024 lds
v_mfma_f32_16x16x32_bf16 v[144:147], a[136:139], v[200:203], v[144:147]
ds_read_b64_tr_b16 v[214:215], v231 offset:512
v_cvt_pk_bf16_f32 v9, v82, v83
v_mfma_f32_16x16x32_bf16 v[148:151], a[140:143], v[200:203], v[148:151]
s_waitcnt lgkmcnt(4)
v_mfma_f32_16x16x32_bf16 v[152:155], a[128:131], v[204:207], v[152:155]
ds_read_b64_tr_b16 v[200:201], v228 offset:4096
v_mfma_f32_16x16x32_bf16 v[156:159], a[132:135], v[204:207], v[156:159]
v_mfma_f32_16x16x32_bf16 v[160:163], a[136:139], v[204:207], v[160:163]
ds_read_b64_tr_b16 v[202:203], v228 offset:4608
v_cvt_pk_bf16_f32 v10, v84, v85
v_mfma_f32_16x16x32_bf16 v[164:167], a[140:143], v[204:207], v[164:167]
s_waitcnt lgkmcnt(4)
v_mfma_f32_16x16x32_bf16 v[168:171], a[128:131], v[208:211], v[168:171]
ds_read_b64_tr_b16 v[204:205], v229 offset:4096
v_mfma_f32_16x16x32_bf16 v[172:175], a[132:135], v[208:211], v[172:175]
v_mfma_f32_16x16x32_bf16 v[176:179], a[136:139], v[208:211], v[176:179]
ds_read_b64_tr_b16 v[206:207], v229 offset:4608
v_mfma_f32_16x16x32_bf16 v[180:183], a[140:143], v[208:211], v[180:183]
s_waitcnt lgkmcnt(4)
v_cvt_pk_bf16_f32 v11, v86, v87
v_mfma_f32_16x16x32_bf16 v[184:187], a[128:131], v[212:215], v[184:187]
ds_read_b64_tr_b16 v[208:209], v230 offset:4096
v_mfma_f32_16x16x32_bf16 v[188:191], a[132:135], v[212:215], v[188:191]
buffer_store_dwordx4 v[8:11], v2, s[20:23], s67 offen offset:0 sc1
v_mfma_f32_16x16x32_bf16 v[192:195], a[136:139], v[212:215], v[192:195]
ds_read_b64_tr_b16 v[210:211], v230 offset:4608
v_mfma_f32_16x16x32_bf16 v[196:199], a[140:143], v[212:215], v[196:199]
s_waitcnt lgkmcnt(4)
v_mfma_f32_16x16x32_bf16 v[136:139], a[144:147], v[200:203], v[136:139]
ds_read_b64_tr_b16 v[212:213], v231 offset:4096
v_mfma_f32_16x16x32_bf16 v[140:143], a[148:151], v[200:203], v[140:143]
buffer_load_dwordx4 v238, s[12:15], s65 offen offset:2048 lds
v_mfma_f32_16x16x32_bf16 v[144:147], a[152:155], v[200:203], v[144:147]
ds_read_b64_tr_b16 v[214:215], v231 offset:4608
v_cvt_pk_bf16_f32 v12, v96, v97
v_mfma_f32_16x16x32_bf16 v[148:151], a[156:159], v[200:203], v[148:151]
s_waitcnt lgkmcnt(4)
v_mfma_f32_16x16x32_bf16 v[152:155], a[144:147], v[204:207], v[152:155]
ds_read_b64_tr_b16 v[200:201], v228 offset:8192
v_mfma_f32_16x16x32_bf16 v[156:159], a[148:151], v[204:207], v[156:159]
v_mfma_f32_16x16x32_bf16 v[160:163], a[152:155], v[204:207], v[160:163]
ds_read_b64_tr_b16 v[202:203], v228 offset:8704
v_mfma_f32_16x16x32_bf16 v[164:167], a[156:159], v[204:207], v[164:167]
s_waitcnt lgkmcnt(4)
v_cvt_pk_bf16_f32 v13, v98, v99
v_mfma_f32_16x16x32_bf16 v[168:171], a[144:147], v[208:211], v[168:171]
ds_read_b64_tr_b16 v[204:205], v229 offset:8192
s_lshr_b32 s68, s2, 3
v_mfma_f32_16x16x32_bf16 v[172:175], a[148:151], v[208:211], v[172:175]
s_lshl_b32 s68, s68, 2
s_add_u32 s68, s68, s40
v_mfma_f32_16x16x32_bf16 v[176:179], a[152:155], v[208:211], v[176:179]
ds_read_b64_tr_b16 v[206:207], v229 offset:8704
s_bfe_u32 s69, s2, 0x20001
v_mfma_f32_16x16x32_bf16 v[180:183], a[156:159], v[208:211], v[180:183]
s_waitcnt lgkmcnt(4)
s_mul_i32 s68, s68, 11008
v_mfma_f32_16x16x32_bf16 v[184:187], a[144:147], v[212:215], v[184:187]
ds_read_b64_tr_b16 v[208:209], v230 offset:8192
v_bfe_u32 v224, v1, 3, 2
v_mfma_f32_16x16x32_bf16 v[188:191], a[148:151], v[212:215], v[188:191]
v_mul_u32_u24 v224, 2752, v224
v_and_b32 v225, 7, v1
v_mfma_f32_16x16x32_bf16 v[192:195], a[152:155], v[212:215], v[192:195]
ds_read_b64_tr_b16 v[210:211], v230 offset:8704
v_cmp_gt_u32 vcc, 5, v225
v_mfma_f32_16x16x32_bf16 v[196:199], a[156:159], v[212:215], v[196:199]
s_waitcnt lgkmcnt(4)
v_lshlrev_b32 v223, 7, v225
v_mfma_f32_16x16x32_bf16 v[136:139], a[160:163], v[200:203], v[136:139]
ds_read_b64_tr_b16 v[212:213], v231 offset:8192
v_subrev_u32 v225, 640, v223
v_mfma_f32_16x16x32_bf16 v[140:143], a[164:167], v[200:203], v[140:143]
buffer_load_dwordx4 v239, s[12:15], s65 offen offset:3072 lds
v_min_u32 v223, 508, v223
v_mfma_f32_16x16x32_bf16 v[144:147], a[168:171], v[200:203], v[144:147]
ds_read_b64_tr_b16 v[214:215], v231 offset:8704
v_min_u32 v225, 252, v225
v_mfma_f32_16x16x32_bf16 v[148:151], a[172:175], v[200:203], v[148:151]
s_waitcnt lgkmcnt(4)
s_mul_i32 s69, s69, 256
v_mfma_f32_16x16x32_bf16 v[152:155], a[160:163], v[204:207], v[152:155]
ds_read_b64_tr_b16 v[200:201], v228 offset:12288
v_add_u32 v225, 2048, v225
v_mfma_f32_16x16x32_bf16 v[156:159], a[164:167], v[204:207], v[156:159]
v_add_u32 v223, s69, v223
v_cndmask_b32 v223, v225, v223, vcc
v_mfma_f32_16x16x32_bf16 v[160:163], a[168:171], v[204:207], v[160:163]
ds_read_b64_tr_b16 v[202:203], v228 offset:12800
v_add_u32 v223, s69, v223
v_mfma_f32_16x16x32_bf16 v[164:167], a[172:175], v[204:207], v[164:167]
s_waitcnt lgkmcnt(4)
v_add_u32 v224, v224, v223
v_mfma_f32_16x16x32_bf16 v[168:171], a[160:163], v[208:211], v[168:171]
ds_read_b64_tr_b16 v[204:205], v229 offset:12288
v_cvt_pk_bf16_f32 v14, v100, v101
v_cvt_pk_bf16_f32 v15, v102, v103
v_mfma_f32_16x16x32_bf16 v[172:175], a[164:167], v[208:211], v[172:175]
buffer_load_dword v222, v224, s[8:11], s68 offen
v_mfma_f32_16x16x32_bf16 v[176:179], a[168:171], v[208:211], v[176:179]
ds_read_b64_tr_b16 v[206:207], v229 offset:12800
v_mfma_f32_16x16x32_bf16 v[180:183], a[172:175], v[208:211], v[180:183]
s_waitcnt lgkmcnt(4)
v_mfma_f32_16x16x32_bf16 v[184:187], a[160:163], v[212:215], v[184:187]
ds_read_b64_tr_b16 v[208:209], v230 offset:12288
v_mfma_f32_16x16x32_bf16 v[188:191], a[164:167], v[212:215], v[188:191]
s_waitcnt vmcnt(7)
v_cmp_le_u32 vcc, 64, v70
s_cmp_eq_u64 vcc, exec
s_cbranch_scc0 KF_g1_spin
KF_g1_back:
buffer_store_dwordx4 v[12:15], v2, s[20:23], s67 offen offset:1024 sc1
v_mfma_f32_16x16x32_bf16 v[192:195], a[168:171], v[212:215], v[192:195]
ds_read_b64_tr_b16 v[210:211], v230 offset:12800
v_cvt_pk_bf16_f32 v16, v112, v113
v_mfma_f32_16x16x32_bf16 v[196:199], a[172:175], v[212:215], v[196:199]
s_waitcnt lgkmcnt(4)
v_mfma_f32_16x16x32_bf16 v[136:139], a[176:179], v[200:203], v[136:139]
ds_read_b64_tr_b16 v[212:213], v231 offset:12288
v_mfma_f32_16x16x32_bf16 v[140:143], a[180:183], v[200:203], v[140:143]
s_barrier
v_mfma_f32_16x16x32_bf16 v[144:147], a[184:187], v[200:203], v[144:147]
ds_read_b64_tr_b16 v[214:215], v231 offset:12800
s_add_u32 m0, s42, 49152
v_mfma_f32_16x16x32_bf16 v[148:151], a[188:191], v[200:203], v[148:151]
s_waitcnt lgkmcnt(4)
s_add_u32 s65, s47, 1048832
v_mfma_f32_16x16x32_bf16 v[152:155], a[176:179], v[204:207], v[152:155]
ds_read_b64_tr_b16 v[200:201], v228 offset:16384
s_lshr_b32 s69, s2, 4
v_mfma_f32_16x16x32_bf16 v[156:159], a[180:183], v[204:207], v[156:159]
buffer_load_dwordx4 v236, s[12:15], s65 offen offset:0 lds
s_sub_u32 s68, 15, s69
v_mfma_f32_16x16x32_bf16 v[160:163], a[184:187], v[204:207], v[160:163]
ds_read_b64_tr_b16 v[202:203], v228 offset:16896
s_min_u32 s69, s69, s68
v_mfma_f32_16x16x32_bf16 v[164:167], a[188:191], v[204:207], v[164:167]
s_waitcnt lgkmcnt(4)
s_add_u32 s69, s69, 256
v_mfma_f32_16x16x32_bf16 v[168:171], a[176:179], v[208:211], v[168:171]
ds_read_b64_tr_b16 v[204:205], v229 offset:16384
s_lshl_b32 s69, s69, 7
v_mfma_f32_16x16x32_bf16 v[172:175], a[180:183], v[208:211], v[172:175]
buffer_atomic_add v6, v3, s[32:35], s69 offen sc1
v_cvt_pk_bf16_f32 v17, v114, v115
v_mfma_f32_16x16x32_bf16 v[176:179], a[184:187], v[208:211], v[176:179]
ds_read_b64_tr_b16 v[206:207], v229 offset:16896
v_cvt_pk_bf16_f32 v18, v116, v117
v_mfma_f32_16x16x32_bf16 v[180:183], a[188:191], v[208:211], v[180:183]
s_waitcnt lgkmcnt(4)
v_mfma_f32_16x16x32_bf16 v[184:187], a[176:179], v[212:215], v[184:187]
ds_read_b64_tr_b16 v[208:209], v230 offset:16384
v_mfma_f32_16x16x32_bf16 v[188:191], a[180:183], v[212:215], v[188:191]
v_mfma_f32_16x16x32_bf16 v[192:195], a[184:187], v[212:215], v[192:195]
ds_read_b64_tr_b16 v[210:211], v230 offset:16896
v_mfma_f32_16x16x32_bf16 v[196:199], a[188:191], v[212:215], v[196:199]
s_waitcnt lgkmcnt(4)
v_cvt_pk_bf16_f32 v19, v118, v119
v_mfma_f32_16x16x32_bf16 v[136:139], a[192:195], v[200:203], v[136:139]
ds_read_b64_tr_b16 v[212:213], v231 offset:16384
v_mfma_f32_16x16x32_bf16 v[140:143], a[196:199], v[200:203], v[140:143]
buffer_load_dwordx4 v237, s[12:15], s65 offen offset:1024 lds
v_mfma_f32_16x16x32_bf16 v[144:147], a[200:203], v[200:203], v[144:147]
ds_read_b64_tr_b16 v[214:215], v231 offset:16896
v_mfma_f32_16x16x32_bf16 v[148:151], a[204:207], v[200:203], v[148:151]
s_waitcnt lgkmcnt(4)
v_mfma_f32_16x16x32_bf16 v[152:155], a[192:195], v[204:207], v[152:155]
ds_read_b64_tr_b16 v[200:201], v228 offset:20480
v_mfma_f32_16x16x32_bf16 v[156:159], a[196:199], v[204:207], v[156:159]
buffer_store_dwordx4 v[16:19], v2, s[20:23], s67 offen offset:2048 sc1
v_mfma_f32_16x16x32_bf16 v[160:163], a[200:203], v[204:207], v[160:163]
ds_read_b64_tr_b16 v[202:203], v228 offset:20992
v_mfma_f32_16x16x32_bf16 v[164:167], a[204:207], v[204:207], v[164:167]
s_waitcnt lgkmcnt(4)
v_mfma_f32_16x16x32_bf16 v[168:171], a[192:195], v[208:211], v[168:171]
ds_read_b64_tr_b16 v[204:205], v229 offset:20480
v_mfma_f32_16x16x32_bf16 v[172:175], a[196:199], v[208:211], v[172:175]
v_mfma_f32_16x16x32_bf16 v[176:179], a[200:203], v[208:211], v[176:179]
ds_read_b64_tr_b16 v[206:207], v229 offset:20992
v_cvt_pk_bf16_f32 v20, v128, v129
v_mfma_f32_16x16x32_bf16 v[180:183], a[204:207], v[208:211], v[180:183]
s_waitcnt lgkmcnt(4)
v_mfma_f32_16x16x32_bf16 v[184:187], a[192:195], v[212:215], v[184:187]
ds_read_b64_tr_b16 v[208:209], v230 offset:20480
v_mfma_f32_16x16x32_bf16 v[188:191], a[196:199], v[212:215], v[188:191]
v_mfma_f32_16x16x32_bf16 v[192:195], a[200:203], v[212:215], v[192:195]
ds_read_b64_tr_b16 v[210:211], v230 offset:20992
v_mfma_f32_16x16x32_bf16 v[196:199], a[204:207], v[212:215], v[196:199]
s_waitcnt lgkmcnt(4)
v_cvt_pk_bf16_f32 v21, v130, v131
v_mfma_f32_16x16x32_bf16 v[136:139], a[208:211], v[200:203], v[136:139]
ds_read_b64_tr_b16 v[212:213], v231 offset:20480
v_mfma_f32_16x16x32_bf16 v[140:143], a[212:215], v[200:203], v[140:143]
buffer_load_dwordx4 v238, s[12:15], s65 offen offset:2048 lds
v_mfma_f32_16x16x32_bf16 v[144:147], a[216:219], v[200:203], v[144:147]
ds_read_b64_tr_b16 v[214:215], v231 offset:20992
v_mfma_f32_16x16x32_bf16 v[148:151], a[220:223], v[200:203], v[148:151]
s_waitcnt lgkmcnt(4)
v_mfma_f32_16x16x32_bf16 v[152:155], a[208:211], v[204:207], v[152:155]
ds_read_b64_tr_b16 v[200:201], v228 offset:24576
v_mfma_f32_16x16x32_bf16 v[156:159], a[212:215], v[204:207], v[156:159]
v_cvt_pk_bf16_f32 v22, v132, v133
v_mfma_f32_16x16x32_bf16 v[160:163], a[216:219], v[204:207], v[160:163]
ds_read_b64_tr_b16 v[202:203], v228 offset:25088
v_mfma_f32_16x16x32_bf16 v[164:167], a[220:223], v[204:207], v[164:167]
s_waitcnt lgkmcnt(4)
v_mfma_f32_16x16x32_bf16 v[168:171], a[208:211], v[208:211], v[168:171]
ds_read_b64_tr_b16 v[204:205], v229 offset:24576
s_lshr_b32 s68, s2, 3
v_mfma_f32_16x16x32_bf16 v[172:175], a[212:215], v[208:211], v[172:175]
s_lshl_b32 s68, s68, 2
s_add_u32 s68, s68, s40
v_mfma_f32_16x16x32_bf16 v[176:179], a[216:219], v[208:211], v[176:179]
ds_read_b64_tr_b16 v[206:207], v229 offset:25088
s_bfe_u32 s69, s2, 0x20001
v_mfma_f32_16x16x32_bf16 v[180:183], a[220:223], v[208:211], v[180:183]
s_waitcnt lgkmcnt(4)
s_mul_i32 s68, s68, 11008
v_mfma_f32_16x16x32_bf16 v[184:187], a[208:211], v[212:215], v[184:187]
ds_read_b64_tr_b16 v[208:209], v230 offset:24576
v_bfe_u32 v224, v1, 3, 2
v_mfma_f32_16x16x32_bf16 v[188:191], a[212:215], v[212:215], v[188:191]
v_mul_u32_u24 v224, 2752, v224
v_and_b32 v225, 7, v1
v_mfma_f32_16x16x32_bf16 v[192:195], a[216:219], v[212:215], v[192:195]
ds_read_b64_tr_b16 v[210:211], v230 offset:25088
v_cmp_gt_u32 vcc, 5, v225
v_mfma_f32_16x16x32_bf16 v[196:199], a[220:223], v[212:215], v[196:199]
s_waitcnt lgkmcnt(4)
v_lshlrev_b32 v223, 7, v225
v_mfma_f32_16x16x32_bf16 v[136:139], a[224:227], v[200:203], v[136:139]
ds_read_b64_tr_b16 v[212:213], v231 offset:24576
v_subrev_u32 v225, 640, v223
v_cvt_pk_bf16_f32 v23, v134, v135
v_mfma_f32_16x16x32_bf16 v[140:143], a[228:231], v[200:203], v[140:143]
buffer_load_dwordx4 v239, s[12:15], s65 offen offset:3072 lds
v_min_u32 v223, 508, v223
v_mfma_f32_16x16x32_bf16 v[144:147], a[232:235], v[200:203], v[144:147]
ds_read_b64_tr_b16 v[214:215], v231 offset:25088
v_min_u32 v225, 252, v225
v_mfma_f32_16x16x32_bf16 v[148:151], a[236:239], v[200:203], v[148:151]
s_waitcnt lgkmcnt(4)
s_mul_i32 s69, s69, 256
v_mfma_f32_16x16x32_bf16 v[152:155], a[224:227], v[204:207], v[152:155]
ds_read_b64_tr_b16 v[200:201], v228 offset:28672
v_add_u32 v225, 2048, v225
v_mfma_f32_16x16x32_bf16 v[156:159], a[228:231], v[204:207], v[156:159]
v_add_u32 v223, s69, v223
v_cndmask_b32 v223, v225, v223, vcc
buffer_store_dwordx4 v[20:23], v2, s[20:23], s67 offen offset:3072 sc1
v_mfma_f32_16x16x32_bf16 v[160:163], a[232:235], v[204:207], v[160:163]
ds_read_b64_tr_b16 v[202:203], v228 offset:29184
v_add_u32 v223, s69, v223
v_mfma_f32_16x16x32_bf16 v[164:167], a[236:239], v[204:207], v[164:167]
s_waitcnt lgkmcnt(4)
v_add_u32 v224, v224, v223
v_mfma_f32_16x16x32_bf16 v[168:171], a[224:227], v[208:211], v[168:171]
ds_read_b64_tr_b16 v[204:205], v229 offset:28672
v_mfma_f32_16x16x32_bf16 v[172:175], a[228:231], v[208:211], v[172:175]
buffer_load_dword v221, v224, s[28:31], s68 offen
v_mfma_f32_16x16x32_bf16 v[176:179], a[232:235], v[208:211], v[176:179]
ds_read_b64_tr_b16 v[206:207], v229 offset:29184
v_mfma_f32_16x16x32_bf16 v[180:183], a[236:239], v[208:211], v[180:183]
s_waitcnt lgkmcnt(4)
v_mfma_f32_16x16x32_bf16 v[184:187], a[224:227], v[212:215], v[184:187]
ds_read_b64_tr_b16 v[208:209], v230 offset:28672
v_mfma_f32_16x16x32_bf16 v[188:191], a[228:231], v[212:215], v[188:191]
v_mfma_f32_16x16x32_bf16 v[192:195], a[232:235], v[212:215], v[192:195]
ds_read_b64_tr_b16 v[210:211], v230 offset:29184
v_mfma_f32_16x16x32_bf16 v[196:199], a[236:239], v[212:215], v[196:199]
s_waitcnt lgkmcnt(4)
v_mfma_f32_16x16x32_bf16 v[136:139], a[240:243], v[200:203], v[136:139]
ds_read_b64_tr_b16 v[212:213], v231 offset:28672
v_mfma_f32_16x16x32_bf16 v[140:143], a[244:247], v[200:203], v[140:143]
s_waitcnt vmcnt(10)
s_barrier
v_mfma_f32_16x16x32_bf16 v[144:147], a[248:251], v[200:203], v[144:147]
ds_read_b64_tr_b16 v[214:215], v231 offset:29184
s_add_u32 m0, s42, 0
v_mfma_f32_16x16x32_bf16 v[148:151], a[252:255], v[200:203], v[148:151]
s_waitcnt lgkmcnt(4)
s_add_u32 s65, s47, 2097408
v_mfma_f32_16x16x32_bf16 v[152:155], a[240:243], v[204:207], v[152:155]
ds_read_b64_tr_b16 v[200:201], v228 offset:32768
v_mfma_f32_16x16x32_bf16 v[156:159], a[244:247], v[204:207], v[156:159]
buffer_load_dwordx4 v236, s[12:15], s65 offen offset:0 lds
v_mfma_f32_16x16x32_bf16 v[160:163], a[248:251], v[204:207], v[160:163]
ds_read_b64_tr_b16 v[202:203], v228 offset:33280
v_mfma_f32_16x16x32_bf16 v[164:167], a[252:255], v[204:207], v[164:167]
s_waitcnt lgkmcnt(4)
v_mfma_f32_16x16x32_bf16 v[168:171], a[240:243], v[208:211], v[168:171]
ds_read_b64_tr_b16 v[204:205], v229 offset:32768
v_mfma_f32_16x16x32_bf16 v[172:175], a[244:247], v[208:211], v[172:175]
v_mfma_f32_16x16x32_bf16 v[176:179], a[248:251], v[208:211], v[176:179]
ds_read_b64_tr_b16 v[206:207], v229 offset:33280
v_mfma_f32_16x16x32_bf16 v[180:183], a[252:255], v[208:211], v[180:183]
s_waitcnt lgkmcnt(4)
v_mfma_f32_16x16x32_bf16 v[184:187], a[240:243], v[212:215], v[184:187]
ds_read_b64_tr_b16 v[208:209], v230 offset:32768
v_mfma_f32_16x16x32_bf16 v[188:191], a[244:247], v[212:215], v[188:191]
v_mfma_f32_16x16x32_bf16 v[192:195], a[248:251], v[212:215], v[192:195]
ds_read_b64_tr_b16 v[210:211], v230 offset:33280
v_mfma_f32_16x16x32_bf16 v[196:199], a[252:255], v[212:215], v[196:199]
s_waitcnt lgkmcnt(4)
v_mfma_f32_16x16x32_bf16 v[72:75], a[0:3], v[200:203], 0
ds_read_b64_tr_b16 v[212:213], v231 offset:32768
v_mfma_f32_16x16x32_bf16 v[76:79], a[4:7], v[200:203], 0
buffer_load_dwordx4 v237, s[12:15], s65 offen offset:1024 lds
v_mfma_f32_16x16x32_bf16 v[80:83], a[8:11], v[200:203], 0
ds_read_b64_tr_b16 v[214:215], v231 offset:33280
v_lshrrev_b32 v216, 4, v1
v_mfma_f32_16x16x32_bf16 v[84:87], a[12:15], v[200:203], 0
s_waitcnt lgkmcnt(4)
v_bfe_u32 v217, v1, 2, 2
v_mfma_f32_16x16x32_bf16 v[88:91], a[0:3], v[204:207], 0
ds_read_b64_tr_b16 v[200:201], v228 offset:36864
v_lshl_add_u32 v217, v216, 3, v217
v_mfma_f32_16x16x32_bf16 v[92:95], a[4:7], v[204:207], 0
v_and_b32 v216, 1, v216
v_and_b32 v218, 3, v1
v_mfma_f32_16x16x32_bf16 v[96:99], a[8:11], v[204:207], 0
ds_read_b64_tr_b16 v[202:203], v228 offset:37376
v_lshlrev_b32 v218, 3, v218
v_mfma_f32_16x16x32_bf16 v[100:103], a[12:15], v[204:207], 0
s_waitcnt lgkmcnt(4)
v_add_u32 v218, 98304, v218
v_mfma_f32_16x16x32_bf16 v[104:107], a[0:3], v[208:211], 0
ds_read_b64_tr_b16 v[204:205], v229 offset:36864
v_lshl_add_u32 v219, v217, 6, v218
v_mfma_f32_16x16x32_bf16 v[108:111], a[4:7], v[208:211], 0
v_lshl_add_u32 v232, v216, 5, v219
v_xor_b32 v233, 32, v232
v_mfma_f32_16x16x32_bf16 v[112:115], a[8:11], v[208:211], 0
ds_read_b64_tr_b16 v[206:207], v229 offset:37376
v_lshl_add_u32 v219, v217, 5, v218
v_mfma_f32_16x16x32_bf16 v[116:119], a[12:15], v[208:211], 0
s_waitcnt lgkmcnt(4)
v_lshl_add_u32 v234, v216, 7, v219
v_mfma_f32_16x16x32_bf16 v[120:123], a[0:3], v[212:215], 0
ds_read_b64_tr_b16 v[208:209], v230 offset:36864
v_subrev_u32 v234, 0, v234
v_mfma_f32_16x16x32_bf16 v[124:127], a[4:7], v[212:215], 0
v_xor_b32 v235, 128, v234
s_movk_i32 s69, 2752
v_mfma_f32_16x16x32_bf16 v[128:131], a[8:11], v[212:215], 0
ds_read_b64_tr_b16 v[210:211], v230 offset:37376
s_lshl_b32 s68, s40, 5
v_mfma_f32_16x16x32_bf16 v[132:135], a[12:15], v[212:215], 0
s_waitcnt lgkmcnt(4)
v_lshrrev_b32 v216, 2, v1
v_mfma_f32_16x16x32_bf16 v[72:75], a[16:19], v[200:203], v[72:75]
ds_read_b64_tr_b16 v[212:213], v231 offset:36864
v_add_u32 v216, s68, v216
v_mfma_f32_16x16x32_bf16 v[76:79], a[20:23], v[200:203], v[76:79]
buffer_load_dwordx4 v238, s[12:15], s65 offen offset:2048 lds
v_mul_lo_u32 v216, v216, s69
v_mfma_f32_16x16x32_bf16 v[80:83], a[24:27], v[200:203], v[80:83]
ds_read_b64_tr_b16 v[214:215], v231 offset:37376
v_and_b32 v217, 3, v1
v_mfma_f32_16x16x32_bf16 v[84:87], a[28:31], v[200:203], v[84:87]
s_waitcnt lgkmcnt(4)
v_lshrrev_b32 v218, 5, v1
v_mfma_f32_16x16x32_bf16 v[88:91], a[16:19], v[204:207], v[88:91]
ds_read_b64_tr_b16 v[200:201], v228 offset:40960
v_lshlrev_b32 v218, 1, v218
v_mfma_f32_16x16x32_bf16 v[92:95], a[20:23], v[204:207], v[92:95]
v_xor_b32 v217, v217, v218
v_lshl_add_u32 v240, v217, 4, v216
v_mfma_f32_16x16x32_bf16 v[96:99], a[24:27], v[204:207], v[96:99]
ds_read_b64_tr_b16 v[202:203], v228 offset:41472
v_add_u32 v241, 43008, v240
v_mfma_f32_16x16x32_bf16 v[100:103], a[28:31], v[204:207], v[100:103]
s_waitcnt lgkmcnt(4)
s_lshl_b32 s68, s40, 6
v_mfma_f32_16x16x32_bf16 v[104:107], a[16:19], v[208:211], v[104:107]
ds_read_b64_tr_b16 v[204:205], v229 offset:40960
v_lshrrev_b32 v216, 1, v1
v_mfma_f32_16x16x32_bf16 v[108:111], a[20:23], v[208:211], v[108:111]
v_bfe_u32 v217, v1, 4, 1
v_lshlrev_b32 v217, 2, v217
v_mfma_f32_16x16x32_bf16 v[112:115], a[24:27], v[208:211], v[112:115]
ds_read_b64_tr_b16 v[206:207], v229 offset:41472
v_xor_b32 v216, v216, v217
v_mfma_f32_16x16x32_bf16 v[116:119], a[28:31], v[208:211], v[116:119]
s_waitcnt lgkmcnt(4)
v_add_u32 v216, s68, v216
v_mfma_f32_16x16x32_bf16 v[120:123], a[16:19], v[212:215], v[120:123]
ds_read_b64_tr_b16 v[208:209], v230 offset:40960
v_mul_lo_u32 v216, v216, s69
s_add_u32 s67, s50, 12288
v_cvt_pk_bf16_f32 v8, v136, v137
v_cvt_pk_bf16_f32 v9, v138, v139
v_cvt_pk_bf16_f32 v10, v140, v141
v_cvt_pk_bf16_f32 v11, v142, v143
v_mfma_f32_16x16x32_bf16 v[124:127], a[20:23], v[212:215], v[124:127]
v_and_b32 v217, 1, v1
v_lshl_add_u32 v242, v217, 4, v216
buffer_store_dwordx4 v[8:11], v2, s[20:23], s67 offen offset:0 sc1
v_mfma_f32_16x16x32_bf16 v[128:131], a[24:27], v[212:215], v[128:131]
ds_read_b64_tr_b16 v[210:211], v230 offset:41472
v_add_u32 v243, 87040, v242
v_mfma_f32_16x16x32_bf16 v[132:135], a[28:31], v[212:215], v[132:135]
s_waitcnt lgkmcnt(4)
v_lshlrev_b32 v216, 3, v1
v_mfma_f32_16x16x32_bf16 v[72:75], a[32:35], v[200:203], v[72:75]
ds_read_b64_tr_b16 v[212:213], v231 offset:40960
s_mul_i32 s68, s45, 90112
v_mfma_f32_16x16x32_bf16 v[76:79], a[36:39], v[200:203], v[76:79]
buffer_load_dwordx4 v239, s[12:15], s65 offen offset:3072 lds
v_add_u32 v248, s68, v216
v_mfma_f32_16x16x32_bf16 v[80:83], a[40:43], v[200:203], v[80:83]
ds_read_b64_tr_b16 v[214:215], v231 offset:41472
v_add_u32 v249, 45056, v248
v_mfma_f32_16x16x32_bf16 v[84:87], a[44:47], v[200:203], v[84:87]
s_waitcnt lgkmcnt(4)
s_mul_i32 s68, s46, 90112
v_mfma_f32_16x16x32_bf16 v[88:91], a[32:35], v[204:207], v[88:91]
ds_read_b64_tr_b16 v[200:201], v228 offset:45056
v_add_u32 v250, s68, v216
v_mfma_f32_16x16x32_bf16 v[92:95], a[36:39], v[204:207], v[92:95]
v_add_u32 v251, 45056, v250
s_lshl_b32 s68, s45, 15
v_mfma_f32_16x16x32_bf16 v[96:99], a[40:43], v[204:207], v[96:99]
ds_read_b64_tr_b16 v[202:203], v228 offset:45568
v_add_u32 v244, s68, v2
v_mfma_f32_16x16x32_bf16 v[100:103], a[44:47], v[204:207], v[100:103]
s_waitcnt lgkmcnt(4)
v_add_u32 v245, 16384, v244
v_mfma_f32_16x16x32_bf16 v[104:107], a[32:35], v[208:211], v[104:107]
ds_read_b64_tr_b16 v[204:205], v229 offset:45056
s_lshl_b32 s68, s46, 15
v_mfma_f32_16x16x32_bf16 v[108:111], a[36:39], v[208:211], v[108:111]
v_add_u32 v246, s68, v2
v_add_u32 v247, 16384, v246
v_mfma_f32_16x16x32_bf16 v[112:115], a[40:43], v[208:211], v[112:115]
ds_read_b64_tr_b16 v[206:207], v229 offset:45568
v_mov_b32 v4, 0xc0135761
v_mfma_f32_16x16x32_bf16 v[116:119], a[44:47], v[208:211], v[116:119]
s_waitcnt lgkmcnt(4)
v_mov_b32 v252, v2
v_mfma_f32_16x16x32_bf16 v[120:123], a[32:35], v[212:215], v[120:123]
ds_read_b64_tr_b16 v[208:209], v230 offset:45056
v_add_u32 v253, 16384, v2
v_mfma_f32_16x16x32_bf16 v[124:127], a[36:39], v[212:215], v[124:127]
s_movk_i32 s56, 0x1000
s_movk_i32 s57, 0x2000
v_mfma_f32_16x16x32_bf16 v[128:131], a[40:43], v[212:215], v[128:131]
ds_read_b64_tr_b16 v[210:211], v230 offset:45568
s_movk_i32 s58, 0x3000
v_mfma_f32_16x16x32_bf16 v[132:135], a[44:47], v[212:215], v[132:135]
s_waitcnt lgkmcnt(4)
s_lshl_b32 s51, s44, 8
v_mfma_f32_16x16x32_bf16 v[72:75], a[48:51], v[200:203], v[72:75]
ds_read_b64_tr_b16 v[212:213], v231 offset:45056
s_lshl_b32 s52, s44, 6
v_mfma_f32_16x16x32_bf16 v[76:79], a[52:55], v[200:203], v[76:79]
s_waitcnt vmcnt(7)
s_barrier
v_mfma_f32_16x16x32_bf16 v[80:83], a[56:59], v[200:203], v[80:83]
ds_read_b64_tr_b16 v[214:215], v231 offset:45568
s_add_u32 m0, s42, 16384
v_mfma_f32_16x16x32_bf16 v[84:87], a[60:63], v[200:203], v[84:87]
s_waitcnt lgkmcnt(4)
s_add_u32 s65, s47, 3145984
v_mfma_f32_16x16x32_bf16 v[88:91], a[48:51], v[204:207], v[88:91]
ds_read_b64_tr_b16 v[200:201], v228 offset:49152
s_lshl_b32 s54, s44, 10
v_mfma_f32_16x16x32_bf16 v[92:95], a[52:55], v[204:207], v[92:95]
buffer_load_dwordx4 v236, s[12:15], s65 offen offset:0 lds
s_add_u32 s68, s44, 64
v_mfma_f32_16x16x32_bf16 v[96:99], a[56:59], v[204:207], v[96:99]
ds_read_b64_tr_b16 v[202:203], v228 offset:49664
s_lshl_b32 s53, s68, 5
v_mfma_f32_16x16x32_bf16 v[100:103], a[60:63], v[204:207], v[100:103]
s_waitcnt lgkmcnt(4)
s_lshl_b32 s55, s68, 9
v_mfma_f32_16x16x32_bf16 v[104:107], a[48:51], v[208:211], v[104:107]
ds_read_b64_tr_b16 v[204:205], v229 offset:49152
s_lshl_b32 s68, s44, 12
v_cvt_pk_bf16_f32 v12, v152, v153
v_cvt_pk_bf16_f32 v13, v154, v155
v_cvt_pk_bf16_f32 v14, v156, v157
v_cvt_pk_bf16_f32 v15, v158, v159
v_mfma_f32_16x16x32_bf16 v[108:111], a[52:55], v[208:211], v[108:111]
s_lshl_b32 s62, s45, 18
s_add_u32 s62, s62, s68
buffer_store_dwordx4 v[12:15], v2, s[20:23], s67 offen offset:1024 sc1
v_mfma_f32_16x16x32_bf16 v[112:115], a[56:59], v[208:211], v[112:115]
ds_read_b64_tr_b16 v[206:207], v229 offset:49664
s_lshl_b32 s63, s46, 18
v_mfma_f32_16x16x32_bf16 v[116:119], a[60:63], v[208:211], v[116:119]
s_waitcnt lgkmcnt(4)
s_add_u32 s63, s63, s68
v_mfma_f32_16x16x32_bf16 v[120:123], a[48:51], v[212:215], v[120:123]
ds_read_b64_tr_b16 v[208:209], v230 offset:49152
s_lshr_b32 s68, s40, 1
v_mfma_f32_16x16x32_bf16 v[124:127], a[52:55], v[212:215], v[124:127]
s_lshl_b32 s68, s68, 15
s_sub_u32 s83, s41, s68
v_mfma_f32_16x16x32_bf16 v[128:131], a[56:59], v[212:215], v[128:131]
ds_read_b64_tr_b16 v[210:211], v230 offset:49664
s_add_u32 s59, s83, 114688
v_mfma_f32_16x16x32_bf16 v[132:135], a[60:63], v[212:215], v[132:135]
s_waitcnt lgkmcnt(4)
s_lshl_b32 s68, s45, 14
v_mfma_f32_16x16x32_bf16 v[72:75], a[64:67], v[200:203], v[72:75]
ds_read_b64_tr_b16 v[212:213], v231 offset:49152
s_add_u32 s60, s68, s59
v_mfma_f32_16x16x32_bf16 v[76:79], a[68:71], v[200:203], v[76:79]
buffer_load_dwordx4 v237, s[12:15], s65 offen offset:1024 lds
s_lshl_b32 s68, s43, 16
v_mfma_f32_16x16x32_bf16 v[80:83], a[72:75], v[200:203], v[80:83]
ds_read_b64_tr_b16 v[214:215], v231 offset:49664
s_sub_u32 s61, 983040, s68
v_mfma_f32_16x16x32_bf16 v[84:87], a[76:79], v[200:203], v[84:87]
s_waitcnt lgkmcnt(4)
s_add_u32 s61, s61, s59
v_mfma_f32_16x16x32_bf16 v[88:91], a[64:67], v[204:207], v[88:91]
ds_read_b64_tr_b16 v[200:201], v228 offset:53248
s_mov_b32 s64, 0
v_mfma_f32_16x16x32_bf16 v[92:95], a[68:71], v[204:207], v[92:95]
v_and_b32 v216, 15, v1
v_lshrrev_b32 v217, 4, v1
v_mfma_f32_16x16x32_bf16 v[96:99], a[72:75], v[204:207], v[96:99]
ds_read_b64_tr_b16 v[202:203], v228 offset:53760
v_lshlrev_b32 v217, 2, v217
v_mfma_f32_16x16x32_bf16 v[100:103], a[76:79], v[204:207], v[100:103]
s_waitcnt lgkmcnt(4)
v_cmp_le_u32 s[70:71], v217, v216
v_mfma_f32_16x16x32_bf16 v[104:107], a[64:67], v[208:211], v[104:107]
ds_read_b64_tr_b16 v[204:205], v229 offset:53248
v_add_u32 v217, 1, v217
v_mfma_f32_16x16x32_bf16 v[108:111], a[68:71], v[208:211], v[108:111]
v_cmp_le_u32 s[72:73], v217, v216
v_add_u32 v217, 1, v217
v_mfma_f32_16x16x32_bf16 v[112:115], a[72:75], v[208:211], v[112:115]
ds_read_b64_tr_b16 v[206:207], v229 offset:53760
v_cmp_le_u32 s[74:75], v217, v216
v_mfma_f32_16x16x32_bf16 v[116:119], a[76:79], v[208:211], v[116:119]
s_waitcnt lgkmcnt(4)
v_add_u32 v217, 1, v217
v_mfma_f32_16x16x32_bf16 v[120:123], a[64:67], v[212:215], v[120:123]
ds_read_b64_tr_b16 v[208:209], v230 offset:53248
v_cmp_le_u32 s[76:77], v217, v216
v_mfma_f32_16x16x32_bf16 v[124:127], a[68:71], v[212:215], v[124:127]
v_cvt_pk_bf16_f32 v16, v168, v169
v_cvt_pk_bf16_f32 v17, v170, v171
v_mfma_f32_16x16x32_bf16 v[128:131], a[72:75], v[212:215], v[128:131]
ds_read_b64_tr_b16 v[210:211], v230 offset:53760
v_cvt_pk_bf16_f32 v18, v172, v173
v_mfma_f32_16x16x32_bf16 v[132:135], a[76:79], v[212:215], v[132:135]
s_waitcnt lgkmcnt(4)
v_cvt_pk_bf16_f32 v19, v174, v175
v_mfma_f32_16x16x32_bf16 v[72:75], a[80:83], v[200:203], v[72:75]
ds_read_b64_tr_b16 v[212:213], v231 offset:53248
s_cmp_ge_u32 s44, 22
s_cselect_b32 s53, 0x40000000, s53
v_mfma_f32_16x16x32_bf16 v[76:79], a[84:87], v[200:203], v[76:79]
buffer_load_dwordx4 v238, s[12:15], s65 offen offset:2048 lds
v_mfma_f32_16x16x32_bf16 v[80:83], a[88:91], v[200:203], v[80:83]
ds_read_b64_tr_b16 v[214:215], v231 offset:53760
v_mfma_f32_16x16x32_bf16 v[84:87], a[92:95], v[200:203], v[84:87]
s_waitcnt lgkmcnt(4)
v_mfma_f32_16x16x32_bf16 v[88:91], a[80:83], v[204:207], v[88:91]
ds_read_b64_tr_b16 v[200:201], v228 offset:57344
s_cmp_ge_u32 s44, 24
s_cselect_b32 s55, 0x40000000, s55
v_mfma_f32_16x16x32_bf16 v[92:95], a[84:87], v[204:207], v[92:95]
v_mov_b32 v71, 0
s_add_u32 s69, s43, 256
buffer_store_dwordx4 v[16:19], v2, s[20:23], s67 offen offset:2048 sc1
v_mfma_f32_16x16x32_bf16 v[96:99], a[88:91], v[204:207], v[96:99]
ds_read_b64_tr_b16 v[202:203], v228 offset:57856
s_lshl_b32 s69, s69, 7
v_mfma_f32_16x16x32_bf16 v[100:103], a[92:95], v[204:207], v[100:103]
s_waitcnt lgkmcnt(4)
buffer_load_dword v70, v71, s[32:35], s69 offen sc1
v_mfma_f32_16x16x32_bf16 v[104:107], a[80:83], v[208:211], v[104:107]
ds_read_b64_tr_b16 v[204:205], v229 offset:57344
v_mfma_f32_16x16x32_bf16 v[108:111], a[84:87], v[208:211], v[108:111]
s_add_u32 s24, s80, 0x3200000
s_addc_u32 s25, s81, 0
v_mfma_f32_16x16x32_bf16 v[112:115], a[88:91], v[208:211], v[112:115]
ds_read_b64_tr_b16 v[206:207], v229 offset:57856
s_mov_b32 s26, 0x580000
v_mfma_f32_16x16x32_bf16 v[116:119], a[92:95], v[208:211], v[116:119]
s_waitcnt lgkmcnt(4)
s_mov_b32 s27, 0x20000
v_mfma_f32_16x16x32_bf16 v[120:123], a[80:83], v[212:215], v[120:123]
ds_read_b64_tr_b16 v[208:209], v230 offset:57344
v_cvt_pk_bf16_f32 v20, v184, v185
v_mfma_f32_16x16x32_bf16 v[124:127], a[84:87], v[212:215], v[124:127]
s_add_u32 s28, s80, 0x2200000
s_addc_u32 s29, s81, 0
v_mfma_f32_16x16x32_bf16 v[128:131], a[88:91], v[212:215], v[128:131]
ds_read_b64_tr_b16 v[210:211], v230 offset:57856
s_mov_b32 s30, 0x1000000
v_mfma_f32_16x16x32_bf16 v[132:135], a[92:95], v[212:215], v[132:135]
s_waitcnt lgkmcnt(4)
s_mov_b32 s31, 0x20000
v_mfma_f32_16x16x32_bf16 v[72:75], a[96:99], v[200:203], v[72:75]
ds_read_b64_tr_b16 v[212:213], v231 offset:57344
v_cvt_pk_bf16_f32 v21, v186, v187
v_mfma_f32_16x16x32_bf16 v[76:79], a[100:103], v[200:203], v[76:79]
buffer_load_dwordx4 v239, s[12:15], s65 offen offset:3072 lds
v_mfma_f32_16x16x32_bf16 v[80:83], a[104:107], v[200:203], v[80:83]
ds_read_b64_tr_b16 v[214:215], v231 offset:57856
v_mfma_f32_16x16x32_bf16 v[84:87], a[108:111], v[200:203], v[84:87]
s_waitcnt lgkmcnt(4)
v_mfma_f32_16x16x32_bf16 v[88:91], a[96:99], v[204:207], v[88:91]
ds_read_b64_tr_b16 v[200:201], v228 offset:61440
v_mfma_f32_16x16x32_bf16 v[92:95], a[100:103], v[204:207], v[92:95]
v_cvt_pk_bf16_f32 v22, v188, v189
v_mfma_f32_16x16x32_bf16 v[96:99], a[104:107], v[204:207], v[96:99]
ds_read_b64_tr_b16 v[202:203], v228 offset:61952
v_mfma_f32_16x16x32_bf16 v[100:103], a[108:111], v[204:207], v[100:103]
s_waitcnt lgkmcnt(4)
v_mfma_f32_16x16x32_bf16 v[104:107], a[96:99], v[208:211], v[104:107]
ds_read_b64_tr_b16 v[204:205], v229 offset:61440
v_mfma_f32_16x16x32_bf16 v[108:111], a[100:103], v[208:211], v[108:111]
v_mfma_f32_16x16x32_bf16 v[112:115], a[104:107], v[208:211], v[112:115]
ds_read_b64_tr_b16 v[206:207], v229 offset:61952
v_mfma_f32_16x16x32_bf16 v[116:119], a[108:111], v[208:211], v[116:119]
s_waitcnt lgkmcnt(4)
v_cvt_pk_bf16_f32 v23, v190, v191
v_mfma_f32_16x16x32_bf16 v[120:123], a[96:99], v[212:215], v[120:123]
ds_read_b64_tr_b16 v[208:209], v230 offset:61440
v_mfma_f32_16x16x32_bf16 v[124:127], a[100:103], v[212:215], v[124:127]
buffer_store_dwordx4 v[20:23], v2, s[20:23], s67 offen offset:3072 sc1
v_mfma_f32_16x16x32_bf16 v[128:131], a[104:107], v[212:215], v[128:131]
ds_read_b64_tr_b16 v[210:211], v230 offset:61952
v_mfma_f32_16x16x32_bf16 v[132:135], a[108:111], v[212:215], v[132:135]
s_waitcnt lgkmcnt(4)
v_mfma_f32_16x16x32_bf16 v[72:75], a[112:115], v[200:203], v[72:75]
ds_read_b64_tr_b16 v[212:213], v231 offset:61440
v_mfma_f32_16x16x32_bf16 v[76:79], a[116:119], v[200:203], v[76:79]
s_waitcnt vmcnt(8)
s_barrier
v_mfma_f32_16x16x32_bf16 v[80:83], a[120:123], v[200:203], v[80:83]
ds_read_b64_tr_b16 v[214:215], v231 offset:61952
s_add_u32 m0, s42, 32768
v_mfma_f32_16x16x32_bf16 v[84:87], a[124:127], v[200:203], v[84:87]
s_waitcnt lgkmcnt(4)
s_add_u32 s65, s47, 384
v_mfma_f32_16x16x32_bf16 v[88:91], a[112:115], v[204:207], v[88:91]
ds_read_b64_tr_b16 v[200:201], v228 offset:0
v_mfma_f32_16x16x32_bf16 v[92:95], a[116:119], v[204:207], v[92:95]
buffer_load_dwordx4 v236, s[12:15], s65 offen offset:0 lds
v_mfma_f32_16x16x32_bf16 v[96:99], a[120:123], v[204:207], v[96:99]
ds_read_b64_tr_b16 v[202:203], v228 offset:512
s_add_u32 s67, s50, 28672
v_mfma_f32_16x16x32_bf16 v[100:103], a[124:127], v[204:207], v[100:103]
s_waitcnt lgkmcnt(4)
v_mfma_f32_16x16x32_bf16 v[104:107], a[112:115], v[208:211], v[104:107]
ds_read_b64_tr_b16 v[204:205], v229 offset:0
v_mfma_f32_16x16x32_bf16 v[108:111], a[116:119], v[208:211], v[108:111]
v_mfma_f32_16x16x32_bf16 v[112:115], a[120:123], v[208:211], v[112:115]
ds_read_b64_tr_b16 v[206:207], v229 offset:512
v_cvt_pk_bf16_f32 v8, v144, v145
v_mfma_f32_16x16x32_bf16 v[116:119], a[124:127], v[208:211], v[116:119]
s_waitcnt lgkmcnt(4)
v_mfma_f32_16x16x32_bf16 v[120:123], a[112:115], v[212:215], v[120:123]
ds_read_b64_tr_b16 v[208:209], v230 offset:0
v_mfma_f32_16x16x32_bf16 v[124:127], a[116:119], v[212:215], v[124:127]
v_mfma_f32_16x16x32_bf16 v[128:131], a[120:123], v[212:215], v[128:131]
ds_read_b64_tr_b16 v[210:211], v230 offset:512
v_mfma_f32_16x16x32_bf16 v[132:135], a[124:127], v[212:215], v[132:135]
s_waitcnt lgkmcnt(4)
v_cvt_pk_bf16_f32 v9, v146, v147
v_mfma_f32_16x16x32_bf16 v[72:75], a[128:131], v[200:203], v[72:75]
ds_read_b64_tr_b16 v[212:213], v231 offset:0
v_mfma_f32_16x16x32_bf16 v[76:79], a[132:135], v[200:203], v[76:79]
buffer_load_dwordx4 v237, s[12:15], s65 offen offset:1024 lds
v_mfma_f32_16x16x32_bf16 v[80:83], a[136:139], v[200:203], v[80:83]
ds_read_b64_tr_b16 v[214:215], v231 offset:512
v_mfma_f32_16x16x32_bf16 v[84:87], a[140:143], v[200:203], v[84:87]
s_waitcnt lgkmcnt(4)
v_cvt_pk_bf16_f32 v10, v148, v149
v_mfma_f32_16x16x32_bf16 v[88:91], a[128:131], v[204:207], v[88:91]
ds_read_b64_tr_b16 v[200:201], v228 offset:4096
v_mfma_f32_16x16x32_bf16 v[92:95], a[132:135], v[204:207], v[92:95]
v_mfma_f32_16x16x32_bf16 v[96:99], a[136:139], v[204:207], v[96:99]
ds_read_b64_tr_b16 v[202:203], v228 offset:4608
v_mfma_f32_16x16x32_bf16 v[100:103], a[140:143], v[204:207], v[100:103]
s_waitcnt lgkmcnt(4)
v_mfma_f32_16x16x32_bf16 v[104:107], a[128:131], v[208:211], v[104:107]
ds_read_b64_tr_b16 v[204:205], v229 offset:4096
v_cvt_pk_bf16_f32 v11, v150, v151
v_mfma_f32_16x16x32_bf16 v[108:111], a[132:135], v[208:211], v[108:111]
buffer_store_dwordx4 v[8:11], v2, s[20:23], s67 offen offset:0 sc1
v_mfma_f32_16x16x32_bf16 v[112:115], a[136:139], v[208:211], v[112:115]
ds_read_b64_tr_b16 v[206:207], v229 offset:4608
v_mfma_f32_16x16x32_bf16 v[116:119], a[140:143], v[208:211], v[116:119]
s_waitcnt lgkmcnt(4)
v_mfma_f32_16x16x32_bf16 v[120:123], a[128:131], v[212:215], v[120:123]
ds_read_b64_tr_b16 v[208:209], v230 offset:4096
v_mfma_f32_16x16x32_bf16 v[124:127], a[132:135], v[212:215], v[124:127]
v_mfma_f32_16x16x32_bf16 v[128:131], a[136:139], v[212:215], v[128:131]
ds_read_b64_tr_b16 v[210:211], v230 offset:4608
v_mfma_f32_16x16x32_bf16 v[132:135], a[140:143], v[212:215], v[132:135]
s_waitcnt lgkmcnt(4)
v_mfma_f32_16x16x32_bf16 v[72:75], a[144:147], v[200:203], v[72:75]
ds_read_b64_tr_b16 v[212:213], v231 offset:4096
v_mfma_f32_16x16x32_bf16 v[76:79], a[148:151], v[200:203], v[76:79]
buffer_load_dwordx4 v238, s[12:15], s65 offen offset:2048 lds
v_mfma_f32_16x16x32_bf16 v[80:83], a[152:155], v[200:203], v[80:83]
ds_read_b64_tr_b16 v[214:215], v231 offset:4608
v_cvt_pk_bf16_f32 v12, v160, v161
v_mfma_f32_16x16x32_bf16 v[84:87], a[156:159], v[200:203], v[84:87]
s_waitcnt lgkmcnt(4)
v_mfma_f32_16x16x32_bf16 v[88:91], a[144:147], v[204:207], v[88:91]
ds_read_b64_tr_b16 v[200:201], v228 offset:8192
v_mfma_f32_16x16x32_bf16 v[92:95], a[148:151], v[204:207], v[92:95]
s_waitcnt vmcnt(6)
v_cmp_le_u32 vcc, 32, v70
s_cmp_eq_u64 vcc, exec
s_cbranch_scc0 KF_x1_spin
KF_x1_back:
v_mfma_f32_16x16x32_bf16 v[96:99], a[152:155], v[204:207], v[96:99]
ds_read_b64_tr_b16 v[202:203], v228 offset:8704
v_mfma_f32_16x16x32_bf16 v[100:103], a[156:159], v[204:207], v[100:103]
s_waitcnt lgkmcnt(4)
v_cvt_pk_bf16_f32 v13, v162, v163
v_mfma_f32_16x16x32_bf16 v[104:107], a[144:147], v[208:211], v[104:107]
ds_read_b64_tr_b16 v[204:205], v229 offset:8192
v_mfma_f32_16x16x32_bf16 v[108:111], a[148:151], v[208:211], v[108:111]
v_mfma_f32_16x16x32_bf16 v[112:115], a[152:155], v[208:211], v[112:115]
ds_read_b64_tr_b16 v[206:207], v229 offset:8704
v_mfma_f32_16x16x32_bf16 v[116:119], a[156:159], v[208:211], v[116:119]
s_waitcnt lgkmcnt(4)
v_mfma_f32_16x16x32_bf16 v[120:123], a[144:147], v[212:215], v[120:123]
ds_read_b64_tr_b16 v[208:209], v230 offset:8192
v_mfma_f32_16x16x32_bf16 v[124:127], a[148:151], v[212:215], v[124:127]
v_cvt_pk_bf16_f32 v14, v164, v165
v_mfma_f32_16x16x32_bf16 v[128:131], a[152:155], v[212:215], v[128:131]
ds_read_b64_tr_b16 v[210:211], v230 offset:8704
v_mfma_f32_16x16x32_bf16 v[132:135], a[156:159], v[212:215], v[132:135]
s_waitcnt lgkmcnt(4)
v_mfma_f32_16x16x32_bf16 v[72:75], a[160:163], v[200:203], v[72:75]
ds_read_b64_tr_b16 v[212:213], v231 offset:8192
v_mfma_f32_16x16x32_bf16 v[76:79], a[164:167], v[200:203], v[76:79]
buffer_load_dwordx4 v239, s[12:15], s65 offen offset:3072 lds
v_mfma_f32_16x16x32_bf16 v[80:83], a[168:171], v[200:203], v[80:83]
ds_read_b64_tr_b16 v[214:215], v231 offset:8704
v_mfma_f32_16x16x32_bf16 v[84:87], a[172:175], v[200:203], v[84:87]
s_waitcnt lgkmcnt(4)
v_cvt_pk_bf16_f32 v15, v166, v167
v_mfma_f32_16x16x32_bf16 v[88:91], a[160:163], v[204:207], v[88:91]
ds_read_b64_tr_b16 v[200:201], v228 offset:12288
v_mfma_f32_16x16x32_bf16 v[92:95], a[164:167], v[204:207], v[92:95]
buffer_store_dwordx4 v[12:15], v2, s[20:23], s67 offen offset:1024 sc1
v_mfma_f32_16x16x32_bf16 v[96:99], a[168:171], v[204:207], v[96:99]
ds_read_b64_tr_b16 v[202:203], v228 offset:12800
v_mfma_f32_16x16x32_bf16 v[100:103], a[172:175], v[204:207], v[100:103]
s_waitcnt lgkmcnt(4)
v_mfma_f32_16x16x32_bf16 v[104:107], a[160:163], v[208:211], v[104:107]
ds_read_b64_tr_b16 v[204:205], v229 offset:12288
v_mfma_f32_16x16x32_bf16 v[108:111], a[164:167], v[208:211], v[108:111]
v_mfma_f32_16x16x32_bf16 v[112:115], a[168:171], v[208:211], v[112:115]
ds_read_b64_tr_b16 v[206:207], v229 offset:12800
v_mfma_f32_16x16x32_bf16 v[116:119], a[172:175], v[208:211], v[116:119]
s_waitcnt lgkmcnt(4)
v_mfma_f32_16x16x32_bf16 v[120:123], a[160:163], v[212:215], v[120:123]
ds_read_b64_tr_b16 v[208:209], v230 offset:12288
v_mfma_f32_16x16x32_bf16 v[124:127], a[164:167], v[212:215], v[124:127]
v_mfma_f32_16x16x32_bf16 v[128:131], a[168:171], v[212:215], v[128:131]
ds_read_b64_tr_b16 v[210:211], v230 offset:12800
v_cvt_pk_bf16_f32 v16, v176, v177
v_mfma_f32_16x16x32_bf16 v[132:135], a[172:175], v[212:215], v[132:135]
s_waitcnt lgkmcnt(4)
v_mfma_f32_16x16x32_bf16 v[72:75], a[176:179], v[200:203], v[72:75]
ds_read_b64_tr_b16 v[212:213], v231 offset:12288
v_mfma_f32_16x16x32_bf16 v[76:79], a[180:183], v[200:203], v[76:79]
s_waitcnt vmcnt(7)
s_barrier
v_mfma_f32_16x16x32_bf16 v[80:83], a[184:187], v[200:203], v[80:83]
ds_read_b64_tr_b16 v[214:215], v231 offset:12800
s_add_u32 m0, s42, 49152
v_mfma_f32_16x16x32_bf16 v[84:87], a[188:191], v[200:203], v[84:87]
s_waitcnt lgkmcnt(4)
s_add_u32 s65, s47, 1048960
v_mfma_f32_16x16x32_bf16 v[88:91], a[176:179], v[204:207], v[88:91]
ds_read_b64_tr_b16 v[200:201], v228 offset:16384
v_cvt_pk_bf16_f32 v17, v178, v179
v_mfma_f32_16x16x32_bf16 v[92:95], a[180:183], v[204:207], v[92:95]
buffer_load_dwordx4 v236, s[12:15], s65 offen offset:0 lds
v_mfma_f32_16x16x32_bf16 v[96:99], a[184:187], v[204:207], v[96:99]
ds_read_b64_tr_b16 v[202:203], v228 offset:16896
v_mfma_f32_16x16x32_bf16 v[100:103], a[188:191], v[204:207], v[100:103]
s_waitcnt lgkmcnt(4)
v_mfma_f32_16x16x32_bf16 v[104:107], a[176:179], v[208:211], v[104:107]
ds_read_b64_tr_b16 v[204:205], v229 offset:16384
v_mfma_f32_16x16x32_bf16 v[108:111], a[180:183], v[208:211], v[108:111]
v_cvt_pk_bf16_f32 v18, v180, v181
v_mfma_f32_16x16x32_bf16 v[112:115], a[184:187], v[208:211], v[112:115]
ds_read_b64_tr_b16 v[206:207], v229 offset:16896
v_mfma_f32_16x16x32_bf16 v[116:119], a[188:191], v[208:211], v[116:119]
s_waitcnt lgkmcnt(4)
v_mfma_f32_16x16x32_bf16 v[120:123], a[176:179], v[212:215], v[120:123]
ds_read_b64_tr_b16 v[208:209], v230 offset:16384
v_mfma_f32_16x16x32_bf16 v[124:127], a[180:183], v[212:215], v[124:127]
v_mfma_f32_16x16x32_bf16 v[128:131], a[184:187], v[212:215], v[128:131]
ds_read_b64_tr_b16 v[210:211], v230 offset:16896
v_mfma_f32_16x16x32_bf16 v[132:135], a[188:191], v[212:215], v[132:135]
s_waitcnt lgkmcnt(4)
v_cvt_pk_bf16_f32 v19, v182, v183
v_mfma_f32_16x16x32_bf16 v[72:75], a[192:195], v[200:203], v[72:75]
ds_read_b64_tr_b16 v[212:213], v231 offset:16384
v_mfma_f32_16x16x32_bf16 v[76:79], a[196:199], v[200:203], v[76:79]
buffer_load_dwordx4 v237, s[12:15], s65 offen offset:1024 lds
v_mfma_f32_16x16x32_bf16 v[80:83], a[200:203], v[200:203], v[80:83]
ds_read_b64_tr_b16 v[214:215], v231 offset:16896
v_mfma_f32_16x16x32_bf16 v[84:87], a[204:207], v[200:203], v[84:87]
s_waitcnt lgkmcnt(4)
v_mfma_f32_16x16x32_bf16 v[88:91], a[192:195], v[204:207], v[88:91]
ds_read_b64_tr_b16 v[200:201], v228 offset:20480
v_mfma_f32_16x16x32_bf16 v[92:95], a[196:199], v[204:207], v[92:95]
buffer_store_dwordx4 v[16:19], v2, s[20:23], s67 offen offset:2048 sc1
v_mfma_f32_16x16x32_bf16 v[96:99], a[200:203], v[204:207], v[96:99]
ds_read_b64_tr_b16 v[202:203], v228 offset:20992
v_mfma_f32_16x16x32_bf16 v[100:103], a[204:207], v[204:207], v[100:103]
s_waitcnt lgkmcnt(4)
v_mfma_f32_16x16x32_bf16 v[104:107], a[192:195], v[208:211], v[104:107]
ds_read_b64_tr_b16 v[204:205], v229 offset:20480
v_mfma_f32_16x16x32_bf16 v[108:111], a[196:199], v[208:211], v[108:111]
v_mfma_f32_16x16x32_bf16 v[112:115], a[200:203], v[208:211], v[112:115]
ds_read_b64_tr_b16 v[206:207], v229 offset:20992
v_cvt_pk_bf16_f32 v20, v192, v193
v_mfma_f32_16x16x32_bf16 v[116:119], a[204:207], v[208:211], v[116:119]
s_waitcnt lgkmcnt(4)
v_mfma_f32_16x16x32_bf16 v[120:123], a[192:195], v[212:215], v[120:123]
ds_read_b64_tr_b16 v[208:209], v230 offset:20480
v_mfma_f32_16x16x32_bf16 v[124:127], a[196:199], v[212:215], v[124:127]
v_mfma_f32_16x16x32_bf16 v[128:131], a[200:203], v[212:215], v[128:131]
ds_read_b64_tr_b16 v[210:211], v230 offset:20992
v_mfma_f32_16x16x32_bf16 v[132:135], a[204:207], v[212:215], v[132:135]
s_waitcnt lgkmcnt(4)
v_cvt_pk_bf16_f32 v21, v194, v195
v_mfma_f32_16x16x32_bf16 v[72:75], a[208:211], v[200:203], v[72:75]
ds_read_b64_tr_b16 v[212:213], v231 offset:20480
v_mfma_f32_16x16x32_bf16 v[76:79], a[212:215], v[200:203], v[76:79]
buffer_load_dwordx4 v238, s[12:15], s65 offen offset:2048 lds
v_mfma_f32_16x16x32_bf16 v[80:83], a[216:219], v[200:203], v[80:83]
ds_read_b64_tr_b16 v[214:215], v231 offset:20992
v_mfma_f32_16x16x32_bf16 v[84:87], a[220:223], v[200:203], v[84:87]
s_waitcnt lgkmcnt(4)
v_mfma_f32_16x16x32_bf16 v[88:91], a[208:211], v[204:207], v[88:91]
ds_read_b64_tr_b16 v[200:201], v228 offset:24576
v_mfma_f32_16x16x32_bf16 v[92:95], a[212:215], v[204:207], v[92:95]
v_cvt_pk_bf16_f32 v22, v196, v197
v_mfma_f32_16x16x32_bf16 v[96:99], a[216:219], v[204:207], v[96:99]
ds_read_b64_tr_b16 v[202:203], v228 offset:25088
v_mfma_f32_16x16x32_bf16 v[100:103], a[220:223], v[204:207], v[100:103]
s_waitcnt lgkmcnt(4)
v_mfma_f32_16x16x32_bf16 v[104:107], a[208:211], v[208:211], v[104:107]
ds_read_b64_tr_b16 v[204:205], v229 offset:24576
v_mfma_f32_16x16x32_bf16 v[108:111], a[212:215], v[208:211], v[108:111]
v_mfma_f32_16x16x32_bf16 v[112:115], a[216:219], v[208:211], v[112:115]
ds_read_b64_tr_b16 v[206:207], v229 offset:25088
v_mfma_f32_16x16x32_bf16 v[116:119], a[220:223], v[208:211], v[116:119]
s_waitcnt lgkmcnt(4)
v_cvt_pk_bf16_f32 v23, v198, v199
v_mfma_f32_16x16x32_bf16 v[120:123], a[208:211], v[212:215], v[120:123]
ds_read_b64_tr_b16 v[208:209], v230 offset:24576
v_mfma_f32_16x16x32_bf16 v[124:127], a[212:215], v[212:215], v[124:127]
buffer_store_dwordx4 v[20:23], v2, s[20:23], s67 offen offset:3072 sc1
v_mfma_f32_16x16x32_bf16 v[128:131], a[216:219], v[212:215], v[128:131]
ds_read_b64_tr_b16 v[210:211], v230 offset:25088
v_mfma_f32_16x16x32_bf16 v[132:135], a[220:223], v[212:215], v[132:135]
s_waitcnt lgkmcnt(4)
v_mfma_f32_16x16x32_bf16 v[72:75], a[224:227], v[200:203], v[72:75]
ds_read_b64_tr_b16 v[212:213], v231 offset:24576
v_mfma_f32_16x16x32_bf16 v[76:79], a[228:231], v[200:203], v[76:79]
buffer_load_dwordx4 v239, s[12:15], s65 offen offset:3072 lds
v_mfma_f32_16x16x32_bf16 v[80:83], a[232:235], v[200:203], v[80:83]
ds_read_b64_tr_b16 v[214:215], v231 offset:25088
v_mfma_f32_16x16x32_bf16 v[84:87], a[236:239], v[200:203], v[84:87]
s_waitcnt lgkmcnt(4)
v_mfma_f32_16x16x32_bf16 v[88:91], a[224:227], v[204:207], v[88:91]
ds_read_b64_tr_b16 v[200:201], v228 offset:28672
v_mfma_f32_16x16x32_bf16 v[92:95], a[228:231], v[204:207], v[92:95]
v_mfma_f32_16x16x32_bf16 v[96:99], a[232:235], v[204:207], v[96:99]
ds_read_b64_tr_b16 v[202:203], v228 offset:29184
v_mfma_f32_16x16x32_bf16 v[100:103], a[236:239], v[204:207], v[100:103]
s_waitcnt lgkmcnt(4)
v_mfma_f32_16x16x32_bf16 v[104:107], a[224:227], v[208:211], v[104:107]
ds_read_b64_tr_b16 v[204:205], v229 offset:28672
v_mfma_f32_16x16x32_bf16 v[108:111], a[228:231], v[208:211], v[108:111]
v_mfma_f32_16x16x32_bf16 v[112:115], a[232:235], v[208:211], v[112:115]
ds_read_b64_tr_b16 v[206:207], v229 offset:29184
v_mfma_f32_16x16x32_bf16 v[116:119], a[236:239], v[208:211], v[116:119]
s_waitcnt lgkmcnt(4)
v_mfma_f32_16x16x32_bf16 v[120:123], a[224:227], v[212:215], v[120:123]
ds_read_b64_tr_b16 v[208:209], v230 offset:28672
v_mfma_f32_16x16x32_bf16 v[124:127], a[228:231], v[212:215], v[124:127]
v_mfma_f32_16x16x32_bf16 v[128:131], a[232:235], v[212:215], v[128:131]
ds_read_b64_tr_b16 v[210:211], v230 offset:29184
v_mfma_f32_16x16x32_bf16 v[132:135], a[236:239], v[212:215], v[132:135]
s_waitcnt lgkmcnt(4)
v_mfma_f32_16x16x32_bf16 v[72:75], a[240:243], v[200:203], v[72:75]
ds_read_b64_tr_b16 v[212:213], v231 offset:28672
v_mfma_f32_16x16x32_bf16 v[76:79], a[244:247], v[200:203], v[76:79]
s_waitcnt vmcnt(7)
s_barrier
v_mfma_f32_16x16x32_bf16 v[80:83], a[248:251], v[200:203], v[80:83]
ds_read_b64_tr_b16 v[214:215], v231 offset:29184
s_add_u32 m0, s42, 0
v_mfma_f32_16x16x32_bf16 v[84:87], a[252:255], v[200:203], v[84:87]
s_waitcnt lgkmcnt(4)
s_add_u32 s65, s47, 2097536
v_mfma_f32_16x16x32_bf16 v[88:91], a[240:243], v[204:207], v[88:91]
ds_read_b64_tr_b16 v[200:201], v228 offset:32768
v_mfma_f32_16x16x32_bf16 v[92:95], a[244:247], v[204:207], v[92:95]
buffer_load_dwordx4 v236, s[12:15], s65 offen offset:0 lds
v_mfma_f32_16x16x32_bf16 v[96:99], a[248:251], v[204:207], v[96:99]
ds_read_b64_tr_b16 v[202:203], v228 offset:33280
v_mfma_f32_16x16x32_bf16 v[100:103], a[252:255], v[204:207], v[100:103]
s_waitcnt lgkmcnt(4)
v_mfma_f32_16x16x32_bf16 v[104:107], a[240:243], v[208:211], v[104:107]
ds_read_b64_tr_b16 v[204:205], v229 offset:32768
v_mfma_f32_16x16x32_bf16 v[108:111], a[244:247], v[208:211], v[108:111]
v_mfma_f32_16x16x32_bf16 v[112:115], a[248:251], v[208:211], v[112:115]
ds_read_b64_tr_b16 v[206:207], v229 offset:33280
v_mfma_f32_16x16x32_bf16 v[116:119], a[252:255], v[208:211], v[116:119]
s_waitcnt lgkmcnt(4)
v_mfma_f32_16x16x32_bf16 v[120:123], a[240:243], v[212:215], v[120:123]
ds_read_b64_tr_b16 v[208:209], v230 offset:32768
v_mfma_f32_16x16x32_bf16 v[124:127], a[244:247], v[212:215], v[124:127]
v_mfma_f32_16x16x32_bf16 v[128:131], a[248:251], v[212:215], v[128:131]
ds_read_b64_tr_b16 v[210:211], v230 offset:33280
v_mfma_f32_16x16x32_bf16 v[132:135], a[252:255], v[212:215], v[132:135]
s_waitcnt lgkmcnt(4)
v_mfma_f32_16x16x32_bf16 v[136:139], a[0:3], v[200:203], 0
ds_read_b64_tr_b16 v[212:213], v231 offset:32768
v_mfma_f32_16x16x32_bf16 v[140:143], a[4:7], v[200:203], 0
buffer_load_dwordx4 v237, s[12:15], s65 offen offset:1024 lds
v_mfma_f32_16x16x32_bf16 v[144:147], a[8:11], v[200:203], 0
ds_read_b64_tr_b16 v[214:215], v231 offset:33280
v_mfma_f32_16x16x32_bf16 v[148:151], a[12:15], v[200:203], 0
s_waitcnt lgkmcnt(4)
v_mfma_f32_16x16x32_bf16 v[152:155], a[0:3], v[204:207], 0
ds_read_b64_tr_b16 v[200:201], v228 offset:36864
v_mfma_f32_16x16x32_bf16 v[156:159], a[4:7], v[204:207], 0
v_mfma_f32_16x16x32_bf16 v[160:163], a[8:11], v[204:207], 0
ds_read_b64_tr_b16 v[202:203], v228 offset:37376
s_add_u32 s67, s50, 1056768
v_mfma_f32_16x16x32_bf16 v[164:167], a[12:15], v[204:207], 0
s_waitcnt lgkmcnt(4)
v_mfma_f32_16x16x32_bf16 v[168:171], a[0:3], v[208:211], 0
ds_read_b64_tr_b16 v[204:205], v229 offset:36864
v_mfma_f32_16x16x32_bf16 v[172:175], a[4:7], v[208:211], 0
v_mfma_f32_16x16x32_bf16 v[176:179], a[8:11], v[208:211], 0
ds_read_b64_tr_b16 v[206:207], v229 offset:37376
v_cvt_pk_bf16_f32 v8, v72, v73
v_mfma_f32_16x16x32_bf16 v[180:183], a[12:15], v[208:211], 0
s_waitcnt lgkmcnt(4)
v_mfma_f32_16x16x32_bf16 v[184:187], a[0:3], v[212:215], 0
ds_read_b64_tr_b16 v[208:209], v230 offset:36864
v_mfma_f32_16x16x32_bf16 v[188:191], a[4:7], v[212:215], 0
v_mfma_f32_16x16x32_bf16 v[192:195], a[8:11], v[212:215], 0
ds_read_b64_tr_b16 v[210:211], v230 offset:37376
v_mfma_f32_16x16x32_bf16 v[196:199], a[12:15], v[212:215], 0
s_waitcnt lgkmcnt(4)
v_cvt_pk_bf16_f32 v9, v74, v75
v_mfma_f32_16x16x32_bf16 v[136:139], a[16:19], v[200:203], v[136:139]
ds_read_b64_tr_b16 v[212:213], v231 offset:36864
v_mfma_f32_16x16x32_bf16 v[140:143], a[20:23], v[200:203], v[140:143]
buffer_load_dwordx4 v238, s[12:15], s65 offen offset:2048 lds
v_mfma_f32_16x16x32_bf16 v[144:147], a[24:27], v[200:203], v[144:147]
ds_read_b64_tr_b16 v[214:215], v231 offset:37376
v_mfma_f32_16x16x32_bf16 v[148:151], a[28:31], v[200:203], v[148:151]
s_waitcnt lgkmcnt(4)
v_cvt_pk_bf16_f32 v10, v76, v77
v_mfma_f32_16x16x32_bf16 v[152:155], a[16:19], v[204:207], v[152:155]
ds_read_b64_tr_b16 v[200:201], v228 offset:40960
v_mfma_f32_16x16x32_bf16 v[156:159], a[20:23], v[204:207], v[156:159]
buffer_load_dwordx4 a[0:3], v244, s[16:19], 0 offen offset:0 sc1
v_mfma_f32_16x16x32_bf16 v[160:163], a[24:27], v[204:207], v[160:163]
ds_read_b64_tr_b16 v[202:203], v228 offset:41472
v_mfma_f32_16x16x32_bf16 v[164:167], a[28:31], v[204:207], v[164:167]
s_waitcnt lgkmcnt(4)
v_mfma_f32_16x16x32_bf16 v[168:171], a[16:19], v[208:211], v[168:171]
ds_read_b64_tr_b16 v[204:205], v229 offset:40960
v_cvt_pk_bf16_f32 v11, v78, v79
v_mfma_f32_16x16x32_bf16 v[172:175], a[20:23], v[208:211], v[172:175]
buffer_store_dwordx4 v[8:11], v2, s[20:23], s67 offen offset:0 sc1
v_mfma_f32_16x16x32_bf16 v[176:179], a[24:27], v[208:211], v[176:179]
ds_read_b64_tr_b16 v[206:207], v229 offset:41472
v_mfma_f32_16x16x32_bf16 v[180:183], a[28:31], v[208:211], v[180:183]
s_waitcnt lgkmcnt(4)
v_mfma_f32_16x16x32_bf16 v[184:187], a[16:19], v[212:215], v[184:187]
ds_read_b64_tr_b16 v[208:209], v230 offset:40960
v_mfma_f32_16x16x32_bf16 v[188:191], a[20:23], v[212:215], v[188:191]
buffer_load_dwordx4 a[4:7], v245, s[16:19], 0 offen offset:0 sc1
v_mfma_f32_16x16x32_bf16 v[192:195], a[24:27], v[212:215], v[192:195]
ds_read_b64_tr_b16 v[210:211], v230 offset:41472
v_mfma_f32_16x16x32_bf16 v[196:199], a[28:31], v[212:215], v[196:199]
s_waitcnt lgkmcnt(4)
v_mfma_f32_16x16x32_bf16 v[136:139], a[32:35], v[200:203], v[136:139]
ds_read_b64_tr_b16 v[212:213], v231 offset:40960
v_mfma_f32_16x16x32_bf16 v[140:143], a[36:39], v[200:203], v[140:143]
buffer_load_dwordx4 v239, s[12:15], s65 offen offset:3072 lds
v_mfma_f32_16x16x32_bf16 v[144:147], a[40:43], v[200:203], v[144:147]
ds_read_b64_tr_b16 v[214:215], v231 offset:41472
v_cvt_pk_bf16_f32 v12, v88, v89
v_mfma_f32_16x16x32_bf16 v[148:151], a[44:47], v[200:203], v[148:151]
s_waitcnt lgkmcnt(4)
v_mfma_f32_16x16x32_bf16 v[152:155], a[32:35], v[204:207], v[152:155]
ds_read_b64_tr_b16 v[200:201], v228 offset:45056
v_mfma_f32_16x16x32_bf16 v[156:159], a[36:39], v[204:207], v[156:159]
buffer_load_dwordx4 a[8:11], v246, s[16:19], 0 offen offset:0 sc1
v_mfma_f32_16x16x32_bf16 v[160:163], a[40:43], v[204:207], v[160:163]
ds_read_b64_tr_b16 v[202:203], v228 offset:45568
v_mfma_f32_16x16x32_bf16 v[164:167], a[44:47], v[204:207], v[164:167]
s_waitcnt lgkmcnt(4)
v_cvt_pk_bf16_f32 v13, v90, v91
v_mfma_f32_16x16x32_bf16 v[168:171], a[32:35], v[208:211], v[168:171]
ds_read_b64_tr_b16 v[204:205], v229 offset:45056
v_mfma_f32_16x16x32_bf16 v[172:175], a[36:39], v[208:211], v[172:175]
buffer_load_dwordx4 a[12:15], v247, s[16:19], 0 offen offset:0 sc1
v_mfma_f32_16x16x32_bf16 v[176:179], a[40:43], v[208:211], v[176:179]
ds_read_b64_tr_b16 v[206:207], v229 offset:45568
v_mfma_f32_16x16x32_bf16 v[180:183], a[44:47], v[208:211], v[180:183]
s_waitcnt lgkmcnt(4)
v_mfma_f32_16x16x32_bf16 v[184:187], a[32:35], v[212:215], v[184:187]
ds_read_b64_tr_b16 v[208:209], v230 offset:45056
v_mfma_f32_16x16x32_bf16 v[188:191], a[36:39], v[212:215], v[188:191]
v_cvt_pk_bf16_f32 v14, v92, v93
buffer_load_dwordx4 a[16:19], v244, s[16:19], 0 offen offset:1024 sc1
v_mfma_f32_16x16x32_bf16 v[192:195], a[40:43], v[212:215], v[192:195]
ds_read_b64_tr_b16 v[210:211], v230 offset:45568
v_mfma_f32_16x16x32_bf16 v[196:199], a[44:47], v[212:215], v[196:199]
s_waitcnt lgkmcnt(4)
v_mfma_f32_16x16x32_bf16 v[136:139], a[48:51], v[200:203], v[136:139]
ds_read_b64_tr_b16 v[212:213], v231 offset:45056
v_mfma_f32_16x16x32_bf16 v[140:143], a[52:55], v[200:203], v[140:143]
s_waitcnt vmcnt(10)
s_barrier
v_mfma_f32_16x16x32_bf16 v[144:147], a[56:59], v[200:203], v[144:147]
ds_read_b64_tr_b16 v[214:215], v231 offset:45568
s_add_u32 m0, s42, 16384
v_mfma_f32_16x16x32_bf16 v[148:151], a[60:63], v[200:203], v[148:151]
s_waitcnt lgkmcnt(4)
s_add_u32 s65, s47, 3146112
v_mfma_f32_16x16x32_bf16 v[152:155], a[48:51], v[204:207], v[152:155]
ds_read_b64_tr_b16 v[200:201], v228 offset:49152
v_cvt_pk_bf16_f32 v15, v94, v95
v_mfma_f32_16x16x32_bf16 v[156:159], a[52:55], v[204:207], v[156:159]
buffer_load_dwordx4 v236, s[12:15], s65 offen offset:0 lds
v_mfma_f32_16x16x32_bf16 v[160:163], a[56:59], v[204:207], v[160:163]
ds_read_b64_tr_b16 v[202:203], v228 offset:49664
v_mfma_f32_16x16x32_bf16 v[164:167], a[60:63], v[204:207], v[164:167]
s_waitcnt lgkmcnt(4)
v_mfma_f32_16x16x32_bf16 v[168:171], a[48:51], v[208:211], v[168:171]
ds_read_b64_tr_b16 v[204:205], v229 offset:49152
v_mfma_f32_16x16x32_bf16 v[172:175], a[52:55], v[208:211], v[172:175]
buffer_store_dwordx4 v[12:15], v2, s[20:23], s67 offen offset:1024 sc1
v_mfma_f32_16x16x32_bf16 v[176:179], a[56:59], v[208:211], v[176:179]
ds_read_b64_tr_b16 v[206:207], v229 offset:49664
v_mfma_f32_16x16x32_bf16 v[180:183], a[60:63], v[208:211], v[180:183]
s_waitcnt lgkmcnt(4)
v_mfma_f32_16x16x32_bf16 v[184:187], a[48:51], v[212:215], v[184:187]
ds_read_b64_tr_b16 v[208:209], v230 offset:49152
v_mfma_f32_16x16x32_bf16 v[188:191], a[52:55], v[212:215], v[188:191]
buffer_load_dwordx4 a[20:23], v245, s[16:19], 0 offen offset:1024 sc1
v_mfma_f32_16x16x32_bf16 v[192:195], a[56:59], v[212:215], v[192:195]
ds_read_b64_tr_b16 v[210:211], v230 offset:49664
v_cvt_pk_bf16_f32 v16, v104, v105
v_mfma_f32_16x16x32_bf16 v[196:199], a[60:63], v[212:215], v[196:199]
s_waitcnt lgkmcnt(4)
v_mfma_f32_16x16x32_bf16 v[136:139], a[64:67], v[200:203], v[136:139]
ds_read_b64_tr_b16 v[212:213], v231 offset:49152
v_mfma_f32_16x16x32_bf16 v[140:143], a[68:71], v[200:203], v[140:143]
buffer_load_dwordx4 v237, s[12:15], s65 offen offset:1024 lds
v_mfma_f32_16x16x32_bf16 v[144:147], a[72:75], v[200:203], v[144:147]
ds_read_b64_tr_b16 v[214:215], v231 offset:49664
v_mfma_f32_16x16x32_bf16 v[148:151], a[76:79], v[200:203], v[148:151]
s_waitcnt lgkmcnt(4)
v_cvt_pk_bf16_f32 v17, v106, v107
v_mfma_f32_16x16x32_bf16 v[152:155], a[64:67], v[204:207], v[152:155]
ds_read_b64_tr_b16 v[200:201], v228 offset:53248
v_mfma_f32_16x16x32_bf16 v[156:159], a[68:71], v[204:207], v[156:159]
buffer_load_dwordx4 a[24:27], v246, s[16:19], 0 offen offset:1024 sc1
v_mfma_f32_16x16x32_bf16 v[160:163], a[72:75], v[204:207], v[160:163]
ds_read_b64_tr_b16 v[202:203], v228 offset:53760
v_mfma_f32_16x16x32_bf16 v[164:167], a[76:79], v[204:207], v[164:167]
s_waitcnt lgkmcnt(4)
v_mfma_f32_16x16x32_bf16 v[168:171], a[64:67], v[208:211], v[168:171]
ds_read_b64_tr_b16 v[204:205], v229 offset:53248
v_mfma_f32_16x16x32_bf16 v[172:175], a[68:71], v[208:211], v[172:175]
v_cvt_pk_bf16_f32 v18, v108, v109
buffer_load_dwordx4 a[28:31], v247, s[16:19], 0 offen offset:1024 sc1
v_mfma_f32_16x16x32_bf16 v[176:179], a[72:75], v[208:211], v[176:179]
ds_read_b64_tr_b16 v[206:207], v229 offset:53760
v_mfma_f32_16x16x32_bf16 v[180:183], a[76:79], v[208:211], v[180:183]
s_waitcnt lgkmcnt(4)
v_mfma_f32_16x16x32_bf16 v[184:187], a[64:67], v[212:215], v[184:187]
ds_read_b64_tr_b16 v[208:209], v230 offset:53248
v_mfma_f32_16x16x32_bf16 v[188:191], a[68:71], v[212:215], v[188:191]
buffer_load_dwordx4 a[32:35], v244, s[16:19], 0 offen offset:2048 sc1
v_mfma_f32_16x16x32_bf16 v[192:195], a[72:75], v[212:215], v[192:195]
ds_read_b64_tr_b16 v[210:211], v230 offset:53760
v_mfma_f32_16x16x32_bf16 v[196:199], a[76:79], v[212:215], v[196:199]
s_waitcnt lgkmcnt(4)
v_cvt_pk_bf16_f32 v19, v110, v111
v_mfma_f32_16x16x32_bf16 v[136:139], a[80:83], v[200:203], v[136:139]
ds_read_b64_tr_b16 v[212:213], v231 offset:53248
v_mfma_f32_16x16x32_bf16 v[140:143], a[84:87], v[200:203], v[140:143]
buffer_load_dwordx4 v238, s[12:15], s65 offen offset:2048 lds
v_mfma_f32_16x16x32_bf16 v[144:147], a[88:91], v[200:203], v[144:147]
ds_read_b64_tr_b16 v[214:215], v231 offset:53760
v_mfma_f32_16x16x32_bf16 v[148:151], a[92:95], v[200:203], v[148:151]
s_waitcnt lgkmcnt(4)
v_mfma_f32_16x16x32_bf16 v[152:155], a[80:83], v[204:207], v[152:155]
ds_read_b64_tr_b16 v[200:201], v228 offset:57344
v_mfma_f32_16x16x32_bf16 v[156:159], a[84:87], v[204:207], v[156:159]
buffer_store_dwordx4 v[16:19], v2, s[20:23], s67 offen offset:2048 sc1
v_mfma_f32_16x16x32_bf16 v[160:163], a[88:91], v[204:207], v[160:163]
ds_read_b64_tr_b16 v[202:203], v228 offset:57856
v_mfma_f32_16x16x32_bf16 v[164:167], a[92:95], v[204:207], v[164:167]
s_waitcnt lgkmcnt(4)
v_mfma_f32_16x16x32_bf16 v[168:171], a[80:83], v[208:211], v[168:171]
ds_read_b64_tr_b16 v[204:205], v229 offset:57344
v_mfma_f32_16x16x32_bf16 v[172:175], a[84:87], v[208:211], v[172:175]
buffer_load_dwordx4 a[36:39], v245, s[16:19], 0 offen offset:2048 sc1
v_mfma_f32_16x16x32_bf16 v[176:179], a[88:91], v[208:211], v[176:179]
ds_read_b64_tr_b16 v[206:207], v229 offset:57856
v_cvt_pk_bf16_f32 v20, v120, v121
v_mfma_f32_16x16x32_bf16 v[180:183], a[92:95], v[208:211], v[180:183]
s_waitcnt lgkmcnt(4)
v_mfma_f32_16x16x32_bf16 v[184:187], a[80:83], v[212:215], v[184:187]
ds_read_b64_tr_b16 v[208:209], v230 offset:57344
v_mfma_f32_16x16x32_bf16 v[188:191], a[84:87], v[212:215], v[188:191]
buffer_load_dwordx4 a[40:43], v246, s[16:19], 0 offen offset:2048 sc1
v_mfma_f32_16x16x32_bf16 v[192:195], a[88:91], v[212:215], v[192:195]
ds_read_b64_tr_b16 v[210:211], v230 offset:57856
v_mfma_f32_16x16x32_bf16 v[196:199], a[92:95], v[212:215], v[196:199]
s_waitcnt lgkmcnt(4)
v_cvt_pk_bf16_f32 v21, v122, v123
v_mfma_f32_16x16x32_bf16 v[136:139], a[96:99], v[200:203], v[136:139]
ds_read_b64_tr_b16 v[212:213], v231 offset:57344
v_mfma_f32_16x16x32_bf16 v[140:143], a[100:103], v[200:203], v[140:143]
buffer_load_dwordx4 v239, s[12:15], s65 offen offset:3072 lds
v_mfma_f32_16x16x32_bf16 v[144:147], a[104:107], v[200:203], v[144:147]
ds_read_b64_tr_b16 v[214:215], v231 offset:57856
v_mfma_f32_16x16x32_bf16 v[148:151], a[108:111], v[200:203], v[148:151]
s_waitcnt lgkmcnt(4)
v_mfma_f32_16x16x32_bf16 v[152:155], a[96:99], v[204:207], v[152:155]
ds_read_b64_tr_b16 v[200:201], v228 offset:61440
v_mfma_f32_16x16x32_bf16 v[156:159], a[100:103], v[204:207], v[156:159]
v_cvt_pk_bf16_f32 v22, v124, v125
buffer_load_dwordx4 a[44:47], v247, s[16:19], 0 offen offset:2048 sc1
v_mfma_f32_16x16x32_bf16 v[160:163], a[104:107], v[204:207], v[160:163]
ds_read_b64_tr_b16 v[202:203], v228 offset:61952
v_mfma_f32_16x16x32_bf16 v[164:167], a[108:111], v[204:207], v[164:167]
s_waitcnt lgkmcnt(4)
v_mfma_f32_16x16x32_bf16 v[168:171], a[96:99], v[208:211], v[168:171]
ds_read_b64_tr_b16 v[204:205], v229 offset:61440
v_mfma_f32_16x16x32_bf16 v[172:175], a[100:103], v[208:211], v[172:175]
buffer_load_dwordx4 a[48:51], v244, s[16:19], 0 offen offset:3072 sc1
v_mfma_f32_16x16x32_bf16 v[176:179], a[104:107], v[208:211], v[176:179]
ds_read_b64_tr_b16 v[206:207], v229 offset:61952
v_mfma_f32_16x16x32_bf16 v[180:183], a[108:111], v[208:211], v[180:183]
s_waitcnt lgkmcnt(4)
v_cvt_pk_bf16_f32 v23, v126, v127
v_mfma_f32_16x16x32_bf16 v[184:187], a[96:99], v[212:215], v[184:187]
ds_read_b64_tr_b16 v[208:209], v230 offset:61440
v_mfma_f32_16x16x32_bf16 v[188:191], a[100:103], v[212:215], v[188:191]
buffer_store_dwordx4 v[20:23], v2, s[20:23], s67 offen offset:3072 sc1
v_mfma_f32_16x16x32_bf16 v[192:195], a[104:107], v[212:215], v[192:195]
ds_read_b64_tr_b16 v[210:211], v230 offset:61952
v_mfma_f32_16x16x32_bf16 v[196:199], a[108:111], v[212:215], v[196:199]
s_waitcnt lgkmcnt(4)
v_mfma_f32_16x16x32_bf16 v[136:139], a[112:115], v[200:203], v[136:139]
ds_read_b64_tr_b16 v[212:213], v231 offset:61440
v_mfma_f32_16x16x32_bf16 v[140:143], a[116:119], v[200:203], v[140:143]
s_waitcnt vmcnt(18)
s_barrier
v_mfma_f32_16x16x32_bf16 v[144:147], a[120:123], v[200:203], v[144:147]
ds_read_b64_tr_b16 v[214:215], v231 offset:61952
s_add_u32 m0, s42, 32768
v_mfma_f32_16x16x32_bf16 v[148:151], a[124:127], v[200:203], v[148:151]
s_waitcnt lgkmcnt(4)
s_add_u32 s65, s51, 0
v_mfma_f32_16x16x32_bf16 v[152:155], a[112:115], v[204:207], v[152:155]
ds_read_b64_tr_b16 v[200:201], v228 offset:0
v_mfma_f32_16x16x32_bf16 v[156:159], a[116:119], v[204:207], v[156:159]
buffer_load_dwordx4 v236, s[4:7], s65 offen offset:0 lds
v_mfma_f32_16x16x32_bf16 v[160:163], a[120:123], v[204:207], v[160:163]
ds_read_b64_tr_b16 v[202:203], v228 offset:512
s_add_u32 s67, s50, 1073152
v_mfma_f32_16x16x32_bf16 v[164:167], a[124:127], v[204:207], v[164:167]
s_waitcnt lgkmcnt(4)
v_mfma_f32_16x16x32_bf16 v[168:171], a[112:115], v[208:211], v[168:171]
ds_read_b64_tr_b16 v[204:205], v229 offset:0
v_mfma_f32_16x16x32_bf16 v[172:175], a[116:119], v[208:211], v[172:175]
buffer_load_dwordx4 a[52:55], v245, s[16:19], 0 offen offset:3072 sc1
v_mfma_f32_16x16x32_bf16 v[176:179], a[120:123], v[208:211], v[176:179]
ds_read_b64_tr_b16 v[206:207], v229 offset:512
v_cvt_pk_bf16_f32 v8, v80, v81
v_mfma_f32_16x16x32_bf16 v[180:183], a[124:127], v[208:211], v[180:183]
s_waitcnt lgkmcnt(4)
v_mfma_f32_16x16x32_bf16 v[184:187], a[112:115], v[212:215], v[184:187]
ds_read_b64_tr_b16 v[208:209], v230 offset:0
v_mfma_f32_16x16x32_bf16 v[188:191], a[116:119], v[212:215], v[188:191]
buffer_load_dwordx4 a[56:59], v246, s[16:19], 0 offen offset:3072 sc1
v_mfma_f32_16x16x32_bf16 v[192:195], a[120:123], v[212:215], v[192:195]
ds_read_b64_tr_b16 v[210:211], v230 offset:512
v_mfma_f32_16x16x32_bf16 v[196:199], a[124:127], v[212:215], v[196:199]
s_waitcnt lgkmcnt(4)
v_cvt_pk_bf16_f32 v9, v82, v83
v_mfma_f32_16x16x32_bf16 v[136:139], a[128:131], v[200:203], v[136:139]
ds_read_b64_tr_b16 v[212:213], v231 offset:0
v_mfma_f32_16x16x32_bf16 v[140:143], a[132:135], v[200:203], v[140:143]
buffer_load_dwordx4 v237, s[4:7], s65 offen offset:1024 lds
v_mfma_f32_16x16x32_bf16 v[144:147], a[136:139], v[200:203], v[144:147]
ds_read_b64_tr_b16 v[214:215], v231 offset:512
v_mfma_f32_16x16x32_bf16 v[148:151], a[140:143], v[200:203], v[148:151]
s_waitcnt lgkmcnt(4)
v_cvt_pk_bf16_f32 v10, v84, v85
v_mfma_f32_16x16x32_bf16 v[152:155], a[128:131], v[204:207], v[152:155]
ds_read_b64_tr_b16 v[200:201], v228 offset:4096
v_mfma_f32_16x16x32_bf16 v[156:159], a[132:135], v[204:207], v[156:159]
buffer_load_dwordx4 a[60:63], v247, s[16:19], 0 offen offset:3072 sc1
v_mfma_f32_16x16x32_bf16 v[160:163], a[136:139], v[204:207], v[160:163]
ds_read_b64_tr_b16 v[202:203], v228 offset:4608
v_mfma_f32_16x16x32_bf16 v[164:167], a[140:143], v[204:207], v[164:167]
s_waitcnt lgkmcnt(4)
v_mfma_f32_16x16x32_bf16 v[168:171], a[128:131], v[208:211], v[168:171]
ds_read_b64_tr_b16 v[204:205], v229 offset:4096
s_mov_b32 s12, s90
v_mfma_f32_16x16x32_bf16 v[172:175], a[132:135], v[208:211], v[172:175]
s_mov_b32 s13, s91
s_mov_b32 s14, 0x158000
buffer_load_dwordx4 a[64:67], v244, s[16:19], s56 offen offset:0 sc1
v_mfma_f32_16x16x32_bf16 v[176:179], a[136:139], v[208:211], v[176:179]
ds_read_b64_tr_b16 v[206:207], v229 offset:4608
s_mov_b32 s15, 0x20000
v_mfma_f32_16x16x32_bf16 v[180:183], a[140:143], v[208:211], v[180:183]
s_waitcnt lgkmcnt(4)
v_cvt_pk_bf16_f32 v11, v86, v87
v_mfma_f32_16x16x32_bf16 v[184:187], a[128:131], v[212:215], v[184:187]
ds_read_b64_tr_b16 v[208:209], v230 offset:4096
v_mfma_f32_16x16x32_bf16 v[188:191], a[132:135], v[212:215], v[188:191]
buffer_store_dwordx4 v[8:11], v2, s[20:23], s67 offen offset:0 sc1
v_mfma_f32_16x16x32_bf16 v[192:195], a[136:139], v[212:215], v[192:195]
ds_read_b64_tr_b16 v[210:211], v230 offset:4608
v_mfma_f32_16x16x32_bf16 v[196:199], a[140:143], v[212:215], v[196:199]
s_waitcnt lgkmcnt(4)
v_mfma_f32_16x16x32_bf16 v[136:139], a[144:147], v[200:203], v[136:139]
ds_read_b64_tr_b16 v[212:213], v231 offset:4096
v_mfma_f32_16x16x32_bf16 v[140:143], a[148:151], v[200:203], v[140:143]
buffer_load_dwordx4 v238, s[4:7], s65 offen offset:2048 lds
v_mfma_f32_16x16x32_bf16 v[144:147], a[152:155], v[200:203], v[144:147]
ds_read_b64_tr_b16 v[214:215], v231 offset:4608
v_cvt_pk_bf16_f32 v12, v96, v97
v_mfma_f32_16x16x32_bf16 v[148:151], a[156:159], v[200:203], v[148:151]
s_waitcnt lgkmcnt(4)
v_mfma_f32_16x16x32_bf16 v[152:155], a[144:147], v[204:207], v[152:155]
ds_read_b64_tr_b16 v[200:201], v228 offset:8192
v_mfma_f32_16x16x32_bf16 v[156:159], a[148:151], v[204:207], v[156:159]
buffer_load_dwordx4 a[68:71], v245, s[16:19], s56 offen offset:0 sc1
v_mfma_f32_16x16x32_bf16 v[160:163], a[152:155], v[204:207], v[160:163]
ds_read_b64_tr_b16 v[202:203], v228 offset:8704
v_mfma_f32_16x16x32_bf16 v[164:167], a[156:159], v[204:207], v[164:167]
s_waitcnt lgkmcnt(4)
v_cvt_pk_bf16_f32 v13, v98, v99
v_mfma_f32_16x16x32_bf16 v[168:171], a[144:147], v[208:211], v[168:171]
ds_read_b64_tr_b16 v[204:205], v229 offset:8192
v_mfma_f32_16x16x32_bf16 v[172:175], a[148:151], v[208:211], v[172:175]
buffer_load_dwordx4 a[72:75], v246, s[16:19], s56 offen offset:0 sc1
v_mfma_f32_16x16x32_bf16 v[176:179], a[152:155], v[208:211], v[176:179]
ds_read_b64_tr_b16 v[206:207], v229 offset:8704
v_mfma_f32_16x16x32_bf16 v[180:183], a[156:159], v[208:211], v[180:183]
s_waitcnt lgkmcnt(4)
v_mfma_f32_16x16x32_bf16 v[184:187], a[144:147], v[212:215], v[184:187]
ds_read_b64_tr_b16 v[208:209], v230 offset:8192
v_mfma_f32_16x16x32_bf16 v[188:191], a[148:151], v[212:215], v[188:191]
v_cvt_pk_bf16_f32 v14, v100, v101
buffer_load_dwordx4 a[76:79], v247, s[16:19], s56 offen offset:0 sc1
v_mfma_f32_16x16x32_bf16 v[192:195], a[152:155], v[212:215], v[192:195]
ds_read_b64_tr_b16 v[210:211], v230 offset:8704
v_mfma_f32_16x16x32_bf16 v[196:199], a[156:159], v[212:215], v[196:199]
s_waitcnt lgkmcnt(4)
v_mfma_f32_16x16x32_bf16 v[136:139], a[160:163], v[200:203], v[136:139]
ds_read_b64_tr_b16 v[212:213], v231 offset:8192
v_mfma_f32_16x16x32_bf16 v[140:143], a[164:167], v[200:203], v[140:143]
buffer_load_dwordx4 v239, s[4:7], s65 offen offset:3072 lds
v_mfma_f32_16x16x32_bf16 v[144:147], a[168:171], v[200:203], v[144:147]
ds_read_b64_tr_b16 v[214:215], v231 offset:8704
v_mfma_f32_16x16x32_bf16 v[148:151], a[172:175], v[200:203], v[148:151]
s_waitcnt lgkmcnt(4)
v_cvt_pk_bf16_f32 v15, v102, v103
v_mfma_f32_16x16x32_bf16 v[152:155], a[160:163], v[204:207], v[152:155]
ds_read_b64_tr_b16 v[200:201], v228 offset:12288
v_mfma_f32_16x16x32_bf16 v[156:159], a[164:167], v[204:207], v[156:159]
buffer_store_dwordx4 v[12:15], v2, s[20:23], s67 offen offset:1024 sc1
v_mfma_f32_16x16x32_bf16 v[160:163], a[168:171], v[204:207], v[160:163]
ds_read_b64_tr_b16 v[202:203], v228 offset:12800
v_mfma_f32_16x16x32_bf16 v[164:167], a[172:175], v[204:207], v[164:167]
s_waitcnt lgkmcnt(4)
v_mfma_f32_16x16x32_bf16 v[168:171], a[160:163], v[208:211], v[168:171]
ds_read_b64_tr_b16 v[204:205], v229 offset:12288
v_mfma_f32_16x16x32_bf16 v[172:175], a[164:167], v[208:211], v[172:175]
buffer_load_dwordx4 a[80:83], v244, s[16:19], s56 offen offset:1024 sc1
v_mfma_f32_16x16x32_bf16 v[176:179], a[168:171], v[208:211], v[176:179]
ds_read_b64_tr_b16 v[206:207], v229 offset:12800
v_mfma_f32_16x16x32_bf16 v[180:183], a[172:175], v[208:211], v[180:183]
s_waitcnt lgkmcnt(4)
v_mfma_f32_16x16x32_bf16 v[184:187], a[160:163], v[212:215], v[184:187]
ds_read_b64_tr_b16 v[208:209], v230 offset:12288
v_mfma_f32_16x16x32_bf16 v[188:191], a[164:167], v[212:215], v[188:191]
buffer_load_dwordx4 a[84:87], v245, s[16:19], s56 offen offset:1024 sc1
v_mfma_f32_16x16x32_bf16 v[192:195], a[168:171], v[212:215], v[192:195]
ds_read_b64_tr_b16 v[210:211], v230 offset:12800
v_cvt_pk_bf16_f32 v16, v112, v113
v_mfma_f32_16x16x32_bf16 v[196:199], a[172:175], v[212:215], v[196:199]
s_waitcnt lgkmcnt(4)
v_mfma_f32_16x16x32_bf16 v[136:139], a[176:179], v[200:203], v[136:139]
ds_read_b64_tr_b16 v[212:213], v231 offset:12288
v_mfma_f32_16x16x32_bf16 v[140:143], a[180:183], v[200:203], v[140:143]
s_waitcnt vmcnt(18)
s_barrier
v_mfma_f32_16x16x32_bf16 v[144:147], a[184:187], v[200:203], v[144:147]
ds_read_b64_tr_b16 v[214:215], v231 offset:12800
s_add_u32 m0, s42, 49152
v_mfma_f32_16x16x32_bf16 v[148:151], a[188:191], v[200:203], v[148:151]
s_waitcnt lgkmcnt(4)
s_add_u32 s65, s51, 1048576
v_mfma_f32_16x16x32_bf16 v[152:155], a[176:179], v[204:207], v[152:155]
ds_read_b64_tr_b16 v[200:201], v228 offset:16384
v_cvt_pk_bf16_f32 v17, v114, v115
v_mfma_f32_16x16x32_bf16 v[156:159], a[180:183], v[204:207], v[156:159]
buffer_load_dwordx4 v236, s[4:7], s65 offen offset:0 lds
v_mfma_f32_16x16x32_bf16 v[160:163], a[184:187], v[204:207], v[160:163]
ds_read_b64_tr_b16 v[202:203], v228 offset:16896
v_mfma_f32_16x16x32_bf16 v[164:167], a[188:191], v[204:207], v[164:167]
s_waitcnt lgkmcnt(4)
v_mfma_f32_16x16x32_bf16 v[168:171], a[176:179], v[208:211], v[168:171]
ds_read_b64_tr_b16 v[204:205], v229 offset:16384
v_mfma_f32_16x16x32_bf16 v[172:175], a[180:183], v[208:211], v[172:175]
v_cvt_pk_bf16_f32 v18, v116, v117
buffer_load_dwordx4 a[88:91], v246, s[16:19], s56 offen offset:1024 sc1
v_mfma_f32_16x16x32_bf16 v[176:179], a[184:187], v[208:211], v[176:179]
ds_read_b64_tr_b16 v[206:207], v229 offset:16896
v_mfma_f32_16x16x32_bf16 v[180:183], a[188:191], v[208:211], v[180:183]
s_waitcnt lgkmcnt(4)
v_mfma_f32_16x16x32_bf16 v[184:187], a[176:179], v[212:215], v[184:187]
ds_read_b64_tr_b16 v[208:209], v230 offset:16384
v_mfma_f32_16x16x32_bf16 v[188:191], a[180:183], v[212:215], v[188:191]
buffer_load_dwordx4 a[92:95], v247, s[16:19], s56 offen offset:1024 sc1
v_mfma_f32_16x16x32_bf16 v[192:195], a[184:187], v[212:215], v[192:195]
ds_read_b64_tr_b16 v[210:211], v230 offset:16896
v_mfma_f32_16x16x32_bf16 v[196:199], a[188:191], v[212:215], v[196:199]
s_waitcnt lgkmcnt(4)
v_cvt_pk_bf16_f32 v19, v118, v119
v_mfma_f32_16x16x32_bf16 v[136:139], a[192:195], v[200:203], v[136:139]
ds_read_b64_tr_b16 v[212:213], v231 offset:16384
v_mfma_f32_16x16x32_bf16 v[140:143], a[196:199], v[200:203], v[140:143]
buffer_load_dwordx4 v237, s[4:7], s65 offen offset:1024 lds
v_mfma_f32_16x16x32_bf16 v[144:147], a[200:203], v[200:203], v[144:147]
ds_read_b64_tr_b16 v[214:215], v231 offset:16896
v_mfma_f32_16x16x32_bf16 v[148:151], a[204:207], v[200:203], v[148:151]
s_waitcnt lgkmcnt(4)
v_mfma_f32_16x16x32_bf16 v[152:155], a[192:195], v[204:207], v[152:155]
ds_read_b64_tr_b16 v[200:201], v228 offset:20480
v_mfma_f32_16x16x32_bf16 v[156:159], a[196:199], v[204:207], v[156:159]
buffer_store_dwordx4 v[16:19], v2, s[20:23], s67 offen offset:2048 sc1
v_mfma_f32_16x16x32_bf16 v[160:163], a[200:203], v[204:207], v[160:163]
ds_read_b64_tr_b16 v[202:203], v228 offset:20992
v_mfma_f32_16x16x32_bf16 v[164:167], a[204:207], v[204:207], v[164:167]
s_waitcnt lgkmcnt(4)
v_mfma_f32_16x16x32_bf16 v[168:171], a[192:195], v[208:211], v[168:171]
ds_read_b64_tr_b16 v[204:205], v229 offset:20480
v_mfma_f32_16x16x32_bf16 v[172:175], a[196:199], v[208:211], v[172:175]
buffer_load_dwordx4 a[96:99], v244, s[16:19], s56 offen offset:2048 sc1
v_mfma_f32_16x16x32_bf16 v[176:179], a[200:203], v[208:211], v[176:179]
ds_read_b64_tr_b16 v[206:207], v229 offset:20992
v_cvt_pk_bf16_f32 v20, v128, v129
v_mfma_f32_16x16x32_bf16 v[180:183], a[204:207], v[208:211], v[180:183]
s_waitcnt lgkmcnt(4)
v_mfma_f32_16x16x32_bf16 v[184:187], a[192:195], v[212:215], v[184:187]
ds_read_b64_tr_b16 v[208:209], v230 offset:20480
v_mfma_f32_16x16x32_bf16 v[188:191], a[196:199], v[212:215], v[188:191]
buffer_load_dwordx4 a[100:103], v245, s[16:19], s56 offen offset:2048 sc1
v_mfma_f32_16x16x32_bf16 v[192:195], a[200:203], v[212:215], v[192:195]
ds_read_b64_tr_b16 v[210:211], v230 offset:20992
v_mfma_f32_16x16x32_bf16 v[196:199], a[204:207], v[212:215], v[196:199]
s_waitcnt lgkmcnt(4)
v_cvt_pk_bf16_f32 v21, v130, v131
v_mfma_f32_16x16x32_bf16 v[136:139], a[208:211], v[200:203], v[136:139]
ds_read_b64_tr_b16 v[212:213], v231 offset:20480
v_mfma_f32_16x16x32_bf16 v[140:143], a[212:215], v[200:203], v[140:143]
buffer_load_dwordx4 v238, s[4:7], s65 offen offset:2048 lds
v_mfma_f32_16x16x32_bf16 v[144:147], a[216:219], v[200:203], v[144:147]
ds_read_b64_tr_b16 v[214:215], v231 offset:20992
v_mfma_f32_16x16x32_bf16 v[148:151], a[220:223], v[200:203], v[148:151]
s_waitcnt lgkmcnt(4)
v_mfma_f32_16x16x32_bf16 v[152:155], a[208:211], v[204:207], v[152:155]
ds_read_b64_tr_b16 v[200:201], v228 offset:24576
v_mfma_f32_16x16x32_bf16 v[156:159], a[212:215], v[204:207], v[156:159]
v_cvt_pk_bf16_f32 v22, v132, v133
buffer_load_dwordx4 a[104:107], v246, s[16:19], s56 offen offset:2048 sc1
v_mfma_f32_16x16x32_bf16 v[160:163], a[216:219], v[204:207], v[160:163]
ds_read_b64_tr_b16 v[202:203], v228 offset:25088
v_mfma_f32_16x16x32_bf16 v[164:167], a[220:223], v[204:207], v[164:167]
s_waitcnt lgkmcnt(4)
v_mfma_f32_16x16x32_bf16 v[168:171], a[208:211], v[208:211], v[168:171]
ds_read_b64_tr_b16 v[204:205], v229 offset:24576
v_mfma_f32_16x16x32_bf16 v[172:175], a[212:215], v[208:211], v[172:175]
buffer_load_dwordx4 a[108:111], v247, s[16:19], s56 offen offset:2048 sc1
v_mfma_f32_16x16x32_bf16 v[176:179], a[216:219], v[208:211], v[176:179]
ds_read_b64_tr_b16 v[206:207], v229 offset:25088
v_mfma_f32_16x16x32_bf16 v[180:183], a[220:223], v[208:211], v[180:183]
s_waitcnt lgkmcnt(4)
v_cvt_pk_bf16_f32 v23, v134, v135
v_mfma_f32_16x16x32_bf16 v[184:187], a[208:211], v[212:215], v[184:187]
ds_read_b64_tr_b16 v[208:209], v230 offset:24576
v_mfma_f32_16x16x32_bf16 v[188:191], a[212:215], v[212:215], v[188:191]
buffer_store_dwordx4 v[20:23], v2, s[20:23], s67 offen offset:3072 sc1
v_mfma_f32_16x16x32_bf16 v[192:195], a[216:219], v[212:215], v[192:195]
ds_read_b64_tr_b16 v[210:211], v230 offset:25088
v_mfma_f32_16x16x32_bf16 v[196:199], a[220:223], v[212:215], v[196:199]
s_waitcnt lgkmcnt(4)
v_mfma_f32_16x16x32_bf16 v[136:139], a[224:227], v[200:203], v[136:139]
ds_read_b64_tr_b16 v[212:213], v231 offset:24576
v_mfma_f32_16x16x32_bf16 v[140:143], a[228:231], v[200:203], v[140:143]
buffer_load_dwordx4 v239, s[4:7], s65 offen offset:3072 lds
v_mfma_f32_16x16x32_bf16 v[144:147], a[232:235], v[200:203], v[144:147]
ds_read_b64_tr_b16 v[214:215], v231 offset:25088
v_mfma_f32_16x16x32_bf16 v[148:151], a[236:239], v[200:203], v[148:151]
s_waitcnt lgkmcnt(4)
v_mfma_f32_16x16x32_bf16 v[152:155], a[224:227], v[204:207], v[152:155]
ds_read_b64_tr_b16 v[200:201], v228 offset:28672
v_mfma_f32_16x16x32_bf16 v[156:159], a[228:231], v[204:207], v[156:159]
buffer_load_dwordx4 a[112:115], v244, s[16:19], s56 offen offset:3072 sc1
v_mfma_f32_16x16x32_bf16 v[160:163], a[232:235], v[204:207], v[160:163]
ds_read_b64_tr_b16 v[202:203], v228 offset:29184
v_mfma_f32_16x16x32_bf16 v[164:167], a[236:239], v[204:207], v[164:167]
s_waitcnt lgkmcnt(4)
v_mfma_f32_16x16x32_bf16 v[168:171], a[224:227], v[208:211], v[168:171]
ds_read_b64_tr_b16 v[204:205], v229 offset:28672
v_mfma_f32_16x16x32_bf16 v[172:175], a[228:231], v[208:211], v[172:175]
buffer_load_dwordx4 a[116:119], v245, s[16:19], s56 offen offset:3072 sc1
v_mfma_f32_16x16x32_bf16 v[176:179], a[232:235], v[208:211], v[176:179]
ds_read_b64_tr_b16 v[206:207], v229 offset:29184
v_mfma_f32_16x16x32_bf16 v[180:183], a[236:239], v[208:211], v[180:183]
s_waitcnt lgkmcnt(4)
v_mfma_f32_16x16x32_bf16 v[184:187], a[224:227], v[212:215], v[184:187]
ds_read_b64_tr_b16 v[208:209], v230 offset:28672
v_mfma_f32_16x16x32_bf16 v[188:191], a[228:231], v[212:215], v[188:191]
buffer_load_dwordx4 a[120:123], v246, s[16:19], s56 offen offset:3072 sc1
v_mfma_f32_16x16x32_bf16 v[192:195], a[232:235], v[212:215], v[192:195]
ds_read_b64_tr_b16 v[210:211], v230 offset:29184
v_mfma_f32_16x16x32_bf16 v[196:199], a[236:239], v[212:215], v[196:199]
s_waitcnt lgkmcnt(4)
v_mfma_f32_16x16x32_bf16 v[136:139], a[240:243], v[200:203], v[136:139]
ds_read_b64_tr_b16 v[212:213], v231 offset:28672
v_mfma_f32_16x16x32_bf16 v[140:143], a[244:247], v[200:203], v[140:143]
s_waitcnt vmcnt(18)
s_barrier
v_mfma_f32_16x16x32_bf16 v[144:147], a[248:251], v[200:203], v[144:147]
ds_read_b64_tr_b16 v[214:215], v231 offset:29184
s_add_u32 m0, s42, 0
v_mfma_f32_16x16x32_bf16 v[148:151], a[252:255], v[200:203], v[148:151]
s_waitcnt lgkmcnt(4)
s_add_u32 s65, s51, 2097152
v_mfma_f32_16x16x32_bf16 v[152:155], a[240:243], v[204:207], v[152:155]
ds_read_b64_tr_b16 v[200:201], v228 offset:32768
v_mfma_f32_16x16x32_bf16 v[156:159], a[244:247], v[204:207], v[156:159]
buffer_load_dwordx4 v236, s[4:7], s65 offen offset:0 lds
v_mfma_f32_16x16x32_bf16 v[160:163], a[248:251], v[204:207], v[160:163]
ds_read_b64_tr_b16 v[202:203], v228 offset:33280
v_mfma_f32_16x16x32_bf16 v[164:167], a[252:255], v[204:207], v[164:167]
s_waitcnt lgkmcnt(4)
v_mfma_f32_16x16x32_bf16 v[168:171], a[240:243], v[208:211], v[168:171]
ds_read_b64_tr_b16 v[204:205], v229 offset:32768
v_mfma_f32_16x16x32_bf16 v[172:175], a[244:247], v[208:211], v[172:175]
buffer_load_dwordx4 a[124:127], v247, s[16:19], s56 offen offset:3072 sc1
v_mfma_f32_16x16x32_bf16 v[176:179], a[248:251], v[208:211], v[176:179]
ds_read_b64_tr_b16 v[206:207], v229 offset:33280
v_mfma_f32_16x16x32_bf16 v[180:183], a[252:255], v[208:211], v[180:183]
s_waitcnt lgkmcnt(4)
v_mfma_f32_16x16x32_bf16 v[184:187], a[240:243], v[212:215], v[184:187]
ds_read_b64_tr_b16 v[208:209], v230 offset:32768
v_mfma_f32_16x16x32_bf16 v[188:191], a[244:247], v[212:215], v[188:191]
buffer_load_dwordx4 a[128:131], v244, s[16:19], s57 offen offset:0 sc1
v_mfma_f32_16x16x32_bf16 v[192:195], a[248:251], v[212:215], v[192:195]
ds_read_b64_tr_b16 v[210:211], v230 offset:33280
v_mfma_f32_16x16x32_bf16 v[196:199], a[252:255], v[212:215], v[196:199]
s_waitcnt lgkmcnt(4)
v_mfma_f32_16x16x32_bf16 v[72:75], v[200:203], a[0:3], 0
ds_read_b64_tr_b16 v[212:213], v231 offset:32768
v_mfma_f32_16x16x32_bf16 v[76:79], v[200:203], a[4:7], 0
buffer_load_dwordx4 v237, s[4:7], s65 offen offset:1024 lds
v_mfma_f32_16x16x32_bf16 v[80:83], v[200:203], a[8:11], 0
ds_read_b64_tr_b16 v[214:215], v231 offset:33280
v_mfma_f32_16x16x32_bf16 v[84:87], v[200:203], a[12:15], 0
s_waitcnt lgkmcnt(4)
v_mfma_f32_16x16x32_bf16 v[88:91], v[204:207], a[0:3], 0
ds_read_b64_tr_b16 v[200:201], v228 offset:36864
v_mfma_f32_16x16x32_bf16 v[92:95], v[204:207], a[4:7], 0
buffer_load_dwordx4 a[132:135], v245, s[16:19], s57 offen offset:0 sc1
v_mfma_f32_16x16x32_bf16 v[96:99], v[204:207], a[8:11], 0
ds_read_b64_tr_b16 v[202:203], v228 offset:37376
s_add_u32 s67, s50, 1060864
v_mfma_f32_16x16x32_bf16 v[100:103], v[204:207], a[12:15], 0
s_waitcnt lgkmcnt(4)
v_mfma_f32_16x16x32_bf16 v[104:107], v[208:211], a[0:3], 0
ds_read_b64_tr_b16 v[204:205], v229 offset:36864
v_mfma_f32_16x16x32_bf16 v[108:111], v[208:211], a[4:7], 0
buffer_load_dwordx4 a[136:139], v246, s[16:19], s57 offen offset:0 sc1
v_mfma_f32_16x16x32_bf16 v[112:115], v[208:211], a[8:11], 0
ds_read_b64_tr_b16 v[206:207], v229 offset:37376
v_cvt_pk_bf16_f32 v8, v136, v137
v_mfma_f32_16x16x32_bf16 v[116:119], v[208:211], a[12:15], 0
s_waitcnt lgkmcnt(4)
v_mfma_f32_16x16x32_bf16 v[120:123], v[212:215], a[0:3], 0
ds_read_b64_tr_b16 v[208:209], v230 offset:36864
v_mfma_f32_16x16x32_bf16 v[124:127], v[212:215], a[4:7], 0
buffer_load_dwordx4 a[140:143], v247, s[16:19], s57 offen offset:0 sc1
v_mfma_f32_16x16x32_bf16 v[128:131], v[212:215], a[8:11], 0
ds_read_b64_tr_b16 v[210:211], v230 offset:37376
v_mfma_f32_16x16x32_bf16 v[132:135], v[212:215], a[12:15], 0
s_waitcnt lgkmcnt(4)
v_cvt_pk_bf16_f32 v9, v138, v139
v_mfma_f32_16x16x32_bf16 v[72:75], v[200:203], a[16:19], v[72:75]
ds_read_b64_tr_b16 v[212:213], v231 offset:36864
v_mfma_f32_16x16x32_bf16 v[76:79], v[200:203], a[20:23], v[76:79]
buffer_load_dwordx4 v238, s[4:7], s65 offen offset:2048 lds
v_mfma_f32_16x16x32_bf16 v[80:83], v[200:203], a[24:27], v[80:83]
ds_read_b64_tr_b16 v[214:215], v231 offset:37376
v_mfma_f32_16x16x32_bf16 v[84:87], v[200:203], a[28:31], v[84:87]
s_waitcnt lgkmcnt(4)
v_cvt_pk_bf16_f32 v10, v140, v141
v_mfma_f32_16x16x32_bf16 v[88:91], v[204:207], a[16:19], v[88:91]
ds_read_b64_tr_b16 v[200:201], v228 offset:40960
v_mfma_f32_16x16x32_bf16 v[92:95], v[204:207], a[20:23], v[92:95]
buffer_load_dwordx4 a[144:147], v244, s[16:19], s57 offen offset:1024 sc1
v_mfma_f32_16x16x32_bf16 v[96:99], v[204:207], a[24:27], v[96:99]
ds_read_b64_tr_b16 v[202:203], v228 offset:41472
v_mfma_f32_16x16x32_bf16 v[100:103], v[204:207], a[28:31], v[100:103]
s_waitcnt lgkmcnt(4)
v_mfma_f32_16x16x32_bf16 v[104:107], v[208:211], a[16:19], v[104:107]
ds_read_b64_tr_b16 v[204:205], v229 offset:40960
v_cvt_pk_bf16_f32 v11, v142, v143
v_mfma_f32_16x16x32_bf16 v[108:111], v[208:211], a[20:23], v[108:111]
buffer_store_dwordx4 v[8:11], v2, s[20:23], s67 offen offset:0 sc1
v_mfma_f32_16x16x32_bf16 v[112:115], v[208:211], a[24:27], v[112:115]
ds_read_b64_tr_b16 v[206:207], v229 offset:41472
v_mfma_f32_16x16x32_bf16 v[116:119], v[208:211], a[28:31], v[116:119]
s_waitcnt lgkmcnt(4)
v_mfma_f32_16x16x32_bf16 v[120:123], v[212:215], a[16:19], v[120:123]
ds_read_b64_tr_b16 v[208:209], v230 offset:40960
v_mfma_f32_16x16x32_bf16 v[124:127], v[212:215], a[20:23], v[124:127]
buffer_load_dwordx4 a[148:151], v245, s[16:19], s57 offen offset:1024 sc1
v_mfma_f32_16x16x32_bf16 v[128:131], v[212:215], a[24:27], v[128:131]
ds_read_b64_tr_b16 v[210:211], v230 offset:41472
v_mfma_f32_16x16x32_bf16 v[132:135], v[212:215], a[28:31], v[132:135]
s_waitcnt lgkmcnt(4)
v_mfma_f32_16x16x32_bf16 v[72:75], v[200:203], a[32:35], v[72:75]
ds_read_b64_tr_b16 v[212:213], v231 offset:40960
v_mfma_f32_16x16x32_bf16 v[76:79], v[200:203], a[36:39], v[76:79]
buffer_load_dwordx4 v239, s[4:7], s65 offen offset:3072 lds
v_mfma_f32_16x16x32_bf16 v[80:83], v[200:203], a[40:43], v[80:83]
ds_read_b64_tr_b16 v[214:215], v231 offset:41472
v_cvt_pk_bf16_f32 v12, v152, v153
v_mfma_f32_16x16x32_bf16 v[84:87], v[200:203], a[44:47], v[84:87]
s_waitcnt lgkmcnt(4)
v_mfma_f32_16x16x32_bf16 v[88:91], v[204:207], a[32:35], v[88:91]
ds_read_b64_tr_b16 v[200:201], v228 offset:45056
v_mfma_f32_16x16x32_bf16 v[92:95], v[204:207], a[36:39], v[92:95]
buffer_load_dwordx4 a[152:155], v246, s[16:19], s57 offen offset:1024 sc1
v_mfma_f32_16x16x32_bf16 v[96:99], v[204:207], a[40:43], v[96:99]
ds_read_b64_tr_b16 v[202:203], v228 offset:45568
v_mfma_f32_16x16x32_bf16 v[100:103], v[204:207], a[44:47], v[100:103]
s_waitcnt lgkmcnt(4)
v_cvt_pk_bf16_f32 v13, v154, v155
v_mfma_f32_16x16x32_bf16 v[104:107], v[208:211], a[32:35], v[104:107]
ds_read_b64_tr_b16 v[204:205], v229 offset:45056
v_mfma_f32_16x16x32_bf16 v[108:111], v[208:211], a[36:39], v[108:111]
buffer_load_dwordx4 a[156:159], v247, s[16:19], s57 offen offset:1024 sc1
v_mfma_f32_16x16x32_bf16 v[112:115], v[208:211], a[40:43], v[112:115]
ds_read_b64_tr_b16 v[206:207], v229 offset:45568
v_mfma_f32_16x16x32_bf16 v[116:119], v[208:211], a[44:47], v[116:119]
s_waitcnt lgkmcnt(4)
v_mfma_f32_16x16x32_bf16 v[120:123], v[212:215], a[32:35], v[120:123]
ds_read_b64_tr_b16 v[208:209], v230 offset:45056
v_mfma_f32_16x16x32_bf16 v[124:127], v[212:215], a[36:39], v[124:127]
v_cvt_pk_bf16_f32 v14, v156, v157
buffer_load_dwordx4 a[160:163], v244, s[16:19], s57 offen offset:2048 sc1
v_mfma_f32_16x16x32_bf16 v[128:131], v[212:215], a[40:43], v[128:131]
ds_read_b64_tr_b16 v[210:211], v230 offset:45568
v_mfma_f32_16x16x32_bf16 v[132:135], v[212:215], a[44:47], v[132:135]
s_waitcnt lgkmcnt(4)
v_mfma_f32_16x16x32_bf16 v[72:75], v[200:203], a[48:51], v[72:75]
ds_read_b64_tr_b16 v[212:213], v231 offset:45056
v_mfma_f32_16x16x32_bf16 v[76:79], v[200:203], a[52:55], v[76:79]
s_waitcnt vmcnt(18)
s_barrier
v_mfma_f32_16x16x32_bf16 v[80:83], v[200:203], a[56:59], v[80:83]
ds_read_b64_tr_b16 v[214:215], v231 offset:45568
s_add_u32 m0, s42, 16384
v_mfma_f32_16x16x32_bf16 v[84:87], v[200:203], a[60:63], v[84:87]
s_waitcnt lgkmcnt(4)
s_add_u32 s65, s51, 3145728
v_mfma_f32_16x16x32_bf16 v[88:91], v[204:207], a[48:51], v[88:91]
ds_read_b64_tr_b16 v[200:201], v228 offset:49152
v_cvt_pk_bf16_f32 v15, v158, v159
v_mfma_f32_16x16x32_bf16 v[92:95], v[204:207], a[52:55], v[92:95]
buffer_load_dwordx4 v236, s[4:7], s65 offen offset:0 lds
v_mfma_f32_16x16x32_bf16 v[96:99], v[204:207], a[56:59], v[96:99]
ds_read_b64_tr_b16 v[202:203], v228 offset:49664
v_mfma_f32_16x16x32_bf16 v[100:103], v[204:207], a[60:63], v[100:103]
s_waitcnt lgkmcnt(4)
v_mfma_f32_16x16x32_bf16 v[104:107], v[208:211], a[48:51], v[104:107]
ds_read_b64_tr_b16 v[204:205], v229 offset:49152
v_mfma_f32_16x16x32_bf16 v[108:111], v[208:211], a[52:55], v[108:111]
buffer_store_dwordx4 v[12:15], v2, s[20:23], s67 offen offset:1024 sc1
v_mfma_f32_16x16x32_bf16 v[112:115], v[208:211], a[56:59], v[112:115]
ds_read_b64_tr_b16 v[206:207], v229 offset:49664
v_mfma_f32_16x16x32_bf16 v[116:119], v[208:211], a[60:63], v[116:119]
s_waitcnt lgkmcnt(4)
v_mfma_f32_16x16x32_bf16 v[120:123], v[212:215], a[48:51], v[120:123]
ds_read_b64_tr_b16 v[208:209], v230 offset:49152
v_mfma_f32_16x16x32_bf16 v[124:127], v[212:215], a[52:55], v[124:127]
buffer_load_dwordx4 a[164:167], v245, s[16:19], s57 offen offset:2048 sc1
v_mfma_f32_16x16x32_bf16 v[128:131], v[212:215], a[56:59], v[128:131]
ds_read_b64_tr_b16 v[210:211], v230 offset:49664
v_cvt_pk_bf16_f32 v16, v168, v169
v_mfma_f32_16x16x32_bf16 v[132:135], v[212:215], a[60:63], v[132:135]
s_waitcnt lgkmcnt(4)
v_mfma_f32_16x16x32_bf16 v[72:75], v[200:203], a[64:67], v[72:75]
ds_read_b64_tr_b16 v[212:213], v231 offset:49152
v_mfma_f32_16x16x32_bf16 v[76:79], v[200:203], a[68:71], v[76:79]
buffer_load_dwordx4 v237, s[4:7], s65 offen offset:1024 lds
v_mfma_f32_16x16x32_bf16 v[80:83], v[200:203], a[72:75], v[80:83]
ds_read_b64_tr_b16 v[214:215], v231 offset:49664
v_mfma_f32_16x16x32_bf16 v[84:87], v[200:203], a[76:79], v[84:87]
s_waitcnt lgkmcnt(4)
v_cvt_pk_bf16_f32 v17, v170, v171
v_mfma_f32_16x16x32_bf16 v[88:91], v[204:207], a[64:67], v[88:91]
ds_read_b64_tr_b16 v[200:201], v228 offset:53248
v_mfma_f32_16x16x32_bf16 v[92:95], v[204:207], a[68:71], v[92:95]
buffer_load_dwordx4 a[168:171], v246, s[16:19], s57 offen offset:2048 sc1
v_mfma_f32_16x16x32_bf16 v[96:99], v[204:207], a[72:75], v[96:99]
ds_read_b64_tr_b16 v[202:203], v228 offset:53760
v_mfma_f32_16x16x32_bf16 v[100:103], v[204:207], a[76:79], v[100:103]
s_waitcnt lgkmcnt(4)
v_mfma_f32_16x16x32_bf16 v[104:107], v[208:211], a[64:67], v[104:107]
ds_read_b64_tr_b16 v[204:205], v229 offset:53248
v_mfma_f32_16x16x32_bf16 v[108:111], v[208:211], a[68:71], v[108:111]
v_cvt_pk_bf16_f32 v18, v172, v173
buffer_load_dwordx4 a[172:175], v247, s[16:19], s57 offen offset:2048 sc1
v_mfma_f32_16x16x32_bf16 v[112:115], v[208:211], a[72:75], v[112:115]
ds_read_b64_tr_b16 v[206:207], v229 offset:53760
v_mfma_f32_16x16x32_bf16 v[116:119], v[208:211], a[76:79], v[116:119]
s_waitcnt lgkmcnt(4)
v_mfma_f32_16x16x32_bf16 v[120:123], v[212:215], a[64:67], v[120:123]
ds_read_b64_tr_b16 v[208:209], v230 offset:53248
v_mfma_f32_16x16x32_bf16 v[124:127], v[212:215], a[68:71], v[124:127]
buffer_load_dwordx4 a[176:179], v244, s[16:19], s57 offen offset:3072 sc1
v_mfma_f32_16x16x32_bf16 v[128:131], v[212:215], a[72:75], v[128:131]
ds_read_b64_tr_b16 v[210:211], v230 offset:53760
v_mfma_f32_16x16x32_bf16 v[132:135], v[212:215], a[76:79], v[132:135]
s_waitcnt lgkmcnt(4)
v_cvt_pk_bf16_f32 v19, v174, v175
v_mfma_f32_16x16x32_bf16 v[72:75], v[200:203], a[80:83], v[72:75]
ds_read_b64_tr_b16 v[212:213], v231 offset:53248
v_mfma_f32_16x16x32_bf16 v[76:79], v[200:203], a[84:87], v[76:79]
buffer_load_dwordx4 v238, s[4:7], s65 offen offset:2048 lds
v_mfma_f32_16x16x32_bf16 v[80:83], v[200:203], a[88:91], v[80:83]
ds_read_b64_tr_b16 v[214:215], v231 offset:53760
v_mfma_f32_16x16x32_bf16 v[84:87], v[200:203], a[92:95], v[84:87]
s_waitcnt lgkmcnt(4)
v_mfma_f32_16x16x32_bf16 v[88:91], v[204:207], a[80:83], v[88:91]
ds_read_b64_tr_b16 v[200:201], v228 offset:57344
v_mfma_f32_16x16x32_bf16 v[92:95], v[204:207], a[84:87], v[92:95]
buffer_store_dwordx4 v[16:19], v2, s[20:23], s67 offen offset:2048 sc1
v_mfma_f32_16x16x32_bf16 v[96:99], v[204:207], a[88:91], v[96:99]
ds_read_b64_tr_b16 v[202:203], v228 offset:57856
v_mfma_f32_16x16x32_bf16 v[100:103], v[204:207], a[92:95], v[100:103]
s_waitcnt lgkmcnt(4)
v_mfma_f32_16x16x32_bf16 v[104:107], v[208:211], a[80:83], v[104:107]
ds_read_b64_tr_b16 v[204:205], v229 offset:57344
v_mfma_f32_16x16x32_bf16 v[108:111], v[208:211], a[84:87], v[108:111]
buffer_load_dwordx4 a[180:183], v245, s[16:19], s57 offen offset:3072 sc1
v_mfma_f32_16x16x32_bf16 v[112:115], v[208:211], a[88:91], v[112:115]
ds_read_b64_tr_b16 v[206:207], v229 offset:57856
v_cvt_pk_bf16_f32 v20, v184, v185
v_mfma_f32_16x16x32_bf16 v[116:119], v[208:211], a[92:95], v[116:119]
s_waitcnt lgkmcnt(4)
v_mfma_f32_16x16x32_bf16 v[120:123], v[212:215], a[80:83], v[120:123]
ds_read_b64_tr_b16 v[208:209], v230 offset:57344
v_mfma_f32_16x16x32_bf16 v[124:127], v[212:215], a[84:87], v[124:127]
buffer_load_dwordx4 a[184:187], v246, s[16:19], s57 offen offset:3072 sc1
v_mfma_f32_16x16x32_bf16 v[128:131], v[212:215], a[88:91], v[128:131]
ds_read_b64_tr_b16 v[210:211], v230 offset:57856
v_mfma_f32_16x16x32_bf16 v[132:135], v[212:215], a[92:95], v[132:135]
s_waitcnt lgkmcnt(4)
v_cvt_pk_bf16_f32 v21, v186, v187
v_mfma_f32_16x16x32_bf16 v[72:75], v[200:203], a[96:99], v[72:75]
ds_read_b64_tr_b16 v[212:213], v231 offset:57344
v_mfma_f32_16x16x32_bf16 v[76:79], v[200:203], a[100:103], v[76:79]
buffer_load_dwordx4 v239, s[4:7], s65 offen offset:3072 lds
v_mfma_f32_16x16x32_bf16 v[80:83], v[200:203], a[104:107], v[80:83]
ds_read_b64_tr_b16 v[214:215], v231 offset:57856
v_mfma_f32_16x16x32_bf16 v[84:87], v[200:203], a[108:111], v[84:87]
s_waitcnt lgkmcnt(4)
v_mfma_f32_16x16x32_bf16 v[88:91], v[204:207], a[96:99], v[88:91]
ds_read_b64_tr_b16 v[200:201], v228 offset:61440
v_mfma_f32_16x16x32_bf16 v[92:95], v[204:207], a[100:103], v[92:95]
v_cvt_pk_bf16_f32 v22, v188, v189
buffer_load_dwordx4 a[188:191], v247, s[16:19], s57 offen offset:3072 sc1
v_mfma_f32_16x16x32_bf16 v[96:99], v[204:207], a[104:107], v[96:99]
ds_read_b64_tr_b16 v[202:203], v228 offset:61952
v_mfma_f32_16x16x32_bf16 v[100:103], v[204:207], a[108:111], v[100:103]
s_waitcnt lgkmcnt(4)
v_mfma_f32_16x16x32_bf16 v[104:107], v[208:211], a[96:99], v[104:107]
ds_read_b64_tr_b16 v[204:205], v229 offset:61440
v_mfma_f32_16x16x32_bf16 v[108:111], v[208:211], a[100:103], v[108:111]
buffer_load_dwordx4 a[192:195], v244, s[16:19], s58 offen offset:0 sc1
v_mfma_f32_16x16x32_bf16 v[112:115], v[208:211], a[104:107], v[112:115]
ds_read_b64_tr_b16 v[206:207], v229 offset:61952
v_mfma_f32_16x16x32_bf16 v[116:119], v[208:211], a[108:111], v[116:119]
s_waitcnt lgkmcnt(4)
v_cvt_pk_bf16_f32 v23, v190, v191
v_mfma_f32_16x16x32_bf16 v[120:123], v[212:215], a[96:99], v[120:123]
ds_read_b64_tr_b16 v[208:209], v230 offset:61440
v_mfma_f32_16x16x32_bf16 v[124:127], v[212:215], a[100:103], v[124:127]
buffer_store_dwordx4 v[20:23], v2, s[20:23], s67 offen offset:3072 sc1
v_mfma_f32_16x16x32_bf16 v[128:131], v[212:215], a[104:107], v[128:131]
ds_read_b64_tr_b16 v[210:211], v230 offset:61952
v_mfma_f32_16x16x32_bf16 v[132:135], v[212:215], a[108:111], v[132:135]
s_waitcnt lgkmcnt(4)
s_waitcnt vmcnt(32)
v_mfma_f32_16x16x32_bf16 v[72:75], v[200:203], a[112:115], v[72:75]
ds_read_b64_tr_b16 v[212:213], v231 offset:61440
s_waitcnt vmcnt(31)
v_mfma_f32_16x16x32_bf16 v[76:79], v[200:203], a[116:119], v[76:79]
s_waitcnt vmcnt(18)
s_barrier
v_mfma_f32_16x16x32_bf16 v[80:83], v[200:203], a[120:123], v[80:83]
ds_read_b64_tr_b16 v[214:215], v231 offset:61952
s_add_u32 m0, s82, 32768
v_mfma_f32_16x16x32_bf16 v[84:87], v[200:203], a[124:127], v[84:87]
s_waitcnt lgkmcnt(4)
s_add_u32 s65, s52, 0
v_mfma_f32_16x16x32_bf16 v[88:91], v[204:207], a[112:115], v[88:91]
ds_read_b64_tr_b16 v[200:201], v228 offset:0
v_mfma_f32_16x16x32_bf16 v[92:95], v[204:207], a[116:119], v[92:95]
buffer_load_dwordx4 v240, s[8:11], s65 offen offset:0 lds
v_mfma_f32_16x16x32_bf16 v[96:99], v[204:207], a[120:123], v[96:99]
ds_read_b64_tr_b16 v[202:203], v228 offset:512
s_add_u32 s67, s50, 1077248
v_mfma_f32_16x16x32_bf16 v[100:103], v[204:207], a[124:127], v[100:103]
s_waitcnt lgkmcnt(4)
v_mfma_f32_16x16x32_bf16 v[104:107], v[208:211], a[112:115], v[104:107]
ds_read_b64_tr_b16 v[204:205], v229 offset:0
v_mfma_f32_16x16x32_bf16 v[108:111], v[208:211], a[116:119], v[108:111]
buffer_load_dwordx4 a[196:199], v245, s[16:19], s58 offen offset:0 sc1
v_mfma_f32_16x16x32_bf16 v[112:115], v[208:211], a[120:123], v[112:115]
ds_read_b64_tr_b16 v[206:207], v229 offset:512
v_cvt_pk_bf16_f32 v8, v144, v145
v_mfma_f32_16x16x32_bf16 v[116:119], v[208:211], a[124:127], v[116:119]
s_waitcnt lgkmcnt(4)
v_mfma_f32_16x16x32_bf16 v[120:123], v[212:215], a[112:115], v[120:123]
ds_read_b64_tr_b16 v[208:209], v230 offset:0
v_mfma_f32_16x16x32_bf16 v[124:127], v[212:215], a[116:119], v[124:127]
buffer_load_dwordx4 a[200:203], v246, s[16:19], s58 offen offset:0 sc1
v_mfma_f32_16x16x32_bf16 v[128:131], v[212:215], a[120:123], v[128:131]
ds_read_b64_tr_b16 v[210:211], v230 offset:512
v_mfma_f32_16x16x32_bf16 v[132:135], v[212:215], a[124:127], v[132:135]
s_waitcnt lgkmcnt(4)
v_cvt_pk_bf16_f32 v9, v146, v147
v_mfma_f32_16x16x32_bf16 v[72:75], v[200:203], a[128:131], v[72:75]
ds_read_b64_tr_b16 v[212:213], v231 offset:0
v_mfma_f32_16x16x32_bf16 v[76:79], v[200:203], a[132:135], v[76:79]
buffer_load_dwordx4 v241, s[8:11], s65 offen offset:1024 lds
s_add_u32 m0, s82, 40960
v_mfma_f32_16x16x32_bf16 v[80:83], v[200:203], a[136:139], v[80:83]
ds_read_b64_tr_b16 v[214:215], v231 offset:512
v_mfma_f32_16x16x32_bf16 v[84:87], v[200:203], a[140:143], v[84:87]
s_waitcnt lgkmcnt(4)
v_cvt_pk_bf16_f32 v10, v148, v149
v_mfma_f32_16x16x32_bf16 v[88:91], v[204:207], a[128:131], v[88:91]
ds_read_b64_tr_b16 v[200:201], v228 offset:4096
v_mfma_f32_16x16x32_bf16 v[92:95], v[204:207], a[132:135], v[92:95]
buffer_load_dwordx4 a[204:207], v247, s[16:19], s58 offen offset:0 sc1
v_mfma_f32_16x16x32_bf16 v[96:99], v[204:207], a[136:139], v[96:99]
ds_read_b64_tr_b16 v[202:203], v228 offset:4608
v_mfma_f32_16x16x32_bf16 v[100:103], v[204:207], a[140:143], v[100:103]
s_waitcnt lgkmcnt(4)
v_mfma_f32_16x16x32_bf16 v[104:107], v[208:211], a[128:131], v[104:107]
ds_read_b64_tr_b16 v[204:205], v229 offset:4096
v_cvt_pk_bf16_f32 v11, v150, v151
v_mfma_f32_16x16x32_bf16 v[108:111], v[208:211], a[132:135], v[108:111]
buffer_store_dwordx4 v[8:11], v2, s[20:23], s67 offen offset:0 sc1
v_mfma_f32_16x16x32_bf16 v[112:115], v[208:211], a[136:139], v[112:115]
ds_read_b64_tr_b16 v[206:207], v229 offset:4608
v_mfma_f32_16x16x32_bf16 v[116:119], v[208:211], a[140:143], v[116:119]
s_waitcnt lgkmcnt(4)
v_mfma_f32_16x16x32_bf16 v[120:123], v[212:215], a[128:131], v[120:123]
ds_read_b64_tr_b16 v[208:209], v230 offset:4096
v_mfma_f32_16x16x32_bf16 v[124:127], v[212:215], a[132:135], v[124:127]
buffer_load_dwordx4 a[208:211], v244, s[16:19], s58 offen offset:1024 sc1
v_mfma_f32_16x16x32_bf16 v[128:131], v[212:215], a[136:139], v[128:131]
ds_read_b64_tr_b16 v[210:211], v230 offset:4608
v_mfma_f32_16x16x32_bf16 v[132:135], v[212:215], a[140:143], v[132:135]
s_waitcnt lgkmcnt(4)
v_mfma_f32_16x16x32_bf16 v[72:75], v[200:203], a[144:147], v[72:75]
ds_read_b64_tr_b16 v[212:213], v231 offset:4096
v_mfma_f32_16x16x32_bf16 v[76:79], v[200:203], a[148:151], v[76:79]
buffer_load_dwordx4 v240, s[12:15], s65 offen offset:0 lds
s_waitcnt vmcnt(25)
v_mfma_f32_16x16x32_bf16 v[80:83], v[200:203], a[152:155], v[80:83]
ds_read_b64_tr_b16 v[214:215], v231 offset:4608
v_cvt_pk_bf16_f32 v12, v160, v161
s_waitcnt vmcnt(24)
v_mfma_f32_16x16x32_bf16 v[84:87], v[200:203], a[156:159], v[84:87]
s_waitcnt lgkmcnt(4)
v_mfma_f32_16x16x32_bf16 v[88:91], v[204:207], a[144:147], v[88:91]
ds_read_b64_tr_b16 v[200:201], v228 offset:8192
v_mfma_f32_16x16x32_bf16 v[92:95], v[204:207], a[148:151], v[92:95]
buffer_load_dwordx4 a[212:215], v245, s[16:19], s58 offen offset:1024 sc1
v_mfma_f32_16x16x32_bf16 v[96:99], v[204:207], a[152:155], v[96:99]
ds_read_b64_tr_b16 v[202:203], v228 offset:8704
v_mfma_f32_16x16x32_bf16 v[100:103], v[204:207], a[156:159], v[100:103]
s_waitcnt lgkmcnt(4)
v_cvt_pk_bf16_f32 v13, v162, v163
v_mfma_f32_16x16x32_bf16 v[104:107], v[208:211], a[144:147], v[104:107]
ds_read_b64_tr_b16 v[204:205], v229 offset:8192
v_mfma_f32_16x16x32_bf16 v[108:111], v[208:211], a[148:151], v[108:111]
buffer_load_dwordx4 a[216:219], v246, s[16:19], s58 offen offset:1024 sc1
v_mfma_f32_16x16x32_bf16 v[112:115], v[208:211], a[152:155], v[112:115]
ds_read_b64_tr_b16 v[206:207], v229 offset:8704
v_mfma_f32_16x16x32_bf16 v[116:119], v[208:211], a[156:159], v[116:119]
s_waitcnt lgkmcnt(4)
v_mfma_f32_16x16x32_bf16 v[120:123], v[212:215], a[144:147], v[120:123]
ds_read_b64_tr_b16 v[208:209], v230 offset:8192
v_mfma_f32_16x16x32_bf16 v[124:127], v[212:215], a[148:151], v[124:127]
v_cvt_pk_bf16_f32 v14, v164, v165
buffer_load_dwordx4 a[220:223], v247, s[16:19], s58 offen offset:1024 sc1
v_mfma_f32_16x16x32_bf16 v[128:131], v[212:215], a[152:155], v[128:131]
ds_read_b64_tr_b16 v[210:211], v230 offset:8704
v_mfma_f32_16x16x32_bf16 v[132:135], v[212:215], a[156:159], v[132:135]
s_waitcnt lgkmcnt(4)
s_waitcnt vmcnt(26)
v_mfma_f32_16x16x32_bf16 v[72:75], v[200:203], a[160:163], v[72:75]
ds_read_b64_tr_b16 v[212:213], v231 offset:8192
s_waitcnt vmcnt(23)
v_mfma_f32_16x16x32_bf16 v[76:79], v[200:203], a[164:167], v[76:79]
buffer_load_dwordx4 v241, s[12:15], s65 offen offset:1024 lds
s_waitcnt vmcnt(22)
v_mfma_f32_16x16x32_bf16 v[80:83], v[200:203], a[168:171], v[80:83]
ds_read_b64_tr_b16 v[214:215], v231 offset:8704
s_waitcnt vmcnt(21)
v_mfma_f32_16x16x32_bf16 v[84:87], v[200:203], a[172:175], v[84:87]
s_waitcnt lgkmcnt(4)
v_cvt_pk_bf16_f32 v15, v166, v167
v_mfma_f32_16x16x32_bf16 v[88:91], v[204:207], a[160:163], v[88:91]
ds_read_b64_tr_b16 v[200:201], v228 offset:12288
v_mfma_f32_16x16x32_bf16 v[92:95], v[204:207], a[164:167], v[92:95]
buffer_store_dwordx4 v[12:15], v2, s[20:23], s67 offen offset:1024 sc1
v_mfma_f32_16x16x32_bf16 v[96:99], v[204:207], a[168:171], v[96:99]
ds_read_b64_tr_b16 v[202:203], v228 offset:12800
v_mfma_f32_16x16x32_bf16 v[100:103], v[204:207], a[172:175], v[100:103]
s_waitcnt lgkmcnt(4)
v_mfma_f32_16x16x32_bf16 v[104:107], v[208:211], a[160:163], v[104:107]
ds_read_b64_tr_b16 v[204:205], v229 offset:12288
v_mfma_f32_16x16x32_bf16 v[108:111], v[208:211], a[164:167], v[108:111]
buffer_load_dwordx4 a[224:227], v244, s[16:19], s58 offen offset:2048 sc1
v_mfma_f32_16x16x32_bf16 v[112:115], v[208:211], a[168:171], v[112:115]
ds_read_b64_tr_b16 v[206:207], v229 offset:12800
v_mfma_f32_16x16x32_bf16 v[116:119], v[208:211], a[172:175], v[116:119]
s_waitcnt lgkmcnt(4)
v_mfma_f32_16x16x32_bf16 v[120:123], v[212:215], a[160:163], v[120:123]
ds_read_b64_tr_b16 v[208:209], v230 offset:12288
v_mfma_f32_16x16x32_bf16 v[124:127], v[212:215], a[164:167], v[124:127]
buffer_load_dwordx4 a[228:231], v245, s[16:19], s58 offen offset:2048 sc1
v_mfma_f32_16x16x32_bf16 v[128:131], v[212:215], a[168:171], v[128:131]
ds_read_b64_tr_b16 v[210:211], v230 offset:12800
v_cvt_pk_bf16_f32 v16, v176, v177
v_mfma_f32_16x16x32_bf16 v[132:135], v[212:215], a[172:175], v[132:135]
s_waitcnt lgkmcnt(4)
s_waitcnt vmcnt(23)
v_mfma_f32_16x16x32_bf16 v[72:75], v[200:203], a[176:179], v[72:75]
ds_read_b64_tr_b16 v[212:213], v231 offset:12288
s_waitcnt vmcnt(20)
v_mfma_f32_16x16x32_bf16 v[76:79], v[200:203], a[180:183], v[76:79]
s_waitcnt vmcnt(18)
s_barrier
v_mfma_f32_16x16x32_bf16 v[80:83], v[200:203], a[184:187], v[80:83]
ds_read_b64_tr_b16 v[214:215], v231 offset:12800
s_add_u32 m0, s82, 49152
s_waitcnt vmcnt(17)
v_mfma_f32_16x16x32_bf16 v[84:87], v[200:203], a[188:191], v[84:87]
s_waitcnt lgkmcnt(4)
s_add_u32 s65, s52, 352256
v_mfma_f32_16x16x32_bf16 v[88:91], v[204:207], a[176:179], v[88:91]
ds_read_b64_tr_b16 v[200:201], v228 offset:16384
v_cvt_pk_bf16_f32 v17, v178, v179
v_mfma_f32_16x16x32_bf16 v[92:95], v[204:207], a[180:183], v[92:95]
buffer_load_dwordx4 v240, s[8:11], s65 offen offset:0 lds
v_mfma_f32_16x16x32_bf16 v[96:99], v[204:207], a[184:187], v[96:99]
ds_read_b64_tr_b16 v[202:203], v228 offset:16896
v_mfma_f32_16x16x32_bf16 v[100:103], v[204:207], a[188:191], v[100:103]
s_waitcnt lgkmcnt(4)
v_mfma_f32_16x16x32_bf16 v[104:107], v[208:211], a[176:179], v[104:107]
ds_read_b64_tr_b16 v[204:205], v229 offset:16384
v_mfma_f32_16x16x32_bf16 v[108:111], v[208:211], a[180:183], v[108:111]
v_cvt_pk_bf16_f32 v18, v180, v181
buffer_load_dwordx4 a[232:235], v246, s[16:19], s58 offen offset:2048 sc1
v_mfma_f32_16x16x32_bf16 v[112:115], v[208:211], a[184:187], v[112:115]
ds_read_b64_tr_b16 v[206:207], v229 offset:16896
v_mfma_f32_16x16x32_bf16 v[116:119], v[208:211], a[188:191], v[116:119]
s_waitcnt lgkmcnt(4)
v_mfma_f32_16x16x32_bf16 v[120:123], v[212:215], a[176:179], v[120:123]
ds_read_b64_tr_b16 v[208:209], v230 offset:16384
v_mfma_f32_16x16x32_bf16 v[124:127], v[212:215], a[180:183], v[124:127]
buffer_load_dwordx4 a[236:239], v247, s[16:19], s58 offen offset:2048 sc1
v_mfma_f32_16x16x32_bf16 v[128:131], v[212:215], a[184:187], v[128:131]
ds_read_b64_tr_b16 v[210:211], v230 offset:16896
v_mfma_f32_16x16x32_bf16 v[132:135], v[212:215], a[188:191], v[132:135]
s_waitcnt lgkmcnt(4)
v_cvt_pk_bf16_f32 v19, v182, v183
s_waitcnt vmcnt(19)
v_mfma_f32_16x16x32_bf16 v[72:75], v[200:203], a[192:195], v[72:75]
ds_read_b64_tr_b16 v[212:213], v231 offset:16384
s_waitcnt vmcnt(16)
v_mfma_f32_16x16x32_bf16 v[76:79], v[200:203], a[196:199], v[76:79]
buffer_load_dwordx4 v241, s[8:11], s65 offen offset:1024 lds
s_add_u32 m0, s82, 57344
s_waitcnt vmcnt(16)
v_mfma_f32_16x16x32_bf16 v[80:83], v[200:203], a[200:203], v[80:83]
ds_read_b64_tr_b16 v[214:215], v231 offset:16896
s_waitcnt vmcnt(14)
v_mfma_f32_16x16x32_bf16 v[84:87], v[200:203], a[204:207], v[84:87]
s_waitcnt lgkmcnt(4)
v_mfma_f32_16x16x32_bf16 v[88:91], v[204:207], a[192:195], v[88:91]
ds_read_b64_tr_b16 v[200:201], v228 offset:20480
v_mfma_f32_16x16x32_bf16 v[92:95], v[204:207], a[196:199], v[92:95]
buffer_store_dwordx4 v[16:19], v2, s[20:23], s67 offen offset:2048 sc1
v_mfma_f32_16x16x32_bf16 v[96:99], v[204:207], a[200:203], v[96:99]
ds_read_b64_tr_b16 v[202:203], v228 offset:20992
v_mfma_f32_16x16x32_bf16 v[100:103], v[204:207], a[204:207], v[100:103]
s_waitcnt lgkmcnt(4)
v_mfma_f32_16x16x32_bf16 v[104:107], v[208:211], a[192:195], v[104:107]
ds_read_b64_tr_b16 v[204:205], v229 offset:20480
v_mfma_f32_16x16x32_bf16 v[108:111], v[208:211], a[196:199], v[108:111]
buffer_load_dwordx4 a[240:243], v244, s[16:19], s58 offen offset:3072 sc1
v_mfma_f32_16x16x32_bf16 v[112:115], v[208:211], a[200:203], v[112:115]
ds_read_b64_tr_b16 v[206:207], v229 offset:20992
v_cvt_pk_bf16_f32 v20, v192, v193
v_mfma_f32_16x16x32_bf16 v[116:119], v[208:211], a[204:207], v[116:119]
s_waitcnt lgkmcnt(4)
v_mfma_f32_16x16x32_bf16 v[120:123], v[212:215], a[192:195], v[120:123]
ds_read_b64_tr_b16 v[208:209], v230 offset:20480
v_mfma_f32_16x16x32_bf16 v[124:127], v[212:215], a[196:199], v[124:127]
buffer_load_dwordx4 a[244:247], v245, s[16:19], s58 offen offset:3072 sc1
v_mfma_f32_16x16x32_bf16 v[128:131], v[212:215], a[200:203], v[128:131]
ds_read_b64_tr_b16 v[210:211], v230 offset:20992
v_mfma_f32_16x16x32_bf16 v[132:135], v[212:215], a[204:207], v[132:135]
s_waitcnt lgkmcnt(4)
v_cvt_pk_bf16_f32 v21, v194, v195
s_waitcnt vmcnt(15)
v_mfma_f32_16x16x32_bf16 v[72:75], v[200:203], a[208:211], v[72:75]
ds_read_b64_tr_b16 v[212:213], v231 offset:20480
s_waitcnt vmcnt(13)
v_mfma_f32_16x16x32_bf16 v[76:79], v[200:203], a[212:215], v[76:79]
buffer_load_dwordx4 v240, s[12:15], s65 offen offset:0 lds
s_waitcnt vmcnt(13)
v_mfma_f32_16x16x32_bf16 v[80:83], v[200:203], a[216:219], v[80:83]
ds_read_b64_tr_b16 v[214:215], v231 offset:20992
s_waitcnt vmcnt(12)
v_mfma_f32_16x16x32_bf16 v[84:87], v[200:203], a[220:223], v[84:87]
s_waitcnt lgkmcnt(4)
v_mfma_f32_16x16x32_bf16 v[88:91], v[204:207], a[208:211], v[88:91]
ds_read_b64_tr_b16 v[200:201], v228 offset:24576
v_mfma_f32_16x16x32_bf16 v[92:95], v[204:207], a[212:215], v[92:95]
v_cvt_pk_bf16_f32 v22, v196, v197
buffer_load_dwordx4 a[248:251], v246, s[16:19], s58 offen offset:3072 sc1
v_mfma_f32_16x16x32_bf16 v[96:99], v[204:207], a[216:219], v[96:99]
ds_read_b64_tr_b16 v[202:203], v228 offset:25088
v_mfma_f32_16x16x32_bf16 v[100:103], v[204:207], a[220:223], v[100:103]
s_waitcnt lgkmcnt(4)
v_mfma_f32_16x16x32_bf16 v[104:107], v[208:211], a[208:211], v[104:107]
ds_read_b64_tr_b16 v[204:205], v229 offset:24576
v_mfma_f32_16x16x32_bf16 v[108:111], v[208:211], a[212:215], v[108:111]
buffer_load_dwordx4 a[252:255], v247, s[16:19], s58 offen offset:3072 sc1
v_mfma_f32_16x16x32_bf16 v[112:115], v[208:211], a[216:219], v[112:115]
ds_read_b64_tr_b16 v[206:207], v229 offset:25088
v_mfma_f32_16x16x32_bf16 v[116:119], v[208:211], a[220:223], v[116:119]
s_waitcnt lgkmcnt(4)
v_cvt_pk_bf16_f32 v23, v198, v199
v_mfma_f32_16x16x32_bf16 v[120:123], v[212:215], a[208:211], v[120:123]
ds_read_b64_tr_b16 v[208:209], v230 offset:24576
v_mfma_f32_16x16x32_bf16 v[124:127], v[212:215], a[212:215], v[124:127]
buffer_store_dwordx4 v[20:23], v2, s[20:23], s67 offen offset:3072 sc1
v_mfma_f32_16x16x32_bf16 v[128:131], v[212:215], a[216:219], v[128:131]
ds_read_b64_tr_b16 v[210:211], v230 offset:25088
v_mfma_f32_16x16x32_bf16 v[132:135], v[212:215], a[220:223], v[132:135]
s_waitcnt lgkmcnt(4)
s_waitcnt vmcnt(12)
v_mfma_f32_16x16x32_bf16 v[72:75], v[200:203], a[224:227], v[72:75]
ds_read_b64_tr_b16 v[212:213], v231 offset:24576
s_waitcnt vmcnt(11)
v_mfma_f32_16x16x32_bf16 v[76:79], v[200:203], a[228:231], v[76:79]
buffer_load_dwordx4 v241, s[12:15], s65 offen offset:1024 lds
s_waitcnt vmcnt(10)
v_mfma_f32_16x16x32_bf16 v[80:83], v[200:203], a[232:235], v[80:83]
ds_read_b64_tr_b16 v[214:215], v231 offset:25088
s_waitcnt vmcnt(9)
v_mfma_f32_16x16x32_bf16 v[84:87], v[200:203], a[236:239], v[84:87]
s_waitcnt lgkmcnt(4)
v_mfma_f32_16x16x32_bf16 v[88:91], v[204:207], a[224:227], v[88:91]
ds_read_b64_tr_b16 v[200:201], v228 offset:28672
v_mfma_f32_16x16x32_bf16 v[92:95], v[204:207], a[228:231], v[92:95]
v_mfma_f32_16x16x32_bf16 v[96:99], v[204:207], a[232:235], v[96:99]
ds_read_b64_tr_b16 v[202:203], v228 offset:29184
v_mfma_f32_16x16x32_bf16 v[100:103], v[204:207], a[236:239], v[100:103]
s_waitcnt lgkmcnt(4)
v_mfma_f32_16x16x32_bf16 v[104:107], v[208:211], a[224:227], v[104:107]
ds_read_b64_tr_b16 v[204:205], v229 offset:28672
v_mfma_f32_16x16x32_bf16 v[108:111], v[208:211], a[228:231], v[108:111]
v_mfma_f32_16x16x32_bf16 v[112:115], v[208:211], a[232:235], v[112:115]
ds_read_b64_tr_b16 v[206:207], v229 offset:29184
v_mfma_f32_16x16x32_bf16 v[116:119], v[208:211], a[236:239], v[116:119]
s_waitcnt lgkmcnt(4)
v_mfma_f32_16x16x32_bf16 v[120:123], v[212:215], a[224:227], v[120:123]
ds_read_b64_tr_b16 v[208:209], v230 offset:28672
v_mfma_f32_16x16x32_bf16 v[124:127], v[212:215], a[228:231], v[124:127]
v_mfma_f32_16x16x32_bf16 v[128:131], v[212:215], a[232:235], v[128:131]
ds_read_b64_tr_b16 v[210:211], v230 offset:29184
v_mfma_f32_16x16x32_bf16 v[132:135], v[212:215], a[236:239], v[132:135]
s_waitcnt lgkmcnt(4)
s_waitcnt vmcnt(6)
v_mfma_f32_16x16x32_bf16 v[72:75], v[200:203], a[240:243], v[72:75]
ds_read_b64_tr_b16 v[212:213], v231 offset:28672
s_waitcnt vmcnt(5)
v_mfma_f32_16x16x32_bf16 v[76:79], v[200:203], a[244:247], v[76:79]
s_barrier
s_waitcnt vmcnt(3)
v_mfma_f32_16x16x32_bf16 v[80:83], v[200:203], a[248:251], v[80:83]
ds_read_b64_tr_b16 v[214:215], v231 offset:29184
s_waitcnt vmcnt(2)
v_mfma_f32_16x16x32_bf16 v[84:87], v[200:203], a[252:255], v[84:87]
s_waitcnt lgkmcnt(4)
v_mfma_f32_16x16x32_bf16 v[88:91], v[204:207], a[240:243], v[88:91]
ds_read_b64_tr_b16 v[200:201], v232 offset:32768
v_mfma_f32_16x16x32_bf16 v[92:95], v[204:207], a[244:247], v[92:95]
s_add_u32 m0, s82, 0
s_add_u32 s65, s52, 704512
v_mfma_f32_16x16x32_bf16 v[96:99], v[204:207], a[248:251], v[96:99]
ds_read_b64_tr_b16 v[202:203], v232 offset:33024
buffer_load_dwordx4 v240, s[8:11], s65 offen offset:0 lds
v_mfma_f32_16x16x32_bf16 v[100:103], v[204:207], a[252:255], v[100:103]
s_waitcnt lgkmcnt(4)
buffer_load_dwordx4 v241, s[8:11], s65 offen offset:1024 lds
v_mfma_f32_16x16x32_bf16 v[104:107], v[208:211], a[240:243], v[104:107]
ds_read_b64_tr_b16 v[204:205], v233 offset:32768
s_add_u32 m0, s82, 8192
v_mfma_f32_16x16x32_bf16 v[108:111], v[208:211], a[244:247], v[108:111]
buffer_load_dwordx4 v240, s[12:15], s65 offen offset:0 lds
buffer_load_dwordx4 v241, s[12:15], s65 offen offset:1024 lds
v_mfma_f32_16x16x32_bf16 v[112:115], v[208:211], a[248:251], v[112:115]
ds_read_b64_tr_b16 v[206:207], v233 offset:33024
v_mfma_f32_16x16x32_bf16 v[116:119], v[208:211], a[252:255], v[116:119]
s_waitcnt lgkmcnt(4)
v_mfma_f32_16x16x32_bf16 v[120:123], v[212:215], a[240:243], v[120:123]
ds_read_b64_tr_b16 v[208:209], v232 offset:40960
v_mfma_f32_16x16x32_bf16 v[124:127], v[212:215], a[244:247], v[124:127]
v_mfma_f32_16x16x32_bf16 v[128:131], v[212:215], a[248:251], v[128:131]
ds_read_b64_tr_b16 v[210:211], v232 offset:41216
v_mfma_f32_16x16x32_bf16 v[132:135], v[212:215], a[252:255], v[132:135]
s_waitcnt lgkmcnt(4)
KF_common:
v_mfma_f32_16x16x32_bf16 v[40:43], v[200:203], a[0:3], 0
ds_read_b64_tr_b16 v[212:213], v233 offset:40960
v_mfma_f32_16x16x32_bf16 v[44:47], v[200:203], a[4:7], 0
v_mfma_f32_16x16x32_bf16 v[48:51], v[200:203], a[8:11], 0
ds_read_b64_tr_b16 v[214:215], v233 offset:41216
v_mfma_f32_16x16x32_bf16 v[52:55], v[200:203], a[12:15], 0
s_waitcnt lgkmcnt(4)
v_mfma_f32_16x16x32_bf16 v[168:171], v[204:207], a[0:3], 0
ds_read_b64_tr_b16 v[200:201], v232 offset:34816
v_mfma_f32_16x16x32_bf16 v[172:175], v[204:207], a[4:7], 0
v_mfma_f32_16x16x32_bf16 v[176:179], v[204:207], a[8:11], 0
ds_read_b64_tr_b16 v[202:203], v232 offset:35072
v_mfma_f32_16x16x32_bf16 v[180:183], v[204:207], a[12:15], 0
s_waitcnt lgkmcnt(4)
v_mfma_f32_16x16x32_bf16 v[56:59], v[208:211], a[0:3], 0
ds_read_b64_tr_b16 v[204:205], v233 offset:34816
v_cvt_pk_bf16_f32 v8, v72, v73
v_mfma_f32_16x16x32_bf16 v[60:63], v[208:211], a[4:7], 0
v_mfma_f32_16x16x32_bf16 v[64:67], v[208:211], a[8:11], 0
ds_read_b64_tr_b16 v[206:207], v233 offset:35072
v_mfma_f32_16x16x32_bf16 v[68:71], v[208:211], a[12:15], 0
s_waitcnt lgkmcnt(4)
v_cvt_pk_bf16_f32 v9, v74, v75
v_mfma_f32_16x16x32_bf16 v[184:187], v[212:215], a[0:3], 0
ds_read_b64_tr_b16 v[208:209], v232 offset:43008
v_mfma_f32_16x16x32_bf16 v[188:191], v[212:215], a[4:7], 0
v_mfma_f32_16x16x32_bf16 v[192:195], v[212:215], a[8:11], 0
ds_read_b64_tr_b16 v[210:211], v232 offset:43264
v_mfma_f32_16x16x32_bf16 v[196:199], v[212:215], a[12:15], 0
s_waitcnt lgkmcnt(4)
v_cvt_pk_bf16_f32 v10, v88, v89
v_mfma_f32_16x16x32_bf16 v[40:43], v[200:203], a[16:19], v[40:43]
ds_read_b64_tr_b16 v[212:213], v233 offset:43008
v_mfma_f32_16x16x32_bf16 v[44:47], v[200:203], a[20:23], v[44:47]
v_mfma_f32_16x16x32_bf16 v[48:51], v[200:203], a[24:27], v[48:51]
ds_read_b64_tr_b16 v[214:215], v233 offset:43264
v_cvt_pk_bf16_f32 v11, v90, v91
v_mfma_f32_16x16x32_bf16 v[52:55], v[200:203], a[28:31], v[52:55]
s_waitcnt lgkmcnt(4)
v_mfma_f32_16x16x32_bf16 v[168:171], v[204:207], a[16:19], v[168:171]
ds_read_b64_tr_b16 v[200:201], v232 offset:36864
v_mfma_f32_16x16x32_bf16 v[172:175], v[204:207], a[20:23], v[172:175]
v_mfma_f32_16x16x32_bf16 v[176:179], v[204:207], a[24:27], v[176:179]
ds_read_b64_tr_b16 v[202:203], v232 offset:37120
v_cvt_pk_bf16_f32 v24, v104, v105
v_mfma_f32_16x16x32_bf16 v[180:183], v[204:207], a[28:31], v[180:183]
s_waitcnt lgkmcnt(4)
v_mfma_f32_16x16x32_bf16 v[56:59], v[208:211], a[16:19], v[56:59]
ds_read_b64_tr_b16 v[204:205], v233 offset:36864
v_mfma_f32_16x16x32_bf16 v[60:63], v[208:211], a[20:23], v[60:63]
v_cvt_pk_bf16_f32 v25, v106, v107
v_mfma_f32_16x16x32_bf16 v[64:67], v[208:211], a[24:27], v[64:67]
ds_read_b64_tr_b16 v[206:207], v233 offset:37120
v_mfma_f32_16x16x32_bf16 v[68:71], v[208:211], a[28:31], v[68:71]
s_waitcnt lgkmcnt(4)
v_mfma_f32_16x16x32_bf16 v[184:187], v[212:215], a[16:19], v[184:187]
ds_read_b64_tr_b16 v[208:209], v232 offset:45056
v_mfma_f32_16x16x32_bf16 v[188:191], v[212:215], a[20:23], v[188:191]
v_cvt_pk_bf16_f32 v26, v120, v121
v_mfma_f32_16x16x32_bf16 v[192:195], v[212:215], a[24:27], v[192:195]
ds_read_b64_tr_b16 v[210:211], v232 offset:45312
v_mfma_f32_16x16x32_bf16 v[196:199], v[212:215], a[28:31], v[196:199]
s_waitcnt lgkmcnt(4)
v_mfma_f32_16x16x32_bf16 v[40:43], v[200:203], a[32:35], v[40:43]
ds_read_b64_tr_b16 v[212:213], v233 offset:45056
v_cvt_pk_bf16_f32 v27, v122, v123
v_mfma_f32_16x16x32_bf16 v[44:47], v[200:203], a[36:39], v[44:47]
v_mfma_f32_16x16x32_bf16 v[48:51], v[200:203], a[40:43], v[48:51]
ds_read_b64_tr_b16 v[214:215], v233 offset:45312
v_mfma_f32_16x16x32_bf16 v[52:55], v[200:203], a[44:47], v[52:55]
s_waitcnt lgkmcnt(4)
v_mfma_f32_16x16x32_bf16 v[168:171], v[204:207], a[32:35], v[168:171]
ds_read_b64_tr_b16 v[200:201], v232 offset:38912
v_cvt_pk_bf16_f32 v12, v76, v77
v_mfma_f32_16x16x32_bf16 v[172:175], v[204:207], a[36:39], v[172:175]
v_mfma_f32_16x16x32_bf16 v[176:179], v[204:207], a[40:43], v[176:179]
ds_read_b64_tr_b16 v[202:203], v232 offset:39168
v_mfma_f32_16x16x32_bf16 v[180:183], v[204:207], a[44:47], v[180:183]
s_waitcnt lgkmcnt(4)
v_cvt_pk_bf16_f32 v13, v78, v79
v_mfma_f32_16x16x32_bf16 v[56:59], v[208:211], a[32:35], v[56:59]
ds_read_b64_tr_b16 v[204:205], v233 offset:38912
v_mfma_f32_16x16x32_bf16 v[60:63], v[208:211], a[36:39], v[60:63]
v_mfma_f32_16x16x32_bf16 v[64:67], v[208:211], a[40:43], v[64:67]
ds_read_b64_tr_b16 v[206:207], v233 offset:39168
v_mfma_f32_16x16x32_bf16 v[68:71], v[208:211], a[44:47], v[68:71]
s_waitcnt lgkmcnt(4)
v_cvt_pk_bf16_f32 v14, v92, v93
v_mfma_f32_16x16x32_bf16 v[184:187], v[212:215], a[32:35], v[184:187]
ds_read_b64_tr_b16 v[208:209], v232 offset:47104
v_mfma_f32_16x16x32_bf16 v[188:191], v[212:215], a[36:39], v[188:191]
v_mfma_f32_16x16x32_bf16 v[192:195], v[212:215], a[40:43], v[192:195]
ds_read_b64_tr_b16 v[210:211], v232 offset:47360
v_cvt_pk_bf16_f32 v15, v94, v95
v_mfma_f32_16x16x32_bf16 v[196:199], v[212:215], a[44:47], v[196:199]
s_waitcnt lgkmcnt(4)
v_mfma_f32_16x16x32_bf16 v[40:43], v[200:203], a[48:51], v[40:43]
ds_read_b64_tr_b16 v[212:213], v233 offset:47104
v_mfma_f32_16x16x32_bf16 v[44:47], v[200:203], a[52:55], v[44:47]
s_waitcnt vmcnt(4)
s_barrier
v_mfma_f32_16x16x32_bf16 v[48:51], v[200:203], a[56:59], v[48:51]
ds_read_b64_tr_b16 v[214:215], v233 offset:47360
s_add_u32 m0, s82, 16384
v_mfma_f32_16x16x32_bf16 v[52:55], v[200:203], a[60:63], v[52:55]
s_waitcnt lgkmcnt(4)
s_add_u32 s65, s52, 1056768
v_mfma_f32_16x16x32_bf16 v[168:171], v[204:207], a[48:51], v[168:171]
ds_read_b64_tr_b16 v[200:201], v232 offset:49152
s_add_u32 s69, s47, 135168
v_mfma_f32_16x16x32_bf16 v[172:175], v[204:207], a[52:55], v[172:175]
buffer_load_dwordx4 v240, s[8:11], s65 offen offset:0 lds
s_lshr_b32 s69, s69, 2
v_mfma_f32_16x16x32_bf16 v[176:179], v[204:207], a[56:59], v[176:179]
ds_read_b64_tr_b16 v[202:203], v232 offset:49408
buffer_atomic_add v6, v3, s[32:35], s69 offen sc1
v_mfma_f32_16x16x32_bf16 v[180:183], v[204:207], a[60:63], v[180:183]
s_waitcnt lgkmcnt(4)
v_cvt_pk_bf16_f32 v28, v108, v109
v_mfma_f32_16x16x32_bf16 v[56:59], v[208:211], a[48:51], v[56:59]
ds_read_b64_tr_b16 v[204:205], v233 offset:49152
v_cvt_pk_bf16_f32 v29, v110, v111
v_mfma_f32_16x16x32_bf16 v[60:63], v[208:211], a[52:55], v[60:63]
v_cvt_pk_bf16_f32 v30, v124, v125
v_mfma_f32_16x16x32_bf16 v[64:67], v[208:211], a[56:59], v[64:67]
ds_read_b64_tr_b16 v[206:207], v233 offset:49408
v_mfma_f32_16x16x32_bf16 v[68:71], v[208:211], a[60:63], v[68:71]
s_waitcnt lgkmcnt(4)
v_mfma_f32_16x16x32_bf16 v[184:187], v[212:215], a[48:51], v[184:187]
ds_read_b64_tr_b16 v[208:209], v232 offset:57344
v_cvt_pk_bf16_f32 v31, v126, v127
v_mfma_f32_16x16x32_bf16 v[188:191], v[212:215], a[52:55], v[188:191]
v_mfma_f32_16x16x32_bf16 v[192:195], v[212:215], a[56:59], v[192:195]
ds_read_b64_tr_b16 v[210:211], v232 offset:57600
v_mfma_f32_16x16x32_bf16 v[196:199], v[212:215], a[60:63], v[196:199]
s_waitcnt lgkmcnt(4)
v_mfma_f32_16x16x32_bf16 v[40:43], v[200:203], a[64:67], v[40:43]
ds_read_b64_tr_b16 v[212:213], v233 offset:57344
v_cvt_pk_bf16_f32 v16, v80, v81
v_mfma_f32_16x16x32_bf16 v[44:47], v[200:203], a[68:71], v[44:47]
buffer_load_dwordx4 v241, s[8:11], s65 offen offset:1024 lds
s_add_u32 m0, s82, 24576
v_mfma_f32_16x16x32_bf16 v[48:51], v[200:203], a[72:75], v[48:51]
ds_read_b64_tr_b16 v[214:215], v233 offset:57600
v_mfma_f32_16x16x32_bf16 v[52:55], v[200:203], a[76:79], v[52:55]
s_waitcnt lgkmcnt(4)
v_mfma_f32_16x16x32_bf16 v[168:171], v[204:207], a[64:67], v[168:171]
ds_read_b64_tr_b16 v[200:201], v232 offset:51200
v_cvt_pk_bf16_f32 v17, v82, v83
v_mfma_f32_16x16x32_bf16 v[172:175], v[204:207], a[68:71], v[172:175]
v_mfma_f32_16x16x32_bf16 v[176:179], v[204:207], a[72:75], v[176:179]
ds_read_b64_tr_b16 v[202:203], v232 offset:51456
v_mfma_f32_16x16x32_bf16 v[180:183], v[204:207], a[76:79], v[180:183]
s_waitcnt lgkmcnt(4)
v_cvt_pk_bf16_f32 v18, v96, v97
v_mfma_f32_16x16x32_bf16 v[56:59], v[208:211], a[64:67], v[56:59]
ds_read_b64_tr_b16 v[204:205], v233 offset:51200
v_mfma_f32_16x16x32_bf16 v[60:63], v[208:211], a[68:71], v[60:63]
v_mfma_f32_16x16x32_bf16 v[64:67], v[208:211], a[72:75], v[64:67]
ds_read_b64_tr_b16 v[206:207], v233 offset:51456
v_mfma_f32_16x16x32_bf16 v[68:71], v[208:211], a[76:79], v[68:71]
s_waitcnt lgkmcnt(4)
v_cvt_pk_bf16_f32 v19, v98, v99
v_mfma_f32_16x16x32_bf16 v[184:187], v[212:215], a[64:67], v[184:187]
ds_read_b64_tr_b16 v[208:209], v232 offset:59392
v_mfma_f32_16x16x32_bf16 v[188:191], v[212:215], a[68:71], v[188:191]
v_mfma_f32_16x16x32_bf16 v[192:195], v[212:215], a[72:75], v[192:195]
ds_read_b64_tr_b16 v[210:211], v232 offset:59648
v_cvt_pk_bf16_f32 v32, v112, v113
v_mfma_f32_16x16x32_bf16 v[196:199], v[212:215], a[76:79], v[196:199]
s_waitcnt lgkmcnt(4)
v_mfma_f32_16x16x32_bf16 v[40:43], v[200:203], a[80:83], v[40:43]
ds_read_b64_tr_b16 v[212:213], v233 offset:59392
v_mfma_f32_16x16x32_bf16 v[44:47], v[200:203], a[84:87], v[44:47]
buffer_load_dwordx4 v240, s[12:15], s65 offen offset:0 lds
v_mfma_f32_16x16x32_bf16 v[48:51], v[200:203], a[88:91], v[48:51]
ds_read_b64_tr_b16 v[214:215], v233 offset:59648
v_cvt_pk_bf16_f32 v33, v114, v115
v_mfma_f32_16x16x32_bf16 v[52:55], v[200:203], a[92:95], v[52:55]
s_waitcnt lgkmcnt(4)
v_mfma_f32_16x16x32_bf16 v[168:171], v[204:207], a[80:83], v[168:171]
ds_read_b64_tr_b16 v[200:201], v232 offset:53248
v_mfma_f32_16x16x32_bf16 v[172:175], v[204:207], a[84:87], v[172:175]
v_cvt_pk_bf16_f32 v34, v128, v129
v_mfma_f32_16x16x32_bf16 v[176:179], v[204:207], a[88:91], v[176:179]
ds_read_b64_tr_b16 v[202:203], v232 offset:53504
s_lshl_b32 s69, s44, 20
v_mfma_f32_16x16x32_bf16 v[180:183], v[204:207], a[92:95], v[180:183]
s_waitcnt lgkmcnt(4)
s_add_u32 s69, s69, 0x200000
v_mfma_f32_16x16x32_bf16 v[56:59], v[208:211], a[80:83], v[56:59]
ds_read_b64_tr_b16 v[204:205], v233 offset:53248
s_lshl_b32 s68, s43, 16
v_mfma_f32_16x16x32_bf16 v[60:63], v[208:211], a[84:87], v[60:63]
s_sub_u32 s22, 0x100000, s68
v_cvt_pk_bf16_f32 v35, v130, v131
v_mfma_f32_16x16x32_bf16 v[64:67], v[208:211], a[88:91], v[64:67]
ds_read_b64_tr_b16 v[206:207], v233 offset:53504
v_mfma_f32_16x16x32_bf16 v[68:71], v[208:211], a[92:95], v[68:71]
s_waitcnt lgkmcnt(4)
v_mfma_f32_16x16x32_bf16 v[184:187], v[212:215], a[80:83], v[184:187]
ds_read_b64_tr_b16 v[208:209], v232 offset:61440
v_cvt_pk_bf16_f32 v20, v84, v85
v_mfma_f32_16x16x32_bf16 v[188:191], v[212:215], a[84:87], v[188:191]
v_mfma_f32_16x16x32_bf16 v[192:195], v[212:215], a[88:91], v[192:195]
ds_read_b64_tr_b16 v[210:211], v232 offset:61696
v_mfma_f32_16x16x32_bf16 v[196:199], v[212:215], a[92:95], v[196:199]
s_waitcnt lgkmcnt(4)
v_mfma_f32_16x16x32_bf16 v[40:43], v[200:203], a[96:99], v[40:43]
ds_read_b64_tr_b16 v[212:213], v233 offset:61440
v_cvt_pk_bf16_f32 v21, v86, v87
v_mfma_f32_16x16x32_bf16 v[44:47], v[200:203], a[100:103], v[44:47]
buffer_load_dwordx4 v241, s[12:15], s65 offen offset:1024 lds
v_mfma_f32_16x16x32_bf16 v[48:51], v[200:203], a[104:107], v[48:51]
ds_read_b64_tr_b16 v[214:215], v233 offset:61696
v_mfma_f32_16x16x32_bf16 v[52:55], v[200:203], a[108:111], v[52:55]
s_waitcnt lgkmcnt(4)
v_cvt_pk_bf16_f32 v22, v100, v101
v_mfma_f32_16x16x32_bf16 v[168:171], v[204:207], a[96:99], v[168:171]
ds_read_b64_tr_b16 v[200:201], v232 offset:55296
v_mfma_f32_16x16x32_bf16 v[172:175], v[204:207], a[100:103], v[172:175]
v_mfma_f32_16x16x32_bf16 v[176:179], v[204:207], a[104:107], v[176:179]
ds_read_b64_tr_b16 v[202:203], v232 offset:55552
v_mfma_f32_16x16x32_bf16 v[180:183], v[204:207], a[108:111], v[180:183]
s_waitcnt lgkmcnt(4)
v_cvt_pk_bf16_f32 v23, v102, v103
v_mfma_f32_16x16x32_bf16 v[56:59], v[208:211], a[96:99], v[56:59]
ds_read_b64_tr_b16 v[204:205], v233 offset:55296
v_mfma_f32_16x16x32_bf16 v[60:63], v[208:211], a[100:103], v[60:63]
s_add_u32 s20, s80, s69
s_addc_u32 s21, s81, 0
v_mfma_f32_16x16x32_bf16 v[64:67], v[208:211], a[104:107], v[64:67]
ds_read_b64_tr_b16 v[206:207], v233 offset:55552
v_cvt_pk_bf16_f32 v36, v116, v117
v_mfma_f32_16x16x32_bf16 v[68:71], v[208:211], a[108:111], v[68:71]
s_waitcnt lgkmcnt(4)
v_mfma_f32_16x16x32_bf16 v[184:187], v[212:215], a[96:99], v[184:187]
ds_read_b64_tr_b16 v[208:209], v232 offset:63488
v_mfma_f32_16x16x32_bf16 v[188:191], v[212:215], a[100:103], v[188:191]
v_mfma_f32_16x16x32_bf16 v[192:195], v[212:215], a[104:107], v[192:195]
ds_read_b64_tr_b16 v[210:211], v232 offset:63744
v_cvt_pk_bf16_f32 v37, v118, v119
v_mfma_f32_16x16x32_bf16 v[196:199], v[212:215], a[108:111], v[196:199]
s_waitcnt lgkmcnt(4)
v_mfma_f32_16x16x32_bf16 v[40:43], v[200:203], a[112:115], v[40:43]
ds_read_b64_tr_b16 v[212:213], v233 offset:63488
v_mfma_f32_16x16x32_bf16 v[44:47], v[200:203], a[116:119], v[44:47]
s_waitcnt vmcnt(5)
s_barrier
v_mfma_f32_16x16x32_bf16 v[48:51], v[200:203], a[120:123], v[48:51]
ds_read_b64_tr_b16 v[214:215], v233 offset:63744
s_add_u32 m0, s82, 32768
v_mfma_f32_16x16x32_bf16 v[52:55], v[200:203], a[124:127], v[52:55]
s_waitcnt lgkmcnt(4)
s_add_u32 s65, s53, 0
v_mfma_f32_16x16x32_bf16 v[168:171], v[204:207], a[112:115], v[168:171]
ds_read_b64_tr_b16 v[200:201], v232 offset:0
v_cvt_pk_bf16_f32 v38, v132, v133
v_mfma_f32_16x16x32_bf16 v[172:175], v[204:207], a[116:119], v[172:175]
buffer_load_dwordx4 v242, s[8:11], s65 offen offset:0 lds
v_cvt_pk_bf16_f32 v39, v134, v135
v_mfma_f32_16x16x32_bf16 v[176:179], v[204:207], a[120:123], v[176:179]
ds_read_b64_tr_b16 v[202:203], v232 offset:256
v_mfma_f32_16x16x32_bf16 v[180:183], v[204:207], a[124:127], v[180:183]
s_waitcnt lgkmcnt(4)
v_mfma_f32_16x16x32_bf16 v[56:59], v[208:211], a[112:115], v[56:59]
ds_read_b64_tr_b16 v[204:205], v233 offset:0
v_mfma_f32_16x16x32_bf16 v[60:63], v[208:211], a[116:119], v[60:63]
v_mfma_f32_16x16x32_bf16 v[64:67], v[208:211], a[120:123], v[64:67]
ds_read_b64_tr_b16 v[206:207], v233 offset:256
v_mfma_f32_16x16x32_bf16 v[68:71], v[208:211], a[124:127], v[68:71]
s_waitcnt lgkmcnt(4)
v_mfma_f32_16x16x32_bf16 v[184:187], v[212:215], a[112:115], v[184:187]
ds_read_b64_tr_b16 v[208:209], v232 offset:8192
v_mfma_f32_16x16x32_bf16 v[188:191], v[212:215], a[116:119], v[188:191]
v_mfma_f32_16x16x32_bf16 v[192:195], v[212:215], a[120:123], v[192:195]
ds_read_b64_tr_b16 v[210:211], v232 offset:8448
v_mfma_f32_16x16x32_bf16 v[196:199], v[212:215], a[124:127], v[196:199]
s_waitcnt lgkmcnt(4)
v_mfma_f32_16x16x32_bf16 v[40:43], v[200:203], a[128:131], v[40:43]
ds_read_b64_tr_b16 v[212:213], v233 offset:8192
v_mfma_f32_16x16x32_bf16 v[44:47], v[200:203], a[132:135], v[44:47]
buffer_load_dwordx4 v243, s[8:11], s65 offen offset:1024 lds
s_add_u32 m0, s82, 40960
v_mfma_f32_16x16x32_bf16 v[48:51], v[200:203], a[136:139], v[48:51]
ds_read_b64_tr_b16 v[214:215], v233 offset:8448
v_mfma_f32_16x16x32_bf16 v[52:55], v[200:203], a[140:143], v[52:55]
s_waitcnt lgkmcnt(4)
v_mfma_f32_16x16x32_bf16 v[168:171], v[204:207], a[128:131], v[168:171]
ds_read_b64_tr_b16 v[200:201], v232 offset:2048
v_mfma_f32_16x16x32_bf16 v[172:175], v[204:207], a[132:135], v[172:175]
v_mfma_f32_16x16x32_bf16 v[176:179], v[204:207], a[136:139], v[176:179]
ds_read_b64_tr_b16 v[202:203], v232 offset:2304
v_mfma_f32_16x16x32_bf16 v[180:183], v[204:207], a[140:143], v[180:183]
s_waitcnt lgkmcnt(4)
v_mfma_f32_16x16x32_bf16 v[56:59], v[208:211], a[128:131], v[56:59]
ds_read_b64_tr_b16 v[204:205], v233 offset:2048
v_mfma_f32_16x16x32_bf16 v[60:63], v[208:211], a[132:135], v[60:63]
v_mfma_f32_16x16x32_bf16 v[64:67], v[208:211], a[136:139], v[64:67]
ds_read_b64_tr_b16 v[206:207], v233 offset:2304
v_mfma_f32_16x16x32_bf16 v[68:71], v[208:211], a[140:143], v[68:71]
s_waitcnt lgkmcnt(4)
v_mfma_f32_16x16x32_bf16 v[184:187], v[212:215], a[128:131], v[184:187]
ds_read_b64_tr_b16 v[208:209], v232 offset:10240
v_mfma_f32_16x16x32_bf16 v[188:191], v[212:215], a[132:135], v[188:191]
v_mfma_f32_16x16x32_bf16 v[192:195], v[212:215], a[136:139], v[192:195]
ds_read_b64_tr_b16 v[210:211], v232 offset:10496
v_mfma_f32_16x16x32_bf16 v[196:199], v[212:215], a[140:143], v[196:199]
s_waitcnt lgkmcnt(4)
v_mfma_f32_16x16x32_bf16 v[40:43], v[200:203], a[144:147], v[40:43]
ds_read_b64_tr_b16 v[212:213], v233 offset:10240
v_mfma_f32_16x16x32_bf16 v[44:47], v[200:203], a[148:151], v[44:47]
buffer_load_dwordx4 v242, s[12:15], s65 offen offset:0 lds
v_mfma_f32_16x16x32_bf16 v[48:51], v[200:203], a[152:155], v[48:51]
ds_read_b64_tr_b16 v[214:215], v233 offset:10496
v_mfma_f32_16x16x32_bf16 v[52:55], v[200:203], a[156:159], v[52:55]
s_waitcnt lgkmcnt(4)
v_mfma_f32_16x16x32_bf16 v[168:171], v[204:207], a[144:147], v[168:171]
ds_read_b64_tr_b16 v[200:201], v232 offset:4096
v_mfma_f32_16x16x32_bf16 v[172:175], v[204:207], a[148:151], v[172:175]
v_mfma_f32_16x16x32_bf16 v[176:179], v[204:207], a[152:155], v[176:179]
ds_read_b64_tr_b16 v[202:203], v232 offset:4352
v_mfma_f32_16x16x32_bf16 v[180:183], v[204:207], a[156:159], v[180:183]
s_waitcnt lgkmcnt(4)
v_mfma_f32_16x16x32_bf16 v[56:59], v[208:211], a[144:147], v[56:59]
ds_read_b64_tr_b16 v[204:205], v233 offset:4096
v_mfma_f32_16x16x32_bf16 v[60:63], v[208:211], a[148:151], v[60:63]
v_mfma_f32_16x16x32_bf16 v[64:67], v[208:211], a[152:155], v[64:67]
ds_read_b64_tr_b16 v[206:207], v233 offset:4352
v_mfma_f32_16x16x32_bf16 v[68:71], v[208:211], a[156:159], v[68:71]
s_waitcnt lgkmcnt(4)
v_mfma_f32_16x16x32_bf16 v[184:187], v[212:215], a[144:147], v[184:187]
ds_read_b64_tr_b16 v[208:209], v232 offset:12288
v_mfma_f32_16x16x32_bf16 v[188:191], v[212:215], a[148:151], v[188:191]
v_mfma_f32_16x16x32_bf16 v[192:195], v[212:215], a[152:155], v[192:195]
ds_read_b64_tr_b16 v[210:211], v232 offset:12544
v_mfma_f32_16x16x32_bf16 v[196:199], v[212:215], a[156:159], v[196:199]
s_waitcnt lgkmcnt(4)
v_mfma_f32_16x16x32_bf16 v[40:43], v[200:203], a[160:163], v[40:43]
ds_read_b64_tr_b16 v[212:213], v233 offset:12288
v_mfma_f32_16x16x32_bf16 v[44:47], v[200:203], a[164:167], v[44:47]
buffer_load_dwordx4 v243, s[12:15], s65 offen offset:1024 lds
v_mfma_f32_16x16x32_bf16 v[48:51], v[200:203], a[168:171], v[48:51]
ds_read_b64_tr_b16 v[214:215], v233 offset:12544
v_mfma_f32_16x16x32_bf16 v[52:55], v[200:203], a[172:175], v[52:55]
s_waitcnt lgkmcnt(4)
v_mfma_f32_16x16x32_bf16 v[168:171], v[204:207], a[160:163], v[168:171]
ds_read_b64_tr_b16 v[200:201], v232 offset:6144
v_mfma_f32_16x16x32_bf16 v[172:175], v[204:207], a[164:167], v[172:175]
v_mfma_f32_16x16x32_bf16 v[176:179], v[204:207], a[168:171], v[176:179]
ds_read_b64_tr_b16 v[202:203], v232 offset:6400
v_mfma_f32_16x16x32_bf16 v[180:183], v[204:207], a[172:175], v[180:183]
s_waitcnt lgkmcnt(4)
v_mfma_f32_16x16x32_bf16 v[56:59], v[208:211], a[160:163], v[56:59]
ds_read_b64_tr_b16 v[204:205], v233 offset:6144
v_mfma_f32_16x16x32_bf16 v[60:63], v[208:211], a[164:167], v[60:63]
v_mfma_f32_16x16x32_bf16 v[64:67], v[208:211], a[168:171], v[64:67]
ds_read_b64_tr_b16 v[206:207], v233 offset:6400
v_mfma_f32_16x16x32_bf16 v[68:71], v[208:211], a[172:175], v[68:71]
s_waitcnt lgkmcnt(4)
v_mfma_f32_16x16x32_bf16 v[184:187], v[212:215], a[160:163], v[184:187]
ds_read_b64_tr_b16 v[208:209], v232 offset:14336
v_mfma_f32_16x16x32_bf16 v[188:191], v[212:215], a[164:167], v[188:191]
v_mfma_f32_16x16x32_bf16 v[192:195], v[212:215], a[168:171], v[192:195]
ds_read_b64_tr_b16 v[210:211], v232 offset:14592
v_mfma_f32_16x16x32_bf16 v[196:199], v[212:215], a[172:175], v[196:199]
s_waitcnt lgkmcnt(4)
v_mfma_f32_16x16x32_bf16 v[40:43], v[200:203], a[176:179], v[40:43]
ds_read_b64_tr_b16 v[212:213], v233 offset:14336
v_mfma_f32_16x16x32_bf16 v[44:47], v[200:203], a[180:183], v[44:47]
s_waitcnt vmcnt(4)
s_barrier
v_mfma_f32_16x16x32_bf16 v[48:51], v[200:203], a[184:187], v[48:51]
ds_read_b64_tr_b16 v[214:215], v233 offset:14592
s_add_u32 m0, s82, 49152
v_mfma_f32_16x16x32_bf16 v[52:55], v[200:203], a[188:191], v[52:55]
s_waitcnt lgkmcnt(4)
s_add_u32 s65, s53, 704512
v_mfma_f32_16x16x32_bf16 v[168:171], v[204:207], a[176:179], v[168:171]
ds_read_b64_tr_b16 v[200:201], v232 offset:16384
v_mfma_f32_16x16x32_bf16 v[172:175], v[204:207], a[180:183], v[172:175]
buffer_load_dwordx4 v242, s[8:11], s65 offen offset:0 lds
v_mfma_f32_16x16x32_bf16 v[176:179], v[204:207], a[184:187], v[176:179]
ds_read_b64_tr_b16 v[202:203], v232 offset:16640
v_mfma_f32_16x16x32_bf16 v[180:183], v[204:207], a[188:191], v[180:183]
s_waitcnt lgkmcnt(4)
v_mfma_f32_16x16x32_bf16 v[56:59], v[208:211], a[176:179], v[56:59]
ds_read_b64_tr_b16 v[204:205], v233 offset:16384
v_mfma_f32_16x16x32_bf16 v[60:63], v[208:211], a[180:183], v[60:63]
v_mfma_f32_16x16x32_bf16 v[64:67], v[208:211], a[184:187], v[64:67]
ds_read_b64_tr_b16 v[206:207], v233 offset:16640
v_mfma_f32_16x16x32_bf16 v[68:71], v[208:211], a[188:191], v[68:71]
s_waitcnt lgkmcnt(4)
v_mfma_f32_16x16x32_bf16 v[184:187], v[212:215], a[176:179], v[184:187]
ds_read_b64_tr_b16 v[208:209], v232 offset:24576
v_mfma_f32_16x16x32_bf16 v[188:191], v[212:215], a[180:183], v[188:191]
v_mfma_f32_16x16x32_bf16 v[192:195], v[212:215], a[184:187], v[192:195]
ds_read_b64_tr_b16 v[210:211], v232 offset:24832
v_mfma_f32_16x16x32_bf16 v[196:199], v[212:215], a[188:191], v[196:199]
s_waitcnt lgkmcnt(4)
v_mfma_f32_16x16x32_bf16 v[40:43], v[200:203], a[192:195], v[40:43]
ds_read_b64_tr_b16 v[212:213], v233 offset:24576
v_mfma_f32_16x16x32_bf16 v[44:47], v[200:203], a[196:199], v[44:47]
buffer_load_dwordx4 v243, s[8:11], s65 offen offset:1024 lds
s_add_u32 m0, s82, 57344
v_mfma_f32_16x16x32_bf16 v[48:51], v[200:203], a[200:203], v[48:51]
ds_read_b64_tr_b16 v[214:215], v233 offset:24832
s_bfe_u32 s67, s2, 0x20001
v_mfma_f32_16x16x32_bf16 v[52:55], v[200:203], a[204:207], v[52:55]
s_waitcnt lgkmcnt(4)
s_sub_u32 s68, 15, s43
v_mfma_f32_16x16x32_bf16 v[168:171], v[204:207], a[192:195], v[168:171]
ds_read_b64_tr_b16 v[200:201], v232 offset:18432
s_bitcmp1_b32 s2, 3
s_cselect_b32 s68, s68, s43
v_mfma_f32_16x16x32_bf16 v[172:175], v[204:207], a[196:199], v[172:175]
s_lshl_b32 s68, s68, 2
s_bfe_u32 s85, s2, 0x20004
v_mfma_f32_16x16x32_bf16 v[176:179], v[204:207], a[200:203], v[176:179]
ds_read_b64_tr_b16 v[202:203], v232 offset:18688
s_add_u32 s85, s85, s68
v_mfma_f32_16x16x32_bf16 v[180:183], v[204:207], a[204:207], v[180:183]
s_waitcnt lgkmcnt(4)
s_lshl_b32 s85, s85, 2
v_mfma_f32_16x16x32_bf16 v[56:59], v[208:211], a[192:195], v[56:59]
ds_read_b64_tr_b16 v[204:205], v233 offset:18432
s_add_u32 s85, s85, s40
v_mfma_f32_16x16x32_bf16 v[60:63], v[208:211], a[196:199], v[60:63]
s_lshl_b32 s85, s85, 2
s_add_u32 s85, s85, s67
v_mfma_f32_16x16x32_bf16 v[64:67], v[208:211], a[200:203], v[64:67]
ds_read_b64_tr_b16 v[206:207], v233 offset:18688
s_lshl_b32 s85, s85, 13
v_mfma_f32_16x16x32_bf16 v[68:71], v[208:211], a[204:207], v[68:71]
s_waitcnt lgkmcnt(4)
v_mov_b32 v244, -1
v_mfma_f32_16x16x32_bf16 v[184:187], v[212:215], a[192:195], v[184:187]
ds_read_b64_tr_b16 v[208:209], v232 offset:26624
v_mov_b32 v245, -1
v_mfma_f32_16x16x32_bf16 v[188:191], v[212:215], a[196:199], v[188:191]
v_mov_b32 v246, -1
v_mov_b32 v247, -1
v_mfma_f32_16x16x32_bf16 v[192:195], v[212:215], a[200:203], v[192:195]
ds_read_b64_tr_b16 v[210:211], v232 offset:26880
s_cmp_eq_u32 s40, s67
s_cselect_b32 s67, 0x40000000, s85
v_mfma_f32_16x16x32_bf16 v[196:199], v[212:215], a[204:207], v[196:199]
s_waitcnt lgkmcnt(4)
v_mfma_f32_16x16x32_bf16 v[40:43], v[200:203], a[208:211], v[40:43]
ds_read_b64_tr_b16 v[212:213], v233 offset:26624
v_mfma_f32_16x16x32_bf16 v[44:47], v[200:203], a[212:215], v[44:47]
buffer_load_dwordx4 v242, s[12:15], s65 offen offset:0 lds
v_mfma_f32_16x16x32_bf16 v[48:51], v[200:203], a[216:219], v[48:51]
ds_read_b64_tr_b16 v[214:215], v233 offset:26880
v_mfma_f32_16x16x32_bf16 v[52:55], v[200:203], a[220:223], v[52:55]
s_waitcnt lgkmcnt(4)
v_mfma_f32_16x16x32_bf16 v[168:171], v[204:207], a[208:211], v[168:171]
ds_read_b64_tr_b16 v[200:201], v232 offset:20480
v_mfma_f32_16x16x32_bf16 v[172:175], v[204:207], a[212:215], v[172:175]
v_mfma_f32_16x16x32_bf16 v[176:179], v[204:207], a[216:219], v[176:179]
ds_read_b64_tr_b16 v[202:203], v232 offset:20736
v_mfma_f32_16x16x32_bf16 v[180:183], v[204:207], a[220:223], v[180:183]
s_waitcnt lgkmcnt(4)
v_mfma_f32_16x16x32_bf16 v[56:59], v[208:211], a[208:211], v[56:59]
ds_read_b64_tr_b16 v[204:205], v233 offset:20480
v_mfma_f32_16x16x32_bf16 v[60:63], v[208:211], a[212:215], v[60:63]
v_mfma_f32_16x16x32_bf16 v[64:67], v[208:211], a[216:219], v[64:67]
ds_read_b64_tr_b16 v[206:207], v233 offset:20736
v_mfma_f32_16x16x32_bf16 v[68:71], v[208:211], a[220:223], v[68:71]
s_waitcnt lgkmcnt(4)
v_mfma_f32_16x16x32_bf16 v[184:187], v[212:215], a[208:211], v[184:187]
ds_read_b64_tr_b16 v[208:209], v232 offset:28672
v_mfma_f32_16x16x32_bf16 v[188:191], v[212:215], a[212:215], v[188:191]
v_mfma_f32_16x16x32_bf16 v[192:195], v[212:215], a[216:219], v[192:195]
ds_read_b64_tr_b16 v[210:211], v232 offset:28928
v_mfma_f32_16x16x32_bf16 v[196:199], v[212:215], a[220:223], v[196:199]
s_waitcnt lgkmcnt(4)
v_mfma_f32_16x16x32_bf16 v[40:43], v[200:203], a[224:227], v[40:43]
ds_read_b64_tr_b16 v[212:213], v233 offset:28672
v_mfma_f32_16x16x32_bf16 v[44:47], v[200:203], a[228:231], v[44:47]
buffer_load_dwordx4 v243, s[12:15], s65 offen offset:1024 lds
v_mfma_f32_16x16x32_bf16 v[48:51], v[200:203], a[232:235], v[48:51]
ds_read_b64_tr_b16 v[214:215], v233 offset:28928
v_mfma_f32_16x16x32_bf16 v[52:55], v[200:203], a[236:239], v[52:55]
s_waitcnt lgkmcnt(4)
v_mfma_f32_16x16x32_bf16 v[168:171], v[204:207], a[224:227], v[168:171]
ds_read_b64_tr_b16 v[200:201], v232 offset:22528
v_mfma_f32_16x16x32_bf16 v[172:175], v[204:207], a[228:231], v[172:175]
v_mfma_f32_16x16x32_bf16 v[176:179], v[204:207], a[232:235], v[176:179]
ds_read_b64_tr_b16 v[202:203], v232 offset:22784
v_mfma_f32_16x16x32_bf16 v[180:183], v[204:207], a[236:239], v[180:183]
s_waitcnt lgkmcnt(4)
v_mfma_f32_16x16x32_bf16 v[56:59], v[208:211], a[224:227], v[56:59]
ds_read_b64_tr_b16 v[204:205], v233 offset:22528
v_mfma_f32_16x16x32_bf16 v[60:63], v[208:211], a[228:231], v[60:63]
v_mfma_f32_16x16x32_bf16 v[64:67], v[208:211], a[232:235], v[64:67]
ds_read_b64_tr_b16 v[206:207], v233 offset:22784
v_mfma_f32_16x16x32_bf16 v[68:71], v[208:211], a[236:239], v[68:71]
s_waitcnt lgkmcnt(4)
v_mfma_f32_16x16x32_bf16 v[184:187], v[212:215], a[224:227], v[184:187]
ds_read_b64_tr_b16 v[208:209], v232 offset:30720
v_mfma_f32_16x16x32_bf16 v[188:191], v[212:215], a[228:231], v[188:191]
v_mfma_f32_16x16x32_bf16 v[192:195], v[212:215], a[232:235], v[192:195]
ds_read_b64_tr_b16 v[210:211], v232 offset:30976
v_mfma_f32_16x16x32_bf16 v[196:199], v[212:215], a[236:239], v[196:199]
s_waitcnt lgkmcnt(4)
v_mfma_f32_16x16x32_bf16 v[40:43], v[200:203], a[240:243], v[40:43]
ds_read_b64_tr_b16 v[212:213], v233 offset:30720
v_mfma_f32_16x16x32_bf16 v[44:47], v[200:203], a[244:247], v[44:47]
s_waitcnt vmcnt(4)
s_barrier
v_mfma_f32_16x16x32_bf16 v[48:51], v[200:203], a[248:251], v[48:51]
ds_read_b64_tr_b16 v[214:215], v233 offset:30976
s_add_u32 m0, s42, 0
v_mfma_f32_16x16x32_bf16 v[52:55], v[200:203], a[252:255], v[52:55]
s_waitcnt lgkmcnt(4)
s_add_u32 s65, s51, 128
v_mfma_f32_16x16x32_bf16 v[168:171], v[204:207], a[240:243], v[168:171]
ds_read_b64_tr_b16 v[200:201], v234 offset:32768
v_mfma_f32_16x16x32_bf16 v[172:175], v[204:207], a[244:247], v[172:175]
buffer_load_dwordx4 v236, s[4:7], s65 offen offset:0 lds
v_mfma_f32_16x16x32_bf16 v[176:179], v[204:207], a[248:251], v[176:179]
ds_read_b64_tr_b16 v[202:203], v235 offset:32768
v_mfma_f32_16x16x32_bf16 v[180:183], v[204:207], a[252:255], v[180:183]
s_waitcnt lgkmcnt(4)
v_mfma_f32_16x16x32_bf16 v[56:59], v[208:211], a[240:243], v[56:59]
ds_read_b64_tr_b16 v[204:205], v234 offset:40960
v_mfma_f32_16x16x32_bf16 v[60:63], v[208:211], a[244:247], v[60:63]
s_add_u32 s12, s80, 0x3800000
s_addc_u32 s13, s81, 0
v_mfma_f32_16x16x32_bf16 v[64:67], v[208:211], a[248:251], v[64:67]
ds_read_b64_tr_b16 v[206:207], v235 offset:40960
s_mov_b32 s14, 0x1000000
v_mfma_f32_16x16x32_bf16 v[68:71], v[208:211], a[252:255], v[68:71]
s_waitcnt lgkmcnt(4)
s_mov_b32 s15, 0x20000
v_mfma_f32_16x16x32_bf16 v[184:187], v[212:215], a[240:243], v[184:187]
ds_read_b64_tr_b16 v[208:209], v234 offset:33792
v_mfma_f32_16x16x32_bf16 v[188:191], v[212:215], a[244:247], v[188:191]
v_mfma_f32_16x16x32_bf16 v[192:195], v[212:215], a[248:251], v[192:195]
ds_read_b64_tr_b16 v[210:211], v235 offset:33792
v_mfma_f32_16x16x32_bf16 v[196:199], v[212:215], a[252:255], v[196:199]
s_waitcnt lgkmcnt(4)
v_mfma_f32_16x16x32_bf16 v[136:139], v[200:203], a[0:3], 0
ds_read_b64_tr_b16 v[212:213], v234 offset:41984
ds_read_b64_tr_b16 v[214:215], v235 offset:41984
v_mfma_f32_16x16x32_bf16 v[140:143], v[200:203], a[4:7], 0
buffer_load_dwordx4 v237, s[4:7], s65 offen offset:1024 lds
v_mfma_f32_16x16x32_bf16 v[144:147], v[200:203], a[8:11], 0
v_mfma_f32_16x16x32_bf16 v[148:151], v[200:203], a[12:15], 0
s_waitcnt lgkmcnt(4)
v_mfma_f32_16x16x32_bf16 v[152:155], v[204:207], a[0:3], 0
ds_read_b64_tr_b16 v[200:201], v234 offset:34816
ds_read_b64_tr_b16 v[202:203], v235 offset:34816
v_mfma_f32_16x16x32_bf16 v[156:159], v[204:207], a[4:7], 0
buffer_store_dwordx4 v[244:247], v2, s[12:15], s67 offen offset:0 sc1
v_mfma_f32_16x16x32_bf16 v[160:163], v[204:207], a[8:11], 0
v_mfma_f32_16x16x32_bf16 v[164:167], v[204:207], a[12:15], 0
s_waitcnt lgkmcnt(4)
v_mfma_f32_16x16x32_bf16 v[136:139], v[208:211], a[16:19], v[136:139]
ds_read_b64_tr_b16 v[204:205], v234 offset:43008
ds_read_b64_tr_b16 v[206:207], v235 offset:43008
v_mfma_f32_16x16x32_bf16 v[140:143], v[208:211], a[20:23], v[140:143]
buffer_store_dwordx4 v[244:247], v2, s[12:15], s67 offen offset:1024 sc1
v_mul_f32 v216, v40, v40
v_mfma_f32_16x16x32_bf16 v[144:147], v[208:211], a[24:27], v[144:147]
v_mul_f32 v217, v41, v41
v_mul_f32 v218, v42, v42
v_mfma_f32_16x16x32_bf16 v[148:151], v[208:211], a[28:31], v[148:151]
s_waitcnt lgkmcnt(4)
v_mul_f32 v219, v43, v43
v_mfma_f32_16x16x32_bf16 v[152:155], v[212:215], a[16:19], v[152:155]
ds_read_b64_tr_b16 v[208:209], v234 offset:35840
ds_read_b64_tr_b16 v[210:211], v235 offset:35840
v_mfma_f32_16x16x32_bf16 v[156:159], v[212:215], a[20:23], v[156:159]
v_fmamk_f32 v216, v216, 0xbdd2d3e8, v4
v_fmamk_f32 v217, v217, 0xbdd2d3e8, v4
v_mfma_f32_16x16x32_bf16 v[160:163], v[212:215], a[24:27], v[160:163]
v_fmamk_f32 v218, v218, 0xbdd2d3e8, v4
v_fmamk_f32 v219, v219, 0xbdd2d3e8, v4
v_mfma_f32_16x16x32_bf16 v[164:167], v[212:215], a[28:31], v[164:167]
s_waitcnt lgkmcnt(4)
v_mul_f32 v216, v216, v40
v_mfma_f32_16x16x32_bf16 v[136:139], v[200:203], a[32:35], v[136:139]
ds_read_b64_tr_b16 v[212:213], v234 offset:44032
ds_read_b64_tr_b16 v[214:215], v235 offset:44032
v_mfma_f32_16x16x32_bf16 v[140:143], v[200:203], a[36:39], v[140:143]
buffer_load_dwordx4 v238, s[4:7], s65 offen offset:2048 lds
v_mul_f32 v217, v217, v41
v_mfma_f32_16x16x32_bf16 v[144:147], v[200:203], a[40:43], v[144:147]
v_mul_f32 v218, v218, v42
v_mul_f32 v219, v219, v43
v_mfma_f32_16x16x32_bf16 v[148:151], v[200:203], a[44:47], v[148:151]
s_waitcnt lgkmcnt(4)
v_mfma_f32_16x16x32_bf16 v[152:155], v[204:207], a[32:35], v[152:155]
ds_read_b64_tr_b16 v[200:201], v234 offset:36864
ds_read_b64_tr_b16 v[202:203], v235 offset:36864
v_mfma_f32_16x16x32_bf16 v[156:159], v[204:207], a[36:39], v[156:159]
buffer_store_dwordx4 v[244:247], v2, s[12:15], s67 offen offset:2048 sc1
v_mfma_f32_16x16x32_bf16 v[160:163], v[204:207], a[40:43], v[160:163]
v_exp_f32 v216, v216
v_mfma_f32_16x16x32_bf16 v[164:167], v[204:207], a[44:47], v[164:167]
s_waitcnt lgkmcnt(4)
v_mul_f32 v56, v56, v40
v_mfma_f32_16x16x32_bf16 v[136:139], v[208:211], a[48:51], v[136:139]
ds_read_b64_tr_b16 v[204:205], v234 offset:45056
ds_read_b64_tr_b16 v[206:207], v235 offset:45056
v_mfma_f32_16x16x32_bf16 v[140:143], v[208:211], a[52:55], v[140:143]
buffer_store_dwordx4 v[244:247], v2, s[12:15], s67 offen offset:3072 sc1
s_add_u32 s67, s67, 4096
v_mfma_f32_16x16x32_bf16 v[144:147], v[208:211], a[56:59], v[144:147]
v_exp_f32 v217, v217
v_mfma_f32_16x16x32_bf16 v[148:151], v[208:211], a[60:63], v[148:151]
s_waitcnt lgkmcnt(4)
v_mul_f32 v57, v57, v41
v_mfma_f32_16x16x32_bf16 v[152:155], v[212:215], a[48:51], v[152:155]
ds_read_b64_tr_b16 v[208:209], v234 offset:37888
ds_read_b64_tr_b16 v[210:211], v235 offset:37888
v_mfma_f32_16x16x32_bf16 v[156:159], v[212:215], a[52:55], v[156:159]
v_exp_f32 v218, v218
v_mfma_f32_16x16x32_bf16 v[160:163], v[212:215], a[56:59], v[160:163]
v_mul_f32 v58, v58, v42
v_mfma_f32_16x16x32_bf16 v[164:167], v[212:215], a[60:63], v[164:167]
s_waitcnt lgkmcnt(4)
v_mfma_f32_16x16x32_bf16 v[136:139], v[200:203], a[64:67], v[136:139]
ds_read_b64_tr_b16 v[212:213], v234 offset:46080
ds_read_b64_tr_b16 v[214:215], v235 offset:46080
v_mfma_f32_16x16x32_bf16 v[140:143], v[200:203], a[68:71], v[140:143]
buffer_load_dwordx4 v239, s[4:7], s65 offen offset:3072 lds
v_mfma_f32_16x16x32_bf16 v[144:147], v[200:203], a[72:75], v[144:147]
v_exp_f32 v219, v219
v_mfma_f32_16x16x32_bf16 v[148:151], v[200:203], a[76:79], v[148:151]
s_waitcnt lgkmcnt(4)
v_mul_f32 v59, v59, v43
v_mfma_f32_16x16x32_bf16 v[152:155], v[204:207], a[64:67], v[152:155]
ds_read_b64_tr_b16 v[200:201], v234 offset:38912
ds_read_b64_tr_b16 v[202:203], v235 offset:38912
v_mfma_f32_16x16x32_bf16 v[156:159], v[204:207], a[68:71], v[156:159]
buffer_store_dwordx4 v[244:247], v2, s[12:15], s67 offen offset:0 sc1
v_add_f32 v216, 1.0, v216
v_mfma_f32_16x16x32_bf16 v[160:163], v[204:207], a[72:75], v[160:163]
v_add_f32 v217, 1.0, v217
v_add_f32 v218, 1.0, v218
v_mfma_f32_16x16x32_bf16 v[164:167], v[204:207], a[76:79], v[164:167]
s_waitcnt lgkmcnt(4)
v_add_f32 v219, 1.0, v219
v_mfma_f32_16x16x32_bf16 v[136:139], v[208:211], a[80:83], v[136:139]
ds_read_b64_tr_b16 v[204:205], v234 offset:47104
ds_read_b64_tr_b16 v[206:207], v235 offset:47104
v_mfma_f32_16x16x32_bf16 v[140:143], v[208:211], a[84:87], v[140:143]
buffer_store_dwordx4 v[244:247], v2, s[12:15], s67 offen offset:1024 sc1
v_mfma_f32_16x16x32_bf16 v[144:147], v[208:211], a[88:91], v[144:147]
v_rcp_f32 v216, v216
v_mfma_f32_16x16x32_bf16 v[148:151], v[208:211], a[92:95], v[148:151]
s_waitcnt lgkmcnt(4)
v_mfma_f32_16x16x32_bf16 v[152:155], v[212:215], a[80:83], v[152:155]
ds_read_b64_tr_b16 v[208:209], v234 offset:39936
ds_read_b64_tr_b16 v[210:211], v235 offset:39936
v_mfma_f32_16x16x32_bf16 v[156:159], v[212:215], a[84:87], v[156:159]
buffer_store_dwordx4 v[244:247], v2, s[12:15], s67 offen offset:2048 sc1
v_mfma_f32_16x16x32_bf16 v[160:163], v[212:215], a[88:91], v[160:163]
v_rcp_f32 v217, v217
v_mfma_f32_16x16x32_bf16 v[164:167], v[212:215], a[92:95], v[164:167]
s_waitcnt lgkmcnt(4)
v_mfma_f32_16x16x32_bf16 v[136:139], v[200:203], a[96:99], v[136:139]
ds_read_b64_tr_b16 v[212:213], v234 offset:48128
ds_read_b64_tr_b16 v[214:215], v235 offset:48128
v_mfma_f32_16x16x32_bf16 v[140:143], v[200:203], a[100:103], v[140:143]
s_waitcnt vmcnt(11)
s_barrier
v_mfma_f32_16x16x32_bf16 v[144:147], v[200:203], a[104:107], v[144:147]
s_add_u32 m0, s42, 16384
s_add_u32 s65, s51, 1048704
v_mfma_f32_16x16x32_bf16 v[148:151], v[200:203], a[108:111], v[148:151]
s_waitcnt lgkmcnt(4)
v_mfma_f32_16x16x32_bf16 v[152:155], v[204:207], a[96:99], v[152:155]
ds_read_b64_tr_b16 v[200:201], v234 offset:49152
ds_read_b64_tr_b16 v[202:203], v235 offset:49152
v_mfma_f32_16x16x32_bf16 v[156:159], v[204:207], a[100:103], v[156:159]
buffer_load_dwordx4 v236, s[4:7], s65 offen offset:0 lds
v_mfma_f32_16x16x32_bf16 v[160:163], v[204:207], a[104:107], v[160:163]
v_rcp_f32 v218, v218
v_mfma_f32_16x16x32_bf16 v[164:167], v[204:207], a[108:111], v[164:167]
s_waitcnt lgkmcnt(4)
v_mfma_f32_16x16x32_bf16 v[136:139], v[208:211], a[112:115], v[136:139]
ds_read_b64_tr_b16 v[204:205], v234 offset:57344
ds_read_b64_tr_b16 v[206:207], v235 offset:57344
v_mfma_f32_16x16x32_bf16 v[140:143], v[208:211], a[116:119], v[140:143]
buffer_store_dwordx4 v[244:247], v2, s[12:15], s67 offen offset:3072 sc1
v_mfma_f32_16x16x32_bf16 v[144:147], v[208:211], a[120:123], v[144:147]
v_rcp_f32 v219, v219
v_mfma_f32_16x16x32_bf16 v[148:151], v[208:211], a[124:127], v[148:151]
s_waitcnt lgkmcnt(4)
v_mul_f32 v56, v56, v216
v_mfma_f32_16x16x32_bf16 v[152:155], v[212:215], a[112:115], v[152:155]
ds_read_b64_tr_b16 v[208:209], v234 offset:50176
ds_read_b64_tr_b16 v[210:211], v235 offset:50176
v_mfma_f32_16x16x32_bf16 v[156:159], v[212:215], a[116:119], v[156:159]
v_mul_f32 v57, v57, v217
v_mul_f32 v58, v58, v218
v_mfma_f32_16x16x32_bf16 v[160:163], v[212:215], a[120:123], v[160:163]
v_mul_f32 v59, v59, v219
v_cvt_pk_bf16_f32 v220, v56, v57
v_mfma_f32_16x16x32_bf16 v[164:167], v[212:215], a[124:127], v[164:167]
s_waitcnt lgkmcnt(4)
v_cvt_pk_bf16_f32 v221, v58, v59
v_mfma_f32_16x16x32_bf16 v[136:139], v[200:203], a[128:131], v[136:139]
ds_read_b64_tr_b16 v[212:213], v234 offset:58368
ds_read_b64_tr_b16 v[214:215], v235 offset:58368
v_mfma_f32_16x16x32_bf16 v[140:143], v[200:203], a[132:135], v[140:143]
buffer_load_dwordx4 v237, s[4:7], s65 offen offset:1024 lds
buffer_store_dwordx2 v[220:221], v248, s[24:27], s54 offen offset:0 sc1
v_mfma_f32_16x16x32_bf16 v[144:147], v[200:203], a[136:139], v[144:147]
v_mul_f32 v222, v44, v44
v_mul_f32 v223, v45, v45
v_mfma_f32_16x16x32_bf16 v[148:151], v[200:203], a[140:143], v[148:151]
s_waitcnt lgkmcnt(4)
v_mul_f32 v224, v46, v46
v_mfma_f32_16x16x32_bf16 v[152:155], v[204:207], a[128:131], v[152:155]
ds_read_b64_tr_b16 v[200:201], v234 offset:51200
ds_read_b64_tr_b16 v[202:203], v235 offset:51200
v_mfma_f32_16x16x32_bf16 v[156:159], v[204:207], a[132:135], v[156:159]
v_mul_f32 v225, v47, v47
v_fmamk_f32 v222, v222, 0xbdd2d3e8, v4
v_mfma_f32_16x16x32_bf16 v[160:163], v[204:207], a[136:139], v[160:163]
v_fmamk_f32 v223, v223, 0xbdd2d3e8, v4
v_fmamk_f32 v224, v224, 0xbdd2d3e8, v4
v_mfma_f32_16x16x32_bf16 v[164:167], v[204:207], a[140:143], v[164:167]
s_waitcnt lgkmcnt(4)
v_fmamk_f32 v225, v225, 0xbdd2d3e8, v4
v_mfma_f32_16x16x32_bf16 v[136:139], v[208:211], a[144:147], v[136:139]
ds_read_b64_tr_b16 v[204:205], v234 offset:59392
ds_read_b64_tr_b16 v[206:207], v235 offset:59392
v_mfma_f32_16x16x32_bf16 v[140:143], v[208:211], a[148:151], v[140:143]
s_lshr_b32 s69, s44, 1
s_add_u32 s69, s69, 264
v_mfma_f32_16x16x32_bf16 v[144:147], v[208:211], a[152:155], v[144:147]
s_lshl_b32 s69, s69, 7
buffer_load_dword v240, off, s[32:35], s69 sc1
v_mfma_f32_16x16x32_bf16 v[148:151], v[208:211], a[156:159], v[148:151]
s_waitcnt lgkmcnt(4)
v_mul_f32 v222, v222, v44
v_mfma_f32_16x16x32_bf16 v[152:155], v[212:215], a[144:147], v[152:155]
ds_read_b64_tr_b16 v[208:209], v234 offset:52224
ds_read_b64_tr_b16 v[210:211], v235 offset:52224
v_mfma_f32_16x16x32_bf16 v[156:159], v[212:215], a[148:151], v[156:159]
v_mul_f32 v223, v223, v45
v_mul_f32 v224, v224, v46
v_mfma_f32_16x16x32_bf16 v[160:163], v[212:215], a[152:155], v[160:163]
v_mul_f32 v225, v225, v47
v_mfma_f32_16x16x32_bf16 v[164:167], v[212:215], a[156:159], v[164:167]
s_waitcnt lgkmcnt(4)
v_mfma_f32_16x16x32_bf16 v[136:139], v[200:203], a[160:163], v[136:139]
ds_read_b64_tr_b16 v[212:213], v234 offset:60416
ds_read_b64_tr_b16 v[214:215], v235 offset:60416
v_mfma_f32_16x16x32_bf16 v[140:143], v[200:203], a[164:167], v[140:143]
buffer_load_dwordx4 v238, s[4:7], s65 offen offset:2048 lds
v_mfma_f32_16x16x32_bf16 v[144:147], v[200:203], a[168:171], v[144:147]
v_exp_f32 v222, v222
v_mfma_f32_16x16x32_bf16 v[148:151], v[200:203], a[172:175], v[148:151]
s_waitcnt lgkmcnt(4)
v_mul_f32 v60, v60, v44
v_mfma_f32_16x16x32_bf16 v[152:155], v[204:207], a[160:163], v[152:155]
ds_read_b64_tr_b16 v[200:201], v234 offset:53248
ds_read_b64_tr_b16 v[202:203], v235 offset:53248
v_mfma_f32_16x16x32_bf16 v[156:159], v[204:207], a[164:167], v[156:159]
v_exp_f32 v223, v223
v_mfma_f32_16x16x32_bf16 v[160:163], v[204:207], a[168:171], v[160:163]
v_mul_f32 v61, v61, v45
v_mfma_f32_16x16x32_bf16 v[164:167], v[204:207], a[172:175], v[164:167]
s_waitcnt lgkmcnt(4)
v_mfma_f32_16x16x32_bf16 v[136:139], v[208:211], a[176:179], v[136:139]
ds_read_b64_tr_b16 v[204:205], v234 offset:61440
ds_read_b64_tr_b16 v[206:207], v235 offset:61440
v_mfma_f32_16x16x32_bf16 v[140:143], v[208:211], a[180:183], v[140:143]
v_exp_f32 v224, v224
v_mfma_f32_16x16x32_bf16 v[144:147], v[208:211], a[184:187], v[144:147]
v_mul_f32 v62, v62, v46
v_mfma_f32_16x16x32_bf16 v[148:151], v[208:211], a[188:191], v[148:151]
s_waitcnt lgkmcnt(4)
v_mfma_f32_16x16x32_bf16 v[152:155], v[212:215], a[176:179], v[152:155]
ds_read_b64_tr_b16 v[208:209], v234 offset:54272
ds_read_b64_tr_b16 v[210:211], v235 offset:54272
v_mfma_f32_16x16x32_bf16 v[156:159], v[212:215], a[180:183], v[156:159]
v_exp_f32 v225, v225
v_mfma_f32_16x16x32_bf16 v[160:163], v[212:215], a[184:187], v[160:163]
v_mul_f32 v63, v63, v47
v_add_f32 v222, 1.0, v222
v_mfma_f32_16x16x32_bf16 v[164:167], v[212:215], a[188:191], v[164:167]
s_waitcnt lgkmcnt(4)
v_add_f32 v223, 1.0, v223
v_mfma_f32_16x16x32_bf16 v[136:139], v[200:203], a[192:195], v[136:139]
ds_read_b64_tr_b16 v[212:213], v234 offset:62464
ds_read_b64_tr_b16 v[214:215], v235 offset:62464
v_mfma_f32_16x16x32_bf16 v[140:143], v[200:203], a[196:199], v[140:143]
buffer_load_dwordx4 v239, s[4:7], s65 offen offset:3072 lds
v_add_f32 v224, 1.0, v224
v_mfma_f32_16x16x32_bf16 v[144:147], v[200:203], a[200:203], v[144:147]
v_add_f32 v225, 1.0, v225
v_mfma_f32_16x16x32_bf16 v[148:151], v[200:203], a[204:207], v[148:151]
s_waitcnt lgkmcnt(4)
v_mfma_f32_16x16x32_bf16 v[152:155], v[204:207], a[192:195], v[152:155]
ds_read_b64_tr_b16 v[200:201], v234 offset:55296
ds_read_b64_tr_b16 v[202:203], v235 offset:55296
v_mfma_f32_16x16x32_bf16 v[156:159], v[204:207], a[196:199], v[156:159]
v_rcp_f32 v222, v222
v_mfma_f32_16x16x32_bf16 v[160:163], v[204:207], a[200:203], v[160:163]
v_rcp_f32 v223, v223
v_mfma_f32_16x16x32_bf16 v[164:167], v[204:207], a[204:207], v[164:167]
s_waitcnt lgkmcnt(4)
v_mfma_f32_16x16x32_bf16 v[136:139], v[208:211], a[208:211], v[136:139]
ds_read_b64_tr_b16 v[204:205], v234 offset:63488
ds_read_b64_tr_b16 v[206:207], v235 offset:63488
v_mfma_f32_16x16x32_bf16 v[140:143], v[208:211], a[212:215], v[140:143]
v_rcp_f32 v224, v224
v_mfma_f32_16x16x32_bf16 v[144:147], v[208:211], a[216:219], v[144:147]
v_rcp_f32 v225, v225
v_mfma_f32_16x16x32_bf16 v[148:151], v[208:211], a[220:223], v[148:151]
s_waitcnt lgkmcnt(4)
v_mul_f32 v60, v60, v222
v_mfma_f32_16x16x32_bf16 v[152:155], v[212:215], a[208:211], v[152:155]
ds_read_b64_tr_b16 v[208:209], v234 offset:56320
ds_read_b64_tr_b16 v[210:211], v235 offset:56320
v_mfma_f32_16x16x32_bf16 v[156:159], v[212:215], a[212:215], v[156:159]
v_mul_f32 v61, v61, v223
v_mul_f32 v62, v62, v224
v_mfma_f32_16x16x32_bf16 v[160:163], v[212:215], a[216:219], v[160:163]
v_mul_f32 v63, v63, v225
v_cvt_pk_bf16_f32 v226, v60, v61
v_mfma_f32_16x16x32_bf16 v[164:167], v[212:215], a[220:223], v[164:167]
s_waitcnt lgkmcnt(4)
v_cvt_pk_bf16_f32 v227, v62, v63
v_mfma_f32_16x16x32_bf16 v[136:139], v[200:203], a[224:227], v[136:139]
ds_read_b64_tr_b16 v[212:213], v234 offset:64512
ds_read_b64_tr_b16 v[214:215], v235 offset:64512
v_mfma_f32_16x16x32_bf16 v[140:143], v[200:203], a[228:231], v[140:143]
s_waitcnt vmcnt(10)
s_barrier
v_mfma_f32_16x16x32_bf16 v[144:147], v[200:203], a[232:235], v[144:147]
s_add_u32 m0, s42, 32768
s_add_u32 s65, s51, 2097280
v_mfma_f32_16x16x32_bf16 v[148:151], v[200:203], a[236:239], v[148:151]
s_waitcnt lgkmcnt(4)
buffer_store_dwordx2 v[226:227], v249, s[24:27], s54 offen offset:0 sc1
v_mfma_f32_16x16x32_bf16 v[152:155], v[204:207], a[224:227], v[152:155]
ds_read_b64_tr_b16 v[200:201], v228 offset:0
ds_read_b64_tr_b16 v[202:203], v228 offset:512
v_mfma_f32_16x16x32_bf16 v[156:159], v[204:207], a[228:231], v[156:159]
buffer_load_dwordx4 v236, s[4:7], s65 offen offset:0 lds
v_mul_f32 v216, v48, v48
v_mfma_f32_16x16x32_bf16 v[160:163], v[204:207], a[232:235], v[160:163]
v_mul_f32 v217, v49, v49
v_mul_f32 v218, v50, v50
v_mfma_f32_16x16x32_bf16 v[164:167], v[204:207], a[236:239], v[164:167]
s_waitcnt lgkmcnt(4)
v_mul_f32 v219, v51, v51
v_mfma_f32_16x16x32_bf16 v[136:139], v[208:211], a[240:243], v[136:139]
ds_read_b64_tr_b16 v[204:205], v229 offset:0
ds_read_b64_tr_b16 v[206:207], v229 offset:512
v_mfma_f32_16x16x32_bf16 v[140:143], v[208:211], a[244:247], v[140:143]
v_fmamk_f32 v216, v216, 0xbdd2d3e8, v4
v_fmamk_f32 v217, v217, 0xbdd2d3e8, v4
v_mfma_f32_16x16x32_bf16 v[144:147], v[208:211], a[248:251], v[144:147]
v_fmamk_f32 v218, v218, 0xbdd2d3e8, v4
v_fmamk_f32 v219, v219, 0xbdd2d3e8, v4
v_mfma_f32_16x16x32_bf16 v[148:151], v[208:211], a[252:255], v[148:151]
s_waitcnt lgkmcnt(4)
v_mul_f32 v216, v216, v48
v_mfma_f32_16x16x32_bf16 v[152:155], v[212:215], a[240:243], v[152:155]
ds_read_b64_tr_b16 v[208:209], v230 offset:0
ds_read_b64_tr_b16 v[210:211], v230 offset:512
v_mfma_f32_16x16x32_bf16 v[156:159], v[212:215], a[244:247], v[156:159]
v_mul_f32 v217, v217, v49
v_mul_f32 v218, v218, v50
v_mfma_f32_16x16x32_bf16 v[160:163], v[212:215], a[248:251], v[160:163]
v_mul_f32 v219, v219, v51
v_mfma_f32_16x16x32_bf16 v[164:167], v[212:215], a[252:255], v[164:167]
s_waitcnt lgkmcnt(4)
v_mfma_f32_16x16x32_bf16 v[72:75], v[200:203], a[0:3], 0
ds_read_b64_tr_b16 v[212:213], v231 offset:0
ds_read_b64_tr_b16 v[214:215], v231 offset:512
v_mfma_f32_16x16x32_bf16 v[76:79], v[200:203], a[4:7], 0
buffer_load_dwordx4 v237, s[4:7], s65 offen offset:1024 lds
v_mfma_f32_16x16x32_bf16 v[80:83], v[200:203], a[8:11], 0
v_exp_f32 v216, v216
v_mfma_f32_16x16x32_bf16 v[84:87], v[200:203], a[12:15], 0
s_waitcnt lgkmcnt(4)
v_mul_f32 v64, v64, v48
v_mfma_f32_16x16x32_bf16 v[88:91], v[204:207], a[0:3], 0
ds_read_b64_tr_b16 v[200:201], v228 offset:4096
ds_read_b64_tr_b16 v[202:203], v228 offset:4608
v_mfma_f32_16x16x32_bf16 v[92:95], v[204:207], a[4:7], 0
v_exp_f32 v217, v217
v_mfma_f32_16x16x32_bf16 v[96:99], v[204:207], a[8:11], 0
v_mul_f32 v65, v65, v49
v_mfma_f32_16x16x32_bf16 v[100:103], v[204:207], a[12:15], 0
s_waitcnt lgkmcnt(4)
v_mfma_f32_16x16x32_bf16 v[104:107], v[208:211], a[0:3], 0
ds_read_b64_tr_b16 v[204:205], v229 offset:4096
ds_read_b64_tr_b16 v[206:207], v229 offset:4608
v_mfma_f32_16x16x32_bf16 v[108:111], v[208:211], a[4:7], 0
v_exp_f32 v218, v218
v_mfma_f32_16x16x32_bf16 v[112:115], v[208:211], a[8:11], 0
v_mul_f32 v66, v66, v50
v_mfma_f32_16x16x32_bf16 v[116:119], v[208:211], a[12:15], 0
s_waitcnt lgkmcnt(4)
v_mfma_f32_16x16x32_bf16 v[120:123], v[212:215], a[0:3], 0
ds_read_b64_tr_b16 v[208:209], v230 offset:4096
ds_read_b64_tr_b16 v[210:211], v230 offset:4608
v_mfma_f32_16x16x32_bf16 v[124:127], v[212:215], a[4:7], 0
v_exp_f32 v219, v219
v_mfma_f32_16x16x32_bf16 v[128:131], v[212:215], a[8:11], 0
v_mul_f32 v67, v67, v51
v_add_f32 v216, 1.0, v216
v_mfma_f32_16x16x32_bf16 v[132:135], v[212:215], a[12:15], 0
s_waitcnt lgkmcnt(4)
v_add_f32 v217, 1.0, v217
v_mfma_f32_16x16x32_bf16 v[72:75], v[200:203], a[16:19], v[72:75]
ds_read_b64_tr_b16 v[212:213], v231 offset:4096
ds_read_b64_tr_b16 v[214:215], v231 offset:4608
v_mfma_f32_16x16x32_bf16 v[76:79], v[200:203], a[20:23], v[76:79]
buffer_load_dwordx4 v238, s[4:7], s65 offen offset:2048 lds
v_add_f32 v218, 1.0, v218
v_mfma_f32_16x16x32_bf16 v[80:83], v[200:203], a[24:27], v[80:83]
v_add_f32 v219, 1.0, v219
v_mfma_f32_16x16x32_bf16 v[84:87], v[200:203], a[28:31], v[84:87]
s_waitcnt lgkmcnt(4)
v_mfma_f32_16x16x32_bf16 v[88:91], v[204:207], a[16:19], v[88:91]
ds_read_b64_tr_b16 v[200:201], v228 offset:8192
ds_read_b64_tr_b16 v[202:203], v228 offset:8704
v_mfma_f32_16x16x32_bf16 v[92:95], v[204:207], a[20:23], v[92:95]
v_rcp_f32 v216, v216
v_mfma_f32_16x16x32_bf16 v[96:99], v[204:207], a[24:27], v[96:99]
v_rcp_f32 v217, v217
v_mfma_f32_16x16x32_bf16 v[100:103], v[204:207], a[28:31], v[100:103]
s_waitcnt lgkmcnt(4)
v_mfma_f32_16x16x32_bf16 v[104:107], v[208:211], a[16:19], v[104:107]
ds_read_b64_tr_b16 v[204:205], v229 offset:8192
ds_read_b64_tr_b16 v[206:207], v229 offset:8704
v_mfma_f32_16x16x32_bf16 v[108:111], v[208:211], a[20:23], v[108:111]
v_rcp_f32 v218, v218
v_mfma_f32_16x16x32_bf16 v[112:115], v[208:211], a[24:27], v[112:115]
v_rcp_f32 v219, v219
v_mfma_f32_16x16x32_bf16 v[116:119], v[208:211], a[28:31], v[116:119]
s_waitcnt lgkmcnt(4)
v_mul_f32 v64, v64, v216
v_mfma_f32_16x16x32_bf16 v[120:123], v[212:215], a[16:19], v[120:123]
ds_read_b64_tr_b16 v[208:209], v230 offset:8192
ds_read_b64_tr_b16 v[210:211], v230 offset:8704
v_mfma_f32_16x16x32_bf16 v[124:127], v[212:215], a[20:23], v[124:127]
v_mul_f32 v65, v65, v217
v_mul_f32 v66, v66, v218
v_mfma_f32_16x16x32_bf16 v[128:131], v[212:215], a[24:27], v[128:131]
v_mul_f32 v67, v67, v219
v_cvt_pk_bf16_f32 v220, v64, v65
v_mfma_f32_16x16x32_bf16 v[132:135], v[212:215], a[28:31], v[132:135]
s_waitcnt lgkmcnt(4)
v_cvt_pk_bf16_f32 v221, v66, v67
v_mfma_f32_16x16x32_bf16 v[72:75], v[200:203], a[32:35], v[72:75]
ds_read_b64_tr_b16 v[212:213], v231 offset:8192
ds_read_b64_tr_b16 v[214:215], v231 offset:8704
v_mfma_f32_16x16x32_bf16 v[76:79], v[200:203], a[36:39], v[76:79]
buffer_load_dwordx4 v239, s[4:7], s65 offen offset:3072 lds
buffer_store_dwordx2 v[220:221], v250, s[24:27], s54 offen offset:0 sc1
v_mfma_f32_16x16x32_bf16 v[80:83], v[200:203], a[40:43], v[80:83]
v_mul_f32 v222, v52, v52
v_mul_f32 v223, v53, v53
v_mfma_f32_16x16x32_bf16 v[84:87], v[200:203], a[44:47], v[84:87]
s_waitcnt lgkmcnt(4)
v_mul_f32 v224, v54, v54
v_mfma_f32_16x16x32_bf16 v[88:91], v[204:207], a[32:35], v[88:91]
ds_read_b64_tr_b16 v[200:201], v228 offset:12288
ds_read_b64_tr_b16 v[202:203], v228 offset:12800
v_mfma_f32_16x16x32_bf16 v[92:95], v[204:207], a[36:39], v[92:95]
v_mul_f32 v225, v55, v55
v_fmamk_f32 v222, v222, 0xbdd2d3e8, v4
v_mfma_f32_16x16x32_bf16 v[96:99], v[204:207], a[40:43], v[96:99]
v_fmamk_f32 v223, v223, 0xbdd2d3e8, v4
v_fmamk_f32 v224, v224, 0xbdd2d3e8, v4
v_mfma_f32_16x16x32_bf16 v[100:103], v[204:207], a[44:47], v[100:103]
s_waitcnt lgkmcnt(4)
v_fmamk_f32 v225, v225, 0xbdd2d3e8, v4
v_mfma_f32_16x16x32_bf16 v[104:107], v[208:211], a[32:35], v[104:107]
ds_read_b64_tr_b16 v[204:205], v229 offset:12288
ds_read_b64_tr_b16 v[206:207], v229 offset:12800
v_mfma_f32_16x16x32_bf16 v[108:111], v[208:211], a[36:39], v[108:111]
v_mul_f32 v222, v222, v52
v_mul_f32 v223, v223, v53
v_mfma_f32_16x16x32_bf16 v[112:115], v[208:211], a[40:43], v[112:115]
v_mul_f32 v224, v224, v54
v_mul_f32 v225, v225, v55
v_mfma_f32_16x16x32_bf16 v[116:119], v[208:211], a[44:47], v[116:119]
s_waitcnt lgkmcnt(4)
v_mfma_f32_16x16x32_bf16 v[120:123], v[212:215], a[32:35], v[120:123]
ds_read_b64_tr_b16 v[208:209], v230 offset:12288
ds_read_b64_tr_b16 v[210:211], v230 offset:12800
v_mfma_f32_16x16x32_bf16 v[124:127], v[212:215], a[36:39], v[124:127]
s_waitcnt vmcnt(8)
v_cmp_le_u32 vcc, 16, v240
s_cmp_eq_u64 vcc, exec
s_cbranch_scc0 KF_k_spin
KF_k_back:
v_mfma_f32_16x16x32_bf16 v[128:131], v[212:215], a[40:43], v[128:131]
v_exp_f32 v222, v222
v_mfma_f32_16x16x32_bf16 v[132:135], v[212:215], a[44:47], v[132:135]
s_waitcnt lgkmcnt(4)
v_mul_f32 v68, v68, v52
v_mfma_f32_16x16x32_bf16 v[72:75], v[200:203], a[48:51], v[72:75]
ds_read_b64_tr_b16 v[212:213], v231 offset:12288
ds_read_b64_tr_b16 v[214:215], v231 offset:12800
v_mfma_f32_16x16x32_bf16 v[76:79], v[200:203], a[52:55], v[76:79]
s_waitcnt vmcnt(6)
s_barrier
v_mfma_f32_16x16x32_bf16 v[80:83], v[200:203], a[56:59], v[80:83]
s_add_u32 m0, s42, 49152
s_add_u32 s65, s51, 3145856
v_mfma_f32_16x16x32_bf16 v[84:87], v[200:203], a[60:63], v[84:87]
s_waitcnt lgkmcnt(4)
v_mfma_f32_16x16x32_bf16 v[88:91], v[204:207], a[48:51], v[88:91]
ds_read_b64_tr_b16 v[200:201], v228 offset:16384
ds_read_b64_tr_b16 v[202:203], v228 offset:16896
v_mfma_f32_16x16x32_bf16 v[92:95], v[204:207], a[52:55], v[92:95]
buffer_load_dwordx4 v236, s[4:7], s65 offen offset:0 lds
v_mfma_f32_16x16x32_bf16 v[96:99], v[204:207], a[56:59], v[96:99]
v_exp_f32 v223, v223
v_mfma_f32_16x16x32_bf16 v[100:103], v[204:207], a[60:63], v[100:103]
s_waitcnt lgkmcnt(4)
v_mul_f32 v69, v69, v53
v_mfma_f32_16x16x32_bf16 v[104:107], v[208:211], a[48:51], v[104:107]
ds_read_b64_tr_b16 v[204:205], v229 offset:16384
ds_read_b64_tr_b16 v[206:207], v229 offset:16896
v_mfma_f32_16x16x32_bf16 v[108:111], v[208:211], a[52:55], v[108:111]
v_exp_f32 v224, v224
v_mfma_f32_16x16x32_bf16 v[112:115], v[208:211], a[56:59], v[112:115]
v_mul_f32 v70, v70, v54
v_mfma_f32_16x16x32_bf16 v[116:119], v[208:211], a[60:63], v[116:119]
s_waitcnt lgkmcnt(4)
v_mfma_f32_16x16x32_bf16 v[120:123], v[212:215], a[48:51], v[120:123]
ds_read_b64_tr_b16 v[208:209], v230 offset:16384
ds_read_b64_tr_b16 v[210:211], v230 offset:16896
v_mfma_f32_16x16x32_bf16 v[124:127], v[212:215], a[52:55], v[124:127]
v_exp_f32 v225, v225
v_mfma_f32_16x16x32_bf16 v[128:131], v[212:215], a[56:59], v[128:131]
v_mul_f32 v71, v71, v55
v_add_f32 v222, 1.0, v222
v_mfma_f32_16x16x32_bf16 v[132:135], v[212:215], a[60:63], v[132:135]
s_waitcnt lgkmcnt(4)
v_add_f32 v223, 1.0, v223
v_mfma_f32_16x16x32_bf16 v[72:75], v[200:203], a[64:67], v[72:75]
ds_read_b64_tr_b16 v[212:213], v231 offset:16384
ds_read_b64_tr_b16 v[214:215], v231 offset:16896
v_mfma_f32_16x16x32_bf16 v[76:79], v[200:203], a[68:71], v[76:79]
buffer_load_dwordx4 v237, s[4:7], s65 offen offset:1024 lds
v_add_f32 v224, 1.0, v224
v_mfma_f32_16x16x32_bf16 v[80:83], v[200:203], a[72:75], v[80:83]
v_add_f32 v225, 1.0, v225
v_mfma_f32_16x16x32_bf16 v[84:87], v[200:203], a[76:79], v[84:87]
s_waitcnt lgkmcnt(4)
v_mfma_f32_16x16x32_bf16 v[88:91], v[204:207], a[64:67], v[88:91]
ds_read_b64_tr_b16 v[200:201], v228 offset:20480
ds_read_b64_tr_b16 v[202:203], v228 offset:20992
v_mfma_f32_16x16x32_bf16 v[92:95], v[204:207], a[68:71], v[92:95]
v_rcp_f32 v222, v222
v_mfma_f32_16x16x32_bf16 v[96:99], v[204:207], a[72:75], v[96:99]
v_rcp_f32 v223, v223
v_mfma_f32_16x16x32_bf16 v[100:103], v[204:207], a[76:79], v[100:103]
s_waitcnt lgkmcnt(4)
v_mfma_f32_16x16x32_bf16 v[104:107], v[208:211], a[64:67], v[104:107]
ds_read_b64_tr_b16 v[204:205], v229 offset:20480
ds_read_b64_tr_b16 v[206:207], v229 offset:20992
v_mfma_f32_16x16x32_bf16 v[108:111], v[208:211], a[68:71], v[108:111]
v_rcp_f32 v224, v224
v_mfma_f32_16x16x32_bf16 v[112:115], v[208:211], a[72:75], v[112:115]
v_rcp_f32 v225, v225
v_mfma_f32_16x16x32_bf16 v[116:119], v[208:211], a[76:79], v[116:119]
s_waitcnt lgkmcnt(4)
v_mul_f32 v68, v68, v222
v_mfma_f32_16x16x32_bf16 v[120:123], v[212:215], a[64:67], v[120:123]
ds_read_b64_tr_b16 v[208:209], v230 offset:20480
ds_read_b64_tr_b16 v[210:211], v230 offset:20992
v_mfma_f32_16x16x32_bf16 v[124:127], v[212:215], a[68:71], v[124:127]
v_mul_f32 v69, v69, v223
v_mul_f32 v70, v70, v224
v_mfma_f32_16x16x32_bf16 v[128:131], v[212:215], a[72:75], v[128:131]
v_mul_f32 v71, v71, v225
v_cvt_pk_bf16_f32 v226, v68, v69
v_mfma_f32_16x16x32_bf16 v[132:135], v[212:215], a[76:79], v[132:135]
s_waitcnt lgkmcnt(4)
v_cvt_pk_bf16_f32 v227, v70, v71
v_mfma_f32_16x16x32_bf16 v[72:75], v[200:203], a[80:83], v[72:75]
ds_read_b64_tr_b16 v[212:213], v231 offset:20480
ds_read_b64_tr_b16 v[214:215], v231 offset:20992
v_mfma_f32_16x16x32_bf16 v[76:79], v[200:203], a[84:87], v[76:79]
buffer_load_dwordx4 v238, s[4:7], s65 offen offset:2048 lds
buffer_store_dwordx2 v[226:227], v251, s[24:27], s54 offen offset:0 sc1
v_mfma_f32_16x16x32_bf16 v[80:83], v[200:203], a[88:91], v[80:83]
v_mul_f32 v216, v168, v168
v_mul_f32 v217, v169, v169
v_mfma_f32_16x16x32_bf16 v[84:87], v[200:203], a[92:95], v[84:87]
s_waitcnt lgkmcnt(4)
v_mul_f32 v218, v170, v170
v_mfma_f32_16x16x32_bf16 v[88:91], v[204:207], a[80:83], v[88:91]
ds_read_b64_tr_b16 v[200:201], v228 offset:24576
ds_read_b64_tr_b16 v[202:203], v228 offset:25088
v_mfma_f32_16x16x32_bf16 v[92:95], v[204:207], a[84:87], v[92:95]
v_mul_f32 v219, v171, v171
v_fmamk_f32 v216, v216, 0xbdd2d3e8, v4
v_mfma_f32_16x16x32_bf16 v[96:99], v[204:207], a[88:91], v[96:99]
v_fmamk_f32 v217, v217, 0xbdd2d3e8, v4
v_fmamk_f32 v218, v218, 0xbdd2d3e8, v4
v_mfma_f32_16x16x32_bf16 v[100:103], v[204:207], a[92:95], v[100:103]
s_waitcnt lgkmcnt(4)
v_fmamk_f32 v219, v219, 0xbdd2d3e8, v4
v_mfma_f32_16x16x32_bf16 v[104:107], v[208:211], a[80:83], v[104:107]
ds_read_b64_tr_b16 v[204:205], v229 offset:24576
ds_read_b64_tr_b16 v[206:207], v229 offset:25088
v_mfma_f32_16x16x32_bf16 v[108:111], v[208:211], a[84:87], v[108:111]
v_mul_f32 v216, v216, v168
v_mul_f32 v217, v217, v169
v_mfma_f32_16x16x32_bf16 v[112:115], v[208:211], a[88:91], v[112:115]
v_mul_f32 v218, v218, v170
v_mul_f32 v219, v219, v171
v_mfma_f32_16x16x32_bf16 v[116:119], v[208:211], a[92:95], v[116:119]
s_waitcnt lgkmcnt(4)
v_mfma_f32_16x16x32_bf16 v[120:123], v[212:215], a[80:83], v[120:123]
ds_read_b64_tr_b16 v[208:209], v230 offset:24576
ds_read_b64_tr_b16 v[210:211], v230 offset:25088
v_mfma_f32_16x16x32_bf16 v[124:127], v[212:215], a[84:87], v[124:127]
v_exp_f32 v216, v216
v_mfma_f32_16x16x32_bf16 v[128:131], v[212:215], a[88:91], v[128:131]
v_mul_f32 v184, v184, v168
v_mfma_f32_16x16x32_bf16 v[132:135], v[212:215], a[92:95], v[132:135]
s_waitcnt lgkmcnt(4)
v_mfma_f32_16x16x32_bf16 v[72:75], v[200:203], a[96:99], v[72:75]
ds_read_b64_tr_b16 v[212:213], v231 offset:24576
ds_read_b64_tr_b16 v[214:215], v231 offset:25088
v_mfma_f32_16x16x32_bf16 v[76:79], v[200:203], a[100:103], v[76:79]
buffer_load_dwordx4 v239, s[4:7], s65 offen offset:3072 lds
v_mfma_f32_16x16x32_bf16 v[80:83], v[200:203], a[104:107], v[80:83]
v_exp_f32 v217, v217
v_mfma_f32_16x16x32_bf16 v[84:87], v[200:203], a[108:111], v[84:87]
s_waitcnt lgkmcnt(4)
v_mul_f32 v185, v185, v169
v_mfma_f32_16x16x32_bf16 v[88:91], v[204:207], a[96:99], v[88:91]
ds_read_b64_tr_b16 v[200:201], v228 offset:28672
ds_read_b64_tr_b16 v[202:203], v228 offset:29184
v_mfma_f32_16x16x32_bf16 v[92:95], v[204:207], a[100:103], v[92:95]
v_exp_f32 v218, v218
v_mfma_f32_16x16x32_bf16 v[96:99], v[204:207], a[104:107], v[96:99]
v_mul_f32 v186, v186, v170
v_mfma_f32_16x16x32_bf16 v[100:103], v[204:207], a[108:111], v[100:103]
s_waitcnt lgkmcnt(4)
v_mfma_f32_16x16x32_bf16 v[104:107], v[208:211], a[96:99], v[104:107]
ds_read_b64_tr_b16 v[204:205], v229 offset:28672
ds_read_b64_tr_b16 v[206:207], v229 offset:29184
v_mfma_f32_16x16x32_bf16 v[108:111], v[208:211], a[100:103], v[108:111]
v_exp_f32 v219, v219
v_mfma_f32_16x16x32_bf16 v[112:115], v[208:211], a[104:107], v[112:115]
v_mul_f32 v187, v187, v171
v_add_f32 v216, 1.0, v216
v_mfma_f32_16x16x32_bf16 v[116:119], v[208:211], a[108:111], v[116:119]
s_waitcnt lgkmcnt(4)
s_add_u32 s65, s41, 0
s_mov_b32 s66, s41
s_cmp_ge_u32 s40, 2
s_cselect_b32 m0, s66, s65
s_cselect_b32 s66, 0x40000000, s65
v_mfma_f32_16x16x32_bf16 v[120:123], v[212:215], a[96:99], v[120:123]
ds_read_b64_tr_b16 v[208:209], v230 offset:28672
ds_read_b64_tr_b16 v[210:211], v230 offset:29184
v_mfma_f32_16x16x32_bf16 v[124:127], v[212:215], a[100:103], v[124:127]
buffer_load_dwordx4 v2, s[20:23], s66 offen offset:0 sc1 lds
v_add_f32 v217, 1.0, v217
v_mfma_f32_16x16x32_bf16 v[128:131], v[212:215], a[104:107], v[128:131]
v_add_f32 v218, 1.0, v218
v_add_f32 v219, 1.0, v219
v_mfma_f32_16x16x32_bf16 v[132:135], v[212:215], a[108:111], v[132:135]
s_waitcnt lgkmcnt(4)
v_mfma_f32_16x16x32_bf16 v[72:75], v[200:203], a[112:115], v[72:75]
ds_read_b64_tr_b16 v[212:213], v231 offset:28672
ds_read_b64_tr_b16 v[214:215], v231 offset:29184
v_mfma_f32_16x16x32_bf16 v[76:79], v[200:203], a[116:119], v[76:79]
s_waitcnt vmcnt(7)
s_barrier
v_mfma_f32_16x16x32_bf16 v[80:83], v[200:203], a[120:123], v[80:83]
v_rcp_f32 v216, v216
v_mfma_f32_16x16x32_bf16 v[84:87], v[200:203], a[124:127], v[84:87]
s_waitcnt lgkmcnt(4)
v_mfma_f32_16x16x32_bf16 v[88:91], v[204:207], a[112:115], v[88:91]
ds_read_b64_tr_b16 v[200:201], v228 offset:32768
ds_read_b64_tr_b16 v[202:203], v228 offset:33280
v_mfma_f32_16x16x32_bf16 v[92:95], v[204:207], a[116:119], v[92:95]
buffer_load_dwordx4 v2, s[20:23], s66 offen offset:1024 sc1 lds
v_mfma_f32_16x16x32_bf16 v[96:99], v[204:207], a[120:123], v[96:99]
v_rcp_f32 v217, v217
v_mfma_f32_16x16x32_bf16 v[100:103], v[204:207], a[124:127], v[100:103]
s_waitcnt lgkmcnt(4)
v_mfma_f32_16x16x32_bf16 v[104:107], v[208:211], a[112:115], v[104:107]
ds_read_b64_tr_b16 v[204:205], v229 offset:32768
ds_read_b64_tr_b16 v[206:207], v229 offset:33280
v_mfma_f32_16x16x32_bf16 v[108:111], v[208:211], a[116:119], v[108:111]
buffer_load_dwordx4 v2, s[20:23], s66 offen offset:2048 sc1 lds
v_mfma_f32_16x16x32_bf16 v[112:115], v[208:211], a[120:123], v[112:115]
v_rcp_f32 v218, v218
v_mfma_f32_16x16x32_bf16 v[116:119], v[208:211], a[124:127], v[116:119]
s_waitcnt lgkmcnt(4)
v_mfma_f32_16x16x32_bf16 v[120:123], v[212:215], a[112:115], v[120:123]
ds_read_b64_tr_b16 v[208:209], v230 offset:32768
ds_read_b64_tr_b16 v[210:211], v230 offset:33280
v_mfma_f32_16x16x32_bf16 v[124:127], v[212:215], a[116:119], v[124:127]
buffer_load_dwordx4 v2, s[20:23], s66 offen offset:3072 sc1 lds
v_mfma_f32_16x16x32_bf16 v[128:131], v[212:215], a[120:123], v[128:131]
v_rcp_f32 v219, v219
v_mfma_f32_16x16x32_bf16 v[132:135], v[212:215], a[124:127], v[132:135]
s_waitcnt lgkmcnt(4)
s_add_u32 s65, s41, 16384
s_mov_b32 s66, s41
s_cmp_ge_u32 s40, 2
s_cselect_b32 m0, s66, s65
s_cselect_b32 s66, 0x40000000, s65
v_mfma_f32_16x16x32_bf16 v[72:75], v[200:203], a[128:131], v[72:75]
ds_read_b64_tr_b16 v[212:213], v231 offset:32768
ds_read_b64_tr_b16 v[214:215], v231 offset:33280
v_mfma_f32_16x16x32_bf16 v[76:79], v[200:203], a[132:135], v[76:79]
buffer_load_dwordx4 v2, s[20:23], s66 offen offset:0 sc1 lds
v_mul_f32 v184, v184, v216
v_mfma_f32_16x16x32_bf16 v[80:83], v[200:203], a[136:139], v[80:83]
v_mul_f32 v185, v185, v217
v_mul_f32 v186, v186, v218
v_mfma_f32_16x16x32_bf16 v[84:87], v[200:203], a[140:143], v[84:87]
s_waitcnt lgkmcnt(4)
v_mul_f32 v187, v187, v219
v_mfma_f32_16x16x32_bf16 v[88:91], v[204:207], a[128:131], v[88:91]
ds_read_b64_tr_b16 v[200:201], v228 offset:36864
ds_read_b64_tr_b16 v[202:203], v228 offset:37376
v_mfma_f32_16x16x32_bf16 v[92:95], v[204:207], a[132:135], v[92:95]
buffer_load_dwordx4 v2, s[20:23], s66 offen offset:1024 sc1 lds
v_cvt_pk_bf16_f32 v220, v184, v185
v_mfma_f32_16x16x32_bf16 v[96:99], v[204:207], a[136:139], v[96:99]
v_cvt_pk_bf16_f32 v221, v186, v187
buffer_store_dwordx2 v[220:221], v248, s[24:27], s54 offen offset:512 sc1
v_mfma_f32_16x16x32_bf16 v[100:103], v[204:207], a[140:143], v[100:103]
s_waitcnt lgkmcnt(4)
v_mul_f32 v222, v172, v172
v_mfma_f32_16x16x32_bf16 v[104:107], v[208:211], a[128:131], v[104:107]
ds_read_b64_tr_b16 v[204:205], v229 offset:36864
ds_read_b64_tr_b16 v[206:207], v229 offset:37376
v_mfma_f32_16x16x32_bf16 v[108:111], v[208:211], a[132:135], v[108:111]
buffer_load_dwordx4 v2, s[20:23], s66 offen offset:2048 sc1 lds
v_mul_f32 v223, v173, v173
v_mfma_f32_16x16x32_bf16 v[112:115], v[208:211], a[136:139], v[112:115]
v_mul_f32 v224, v174, v174
v_mul_f32 v225, v175, v175
v_mfma_f32_16x16x32_bf16 v[116:119], v[208:211], a[140:143], v[116:119]
s_waitcnt lgkmcnt(4)
v_fmamk_f32 v222, v222, 0xbdd2d3e8, v4
v_mfma_f32_16x16x32_bf16 v[120:123], v[212:215], a[128:131], v[120:123]
ds_read_b64_tr_b16 v[208:209], v230 offset:36864
ds_read_b64_tr_b16 v[210:211], v230 offset:37376
v_mfma_f32_16x16x32_bf16 v[124:127], v[212:215], a[132:135], v[124:127]
buffer_load_dwordx4 v2, s[20:23], s66 offen offset:3072 sc1 lds
v_fmamk_f32 v223, v223, 0xbdd2d3e8, v4
v_mfma_f32_16x16x32_bf16 v[128:131], v[212:215], a[136:139], v[128:131]
v_fmamk_f32 v224, v224, 0xbdd2d3e8, v4
v_fmamk_f32 v225, v225, 0xbdd2d3e8, v4
v_mfma_f32_16x16x32_bf16 v[132:135], v[212:215], a[140:143], v[132:135]
s_waitcnt lgkmcnt(4)
s_add_u32 s66, s83, 32768
s_mov_b32 m0, s66
v_mfma_f32_16x16x32_bf16 v[72:75], v[200:203], a[144:147], v[72:75]
ds_read_b64_tr_b16 v[212:213], v231 offset:36864
ds_read_b64_tr_b16 v[214:215], v231 offset:37376
v_mfma_f32_16x16x32_bf16 v[76:79], v[200:203], a[148:151], v[76:79]
buffer_load_dwordx4 v2, s[20:23], s66 offen offset:0 sc1 lds
v_mul_f32 v222, v222, v172
v_mfma_f32_16x16x32_bf16 v[80:83], v[200:203], a[152:155], v[80:83]
v_mul_f32 v223, v223, v173
v_mul_f32 v224, v224, v174
v_mfma_f32_16x16x32_bf16 v[84:87], v[200:203], a[156:159], v[84:87]
s_waitcnt lgkmcnt(4)
v_mul_f32 v225, v225, v175
v_mfma_f32_16x16x32_bf16 v[88:91], v[204:207], a[144:147], v[88:91]
ds_read_b64_tr_b16 v[200:201], v228 offset:40960
ds_read_b64_tr_b16 v[202:203], v228 offset:41472
v_mfma_f32_16x16x32_bf16 v[92:95], v[204:207], a[148:151], v[92:95]
buffer_load_dwordx4 v2, s[20:23], s66 offen offset:1024 sc1 lds
v_mfma_f32_16x16x32_bf16 v[96:99], v[204:207], a[152:155], v[96:99]
v_exp_f32 v222, v222
v_mfma_f32_16x16x32_bf16 v[100:103], v[204:207], a[156:159], v[100:103]
s_waitcnt lgkmcnt(4)
v_mul_f32 v188, v188, v172
v_mfma_f32_16x16x32_bf16 v[104:107], v[208:211], a[144:147], v[104:107]
ds_read_b64_tr_b16 v[204:205], v229 offset:40960
ds_read_b64_tr_b16 v[206:207], v229 offset:41472
v_mfma_f32_16x16x32_bf16 v[108:111], v[208:211], a[148:151], v[108:111]
buffer_load_dwordx4 v2, s[20:23], s66 offen offset:2048 sc1 lds
v_mfma_f32_16x16x32_bf16 v[112:115], v[208:211], a[152:155], v[112:115]
v_exp_f32 v223, v223
v_mfma_f32_16x16x32_bf16 v[116:119], v[208:211], a[156:159], v[116:119]
s_waitcnt lgkmcnt(4)
v_mul_f32 v189, v189, v173
v_mfma_f32_16x16x32_bf16 v[120:123], v[212:215], a[144:147], v[120:123]
ds_read_b64_tr_b16 v[208:209], v230 offset:40960
ds_read_b64_tr_b16 v[210:211], v230 offset:41472
v_mfma_f32_16x16x32_bf16 v[124:127], v[212:215], a[148:151], v[124:127]
buffer_load_dwordx4 v2, s[20:23], s66 offen offset:3072 sc1 lds
v_mfma_f32_16x16x32_bf16 v[128:131], v[212:215], a[152:155], v[128:131]
v_exp_f32 v224, v224
v_mfma_f32_16x16x32_bf16 v[132:135], v[212:215], a[156:159], v[132:135]
s_waitcnt lgkmcnt(4)
s_add_u32 s66, s83, 49152
s_mov_b32 m0, s66
v_mfma_f32_16x16x32_bf16 v[72:75], v[200:203], a[160:163], v[72:75]
ds_read_b64_tr_b16 v[212:213], v231 offset:40960
ds_read_b64_tr_b16 v[214:215], v231 offset:41472
v_mfma_f32_16x16x32_bf16 v[76:79], v[200:203], a[164:167], v[76:79]
buffer_load_dwordx4 v2, s[20:23], s66 offen offset:0 sc1 lds
v_mul_f32 v190, v190, v174
v_mfma_f32_16x16x32_bf16 v[80:83], v[200:203], a[168:171], v[80:83]
v_exp_f32 v225, v225
v_mfma_f32_16x16x32_bf16 v[84:87], v[200:203], a[172:175], v[84:87]
s_waitcnt lgkmcnt(4)
v_mul_f32 v191, v191, v175
v_mfma_f32_16x16x32_bf16 v[88:91], v[204:207], a[160:163], v[88:91]
ds_read_b64_tr_b16 v[200:201], v228 offset:45056
ds_read_b64_tr_b16 v[202:203], v228 offset:45568
v_mfma_f32_16x16x32_bf16 v[92:95], v[204:207], a[164:167], v[92:95]
buffer_load_dwordx4 v2, s[20:23], s66 offen offset:1024 sc1 lds
v_add_f32 v222, 1.0, v222
v_mfma_f32_16x16x32_bf16 v[96:99], v[204:207], a[168:171], v[96:99]
v_add_f32 v223, 1.0, v223
v_add_f32 v224, 1.0, v224
v_mfma_f32_16x16x32_bf16 v[100:103], v[204:207], a[172:175], v[100:103]
s_waitcnt lgkmcnt(4)
v_add_f32 v225, 1.0, v225
v_mfma_f32_16x16x32_bf16 v[104:107], v[208:211], a[160:163], v[104:107]
ds_read_b64_tr_b16 v[204:205], v229 offset:45056
ds_read_b64_tr_b16 v[206:207], v229 offset:45568
v_mfma_f32_16x16x32_bf16 v[108:111], v[208:211], a[164:167], v[108:111]
buffer_load_dwordx4 v2, s[20:23], s66 offen offset:2048 sc1 lds
v_mfma_f32_16x16x32_bf16 v[112:115], v[208:211], a[168:171], v[112:115]
v_rcp_f32 v222, v222
v_mfma_f32_16x16x32_bf16 v[116:119], v[208:211], a[172:175], v[116:119]
s_waitcnt lgkmcnt(4)
v_mfma_f32_16x16x32_bf16 v[120:123], v[212:215], a[160:163], v[120:123]
ds_read_b64_tr_b16 v[208:209], v230 offset:45056
ds_read_b64_tr_b16 v[210:211], v230 offset:45568
v_mfma_f32_16x16x32_bf16 v[124:127], v[212:215], a[164:167], v[124:127]
buffer_load_dwordx4 v2, s[20:23], s66 offen offset:3072 sc1 lds
v_mfma_f32_16x16x32_bf16 v[128:131], v[212:215], a[168:171], v[128:131]
v_rcp_f32 v223, v223
v_mfma_f32_16x16x32_bf16 v[132:135], v[212:215], a[172:175], v[132:135]
s_waitcnt lgkmcnt(4)
s_add_u32 s66, s83, 65536
s_mov_b32 m0, s66
v_mfma_f32_16x16x32_bf16 v[72:75], v[200:203], a[176:179], v[72:75]
ds_read_b64_tr_b16 v[212:213], v231 offset:45056
ds_read_b64_tr_b16 v[214:215], v231 offset:45568
v_mfma_f32_16x16x32_bf16 v[76:79], v[200:203], a[180:183], v[76:79]
s_waitcnt vmcnt(17)
s_barrier
v_mfma_f32_16x16x32_bf16 v[80:83], v[200:203], a[184:187], v[80:83]
v_rcp_f32 v224, v224
v_mfma_f32_16x16x32_bf16 v[84:87], v[200:203], a[188:191], v[84:87]
s_waitcnt lgkmcnt(4)
v_mfma_f32_16x16x32_bf16 v[88:91], v[204:207], a[176:179], v[88:91]
ds_read_b64_tr_b16 v[200:201], v228 offset:49152
ds_read_b64_tr_b16 v[202:203], v228 offset:49664
v_mfma_f32_16x16x32_bf16 v[92:95], v[204:207], a[180:183], v[92:95]
buffer_load_dwordx4 v2, s[20:23], s66 offen offset:0 sc1 lds
v_mfma_f32_16x16x32_bf16 v[96:99], v[204:207], a[184:187], v[96:99]
v_rcp_f32 v225, v225
v_mfma_f32_16x16x32_bf16 v[100:103], v[204:207], a[188:191], v[100:103]
s_waitcnt lgkmcnt(4)
v_mul_f32 v188, v188, v222
v_mfma_f32_16x16x32_bf16 v[104:107], v[208:211], a[176:179], v[104:107]
ds_read_b64_tr_b16 v[204:205], v229 offset:49152
ds_read_b64_tr_b16 v[206:207], v229 offset:49664
v_mfma_f32_16x16x32_bf16 v[108:111], v[208:211], a[180:183], v[108:111]
buffer_load_dwordx4 v2, s[20:23], s66 offen offset:1024 sc1 lds
v_mul_f32 v189, v189, v223
v_mfma_f32_16x16x32_bf16 v[112:115], v[208:211], a[184:187], v[112:115]
v_mul_f32 v190, v190, v224
v_mul_f32 v191, v191, v225
v_mfma_f32_16x16x32_bf16 v[116:119], v[208:211], a[188:191], v[116:119]
s_waitcnt lgkmcnt(4)
v_cvt_pk_bf16_f32 v226, v188, v189
v_mfma_f32_16x16x32_bf16 v[120:123], v[212:215], a[176:179], v[120:123]
ds_read_b64_tr_b16 v[208:209], v230 offset:49152
ds_read_b64_tr_b16 v[210:211], v230 offset:49664
v_mfma_f32_16x16x32_bf16 v[124:127], v[212:215], a[180:183], v[124:127]
buffer_load_dwordx4 v2, s[20:23], s66 offen offset:2048 sc1 lds
v_cvt_pk_bf16_f32 v227, v190, v191
v_mfma_f32_16x16x32_bf16 v[128:131], v[212:215], a[184:187], v[128:131]
buffer_store_dwordx2 v[226:227], v249, s[24:27], s54 offen offset:512 sc1
v_mul_f32 v216, v176, v176
v_mfma_f32_16x16x32_bf16 v[132:135], v[212:215], a[188:191], v[132:135]
s_waitcnt lgkmcnt(4)
v_mul_f32 v217, v177, v177
v_mfma_f32_16x16x32_bf16 v[72:75], v[200:203], a[192:195], v[72:75]
ds_read_b64_tr_b16 v[212:213], v231 offset:49152
ds_read_b64_tr_b16 v[214:215], v231 offset:49664
v_mfma_f32_16x16x32_bf16 v[76:79], v[200:203], a[196:199], v[76:79]
buffer_load_dwordx4 v2, s[20:23], s66 offen offset:3072 sc1 lds
v_mul_f32 v218, v178, v178
v_mfma_f32_16x16x32_bf16 v[80:83], v[200:203], a[200:203], v[80:83]
v_mul_f32 v219, v179, v179
v_fmamk_f32 v216, v216, 0xbdd2d3e8, v4
v_mfma_f32_16x16x32_bf16 v[84:87], v[200:203], a[204:207], v[84:87]
s_waitcnt lgkmcnt(4)
s_add_u32 s66, s83, 81920
s_mov_b32 m0, s66
v_mfma_f32_16x16x32_bf16 v[88:91], v[204:207], a[192:195], v[88:91]
ds_read_b64_tr_b16 v[200:201], v228 offset:53248
ds_read_b64_tr_b16 v[202:203], v228 offset:53760
v_mfma_f32_16x16x32_bf16 v[92:95], v[204:207], a[196:199], v[92:95]
buffer_load_dwordx4 v2, s[20:23], s66 offen offset:0 sc1 lds
v_fmamk_f32 v217, v217, 0xbdd2d3e8, v4
v_mfma_f32_16x16x32_bf16 v[96:99], v[204:207], a[200:203], v[96:99]
v_fmamk_f32 v218, v218, 0xbdd2d3e8, v4
v_fmamk_f32 v219, v219, 0xbdd2d3e8, v4
v_mfma_f32_16x16x32_bf16 v[100:103], v[204:207], a[204:207], v[100:103]
s_waitcnt lgkmcnt(4)
v_mul_f32 v216, v216, v176
v_mfma_f32_16x16x32_bf16 v[104:107], v[208:211], a[192:195], v[104:107]
ds_read_b64_tr_b16 v[204:205], v229 offset:53248
ds_read_b64_tr_b16 v[206:207], v229 offset:53760
v_mfma_f32_16x16x32_bf16 v[108:111], v[208:211], a[196:199], v[108:111]
buffer_load_dwordx4 v2, s[20:23], s66 offen offset:1024 sc1 lds
v_mul_f32 v217, v217, v177
v_mfma_f32_16x16x32_bf16 v[112:115], v[208:211], a[200:203], v[112:115]
v_mul_f32 v218, v218, v178
v_mul_f32 v219, v219, v179
v_mfma_f32_16x16x32_bf16 v[116:119], v[208:211], a[204:207], v[116:119]
s_waitcnt lgkmcnt(4)
v_mfma_f32_16x16x32_bf16 v[120:123], v[212:215], a[192:195], v[120:123]
ds_read_b64_tr_b16 v[208:209], v230 offset:53248
ds_read_b64_tr_b16 v[210:211], v230 offset:53760
v_mfma_f32_16x16x32_bf16 v[124:127], v[212:215], a[196:199], v[124:127]
buffer_load_dwordx4 v2, s[20:23], s66 offen offset:2048 sc1 lds
v_mfma_f32_16x16x32_bf16 v[128:131], v[212:215], a[200:203], v[128:131]
v_exp_f32 v216, v216
v_mfma_f32_16x16x32_bf16 v[132:135], v[212:215], a[204:207], v[132:135]
s_waitcnt lgkmcnt(4)
v_mul_f32 v192, v192, v176
v_mfma_f32_16x16x32_bf16 v[72:75], v[200:203], a[208:211], v[72:75]
ds_read_b64_tr_b16 v[212:213], v231 offset:53248
ds_read_b64_tr_b16 v[214:215], v231 offset:53760
v_mfma_f32_16x16x32_bf16 v[76:79], v[200:203], a[212:215], v[76:79]
buffer_load_dwordx4 v2, s[20:23], s66 offen offset:3072 sc1 lds
v_mfma_f32_16x16x32_bf16 v[80:83], v[200:203], a[216:219], v[80:83]
v_exp_f32 v217, v217
v_mfma_f32_16x16x32_bf16 v[84:87], v[200:203], a[220:223], v[84:87]
s_waitcnt lgkmcnt(4)
s_add_u32 s66, s83, 98304
s_mov_b32 m0, s66
v_mfma_f32_16x16x32_bf16 v[88:91], v[204:207], a[208:211], v[88:91]
ds_read_b64_tr_b16 v[200:201], v228 offset:57344
ds_read_b64_tr_b16 v[202:203], v228 offset:57856
v_mfma_f32_16x16x32_bf16 v[92:95], v[204:207], a[212:215], v[92:95]
buffer_load_dwordx4 v2, s[20:23], s66 offen offset:0 sc1 lds
v_mul_f32 v193, v193, v177
v_mfma_f32_16x16x32_bf16 v[96:99], v[204:207], a[216:219], v[96:99]
v_exp_f32 v218, v218
v_mfma_f32_16x16x32_bf16 v[100:103], v[204:207], a[220:223], v[100:103]
s_waitcnt lgkmcnt(4)
v_mul_f32 v194, v194, v178
v_mfma_f32_16x16x32_bf16 v[104:107], v[208:211], a[208:211], v[104:107]
ds_read_b64_tr_b16 v[204:205], v229 offset:57344
ds_read_b64_tr_b16 v[206:207], v229 offset:57856
v_mfma_f32_16x16x32_bf16 v[108:111], v[208:211], a[212:215], v[108:111]
buffer_load_dwordx4 v2, s[20:23], s66 offen offset:1024 sc1 lds
v_mfma_f32_16x16x32_bf16 v[112:115], v[208:211], a[216:219], v[112:115]
v_exp_f32 v219, v219
v_mfma_f32_16x16x32_bf16 v[116:119], v[208:211], a[220:223], v[116:119]
s_waitcnt lgkmcnt(4)
v_mul_f32 v195, v195, v179
v_mfma_f32_16x16x32_bf16 v[120:123], v[212:215], a[208:211], v[120:123]
ds_read_b64_tr_b16 v[208:209], v230 offset:57344
ds_read_b64_tr_b16 v[210:211], v230 offset:57856
v_mfma_f32_16x16x32_bf16 v[124:127], v[212:215], a[212:215], v[124:127]
buffer_load_dwordx4 v2, s[20:23], s66 offen offset:2048 sc1 lds
v_add_f32 v216, 1.0, v216
v_mfma_f32_16x16x32_bf16 v[128:131], v[212:215], a[216:219], v[128:131]
v_add_f32 v217, 1.0, v217
v_add_f32 v218, 1.0, v218
v_mfma_f32_16x16x32_bf16 v[132:135], v[212:215], a[220:223], v[132:135]
s_waitcnt lgkmcnt(4)
v_add_f32 v219, 1.0, v219
v_mfma_f32_16x16x32_bf16 v[72:75], v[200:203], a[224:227], v[72:75]
ds_read_b64_tr_b16 v[212:213], v231 offset:57344
ds_read_b64_tr_b16 v[214:215], v231 offset:57856
v_mfma_f32_16x16x32_bf16 v[76:79], v[200:203], a[228:231], v[76:79]
buffer_load_dwordx4 v2, s[20:23], s66 offen offset:3072 sc1 lds
v_mfma_f32_16x16x32_bf16 v[80:83], v[200:203], a[232:235], v[80:83]
v_rcp_f32 v216, v216
v_mfma_f32_16x16x32_bf16 v[84:87], v[200:203], a[236:239], v[84:87]
s_waitcnt lgkmcnt(4)
v_mfma_f32_16x16x32_bf16 v[88:91], v[204:207], a[224:227], v[88:91]
ds_read_b64_tr_b16 v[200:201], v228 offset:61440
ds_read_b64_tr_b16 v[202:203], v228 offset:61952
v_mfma_f32_16x16x32_bf16 v[92:95], v[204:207], a[228:231], v[92:95]
v_rcp_f32 v217, v217
v_mfma_f32_16x16x32_bf16 v[96:99], v[204:207], a[232:235], v[96:99]
v_rcp_f32 v218, v218
v_mfma_f32_16x16x32_bf16 v[100:103], v[204:207], a[236:239], v[100:103]
s_waitcnt lgkmcnt(4)
v_mfma_f32_16x16x32_bf16 v[104:107], v[208:211], a[224:227], v[104:107]
ds_read_b64_tr_b16 v[204:205], v229 offset:61440
ds_read_b64_tr_b16 v[206:207], v229 offset:61952
v_mfma_f32_16x16x32_bf16 v[108:111], v[208:211], a[228:231], v[108:111]
v_rcp_f32 v219, v219
v_mfma_f32_16x16x32_bf16 v[112:115], v[208:211], a[232:235], v[112:115]
v_mul_f32 v192, v192, v216
v_mul_f32 v193, v193, v217
v_mfma_f32_16x16x32_bf16 v[116:119], v[208:211], a[236:239], v[116:119]
s_waitcnt lgkmcnt(4)
v_mul_f32 v194, v194, v218
v_mfma_f32_16x16x32_bf16 v[120:123], v[212:215], a[224:227], v[120:123]
ds_read_b64_tr_b16 v[208:209], v230 offset:61440
ds_read_b64_tr_b16 v[210:211], v230 offset:61952
v_mfma_f32_16x16x32_bf16 v[124:127], v[212:215], a[228:231], v[124:127]
v_mul_f32 v195, v195, v219
v_cvt_pk_bf16_f32 v220, v192, v193
v_mfma_f32_16x16x32_bf16 v[128:131], v[212:215], a[232:235], v[128:131]
v_cvt_pk_bf16_f32 v221, v194, v195
buffer_store_dwordx2 v[220:221], v250, s[24:27], s54 offen offset:512 sc1
v_mfma_f32_16x16x32_bf16 v[132:135], v[212:215], a[236:239], v[132:135]
s_waitcnt lgkmcnt(4)
v_mul_f32 v222, v180, v180
v_mfma_f32_16x16x32_bf16 v[72:75], v[200:203], a[240:243], v[72:75]
ds_read_b64_tr_b16 v[212:213], v231 offset:61440
ds_read_b64_tr_b16 v[214:215], v231 offset:61952
v_mfma_f32_16x16x32_bf16 v[76:79], v[200:203], a[244:247], v[76:79]
v_mul_f32 v223, v181, v181
v_mul_f32 v224, v182, v182
v_mfma_f32_16x16x32_bf16 v[80:83], v[200:203], a[248:251], v[80:83]
v_mul_f32 v225, v183, v183
v_fmamk_f32 v222, v222, 0xbdd2d3e8, v4
v_mfma_f32_16x16x32_bf16 v[84:87], v[200:203], a[252:255], v[84:87]
s_waitcnt lgkmcnt(4)
v_fmamk_f32 v223, v223, 0xbdd2d3e8, v4
v_mfma_f32_16x16x32_bf16 v[88:91], v[204:207], a[240:243], v[88:91]
v_fmamk_f32 v224, v224, 0xbdd2d3e8, v4
v_fmamk_f32 v225, v225, 0xbdd2d3e8, v4
v_mfma_f32_16x16x32_bf16 v[92:95], v[204:207], a[244:247], v[92:95]
v_mul_f32 v222, v222, v180
v_mul_f32 v223, v223, v181
v_mfma_f32_16x16x32_bf16 v[96:99], v[204:207], a[248:251], v[96:99]
v_mul_f32 v224, v224, v182
v_mul_f32 v225, v225, v183
v_mfma_f32_16x16x32_bf16 v[100:103], v[204:207], a[252:255], v[100:103]
s_waitcnt lgkmcnt(2)
v_mfma_f32_16x16x32_bf16 v[104:107], v[208:211], a[240:243], v[104:107]
v_exp_f32 v222, v222
v_mfma_f32_16x16x32_bf16 v[108:111], v[208:211], a[244:247], v[108:111]
v_mul_f32 v196, v196, v180
v_mfma_f32_16x16x32_bf16 v[112:115], v[208:211], a[248:251], v[112:115]
v_exp_f32 v223, v223
v_mfma_f32_16x16x32_bf16 v[116:119], v[208:211], a[252:255], v[116:119]
s_waitcnt lgkmcnt(0)
v_mul_f32 v197, v197, v181
v_mfma_f32_16x16x32_bf16 v[120:123], v[212:215], a[240:243], v[120:123]
v_exp_f32 v224, v224
v_mfma_f32_16x16x32_bf16 v[124:127], v[212:215], a[244:247], v[124:127]
v_mul_f32 v198, v198, v182
v_mfma_f32_16x16x32_bf16 v[128:131], v[212:215], a[248:251], v[128:131]
v_exp_f32 v225, v225
v_mfma_f32_16x16x32_bf16 v[132:135], v[212:215], a[252:255], v[132:135]
v_mul_f32 v199, v199, v183
v_add_f32 v222, 1.0, v222
v_add_f32 v223, 1.0, v223
v_add_f32 v224, 1.0, v224
v_add_f32 v225, 1.0, v225
v_rcp_f32 v222, v222
v_rcp_f32 v223, v223
v_rcp_f32 v224, v224
v_rcp_f32 v225, v225
v_mul_f32 v196, v196, v222
v_mul_f32 v197, v197, v223
v_mul_f32 v198, v198, v224
v_mul_f32 v199, v199, v225
v_cvt_pk_bf16_f32 v226, v196, v197
v_cvt_pk_bf16_f32 v227, v198, v199
buffer_store_dwordx2 v[226:227], v251, s[24:27], s54 offen offset:512 sc1
v_mul_f32 v216, v136, v136
v_mul_f32 v217, v137, v137
v_mul_f32 v218, v138, v138
v_mul_f32 v219, v139, v139
v_fmamk_f32 v216, v216, 0xbdd2d3e8, v4
v_fmamk_f32 v217, v217, 0xbdd2d3e8, v4
v_fmamk_f32 v218, v218, 0xbdd2d3e8, v4
v_fmamk_f32 v219, v219, 0xbdd2d3e8, v4
v_mul_f32 v216, v216, v136
v_mul_f32 v217, v217, v137
v_mul_f32 v218, v218, v138
v_mul_f32 v219, v219, v139
v_exp_f32 v216, v216
v_mul_f32 v152, v152, v136
v_exp_f32 v217, v217
v_mul_f32 v153, v153, v137
v_exp_f32 v218, v218
v_mul_f32 v154, v154, v138
v_exp_f32 v219, v219
v_mul_f32 v155, v155, v139
v_add_f32 v216, 1.0, v216
v_add_f32 v217, 1.0, v217
v_add_f32 v218, 1.0, v218
v_add_f32 v219, 1.0, v219
v_rcp_f32 v216, v216
v_rcp_f32 v217, v217
v_rcp_f32 v218, v218
v_rcp_f32 v219, v219
v_mul_f32 v152, v152, v216
v_mul_f32 v153, v153, v217
v_mul_f32 v154, v154, v218
v_mul_f32 v155, v155, v219
v_cvt_pk_bf16_f32 v220, v152, v153
v_cvt_pk_bf16_f32 v221, v154, v155
buffer_store_dwordx2 v[220:221], v248, s[24:27], s55 offen offset:0 sc1
v_lshrrev_b32 v244, 4, v1
v_lshlrev_b32 v244, 8, v244
v_cvt_pk_bf16_f32 v40, v72, v73
v_cvt_pk_bf16_f32 v41, v74, v75
v_cvt_pk_bf16_f32 v42, v88, v89
v_cvt_pk_bf16_f32 v43, v90, v91
v_cvt_pk_bf16_f32 v56, v104, v105
v_cvt_pk_bf16_f32 v57, v106, v107
v_cvt_pk_bf16_f32 v58, v120, v121
v_cvt_pk_bf16_f32 v59, v122, v123
s_waitcnt vmcnt(24)
s_barrier
ds_read_b128 v[200:203], v244 offset:0
ds_read_b128 v[204:207], v244 offset:1024
ds_read_b128 v[208:211], v244 offset:2048
ds_read_b128 v[212:215], v244 offset:3072
ds_read_b128 a[144:147], v252 offset:0
ds_read_b128 a[148:151], v252 offset:1024
ds_read_b128 a[152:155], v252 offset:2048
ds_read_b128 a[156:159], v252 offset:3072
ds_read_b128 a[160:163], v252 offset:4096
ds_read_b128 a[164:167], v252 offset:5120
ds_read_b128 a[168:171], v252 offset:6144
ds_read_b128 a[172:175], v252 offset:7168
v_cvt_pk_bf16_f32 v44, v76, v77
v_cvt_pk_bf16_f32 v45, v78, v79
v_cvt_pk_bf16_f32 v46, v92, v93
v_cvt_pk_bf16_f32 v47, v94, v95
v_cvt_pk_bf16_f32 v60, v108, v109
v_cvt_pk_bf16_f32 v61, v110, v111
v_cvt_pk_bf16_f32 v62, v124, v125
v_cvt_pk_bf16_f32 v63, v126, v127
v_cvt_pk_bf16_f32 v48, v80, v81
v_cvt_pk_bf16_f32 v49, v82, v83
v_cvt_pk_bf16_f32 v50, v96, v97
v_cvt_pk_bf16_f32 v51, v98, v99
v_cvt_pk_bf16_f32 v64, v112, v113
v_cvt_pk_bf16_f32 v65, v114, v115
v_cvt_pk_bf16_f32 v66, v128, v129
v_cvt_pk_bf16_f32 v67, v130, v131
v_cvt_pk_bf16_f32 v52, v84, v85
v_cvt_pk_bf16_f32 v53, v86, v87
v_cvt_pk_bf16_f32 v54, v100, v101
v_cvt_pk_bf16_f32 v55, v102, v103
v_cvt_pk_bf16_f32 v68, v116, v117
v_cvt_pk_bf16_f32 v69, v118, v119
v_cvt_pk_bf16_f32 v70, v132, v133
v_cvt_pk_bf16_f32 v71, v134, v135
s_waitcnt lgkmcnt(11)
v_xor_b32 v200, 0x80008000, v200
v_xor_b32 v201, 0x80008000, v201
v_xor_b32 v202, 0x80008000, v202
v_xor_b32 v203, 0x80008000, v203
s_waitcnt lgkmcnt(10)
v_xor_b32 v204, 0x80008000, v204
v_xor_b32 v205, 0x80008000, v205
v_xor_b32 v206, 0x80008000, v206
v_xor_b32 v207, 0x80008000, v207
s_waitcnt lgkmcnt(9)
v_xor_b32 v208, 0x80008000, v208
v_xor_b32 v209, 0x80008000, v209
v_xor_b32 v210, 0x80008000, v210
v_xor_b32 v211, 0x80008000, v211
s_waitcnt lgkmcnt(8)
v_xor_b32 v212, 0x80008000, v212
v_xor_b32 v213, 0x80008000, v213
v_xor_b32 v214, 0x80008000, v214
v_xor_b32 v215, 0x80008000, v215
v_mov_b32 v184, 0x3f803f80
v_mov_b32 v185, 0x3f803f80
v_mov_b32 v186, 0x3f803f80
v_mov_b32 v187, 0x3f803f80
v_mfma_f32_16x16x32_bf16 v[168:171], v[200:203], v[8:11], 0
v_mul_f32 v222, v140, v140
v_mul_f32 v223, v141, v141
v_mfma_f32_16x16x32_bf16 v[172:175], v[200:203], v[12:15], 0
v_mul_f32 v224, v142, v142
v_mul_f32 v225, v143, v143
v_mfma_f32_16x16x32_bf16 v[176:179], v[200:203], v[16:19], 0
v_fmamk_f32 v222, v222, 0xbdd2d3e8, v4
v_fmamk_f32 v223, v223, 0xbdd2d3e8, v4
v_mfma_f32_16x16x32_bf16 v[180:183], v[200:203], v[20:23], 0
v_fmamk_f32 v224, v224, 0xbdd2d3e8, v4
v_fmamk_f32 v225, v225, 0xbdd2d3e8, v4
v_mfma_f32_16x16x32_bf16 v[168:171], v[204:207], v[24:27], v[168:171]
v_mul_f32 v222, v222, v140
v_mul_f32 v223, v223, v141
v_mfma_f32_16x16x32_bf16 v[172:175], v[204:207], v[28:31], v[172:175]
v_mul_f32 v224, v224, v142
v_mul_f32 v225, v225, v143
v_mfma_f32_16x16x32_bf16 v[176:179], v[204:207], v[32:35], v[176:179]
v_exp_f32 v222, v222
v_mfma_f32_16x16x32_bf16 v[180:183], v[204:207], v[36:39], v[180:183]
v_mul_f32 v156, v156, v140
v_mfma_f32_16x16x32_bf16 v[168:171], v[208:211], v[40:43], v[168:171]
v_exp_f32 v223, v223
v_mfma_f32_16x16x32_bf16 v[172:175], v[208:211], v[44:47], v[172:175]
v_mul_f32 v157, v157, v141
v_mfma_f32_16x16x32_bf16 v[176:179], v[208:211], v[48:51], v[176:179]
v_exp_f32 v224, v224
v_mfma_f32_16x16x32_bf16 v[180:183], v[208:211], v[52:55], v[180:183]
v_mul_f32 v158, v158, v142
v_mfma_f32_16x16x32_bf16 v[168:171], v[212:215], v[56:59], v[168:171]
v_exp_f32 v225, v225
v_mfma_f32_16x16x32_bf16 v[172:175], v[212:215], v[60:63], v[172:175]
v_mul_f32 v159, v159, v143
v_add_f32 v222, 1.0, v222
v_mfma_f32_16x16x32_bf16 v[176:179], v[212:215], v[64:67], v[176:179]
v_add_f32 v223, 1.0, v223
v_add_f32 v224, 1.0, v224
v_mfma_f32_16x16x32_bf16 v[180:183], v[212:215], v[68:71], v[180:183]
v_add_f32 v225, 1.0, v225
v_rcp_f32 v222, v222
s_sub_u32 s84, s61, 196608
s_waitcnt lgkmcnt(4)
v_mfma_f32_16x16x32_bf16 v[72:75], a[144:147], v[8:11], v[168:171]
v_mov_b32 v254, v252
v_add_u32 v252, 0x8000, v252
v_mfma_f32_16x16x32_bf16 v[76:79], a[144:147], v[12:15], v[172:175]
v_and_b32 v252, 0x1ffff, v252
v_mfma_f32_16x16x32_bf16 v[80:83], a[144:147], v[16:19], v[176:179]
v_rcp_f32 v223, v223
v_mfma_f32_16x16x32_bf16 v[84:87], a[144:147], v[20:23], v[180:183]
ds_read_b128 a[144:147], v253 offset:0
v_mfma_f32_16x16x32_bf16 v[72:75], a[148:151], v[24:27], v[72:75]
v_rcp_f32 v224, v224
v_mfma_f32_16x16x32_bf16 v[76:79], a[148:151], v[28:31], v[76:79]
v_rcp_f32 v225, v225
v_mfma_f32_16x16x32_bf16 v[80:83], a[148:151], v[32:35], v[80:83]
v_mul_f32 v156, v156, v222
v_mul_f32 v157, v157, v223
v_mfma_f32_16x16x32_bf16 v[84:87], a[148:151], v[36:39], v[84:87]
ds_read_b128 a[148:151], v253 offset:1024
v_mul_f32 v158, v158, v224
v_mfma_f32_16x16x32_bf16 v[72:75], a[152:155], v[40:43], v[72:75]
v_mul_f32 v159, v159, v225
v_cvt_pk_bf16_f32 v226, v156, v157
v_mfma_f32_16x16x32_bf16 v[76:79], a[152:155], v[44:47], v[76:79]
v_cvt_pk_bf16_f32 v227, v158, v159
v_mfma_f32_16x16x32_bf16 v[80:83], a[152:155], v[48:51], v[80:83]
buffer_store_dwordx2 v[226:227], v249, s[24:27], s55 offen offset:0 sc1
v_mul_f32 v216, v144, v144
v_mfma_f32_16x16x32_bf16 v[84:87], a[152:155], v[52:55], v[84:87]
ds_read_b128 a[152:155], v253 offset:2048
v_mul_f32 v217, v145, v145
v_mfma_f32_16x16x32_bf16 v[72:75], a[156:159], v[56:59], v[72:75]
v_mul_f32 v218, v146, v146
v_mul_f32 v219, v147, v147
v_mfma_f32_16x16x32_bf16 v[76:79], a[156:159], v[60:63], v[76:79]
v_fmamk_f32 v216, v216, 0xbdd2d3e8, v4
v_fmamk_f32 v217, v217, 0xbdd2d3e8, v4
v_mfma_f32_16x16x32_bf16 v[80:83], a[156:159], v[64:67], v[80:83]
v_fmamk_f32 v218, v218, 0xbdd2d3e8, v4
v_fmamk_f32 v219, v219, 0xbdd2d3e8, v4
v_mfma_f32_16x16x32_bf16 v[84:87], a[156:159], v[68:71], v[84:87]
ds_read_b128 a[156:159], v253 offset:3072
s_waitcnt lgkmcnt(4)
v_mfma_f32_16x16x32_bf16 v[88:91], a[160:163], v[8:11], v[168:171]
v_mul_f32 v216, v216, v144
v_mul_f32 v217, v217, v145
v_mfma_f32_16x16x32_bf16 v[92:95], a[160:163], v[12:15], v[172:175]
v_mul_f32 v218, v218, v146
v_mul_f32 v219, v219, v147
v_mfma_f32_16x16x32_bf16 v[96:99], a[160:163], v[16:19], v[176:179]
v_exp_f32 v216, v216
v_mfma_f32_16x16x32_bf16 v[100:103], a[160:163], v[20:23], v[180:183]
ds_read_b128 a[160:163], v253 offset:4096
v_mul_f32 v160, v160, v144
v_mfma_f32_16x16x32_bf16 v[88:91], a[164:167], v[24:27], v[88:91]
v_exp_f32 v217, v217
v_mfma_f32_16x16x32_bf16 v[92:95], a[164:167], v[28:31], v[92:95]
v_mul_f32 v161, v161, v145
v_mfma_f32_16x16x32_bf16 v[96:99], a[164:167], v[32:35], v[96:99]
v_exp_f32 v218, v218
v_mfma_f32_16x16x32_bf16 v[100:103], a[164:167], v[36:39], v[100:103]
ds_read_b128 a[164:167], v253 offset:5120
v_mul_f32 v162, v162, v146
v_mfma_f32_16x16x32_bf16 v[88:91], a[168:171], v[40:43], v[88:91]
v_exp_f32 v219, v219
v_mfma_f32_16x16x32_bf16 v[92:95], a[168:171], v[44:47], v[92:95]
v_mul_f32 v163, v163, v147
v_add_f32 v216, 1.0, v216
v_mfma_f32_16x16x32_bf16 v[96:99], a[168:171], v[48:51], v[96:99]
v_add_f32 v217, 1.0, v217
v_add_f32 v218, 1.0, v218
v_mfma_f32_16x16x32_bf16 v[100:103], a[168:171], v[52:55], v[100:103]
ds_read_b128 a[168:171], v253 offset:6144
v_add_f32 v219, 1.0, v219
v_mfma_f32_16x16x32_bf16 v[88:91], a[172:175], v[56:59], v[88:91]
v_rcp_f32 v216, v216
v_mfma_f32_16x16x32_bf16 v[92:95], a[172:175], v[60:63], v[92:95]
v_rcp_f32 v217, v217
v_mfma_f32_16x16x32_bf16 v[96:99], a[172:175], v[64:67], v[96:99]
v_rcp_f32 v218, v218
v_rcp_f32 v219, v219
v_mul_f32 v160, v160, v216
v_mul_f32 v161, v161, v217
v_mul_f32 v162, v162, v218
v_mul_f32 v163, v163, v219
v_cvt_pk_bf16_f32 v220, v160, v161
v_cvt_pk_bf16_f32 v221, v162, v163
buffer_store_dwordx2 v[220:221], v250, s[24:27], s55 offen offset:0 sc1
v_mul_f32 v222, v148, v148
v_mul_f32 v223, v149, v149
v_mul_f32 v224, v150, v150
v_mul_f32 v225, v151, v151
v_fmamk_f32 v222, v222, 0xbdd2d3e8, v4
v_fmamk_f32 v223, v223, 0xbdd2d3e8, v4
v_fmamk_f32 v224, v224, 0xbdd2d3e8, v4
v_fmamk_f32 v225, v225, 0xbdd2d3e8, v4
v_mul_f32 v222, v222, v148
v_mul_f32 v223, v223, v149
v_mul_f32 v224, v224, v150
v_mul_f32 v225, v225, v151
v_exp_f32 v222, v222
v_mul_f32 v164, v164, v148
v_exp_f32 v223, v223
v_mul_f32 v165, v165, v149
v_exp_f32 v224, v224
v_mul_f32 v166, v166, v150
v_exp_f32 v225, v225
v_mul_f32 v167, v167, v151
v_add_f32 v222, 1.0, v222
v_add_f32 v223, 1.0, v223
v_add_f32 v224, 1.0, v224
v_add_f32 v225, 1.0, v225
v_rcp_f32 v222, v222
v_rcp_f32 v223, v223
v_rcp_f32 v224, v224
v_rcp_f32 v225, v225
v_mul_f32 v164, v164, v222
v_mul_f32 v165, v165, v223
v_mul_f32 v166, v166, v224
v_mul_f32 v167, v167, v225
v_cvt_pk_bf16_f32 v226, v164, v165
v_cvt_pk_bf16_f32 v227, v166, v167
buffer_store_dwordx2 v[226:227], v251, s[24:27], s55 offen offset:0 sc1
v_mfma_f32_16x16x32_bf16 v[100:103], a[172:175], v[68:71], v[100:103]
ds_read_b128 a[172:175], v253 offset:7168
s_waitcnt vmcnt(12)
s_barrier
s_cmp_lg_u32 s45, 0
s_cbranch_scc1 KF_a_ne0
s_waitcnt lgkmcnt(4)
v_mfma_f32_16x16x32_bf16 v[112:115], a[144:147], v[16:19], v[176:179]
v_mov_b32 v255, v253
v_add_u32 v253, 0x8000, v253
v_mfma_f32_16x16x32_bf16 v[116:119], a[144:147], v[20:23], v[180:183]
ds_read_b128 a[144:147], v252 offset:0
v_and_b32 v253, 0x1ffff, v253
v_mfma_f32_16x16x32_bf16 v[112:115], a[148:151], v[32:35], v[112:115]
ds_read_b128 a[176:179], v254 offset:8192
s_and_b32 m0, s59, 0x1ffff
v_mfma_f32_16x16x32_bf16 v[116:119], a[148:151], v[36:39], v[116:119]
ds_read_b128 a[148:151], v252 offset:1024
buffer_load_dwordx4 v2, s[20:23], s59 offen offset:0 sc1 lds
v_mfma_f32_16x16x32_bf16 v[112:115], a[152:155], v[48:51], v[112:115]
ds_read_b128 a[180:183], v254 offset:9216
buffer_load_dwordx4 v2, s[20:23], s59 offen offset:1024 sc1 lds
v_mfma_f32_16x16x32_bf16 v[116:119], a[152:155], v[52:55], v[116:119]
ds_read_b128 a[152:155], v252 offset:2048
v_mfma_f32_16x16x32_bf16 v[112:115], a[156:159], v[64:67], v[112:115]
ds_read_b128 a[184:187], v254 offset:10240
v_mfma_f32_16x16x32_bf16 v[116:119], a[156:159], v[68:71], v[116:119]
ds_read_b128 a[156:159], v252 offset:3072
s_waitcnt lgkmcnt(7)
v_mfma_f32_16x16x32_bf16 v[128:131], a[160:163], v[16:19], v[176:179]
ds_read_b128 a[188:191], v254 offset:11264
buffer_load_dwordx4 v2, s[20:23], s59 offen offset:2048 sc1 lds
v_mfma_f32_16x16x32_bf16 v[132:135], a[160:163], v[20:23], v[180:183]
ds_read_b128 a[160:163], v252 offset:4096
v_mfma_f32_16x16x32_bf16 v[128:131], a[164:167], v[32:35], v[128:131]
ds_read_b128 a[192:195], v254 offset:12288
buffer_load_dwordx4 v2, s[20:23], s59 offen offset:3072 sc1 lds
v_mfma_f32_16x16x32_bf16 v[132:135], a[164:167], v[36:39], v[132:135]
ds_read_b128 a[164:167], v252 offset:5120
v_mfma_f32_16x16x32_bf16 v[128:131], a[168:171], v[48:51], v[128:131]
ds_read_b128 a[196:199], v254 offset:13312
v_mfma_f32_16x16x32_bf16 v[132:135], a[168:171], v[52:55], v[132:135]
ds_read_b128 a[168:171], v252 offset:6144
v_mfma_f32_16x16x32_bf16 v[128:131], a[172:175], v[64:67], v[128:131]
ds_read_b128 a[200:203], v254 offset:14336
v_mfma_f32_16x16x32_bf16 v[132:135], a[172:175], v[68:71], v[132:135]
s_add_u32 s59, s59, 16384
ds_read_b128 a[172:175], v252 offset:7168
v_exp_f32 v72, v72
v_exp_f32 v73, v73
v_exp_f32 v74, v74
v_cndmask_b32 v72, 0, v72, s[70:71]
v_cndmask_b32 v73, 0, v73, s[72:73]
v_cvt_pk_bf16_f32 v136, v72, v73
v_exp_f32 v75, v75
v_exp_f32 v76, v76
v_cndmask_b32 v74, 0, v74, s[74:75]
v_cndmask_b32 v75, 0, v75, s[76:77]
v_cvt_pk_bf16_f32 v137, v74, v75
v_exp_f32 v77, v77
v_exp_f32 v78, v78
v_cvt_pk_bf16_f32 v140, v76, v77
v_exp_f32 v79, v79
v_exp_f32 v80, v80
v_cvt_pk_bf16_f32 v141, v78, v79
v_exp_f32 v81, v81
v_exp_f32 v82, v82
v_cvt_pk_bf16_f32 v144, v80, v81
v_exp_f32 v83, v83
v_exp_f32 v84, v84
v_cvt_pk_bf16_f32 v145, v82, v83
v_exp_f32 v85, v85
v_exp_f32 v86, v86
v_cvt_pk_bf16_f32 v148, v84, v85
v_exp_f32 v87, v87
v_mov_b32 v138, 0
v_mov_b32 v139, 0
v_exp_f32 v92, v92
v_cvt_pk_bf16_f32 v149, v86, v87
v_exp_f32 v93, v93
v_exp_f32 v94, v94
v_cndmask_b32 v92, 0, v92, s[70:71]
v_cndmask_b32 v93, 0, v93, s[72:73]
v_cvt_pk_bf16_f32 v142, v92, v93
v_exp_f32 v95, v95
v_exp_f32 v96, v96
v_cndmask_b32 v94, 0, v94, s[74:75]
v_cndmask_b32 v95, 0, v95, s[76:77]
v_cvt_pk_bf16_f32 v143, v94, v95
v_exp_f32 v97, v97
v_exp_f32 v98, v98
v_cvt_pk_bf16_f32 v146, v96, v97
v_exp_f32 v99, v99
v_exp_f32 v100, v100
v_cvt_pk_bf16_f32 v147, v98, v99
v_exp_f32 v101, v101
v_exp_f32 v102, v102
v_cvt_pk_bf16_f32 v150, v100, v101
v_exp_f32 v103, v103
s_nop 0
v_cvt_pk_bf16_f32 v151, v102, v103
s_waitcnt lgkmcnt(7)
v_mfma_f32_16x16x32_bf16 v[80:83], a[144:147], v[16:19], v[176:179]
s_and_b32 m0, s59, 0x1ffff
v_mfma_f32_16x16x32_bf16 v[84:87], a[144:147], v[20:23], v[180:183]
ds_read_b128 a[204:207], v254 offset:15360
v_mov_b32 v254, v252
v_mfma_f32_16x16x32_bf16 a[0:3], a[176:179], v[136:139], 0
v_add_u32 v252, 0x8000, v252
v_and_b32 v252, 0x1ffff, v252
v_mfma_f32_16x16x32_bf16 a[32:35], a[176:179], v[140:143], 0
ds_read_b128 a[144:147], v253 offset:0
buffer_load_dwordx4 v2, s[20:23], s59 offen offset:0 sc1 lds
v_mfma_f32_16x16x32_bf16 a[64:67], a[176:179], v[144:147], 0
v_exp_f32 v112, v112
v_mfma_f32_16x16x32_bf16 a[96:99], a[176:179], v[148:151], 0
v_exp_f32 v113, v113
v_mfma_f32_16x16x32_bf16 v[80:83], a[148:151], v[32:35], v[80:83]
v_exp_f32 v114, v114
v_mfma_f32_16x16x32_bf16 v[84:87], a[148:151], v[36:39], v[84:87]
ds_read_b128 a[176:179], v255 offset:8192
v_cvt_pk_bf16_f32 v160, v112, v113
v_mfma_f32_16x16x32_bf16 a[4:7], a[180:183], v[136:139], 0
v_exp_f32 v115, v115
v_mfma_f32_16x16x32_bf16 a[36:39], a[180:183], v[140:143], 0
ds_read_b128 a[148:151], v253 offset:1024
s_mov_b32 s4, s86
v_mfma_f32_16x16x32_bf16 a[68:71], a[180:183], v[144:147], 0
v_exp_f32 v116, v116
v_mfma_f32_16x16x32_bf16 a[100:103], a[180:183], v[148:151], 0
v_cvt_pk_bf16_f32 v161, v114, v115
s_mov_b32 s5, s87
v_mfma_f32_16x16x32_bf16 a[128:131], v[184:187], v[136:139], 0
v_exp_f32 v117, v117
v_mfma_f32_16x16x32_bf16 v[80:83], a[152:155], v[48:51], v[80:83]
buffer_load_dwordx4 v2, s[20:23], s59 offen offset:1024 sc1 lds
s_mov_b32 s6, 0x400000
v_mfma_f32_16x16x32_bf16 v[84:87], a[152:155], v[52:55], v[84:87]
ds_read_b128 a[180:183], v255 offset:9216
s_mov_b32 s7, 0x20000
v_mfma_f32_16x16x32_bf16 a[8:11], a[184:187], v[136:139], 0
v_exp_f32 v118, v118
v_mfma_f32_16x16x32_bf16 a[40:43], a[184:187], v[140:143], 0
ds_read_b128 a[152:155], v253 offset:2048
v_cvt_pk_bf16_f32 v164, v116, v117
v_mfma_f32_16x16x32_bf16 a[72:75], a[184:187], v[144:147], 0
v_exp_f32 v119, v119
v_mfma_f32_16x16x32_bf16 a[104:107], a[184:187], v[148:151], 0
v_exp_f32 v128, v128
v_mfma_f32_16x16x32_bf16 v[80:83], a[156:159], v[64:67], v[80:83]
v_cvt_pk_bf16_f32 v165, v118, v119
s_mov_b32 s8, s92
v_mfma_f32_16x16x32_bf16 v[84:87], a[156:159], v[68:71], v[84:87]
ds_read_b128 a[184:187], v255 offset:10240
s_mov_b32 s9, s93
v_mfma_f32_16x16x32_bf16 a[12:15], a[188:191], v[136:139], 0
v_exp_f32 v129, v129
v_mfma_f32_16x16x32_bf16 a[44:47], a[188:191], v[140:143], 0
ds_read_b128 a[156:159], v253 offset:3072
s_mov_b32 s10, 0x158000
v_mfma_f32_16x16x32_bf16 a[76:79], a[188:191], v[144:147], 0
v_exp_f32 v130, v130
v_mfma_f32_16x16x32_bf16 a[108:111], a[188:191], v[148:151], 0
v_cvt_pk_bf16_f32 v162, v128, v129
s_mov_b32 s11, 0x20000
v_mfma_f32_16x16x32_bf16 a[132:135], v[184:187], v[140:143], 0
s_waitcnt lgkmcnt(7)
buffer_load_dwordx4 v2, s[20:23], s59 offen offset:2048 sc1 lds
v_mfma_f32_16x16x32_bf16 v[96:99], a[160:163], v[16:19], v[176:179]
v_exp_f32 v131, v131
v_mfma_f32_16x16x32_bf16 v[100:103], a[160:163], v[20:23], v[180:183]
ds_read_b128 a[188:191], v255 offset:11264
s_bfe_u32 s53, s2, 0x20001
v_mfma_f32_16x16x32_bf16 a[16:19], a[192:195], v[136:139], 0
v_exp_f32 v132, v132
v_mfma_f32_16x16x32_bf16 a[48:51], a[192:195], v[140:143], 0
ds_read_b128 a[160:163], v253 offset:4096
v_cvt_pk_bf16_f32 v163, v130, v131
v_mfma_f32_16x16x32_bf16 a[80:83], a[192:195], v[144:147], 0
v_exp_f32 v133, v133
v_mfma_f32_16x16x32_bf16 a[112:115], a[192:195], v[148:151], 0
v_exp_f32 v134, v134
v_mfma_f32_16x16x32_bf16 v[96:99], a[164:167], v[32:35], v[96:99]
v_cvt_pk_bf16_f32 v166, v132, v133
s_sub_u32 s65, 15, s43
v_mfma_f32_16x16x32_bf16 v[100:103], a[164:167], v[36:39], v[100:103]
ds_read_b128 a[192:195], v255 offset:12288
s_bitcmp1_b32 s2, 3
v_mfma_f32_16x16x32_bf16 a[20:23], a[196:199], v[136:139], 0
v_exp_f32 v135, v135
v_mfma_f32_16x16x32_bf16 a[52:55], a[196:199], v[140:143], 0
ds_read_b128 a[164:167], v253 offset:5120
v_cvt_pk_bf16_f32 v167, v134, v135
v_mfma_f32_16x16x32_bf16 a[84:87], a[196:199], v[144:147], 0
s_cselect_b32 s55, s65, s43
s_bfe_u32 s56, s2, 0x20004
v_mfma_f32_16x16x32_bf16 a[116:119], a[196:199], v[148:151], 0
buffer_load_dwordx4 v2, s[20:23], s59 offen offset:3072 sc1 lds
s_lshl_b32 s54, s55, 2
v_mfma_f32_16x16x32_bf16 a[136:139], v[184:187], v[144:147], 0
s_add_u32 s54, s54, s56
s_mul_i32 s47, s53, 11264
v_mfma_f32_16x16x32_bf16 v[96:99], a[168:171], v[48:51], v[96:99]
s_lshl_b32 s48, s53, 15
s_lshl_b32 s65, s56, 8
v_mfma_f32_16x16x32_bf16 v[100:103], a[168:171], v[52:55], v[100:103]
ds_read_b128 a[196:199], v255 offset:13312
s_mul_i32 s66, s53, 360448
v_mfma_f32_16x16x32_bf16 a[24:27], a[200:203], v[136:139], 0
s_add_u32 s49, s65, s66
s_lshl_b32 s66, s53, 20
v_mfma_f32_16x16x32_bf16 a[56:59], a[200:203], v[140:143], 0
ds_read_b128 a[168:171], v253 offset:6144
s_add_u32 s50, s65, s66
v_mfma_f32_16x16x32_bf16 a[88:91], a[200:203], v[144:147], 0
s_and_b32 s65, s43, 1
s_lshl_b32 s65, s65, 16
v_mfma_f32_16x16x32_bf16 a[120:123], a[200:203], v[148:151], 0
s_add_u32 s51, s65, s41
s_xor_b32 s52, s51, 0x10000
v_mfma_f32_16x16x32_bf16 v[96:99], a[172:175], v[64:67], v[96:99]
v_and_b32 v245, 31, v1
v_lshlrev_b32 v245, 7, v245
v_mfma_f32_16x16x32_bf16 v[100:103], a[172:175], v[68:71], v[100:103]
ds_read_b128 a[200:203], v255 offset:14336
v_mov_b32 v244, 0
v_mfma_f32_16x16x32_bf16 a[28:31], a[204:207], v[136:139], 0
s_mov_b32 s69, 35840
s_lshl_b32 s65, s55, 3
v_mfma_f32_16x16x32_bf16 a[60:63], a[204:207], v[140:143], 0
ds_read_b128 a[172:175], v253 offset:7168
s_lshl_b32 s66, s40, 1
v_mfma_f32_16x16x32_bf16 a[92:95], a[204:207], v[144:147], 0
s_add_u32 s65, s65, s66
s_lshl_b32 s66, s65, 17
v_mfma_f32_16x16x32_bf16 a[124:127], a[204:207], v[148:151], 0
v_add_u32 v234, s66, v2
v_add_u32 v235, 130048, v234
s_mul_i32 s66, s65, 45056
v_add_u32 v236, s66, v2
v_add_u32 v237, 44032, v236
v_lshrrev_b32 v246, 3, v1
v_and_b32 v247, 7, v1
v_and_b32 v248, 6, v246
v_xor_b32 v247, v247, v248
v_lshlrev_b32 v246, 10, v246
v_lshl_add_u32 v246, v247, 4, v246
s_and_b32 s65, s40, 1
s_lshl_b32 s65, s65, 14
s_lshr_b32 s66, s40, 1
s_lshl_b32 s66, s66, 7
s_add_u32 s65, s65, s66
v_add_u32 v238, s65, v246
v_add_u32 v239, 7168, v238
v_mfma_f32_16x16x32_bf16 a[140:143], v[184:187], v[148:151], 0
s_add_u32 s59, s59, 16384
s_waitcnt vmcnt(12)
s_barrier
s_lshl_b32 s65, s43, 2
s_add_u32 s65, s65, s40
s_add_u32 s65, s65, 280
s_lshl_b32 s65, s65, 7
s_waitcnt vmcnt(8)
buffer_atomic_add v6, v5, s[32:35], s65 offen sc1
s_branch KF_after_e
KF_a_ne0:
s_waitcnt lgkmcnt(4)
v_mfma_f32_16x16x32_bf16 v[104:107], a[144:147], v[8:11], v[168:171]
v_mov_b32 v255, v253
v_add_u32 v253, 0x8000, v253
v_mfma_f32_16x16x32_bf16 v[108:111], a[144:147], v[12:15], v[172:175]
v_and_b32 v253, 0x1ffff, v253
s_and_b32 m0, s59, 0x1ffff
v_mfma_f32_16x16x32_bf16 v[112:115], a[144:147], v[16:19], v[176:179]
buffer_load_dwordx4 v2, s[20:23], s59 offen offset:0 sc1 lds
v_mfma_f32_16x16x32_bf16 v[116:119], a[144:147], v[20:23], v[180:183]
ds_read_b128 a[144:147], v252 offset:0
v_mfma_f32_16x16x32_bf16 v[104:107], a[148:151], v[24:27], v[104:107]
ds_read_b128 a[176:179], v254 offset:8192
v_mfma_f32_16x16x32_bf16 v[108:111], a[148:151], v[28:31], v[108:111]
v_exp_f32 v72, v72
v_mfma_f32_16x16x32_bf16 v[112:115], a[148:151], v[32:35], v[112:115]
v_exp_f32 v73, v73
v_mfma_f32_16x16x32_bf16 v[116:119], a[148:151], v[36:39], v[116:119]
ds_read_b128 a[148:151], v252 offset:1024
v_mfma_f32_16x16x32_bf16 v[104:107], a[152:155], v[40:43], v[104:107]
ds_read_b128 a[180:183], v254 offset:9216
buffer_load_dwordx4 v2, s[20:23], s59 offen offset:1024 sc1 lds
v_mfma_f32_16x16x32_bf16 v[108:111], a[152:155], v[44:47], v[108:111]
v_exp_f32 v74, v74
v_mfma_f32_16x16x32_bf16 v[112:115], a[152:155], v[48:51], v[112:115]
v_cvt_pk_bf16_f32 v136, v72, v73
v_mfma_f32_16x16x32_bf16 v[116:119], a[152:155], v[52:55], v[116:119]
ds_read_b128 a[152:155], v252 offset:2048
v_mfma_f32_16x16x32_bf16 v[104:107], a[156:159], v[56:59], v[104:107]
ds_read_b128 a[184:187], v254 offset:10240
v_mfma_f32_16x16x32_bf16 v[108:111], a[156:159], v[60:63], v[108:111]
v_exp_f32 v75, v75
v_mfma_f32_16x16x32_bf16 v[112:115], a[156:159], v[64:67], v[112:115]
v_exp_f32 v76, v76
v_mfma_f32_16x16x32_bf16 v[116:119], a[156:159], v[68:71], v[116:119]
ds_read_b128 a[156:159], v252 offset:3072
s_waitcnt lgkmcnt(7)
v_mfma_f32_16x16x32_bf16 v[120:123], a[160:163], v[8:11], v[168:171]
ds_read_b128 a[188:191], v254 offset:11264
buffer_load_dwordx4 v2, s[20:23], s59 offen offset:2048 sc1 lds
v_mfma_f32_16x16x32_bf16 v[124:127], a[160:163], v[12:15], v[172:175]
v_cvt_pk_bf16_f32 v137, v74, v75
v_mfma_f32_16x16x32_bf16 v[128:131], a[160:163], v[16:19], v[176:179]
v_exp_f32 v77, v77
v_mfma_f32_16x16x32_bf16 v[132:135], a[160:163], v[20:23], v[180:183]
ds_read_b128 a[160:163], v252 offset:4096
v_mfma_f32_16x16x32_bf16 v[120:123], a[164:167], v[24:27], v[120:123]
ds_read_b128 a[192:195], v254 offset:12288
v_mfma_f32_16x16x32_bf16 v[124:127], a[164:167], v[28:31], v[124:127]
v_exp_f32 v78, v78
v_mfma_f32_16x16x32_bf16 v[128:131], a[164:167], v[32:35], v[128:131]
buffer_load_dwordx4 v2, s[20:23], s59 offen offset:3072 sc1 lds
v_cvt_pk_bf16_f32 v140, v76, v77
v_mfma_f32_16x16x32_bf16 v[132:135], a[164:167], v[36:39], v[132:135]
ds_read_b128 a[164:167], v252 offset:5120
v_mfma_f32_16x16x32_bf16 v[120:123], a[168:171], v[40:43], v[120:123]
ds_read_b128 a[196:199], v254 offset:13312
v_mfma_f32_16x16x32_bf16 v[124:127], a[168:171], v[44:47], v[124:127]
v_exp_f32 v79, v79
v_mfma_f32_16x16x32_bf16 v[128:131], a[168:171], v[48:51], v[128:131]
v_exp_f32 v80, v80
v_mfma_f32_16x16x32_bf16 v[132:135], a[168:171], v[52:55], v[132:135]
ds_read_b128 a[168:171], v252 offset:6144
v_cvt_pk_bf16_f32 v141, v78, v79
v_mfma_f32_16x16x32_bf16 v[120:123], a[172:175], v[56:59], v[120:123]
ds_read_b128 a[200:203], v254 offset:14336
v_mfma_f32_16x16x32_bf16 v[124:127], a[172:175], v[60:63], v[124:127]
v_exp_f32 v81, v81
v_mfma_f32_16x16x32_bf16 v[128:131], a[172:175], v[64:67], v[128:131]
v_exp_f32 v82, v82
v_mfma_f32_16x16x32_bf16 v[132:135], a[172:175], v[68:71], v[132:135]
s_add_u32 s59, s59, 16384
ds_read_b128 a[172:175], v252 offset:7168
v_cvt_pk_bf16_f32 v144, v80, v81
v_exp_f32 v83, v83
v_exp_f32 v84, v84
v_cvt_pk_bf16_f32 v145, v82, v83
v_exp_f32 v85, v85
v_exp_f32 v86, v86
v_cvt_pk_bf16_f32 v148, v84, v85
v_exp_f32 v87, v87
v_exp_f32 v88, v88
v_cvt_pk_bf16_f32 v149, v86, v87
v_exp_f32 v89, v89
v_exp_f32 v90, v90
v_cvt_pk_bf16_f32 v138, v88, v89
v_exp_f32 v91, v91
v_exp_f32 v92, v92
v_cvt_pk_bf16_f32 v139, v90, v91
v_exp_f32 v93, v93
v_exp_f32 v94, v94
v_cvt_pk_bf16_f32 v142, v92, v93
v_exp_f32 v95, v95
v_exp_f32 v96, v96
v_cvt_pk_bf16_f32 v143, v94, v95
v_exp_f32 v97, v97
v_exp_f32 v98, v98
v_cvt_pk_bf16_f32 v146, v96, v97
v_exp_f32 v99, v99
v_exp_f32 v100, v100
v_cvt_pk_bf16_f32 v147, v98, v99
v_exp_f32 v101, v101
v_exp_f32 v102, v102
v_cvt_pk_bf16_f32 v150, v100, v101
v_exp_f32 v103, v103
s_nop 0
v_cvt_pk_bf16_f32 v151, v102, v103
s_cmp_lg_u32 s45, 1
s_cbranch_scc1 KF_a_ge2
s_waitcnt lgkmcnt(7)
v_mfma_f32_16x16x32_bf16 v[80:83], a[144:147], v[16:19], v[176:179]
s_and_b32 m0, s59, 0x1ffff
v_mfma_f32_16x16x32_bf16 v[84:87], a[144:147], v[20:23], v[180:183]
ds_read_b128 a[204:207], v254 offset:15360
v_mov_b32 v254, v252
v_mfma_f32_16x16x32_bf16 a[0:3], a[176:179], v[136:139], 0
v_add_u32 v252, 0x8000, v252
v_and_b32 v252, 0x1ffff, v252
v_mfma_f32_16x16x32_bf16 a[32:35], a[176:179], v[140:143], 0
ds_read_b128 a[144:147], v253 offset:0
buffer_load_dwordx4 v2, s[20:23], s59 offen offset:0 sc1 lds
v_mfma_f32_16x16x32_bf16 a[64:67], a[176:179], v[144:147], 0
v_exp_f32 v104, v104
v_mfma_f32_16x16x32_bf16 a[96:99], a[176:179], v[148:151], 0
v_exp_f32 v105, v105
v_mfma_f32_16x16x32_bf16 v[80:83], a[148:151], v[32:35], v[80:83]
v_exp_f32 v106, v106
v_mfma_f32_16x16x32_bf16 v[84:87], a[148:151], v[36:39], v[84:87]
ds_read_b128 a[176:179], v255 offset:8192
v_cndmask_b32 v104, 0, v104, s[70:71]
v_mfma_f32_16x16x32_bf16 a[4:7], a[180:183], v[136:139], 0
v_cndmask_b32 v105, 0, v105, s[72:73]
v_cvt_pk_bf16_f32 v152, v104, v105
v_mfma_f32_16x16x32_bf16 a[36:39], a[180:183], v[140:143], 0
ds_read_b128 a[148:151], v253 offset:1024
s_mov_b32 s4, s86
v_mfma_f32_16x16x32_bf16 a[68:71], a[180:183], v[144:147], 0
v_exp_f32 v107, v107
v_mfma_f32_16x16x32_bf16 a[100:103], a[180:183], v[148:151], 0
v_exp_f32 v108, v108
v_mfma_f32_16x16x32_bf16 a[128:131], v[184:187], v[136:139], 0
v_cndmask_b32 v106, 0, v106, s[74:75]
v_cndmask_b32 v107, 0, v107, s[76:77]
v_mfma_f32_16x16x32_bf16 v[80:83], a[152:155], v[48:51], v[80:83]
buffer_load_dwordx4 v2, s[20:23], s59 offen offset:1024 sc1 lds
v_cvt_pk_bf16_f32 v153, v106, v107
v_mfma_f32_16x16x32_bf16 v[84:87], a[152:155], v[52:55], v[84:87]
ds_read_b128 a[180:183], v255 offset:9216
s_mov_b32 s5, s87
v_mfma_f32_16x16x32_bf16 a[8:11], a[184:187], v[136:139], 0
v_exp_f32 v109, v109
v_mfma_f32_16x16x32_bf16 a[40:43], a[184:187], v[140:143], 0
ds_read_b128 a[152:155], v253 offset:2048
s_mov_b32 s6, 0x400000
v_mfma_f32_16x16x32_bf16 a[72:75], a[184:187], v[144:147], 0
v_exp_f32 v110, v110
v_mfma_f32_16x16x32_bf16 a[104:107], a[184:187], v[148:151], 0
v_cvt_pk_bf16_f32 v156, v108, v109
s_mov_b32 s7, 0x20000
v_mfma_f32_16x16x32_bf16 v[80:83], a[156:159], v[64:67], v[80:83]
v_exp_f32 v111, v111
v_mfma_f32_16x16x32_bf16 v[84:87], a[156:159], v[68:71], v[84:87]
ds_read_b128 a[184:187], v255 offset:10240
s_mov_b32 s8, s92
v_mfma_f32_16x16x32_bf16 a[12:15], a[188:191], v[136:139], 0
v_exp_f32 v112, v112
v_mfma_f32_16x16x32_bf16 a[44:47], a[188:191], v[140:143], 0
ds_read_b128 a[156:159], v253 offset:3072
v_cvt_pk_bf16_f32 v157, v110, v111
v_mfma_f32_16x16x32_bf16 a[76:79], a[188:191], v[144:147], 0
v_exp_f32 v113, v113
v_mfma_f32_16x16x32_bf16 a[108:111], a[188:191], v[148:151], 0
v_exp_f32 v114, v114
v_mfma_f32_16x16x32_bf16 a[132:135], v[184:187], v[140:143], 0
s_waitcnt lgkmcnt(7)
buffer_load_dwordx4 v2, s[20:23], s59 offen offset:2048 sc1 lds
v_mfma_f32_16x16x32_bf16 v[96:99], a[160:163], v[16:19], v[176:179]
v_cvt_pk_bf16_f32 v160, v112, v113
s_mov_b32 s9, s93
v_mfma_f32_16x16x32_bf16 v[100:103], a[160:163], v[20:23], v[180:183]
ds_read_b128 a[188:191], v255 offset:11264
s_mov_b32 s10, 0x158000
v_mfma_f32_16x16x32_bf16 a[16:19], a[192:195], v[136:139], 0
v_exp_f32 v115, v115
v_mfma_f32_16x16x32_bf16 a[48:51], a[192:195], v[140:143], 0
ds_read_b128 a[160:163], v253 offset:4096
s_mov_b32 s11, 0x20000
v_mfma_f32_16x16x32_bf16 a[80:83], a[192:195], v[144:147], 0
v_exp_f32 v116, v116
v_mfma_f32_16x16x32_bf16 a[112:115], a[192:195], v[148:151], 0
v_cvt_pk_bf16_f32 v161, v114, v115
s_bfe_u32 s53, s2, 0x20001
v_mfma_f32_16x16x32_bf16 v[96:99], a[164:167], v[32:35], v[96:99]
v_exp_f32 v117, v117
v_mfma_f32_16x16x32_bf16 v[100:103], a[164:167], v[36:39], v[100:103]
ds_read_b128 a[192:195], v255 offset:12288
s_sub_u32 s65, 15, s43
v_mfma_f32_16x16x32_bf16 a[20:23], a[196:199], v[136:139], 0
v_exp_f32 v118, v118
v_mfma_f32_16x16x32_bf16 a[52:55], a[196:199], v[140:143], 0
ds_read_b128 a[164:167], v253 offset:5120
v_cvt_pk_bf16_f32 v164, v116, v117
v_mfma_f32_16x16x32_bf16 a[84:87], a[196:199], v[144:147], 0
v_exp_f32 v119, v119
v_mfma_f32_16x16x32_bf16 a[116:119], a[196:199], v[148:151], 0
buffer_load_dwordx4 v2, s[20:23], s59 offen offset:3072 sc1 lds
v_mov_b32 v154, 0
v_mfma_f32_16x16x32_bf16 a[136:139], v[184:187], v[144:147], 0
v_mov_b32 v155, 0
s_bitcmp1_b32 s2, 3
v_mfma_f32_16x16x32_bf16 v[96:99], a[168:171], v[48:51], v[96:99]
v_exp_f32 v124, v124
v_mfma_f32_16x16x32_bf16 v[100:103], a[168:171], v[52:55], v[100:103]
ds_read_b128 a[196:199], v255 offset:13312
v_cvt_pk_bf16_f32 v165, v118, v119
v_mfma_f32_16x16x32_bf16 a[24:27], a[200:203], v[136:139], 0
v_exp_f32 v125, v125
v_mfma_f32_16x16x32_bf16 a[56:59], a[200:203], v[140:143], 0
ds_read_b128 a[168:171], v253 offset:6144
s_cselect_b32 s55, s65, s43
v_mfma_f32_16x16x32_bf16 a[88:91], a[200:203], v[144:147], 0
v_exp_f32 v126, v126
v_mfma_f32_16x16x32_bf16 a[120:123], a[200:203], v[148:151], 0
v_cndmask_b32 v124, 0, v124, s[70:71]
v_cndmask_b32 v125, 0, v125, s[72:73]
v_mfma_f32_16x16x32_bf16 v[96:99], a[172:175], v[64:67], v[96:99]
v_cvt_pk_bf16_f32 v158, v124, v125
s_bfe_u32 s56, s2, 0x20004
v_mfma_f32_16x16x32_bf16 v[100:103], a[172:175], v[68:71], v[100:103]
ds_read_b128 a[200:203], v255 offset:14336
s_lshl_b32 s54, s55, 2
v_mfma_f32_16x16x32_bf16 a[28:31], a[204:207], v[136:139], 0
v_exp_f32 v127, v127
v_mfma_f32_16x16x32_bf16 a[60:63], a[204:207], v[140:143], 0
ds_read_b128 a[172:175], v253 offset:7168
s_add_u32 s54, s54, s56
v_mfma_f32_16x16x32_bf16 a[92:95], a[204:207], v[144:147], 0
v_exp_f32 v128, v128
v_mfma_f32_16x16x32_bf16 a[124:127], a[204:207], v[148:151], 0
v_cndmask_b32 v126, 0, v126, s[74:75]
v_cndmask_b32 v127, 0, v127, s[76:77]
s_mul_i32 s47, s53, 11264
s_lshl_b32 s48, s53, 15
s_lshl_b32 s65, s56, 8
s_mul_i32 s66, s53, 360448
s_add_u32 s49, s65, s66
s_lshl_b32 s66, s53, 20
s_add_u32 s50, s65, s66
s_and_b32 s65, s43, 1
s_lshl_b32 s65, s65, 16
s_add_u32 s51, s65, s41
s_xor_b32 s52, s51, 0x10000
v_and_b32 v245, 31, v1
v_lshlrev_b32 v245, 7, v245
v_mov_b32 v244, 0
s_mov_b32 s69, 35840
s_lshl_b32 s65, s55, 3
s_lshl_b32 s66, s40, 1
s_add_u32 s65, s65, s66
s_lshl_b32 s66, s65, 17
v_add_u32 v234, s66, v2
v_add_u32 v235, 130048, v234
s_mul_i32 s66, s65, 45056
v_add_u32 v236, s66, v2
v_add_u32 v237, 44032, v236
v_lshrrev_b32 v246, 3, v1
v_and_b32 v247, 7, v1
v_and_b32 v248, 6, v246
v_xor_b32 v247, v247, v248
v_lshlrev_b32 v246, 10, v246
v_lshl_add_u32 v246, v247, 4, v246
s_and_b32 s65, s40, 1
s_lshl_b32 s65, s65, 14
s_lshr_b32 s66, s40, 1
s_lshl_b32 s66, s66, 7
s_add_u32 s65, s65, s66
v_add_u32 v238, s65, v246
v_add_u32 v239, 7168, v238
v_mfma_f32_16x16x32_bf16 a[140:143], v[184:187], v[148:151], 0
s_add_u32 s59, s59, 16384
v_cvt_pk_bf16_f32 v159, v126, v127
v_exp_f32 v129, v129
v_exp_f32 v130, v130
v_cvt_pk_bf16_f32 v162, v128, v129
v_exp_f32 v131, v131
v_exp_f32 v132, v132
v_cvt_pk_bf16_f32 v163, v130, v131
v_exp_f32 v133, v133
v_exp_f32 v134, v134
v_cvt_pk_bf16_f32 v166, v132, v133
v_exp_f32 v135, v135
s_nop 0
v_cvt_pk_bf16_f32 v167, v134, v135
s_waitcnt vmcnt(12)
s_barrier
s_lshl_b32 s65, s43, 2
s_add_u32 s65, s65, s40
s_add_u32 s65, s65, 280
s_lshl_b32 s65, s65, 7
s_waitcnt vmcnt(8)
buffer_atomic_add v6, v5, s[32:35], s65 offen sc1
s_branch KF_trans_o2
KF_a_ge2:
s_waitcnt lgkmcnt(7)
v_mfma_f32_16x16x32_bf16 v[72:75], a[144:147], v[8:11], v[168:171]
v_exp_f32 v104, v104
v_mfma_f32_16x16x32_bf16 v[76:79], a[144:147], v[12:15], v[172:175]
ds_read_b128 a[204:207], v254 offset:15360
s_mov_b32 s4, s86
v_mfma_f32_16x16x32_bf16 v[80:83], a[144:147], v[16:19], v[176:179]
v_exp_f32 v105, v105
v_mfma_f32_16x16x32_bf16 v[84:87], a[144:147], v[20:23], v[180:183]
v_mov_b32 v254, v252
s_mov_b32 s5, s87
v_mfma_f32_16x16x32_bf16 a[0:3], a[176:179], v[136:139], 0
v_exp_f32 v106, v106
v_mfma_f32_16x16x32_bf16 a[32:35], a[176:179], v[140:143], 0
ds_read_b128 a[144:147], v253 offset:0
v_cvt_pk_bf16_f32 v152, v104, v105
v_mfma_f32_16x16x32_bf16 a[64:67], a[176:179], v[144:147], 0
v_exp_f32 v107, v107
v_mfma_f32_16x16x32_bf16 a[96:99], a[176:179], v[148:151], 0
v_add_u32 v252, 0x8000, v252
s_mov_b32 s6, 0x400000
v_mfma_f32_16x16x32_bf16 v[72:75], a[148:151], v[24:27], v[72:75]
v_exp_f32 v108, v108
v_mfma_f32_16x16x32_bf16 v[76:79], a[148:151], v[28:31], v[76:79]
ds_read_b128 a[176:179], v255 offset:8192
v_cvt_pk_bf16_f32 v153, v106, v107
v_mfma_f32_16x16x32_bf16 v[80:83], a[148:151], v[32:35], v[80:83]
v_exp_f32 v109, v109
v_mfma_f32_16x16x32_bf16 v[84:87], a[148:151], v[36:39], v[84:87]
s_and_b32 m0, s59, 0x1ffff
s_mov_b32 s7, 0x20000
v_mfma_f32_16x16x32_bf16 a[4:7], a[180:183], v[136:139], 0
v_exp_f32 v110, v110
v_mfma_f32_16x16x32_bf16 a[36:39], a[180:183], v[140:143], 0
ds_read_b128 a[148:151], v253 offset:1024
v_cvt_pk_bf16_f32 v156, v108, v109
v_mfma_f32_16x16x32_bf16 a[68:71], a[180:183], v[144:147], 0
v_exp_f32 v111, v111
v_mfma_f32_16x16x32_bf16 a[100:103], a[180:183], v[148:151], 0
v_and_b32 v252, 0x1ffff, v252
s_mov_b32 s8, s92
v_mfma_f32_16x16x32_bf16 a[128:131], v[184:187], v[136:139], 0
s_mov_b32 s9, s93
s_mov_b32 s10, 0x158000
v_mfma_f32_16x16x32_bf16 v[72:75], a[152:155], v[40:43], v[72:75]
v_exp_f32 v112, v112
v_mfma_f32_16x16x32_bf16 v[76:79], a[152:155], v[44:47], v[76:79]
ds_read_b128 a[180:183], v255 offset:9216
v_cvt_pk_bf16_f32 v157, v110, v111
v_mfma_f32_16x16x32_bf16 v[80:83], a[152:155], v[48:51], v[80:83]
v_exp_f32 v113, v113
v_mfma_f32_16x16x32_bf16 v[84:87], a[152:155], v[52:55], v[84:87]
buffer_load_dwordx4 v2, s[20:23], s59 offen offset:0 sc1 lds
s_mov_b32 s11, 0x20000
v_mfma_f32_16x16x32_bf16 a[8:11], a[184:187], v[136:139], 0
v_exp_f32 v114, v114
v_mfma_f32_16x16x32_bf16 a[40:43], a[184:187], v[140:143], 0
ds_read_b128 a[152:155], v253 offset:2048
v_cvt_pk_bf16_f32 v160, v112, v113
v_mfma_f32_16x16x32_bf16 a[72:75], a[184:187], v[144:147], 0
v_exp_f32 v115, v115
v_mfma_f32_16x16x32_bf16 a[104:107], a[184:187], v[148:151], 0
s_bfe_u32 s53, s2, 0x20001
s_sub_u32 s65, 15, s43
v_mfma_f32_16x16x32_bf16 v[72:75], a[156:159], v[56:59], v[72:75]
v_exp_f32 v116, v116
v_mfma_f32_16x16x32_bf16 v[76:79], a[156:159], v[60:63], v[76:79]
ds_read_b128 a[184:187], v255 offset:10240
v_cvt_pk_bf16_f32 v161, v114, v115
v_mfma_f32_16x16x32_bf16 v[80:83], a[156:159], v[64:67], v[80:83]
v_exp_f32 v117, v117
v_mfma_f32_16x16x32_bf16 v[84:87], a[156:159], v[68:71], v[84:87]
s_bitcmp1_b32 s2, 3
s_cselect_b32 s55, s65, s43
v_mfma_f32_16x16x32_bf16 a[12:15], a[188:191], v[136:139], 0
v_exp_f32 v118, v118
v_mfma_f32_16x16x32_bf16 a[44:47], a[188:191], v[140:143], 0
ds_read_b128 a[156:159], v253 offset:3072
v_cvt_pk_bf16_f32 v164, v116, v117
v_mfma_f32_16x16x32_bf16 a[76:79], a[188:191], v[144:147], 0
v_exp_f32 v119, v119
v_mfma_f32_16x16x32_bf16 a[108:111], a[188:191], v[148:151], 0
s_bfe_u32 s56, s2, 0x20004
s_lshl_b32 s54, s55, 2
v_mfma_f32_16x16x32_bf16 a[132:135], v[184:187], v[140:143], 0
s_waitcnt lgkmcnt(7)
s_add_u32 s54, s54, s56
v_mfma_f32_16x16x32_bf16 v[88:91], a[160:163], v[8:11], v[168:171]
v_exp_f32 v120, v120
v_mfma_f32_16x16x32_bf16 v[92:95], a[160:163], v[12:15], v[172:175]
ds_read_b128 a[188:191], v255 offset:11264
v_cvt_pk_bf16_f32 v165, v118, v119
v_mfma_f32_16x16x32_bf16 v[96:99], a[160:163], v[16:19], v[176:179]
v_exp_f32 v121, v121
v_mfma_f32_16x16x32_bf16 v[100:103], a[160:163], v[20:23], v[180:183]
buffer_load_dwordx4 v2, s[20:23], s59 offen offset:1024 sc1 lds
s_mul_i32 s47, s53, 11264
v_mfma_f32_16x16x32_bf16 a[16:19], a[192:195], v[136:139], 0
v_exp_f32 v122, v122
v_mfma_f32_16x16x32_bf16 a[48:51], a[192:195], v[140:143], 0
ds_read_b128 a[160:163], v253 offset:4096
v_cvt_pk_bf16_f32 v154, v120, v121
v_mfma_f32_16x16x32_bf16 a[80:83], a[192:195], v[144:147], 0
v_exp_f32 v123, v123
v_mfma_f32_16x16x32_bf16 a[112:115], a[192:195], v[148:151], 0
s_lshl_b32 s48, s53, 15
s_lshl_b32 s65, s56, 8
v_mfma_f32_16x16x32_bf16 v[88:91], a[164:167], v[24:27], v[88:91]
v_exp_f32 v124, v124
v_mfma_f32_16x16x32_bf16 v[92:95], a[164:167], v[28:31], v[92:95]
ds_read_b128 a[192:195], v255 offset:12288
v_cvt_pk_bf16_f32 v155, v122, v123
v_mfma_f32_16x16x32_bf16 v[96:99], a[164:167], v[32:35], v[96:99]
v_exp_f32 v125, v125
v_mfma_f32_16x16x32_bf16 v[100:103], a[164:167], v[36:39], v[100:103]
s_mul_i32 s66, s53, 360448
s_add_u32 s49, s65, s66
v_mfma_f32_16x16x32_bf16 a[20:23], a[196:199], v[136:139], 0
v_exp_f32 v126, v126
v_mfma_f32_16x16x32_bf16 a[52:55], a[196:199], v[140:143], 0
ds_read_b128 a[164:167], v253 offset:5120
v_cvt_pk_bf16_f32 v158, v124, v125
v_mfma_f32_16x16x32_bf16 a[84:87], a[196:199], v[144:147], 0
v_exp_f32 v127, v127
v_mfma_f32_16x16x32_bf16 a[116:119], a[196:199], v[148:151], 0
buffer_load_dwordx4 v2, s[20:23], s59 offen offset:2048 sc1 lds
s_lshl_b32 s66, s53, 20
v_mfma_f32_16x16x32_bf16 a[136:139], v[184:187], v[144:147], 0
s_add_u32 s50, s65, s66
s_and_b32 s65, s43, 1
v_mfma_f32_16x16x32_bf16 v[88:91], a[168:171], v[40:43], v[88:91]
v_exp_f32 v128, v128
v_mfma_f32_16x16x32_bf16 v[92:95], a[168:171], v[44:47], v[92:95]
ds_read_b128 a[196:199], v255 offset:13312
v_cvt_pk_bf16_f32 v159, v126, v127
v_mfma_f32_16x16x32_bf16 v[96:99], a[168:171], v[48:51], v[96:99]
v_exp_f32 v129, v129
v_mfma_f32_16x16x32_bf16 v[100:103], a[168:171], v[52:55], v[100:103]
s_lshl_b32 s65, s65, 16
s_add_u32 s51, s65, s41
v_mfma_f32_16x16x32_bf16 a[24:27], a[200:203], v[136:139], 0
v_exp_f32 v130, v130
v_mfma_f32_16x16x32_bf16 a[56:59], a[200:203], v[140:143], 0
ds_read_b128 a[168:171], v253 offset:6144
v_cvt_pk_bf16_f32 v162, v128, v129
v_mfma_f32_16x16x32_bf16 a[88:91], a[200:203], v[144:147], 0
v_exp_f32 v131, v131
v_mfma_f32_16x16x32_bf16 a[120:123], a[200:203], v[148:151], 0
s_xor_b32 s52, s51, 0x10000
v_and_b32 v245, 31, v1
v_mfma_f32_16x16x32_bf16 v[88:91], a[172:175], v[56:59], v[88:91]
v_exp_f32 v132, v132
v_mfma_f32_16x16x32_bf16 v[92:95], a[172:175], v[60:63], v[92:95]
ds_read_b128 a[200:203], v255 offset:14336
v_cvt_pk_bf16_f32 v163, v130, v131
v_mfma_f32_16x16x32_bf16 v[96:99], a[172:175], v[64:67], v[96:99]
v_exp_f32 v133, v133
v_mfma_f32_16x16x32_bf16 v[100:103], a[172:175], v[68:71], v[100:103]
buffer_load_dwordx4 v2, s[20:23], s59 offen offset:3072 sc1 lds
v_lshlrev_b32 v245, 7, v245
v_mfma_f32_16x16x32_bf16 a[28:31], a[204:207], v[136:139], 0
v_exp_f32 v134, v134
v_mfma_f32_16x16x32_bf16 a[60:63], a[204:207], v[140:143], 0
ds_read_b128 a[172:175], v253 offset:7168
v_cvt_pk_bf16_f32 v166, v132, v133
v_mfma_f32_16x16x32_bf16 a[92:95], a[204:207], v[144:147], 0
v_exp_f32 v135, v135
v_mfma_f32_16x16x32_bf16 a[124:127], a[204:207], v[148:151], 0
v_cvt_pk_bf16_f32 v167, v134, v135
s_add_u32 s59, s59, 16384
v_mov_b32 v244, 0
s_mov_b32 s69, 35840
s_lshl_b32 s65, s55, 3
s_lshl_b32 s66, s40, 1
s_add_u32 s65, s65, s66
s_lshl_b32 s66, s65, 17
v_add_u32 v234, s66, v2
v_add_u32 v235, 130048, v234
s_mul_i32 s66, s65, 45056
v_add_u32 v236, s66, v2
v_add_u32 v237, 44032, v236
v_lshrrev_b32 v246, 3, v1
v_and_b32 v247, 7, v1
v_and_b32 v248, 6, v246
v_xor_b32 v247, v247, v248
v_lshlrev_b32 v246, 10, v246
v_lshl_add_u32 v246, v247, 4, v246
s_and_b32 s65, s40, 1
s_lshl_b32 s65, s65, 14
s_lshr_b32 s66, s40, 1
s_lshl_b32 s66, s66, 7
s_add_u32 s65, s65, s66
v_add_u32 v238, s65, v246
v_add_u32 v239, 7168, v238
v_mfma_f32_16x16x32_bf16 a[140:143], v[184:187], v[148:151], 0
s_waitcnt vmcnt(12)
s_barrier
s_lshl_b32 s65, s43, 2
s_add_u32 s65, s65, s40
s_add_u32 s65, s65, 280
s_lshl_b32 s65, s65, 7
s_waitcnt vmcnt(8)
buffer_atomic_add v6, v5, s[32:35], s65 offen sc1
s_cmp_ge_u32 s59, s60
s_cbranch_scc1 KF_trans_e
KF_dual:
s_waitcnt lgkmcnt(7)
v_mfma_f32_16x16x32_bf16 v[104:107], a[144:147], v[8:11], v[168:171]
v_exp_f32 v72, v72
v_mfma_f32_16x16x32_bf16 v[108:111], a[144:147], v[12:15], v[172:175]
ds_read_b128 a[204:207], v255 offset:15360
v_mfma_f32_16x16x32_bf16 v[112:115], a[144:147], v[16:19], v[176:179]
v_exp_f32 v73, v73
v_mfma_f32_16x16x32_bf16 v[116:119], a[144:147], v[20:23], v[180:183]
v_mov_b32 v255, v253
v_mfma_f32_16x16x32_bf16 a[0:3], a[176:179], v[152:155], a[0:3]
v_exp_f32 v74, v74
v_mfma_f32_16x16x32_bf16 a[32:35], a[176:179], v[156:159], a[32:35]
ds_read_b128 a[144:147], v252 offset:0
v_cvt_pk_bf16_f32 v136, v72, v73
v_mfma_f32_16x16x32_bf16 a[64:67], a[176:179], v[160:163], a[64:67]
v_exp_f32 v75, v75
v_mfma_f32_16x16x32_bf16 a[96:99], a[176:179], v[164:167], a[96:99]
v_add_u32 v253, 0x8000, v253
v_mfma_f32_16x16x32_bf16 v[104:107], a[148:151], v[24:27], v[104:107]
v_exp_f32 v76, v76
v_mfma_f32_16x16x32_bf16 v[108:111], a[148:151], v[28:31], v[108:111]
ds_read_b128 a[176:179], v254 offset:8192
v_cvt_pk_bf16_f32 v137, v74, v75
v_mfma_f32_16x16x32_bf16 v[112:115], a[148:151], v[32:35], v[112:115]
v_exp_f32 v77, v77
v_mfma_f32_16x16x32_bf16 v[116:119], a[148:151], v[36:39], v[116:119]
s_and_b32 m0, s59, 0x1ffff
v_mfma_f32_16x16x32_bf16 a[4:7], a[180:183], v[152:155], a[4:7]
v_exp_f32 v78, v78
v_mfma_f32_16x16x32_bf16 a[36:39], a[180:183], v[156:159], a[36:39]
ds_read_b128 a[148:151], v252 offset:1024
v_cvt_pk_bf16_f32 v140, v76, v77
v_mfma_f32_16x16x32_bf16 a[68:71], a[180:183], v[160:163], a[68:71]
v_exp_f32 v79, v79
v_mfma_f32_16x16x32_bf16 a[100:103], a[180:183], v[164:167], a[100:103]
v_and_b32 v253, 0x1ffff, v253
v_mfma_f32_16x16x32_bf16 a[128:131], v[184:187], v[152:155], a[128:131]
v_mfma_f32_16x16x32_bf16 v[104:107], a[152:155], v[40:43], v[104:107]
v_exp_f32 v80, v80
v_mfma_f32_16x16x32_bf16 v[108:111], a[152:155], v[44:47], v[108:111]
ds_read_b128 a[180:183], v254 offset:9216
v_cvt_pk_bf16_f32 v141, v78, v79
v_mfma_f32_16x16x32_bf16 v[112:115], a[152:155], v[48:51], v[112:115]
v_exp_f32 v81, v81
v_mfma_f32_16x16x32_bf16 v[116:119], a[152:155], v[52:55], v[116:119]
buffer_load_dwordx4 v2, s[20:23], s59 offen offset:0 sc1 lds
v_mfma_f32_16x16x32_bf16 a[8:11], a[184:187], v[152:155], a[8:11]
v_exp_f32 v82, v82
v_mfma_f32_16x16x32_bf16 a[40:43], a[184:187], v[156:159], a[40:43]
ds_read_b128 a[152:155], v252 offset:2048
v_cvt_pk_bf16_f32 v144, v80, v81
v_mfma_f32_16x16x32_bf16 a[72:75], a[184:187], v[160:163], a[72:75]
v_exp_f32 v83, v83
v_mfma_f32_16x16x32_bf16 a[104:107], a[184:187], v[164:167], a[104:107]
v_mfma_f32_16x16x32_bf16 v[104:107], a[156:159], v[56:59], v[104:107]
v_exp_f32 v84, v84
v_mfma_f32_16x16x32_bf16 v[108:111], a[156:159], v[60:63], v[108:111]
ds_read_b128 a[184:187], v254 offset:10240
v_cvt_pk_bf16_f32 v145, v82, v83
v_mfma_f32_16x16x32_bf16 v[112:115], a[156:159], v[64:67], v[112:115]
v_exp_f32 v85, v85
v_mfma_f32_16x16x32_bf16 v[116:119], a[156:159], v[68:71], v[116:119]
v_mfma_f32_16x16x32_bf16 a[12:15], a[188:191], v[152:155], a[12:15]
v_exp_f32 v86, v86
v_mfma_f32_16x16x32_bf16 a[44:47], a[188:191], v[156:159], a[44:47]
ds_read_b128 a[156:159], v252 offset:3072
v_cvt_pk_bf16_f32 v148, v84, v85
v_mfma_f32_16x16x32_bf16 a[76:79], a[188:191], v[160:163], a[76:79]
v_exp_f32 v87, v87
v_mfma_f32_16x16x32_bf16 a[108:111], a[188:191], v[164:167], a[108:111]
v_mfma_f32_16x16x32_bf16 a[132:135], v[184:187], v[156:159], a[132:135]
s_waitcnt lgkmcnt(7)
v_mfma_f32_16x16x32_bf16 v[120:123], a[160:163], v[8:11], v[168:171]
v_exp_f32 v88, v88
v_mfma_f32_16x16x32_bf16 v[124:127], a[160:163], v[12:15], v[172:175]
ds_read_b128 a[188:191], v254 offset:11264
v_cvt_pk_bf16_f32 v149, v86, v87
v_mfma_f32_16x16x32_bf16 v[128:131], a[160:163], v[16:19], v[176:179]
v_exp_f32 v89, v89
v_mfma_f32_16x16x32_bf16 v[132:135], a[160:163], v[20:23], v[180:183]
buffer_load_dwordx4 v2, s[20:23], s59 offen offset:1024 sc1 lds
v_mfma_f32_16x16x32_bf16 a[16:19], a[192:195], v[152:155], a[16:19]
v_exp_f32 v90, v90
v_mfma_f32_16x16x32_bf16 a[48:51], a[192:195], v[156:159], a[48:51]
ds_read_b128 a[160:163], v252 offset:4096
v_cvt_pk_bf16_f32 v138, v88, v89
v_mfma_f32_16x16x32_bf16 a[80:83], a[192:195], v[160:163], a[80:83]
v_exp_f32 v91, v91
v_mfma_f32_16x16x32_bf16 a[112:115], a[192:195], v[164:167], a[112:115]
v_mfma_f32_16x16x32_bf16 v[120:123], a[164:167], v[24:27], v[120:123]
v_exp_f32 v92, v92
v_mfma_f32_16x16x32_bf16 v[124:127], a[164:167], v[28:31], v[124:127]
ds_read_b128 a[192:195], v254 offset:12288
v_cvt_pk_bf16_f32 v139, v90, v91
v_mfma_f32_16x16x32_bf16 v[128:131], a[164:167], v[32:35], v[128:131]
v_exp_f32 v93, v93
v_mfma_f32_16x16x32_bf16 v[132:135], a[164:167], v[36:39], v[132:135]
v_mfma_f32_16x16x32_bf16 a[20:23], a[196:199], v[152:155], a[20:23]
v_exp_f32 v94, v94
v_mfma_f32_16x16x32_bf16 a[52:55], a[196:199], v[156:159], a[52:55]
ds_read_b128 a[164:167], v252 offset:5120
v_cvt_pk_bf16_f32 v142, v92, v93
v_mfma_f32_16x16x32_bf16 a[84:87], a[196:199], v[160:163], a[84:87]
v_exp_f32 v95, v95
v_mfma_f32_16x16x32_bf16 a[116:119], a[196:199], v[164:167], a[116:119]
buffer_load_dwordx4 v2, s[20:23], s59 offen offset:2048 sc1 lds
v_mfma_f32_16x16x32_bf16 a[136:139], v[184:187], v[160:163], a[136:139]
v_mfma_f32_16x16x32_bf16 v[120:123], a[168:171], v[40:43], v[120:123]
v_exp_f32 v96, v96
v_mfma_f32_16x16x32_bf16 v[124:127], a[168:171], v[44:47], v[124:127]
ds_read_b128 a[196:199], v254 offset:13312
v_cvt_pk_bf16_f32 v143, v94, v95
v_mfma_f32_16x16x32_bf16 v[128:131], a[168:171], v[48:51], v[128:131]
v_exp_f32 v97, v97
v_mfma_f32_16x16x32_bf16 v[132:135], a[168:171], v[52:55], v[132:135]
v_mfma_f32_16x16x32_bf16 a[24:27], a[200:203], v[152:155], a[24:27]
v_exp_f32 v98, v98
v_mfma_f32_16x16x32_bf16 a[56:59], a[200:203], v[156:159], a[56:59]
ds_read_b128 a[168:171], v252 offset:6144
v_cvt_pk_bf16_f32 v146, v96, v97
v_mfma_f32_16x16x32_bf16 a[88:91], a[200:203], v[160:163], a[88:91]
v_exp_f32 v99, v99
v_mfma_f32_16x16x32_bf16 a[120:123], a[200:203], v[164:167], a[120:123]
v_mfma_f32_16x16x32_bf16 v[120:123], a[172:175], v[56:59], v[120:123]
v_exp_f32 v100, v100
v_mfma_f32_16x16x32_bf16 v[124:127], a[172:175], v[60:63], v[124:127]
ds_read_b128 a[200:203], v254 offset:14336
v_cvt_pk_bf16_f32 v147, v98, v99
v_mfma_f32_16x16x32_bf16 v[128:131], a[172:175], v[64:67], v[128:131]
v_exp_f32 v101, v101
v_mfma_f32_16x16x32_bf16 v[132:135], a[172:175], v[68:71], v[132:135]
buffer_load_dwordx4 v2, s[20:23], s59 offen offset:3072 sc1 lds
v_mfma_f32_16x16x32_bf16 a[28:31], a[204:207], v[152:155], a[28:31]
v_exp_f32 v102, v102
v_mfma_f32_16x16x32_bf16 a[60:63], a[204:207], v[156:159], a[60:63]
ds_read_b128 a[172:175], v252 offset:7168
v_cvt_pk_bf16_f32 v150, v100, v101
v_mfma_f32_16x16x32_bf16 a[92:95], a[204:207], v[160:163], a[92:95]
v_exp_f32 v103, v103
v_mfma_f32_16x16x32_bf16 a[124:127], a[204:207], v[164:167], a[124:127]
v_cvt_pk_bf16_f32 v151, v102, v103
s_add_u32 s59, s59, 16384
s_cmp_ge_u32 s59, s60
v_mfma_f32_16x16x32_bf16 a[140:143], v[184:187], v[164:167], a[140:143]
s_cbranch_scc1 KF_trans_o
s_waitcnt lgkmcnt(7)
v_mfma_f32_16x16x32_bf16 v[72:75], a[144:147], v[8:11], v[168:171]
v_exp_f32 v104, v104
v_mfma_f32_16x16x32_bf16 v[76:79], a[144:147], v[12:15], v[172:175]
ds_read_b128 a[204:207], v254 offset:15360
v_mfma_f32_16x16x32_bf16 v[80:83], a[144:147], v[16:19], v[176:179]
v_exp_f32 v105, v105
v_mfma_f32_16x16x32_bf16 v[84:87], a[144:147], v[20:23], v[180:183]
v_mov_b32 v254, v252
v_mfma_f32_16x16x32_bf16 a[0:3], a[176:179], v[136:139], a[0:3]
v_exp_f32 v106, v106
v_mfma_f32_16x16x32_bf16 a[32:35], a[176:179], v[140:143], a[32:35]
ds_read_b128 a[144:147], v253 offset:0
v_cvt_pk_bf16_f32 v152, v104, v105
v_mfma_f32_16x16x32_bf16 a[64:67], a[176:179], v[144:147], a[64:67]
v_exp_f32 v107, v107
v_mfma_f32_16x16x32_bf16 a[96:99], a[176:179], v[148:151], a[96:99]
v_add_u32 v252, 0x8000, v252
v_mfma_f32_16x16x32_bf16 v[72:75], a[148:151], v[24:27], v[72:75]
v_exp_f32 v108, v108
v_mfma_f32_16x16x32_bf16 v[76:79], a[148:151], v[28:31], v[76:79]
ds_read_b128 a[176:179], v255 offset:8192
v_cvt_pk_bf16_f32 v153, v106, v107
v_mfma_f32_16x16x32_bf16 v[80:83], a[148:151], v[32:35], v[80:83]
v_exp_f32 v109, v109
v_mfma_f32_16x16x32_bf16 v[84:87], a[148:151], v[36:39], v[84:87]
s_and_b32 m0, s59, 0x1ffff
v_mfma_f32_16x16x32_bf16 a[4:7], a[180:183], v[136:139], a[4:7]
v_exp_f32 v110, v110
v_mfma_f32_16x16x32_bf16 a[36:39], a[180:183], v[140:143], a[36:39]
ds_read_b128 a[148:151], v253 offset:1024
v_cvt_pk_bf16_f32 v156, v108, v109
v_mfma_f32_16x16x32_bf16 a[68:71], a[180:183], v[144:147], a[68:71]
v_exp_f32 v111, v111
v_mfma_f32_16x16x32_bf16 a[100:103], a[180:183], v[148:151], a[100:103]
v_and_b32 v252, 0x1ffff, v252
v_mfma_f32_16x16x32_bf16 a[128:131], v[184:187], v[136:139], a[128:131]
v_mfma_f32_16x16x32_bf16 v[72:75], a[152:155], v[40:43], v[72:75]
v_exp_f32 v112, v112
v_mfma_f32_16x16x32_bf16 v[76:79], a[152:155], v[44:47], v[76:79]
ds_read_b128 a[180:183], v255 offset:9216
v_cvt_pk_bf16_f32 v157, v110, v111
v_mfma_f32_16x16x32_bf16 v[80:83], a[152:155], v[48:51], v[80:83]
v_exp_f32 v113, v113
v_mfma_f32_16x16x32_bf16 v[84:87], a[152:155], v[52:55], v[84:87]
buffer_load_dwordx4 v2, s[20:23], s59 offen offset:0 sc1 lds
v_mfma_f32_16x16x32_bf16 a[8:11], a[184:187], v[136:139], a[8:11]
v_exp_f32 v114, v114
v_mfma_f32_16x16x32_bf16 a[40:43], a[184:187], v[140:143], a[40:43]
ds_read_b128 a[152:155], v253 offset:2048
v_cvt_pk_bf16_f32 v160, v112, v113
v_mfma_f32_16x16x32_bf16 a[72:75], a[184:187], v[144:147], a[72:75]
v_exp_f32 v115, v115
v_mfma_f32_16x16x32_bf16 a[104:107], a[184:187], v[148:151], a[104:107]
v_mfma_f32_16x16x32_bf16 v[72:75], a[156:159], v[56:59], v[72:75]
v_exp_f32 v116, v116
v_mfma_f32_16x16x32_bf16 v[76:79], a[156:159], v[60:63], v[76:79]
ds_read_b128 a[184:187], v255 offset:10240
v_cvt_pk_bf16_f32 v161, v114, v115
v_mfma_f32_16x16x32_bf16 v[80:83], a[156:159], v[64:67], v[80:83]
v_exp_f32 v117, v117
v_mfma_f32_16x16x32_bf16 v[84:87], a[156:159], v[68:71], v[84:87]
v_mfma_f32_16x16x32_bf16 a[12:15], a[188:191], v[136:139], a[12:15]
v_exp_f32 v118, v118
v_mfma_f32_16x16x32_bf16 a[44:47], a[188:191], v[140:143], a[44:47]
ds_read_b128 a[156:159], v253 offset:3072
v_cvt_pk_bf16_f32 v164, v116, v117
v_mfma_f32_16x16x32_bf16 a[76:79], a[188:191], v[144:147], a[76:79]
v_exp_f32 v119, v119
v_mfma_f32_16x16x32_bf16 a[108:111], a[188:191], v[148:151], a[108:111]
v_mfma_f32_16x16x32_bf16 a[132:135], v[184:187], v[140:143], a[132:135]
s_waitcnt lgkmcnt(7)
v_mfma_f32_16x16x32_bf16 v[88:91], a[160:163], v[8:11], v[168:171]
v_exp_f32 v120, v120
v_mfma_f32_16x16x32_bf16 v[92:95], a[160:163], v[12:15], v[172:175]
ds_read_b128 a[188:191], v255 offset:11264
v_cvt_pk_bf16_f32 v165, v118, v119
v_mfma_f32_16x16x32_bf16 v[96:99], a[160:163], v[16:19], v[176:179]
v_exp_f32 v121, v121
v_mfma_f32_16x16x32_bf16 v[100:103], a[160:163], v[20:23], v[180:183]
buffer_load_dwordx4 v2, s[20:23], s59 offen offset:1024 sc1 lds
v_mfma_f32_16x16x32_bf16 a[16:19], a[192:195], v[136:139], a[16:19]
v_exp_f32 v122, v122
v_mfma_f32_16x16x32_bf16 a[48:51], a[192:195], v[140:143], a[48:51]
ds_read_b128 a[160:163], v253 offset:4096
v_cvt_pk_bf16_f32 v154, v120, v121
v_mfma_f32_16x16x32_bf16 a[80:83], a[192:195], v[144:147], a[80:83]
v_exp_f32 v123, v123
v_mfma_f32_16x16x32_bf16 a[112:115], a[192:195], v[148:151], a[112:115]
v_mfma_f32_16x16x32_bf16 v[88:91], a[164:167], v[24:27], v[88:91]
v_exp_f32 v124, v124
v_mfma_f32_16x16x32_bf16 v[92:95], a[164:167], v[28:31], v[92:95]
ds_read_b128 a[192:195], v255 offset:12288
v_cvt_pk_bf16_f32 v155, v122, v123
v_mfma_f32_16x16x32_bf16 v[96:99], a[164:167], v[32:35], v[96:99]
v_exp_f32 v125, v125
v_mfma_f32_16x16x32_bf16 v[100:103], a[164:167], v[36:39], v[100:103]
v_mfma_f32_16x16x32_bf16 a[20:23], a[196:199], v[136:139], a[20:23]
v_exp_f32 v126, v126
v_mfma_f32_16x16x32_bf16 a[52:55], a[196:199], v[140:143], a[52:55]
ds_read_b128 a[164:167], v253 offset:5120
v_cvt_pk_bf16_f32 v158, v124, v125
v_mfma_f32_16x16x32_bf16 a[84:87], a[196:199], v[144:147], a[84:87]
v_exp_f32 v127, v127
v_mfma_f32_16x16x32_bf16 a[116:119], a[196:199], v[148:151], a[116:119]
buffer_load_dwordx4 v2, s[20:23], s59 offen offset:2048 sc1 lds
v_mfma_f32_16x16x32_bf16 a[136:139], v[184:187], v[144:147], a[136:139]
v_mfma_f32_16x16x32_bf16 v[88:91], a[168:171], v[40:43], v[88:91]
v_exp_f32 v128, v128
v_mfma_f32_16x16x32_bf16 v[92:95], a[168:171], v[44:47], v[92:95]
ds_read_b128 a[196:199], v255 offset:13312
v_cvt_pk_bf16_f32 v159, v126, v127
v_mfma_f32_16x16x32_bf16 v[96:99], a[168:171], v[48:51], v[96:99]
v_exp_f32 v129, v129
v_mfma_f32_16x16x32_bf16 v[100:103], a[168:171], v[52:55], v[100:103]
v_mfma_f32_16x16x32_bf16 a[24:27], a[200:203], v[136:139], a[24:27]
v_exp_f32 v130, v130
v_mfma_f32_16x16x32_bf16 a[56:59], a[200:203], v[140:143], a[56:59]
ds_read_b128 a[168:171], v253 offset:6144
v_cvt_pk_bf16_f32 v162, v128, v129
v_mfma_f32_16x16x32_bf16 a[88:91], a[200:203], v[144:147], a[88:91]
v_exp_f32 v131, v131
v_mfma_f32_16x16x32_bf16 a[120:123], a[200:203], v[148:151], a[120:123]
v_mfma_f32_16x16x32_bf16 v[88:91], a[172:175], v[56:59], v[88:91]
v_exp_f32 v132, v132
v_mfma_f32_16x16x32_bf16 v[92:95], a[172:175], v[60:63], v[92:95]
ds_read_b128 a[200:203], v255 offset:14336
v_cvt_pk_bf16_f32 v163, v130, v131
v_mfma_f32_16x16x32_bf16 v[96:99], a[172:175], v[64:67], v[96:99]
v_exp_f32 v133, v133
v_mfma_f32_16x16x32_bf16 v[100:103], a[172:175], v[68:71], v[100:103]
buffer_load_dwordx4 v2, s[20:23], s59 offen offset:3072 sc1 lds
v_mfma_f32_16x16x32_bf16 a[28:31], a[204:207], v[136:139], a[28:31]
v_exp_f32 v134, v134
v_mfma_f32_16x16x32_bf16 a[60:63], a[204:207], v[140:143], a[60:63]
ds_read_b128 a[172:175], v253 offset:7168
v_cvt_pk_bf16_f32 v166, v132, v133
v_mfma_f32_16x16x32_bf16 a[92:95], a[204:207], v[144:147], a[92:95]
v_exp_f32 v135, v135
v_mfma_f32_16x16x32_bf16 a[124:127], a[204:207], v[148:151], a[124:127]
v_cvt_pk_bf16_f32 v167, v134, v135
s_add_u32 s59, s59, 16384
s_cmp_ge_u32 s59, s60
v_mfma_f32_16x16x32_bf16 a[140:143], v[184:187], v[148:151], a[140:143]
s_waitcnt vmcnt(12)
s_barrier
s_cbranch_scc0 KF_dual
KF_trans_e:
s_waitcnt lgkmcnt(7)
v_mfma_f32_16x16x32_bf16 v[112:115], a[144:147], v[16:19], v[176:179]
s_and_b32 m0, s59, 0x1ffff
v_mfma_f32_16x16x32_bf16 v[116:119], a[144:147], v[20:23], v[180:183]
ds_read_b128 a[204:207], v255 offset:15360
v_mov_b32 v255, v253
v_mfma_f32_16x16x32_bf16 a[0:3], a[176:179], v[152:155], a[0:3]
v_add_u32 v253, 0x8000, v253
v_and_b32 v253, 0x1ffff, v253
v_mfma_f32_16x16x32_bf16 a[32:35], a[176:179], v[156:159], a[32:35]
ds_read_b128 a[144:147], v252 offset:0
buffer_load_dwordx4 v2, s[20:23], s59 offen offset:0 sc1 lds
v_mfma_f32_16x16x32_bf16 a[64:67], a[176:179], v[160:163], a[64:67]
v_exp_f32 v72, v72
v_mfma_f32_16x16x32_bf16 a[96:99], a[176:179], v[164:167], a[96:99]
v_exp_f32 v73, v73
v_mfma_f32_16x16x32_bf16 v[112:115], a[148:151], v[32:35], v[112:115]
v_exp_f32 v74, v74
v_mfma_f32_16x16x32_bf16 v[116:119], a[148:151], v[36:39], v[116:119]
ds_read_b128 a[176:179], v254 offset:8192
v_cndmask_b32 v72, 0, v72, s[70:71]
v_mfma_f32_16x16x32_bf16 a[4:7], a[180:183], v[152:155], a[4:7]
v_cndmask_b32 v73, 0, v73, s[72:73]
v_cvt_pk_bf16_f32 v136, v72, v73
v_mfma_f32_16x16x32_bf16 a[36:39], a[180:183], v[156:159], a[36:39]
ds_read_b128 a[148:151], v252 offset:1024
v_mfma_f32_16x16x32_bf16 a[68:71], a[180:183], v[160:163], a[68:71]
v_exp_f32 v75, v75
v_mfma_f32_16x16x32_bf16 a[100:103], a[180:183], v[164:167], a[100:103]
v_exp_f32 v76, v76
v_mfma_f32_16x16x32_bf16 a[128:131], v[184:187], v[152:155], a[128:131]
v_cndmask_b32 v74, 0, v74, s[74:75]
v_cndmask_b32 v75, 0, v75, s[76:77]
v_mfma_f32_16x16x32_bf16 v[112:115], a[152:155], v[48:51], v[112:115]
buffer_load_dwordx4 v2, s[20:23], s59 offen offset:1024 sc1 lds
v_cvt_pk_bf16_f32 v137, v74, v75
v_mfma_f32_16x16x32_bf16 v[116:119], a[152:155], v[52:55], v[116:119]
ds_read_b128 a[180:183], v254 offset:9216
v_mfma_f32_16x16x32_bf16 a[8:11], a[184:187], v[152:155], a[8:11]
v_exp_f32 v77, v77
v_mfma_f32_16x16x32_bf16 a[40:43], a[184:187], v[156:159], a[40:43]
ds_read_b128 a[152:155], v252 offset:2048
v_mfma_f32_16x16x32_bf16 a[72:75], a[184:187], v[160:163], a[72:75]
v_exp_f32 v78, v78
v_mfma_f32_16x16x32_bf16 a[104:107], a[184:187], v[164:167], a[104:107]
v_cvt_pk_bf16_f32 v140, v76, v77
v_mfma_f32_16x16x32_bf16 v[112:115], a[156:159], v[64:67], v[112:115]
v_exp_f32 v79, v79
v_mfma_f32_16x16x32_bf16 v[116:119], a[156:159], v[68:71], v[116:119]
ds_read_b128 a[184:187], v254 offset:10240
v_mfma_f32_16x16x32_bf16 a[12:15], a[188:191], v[152:155], a[12:15]
v_exp_f32 v80, v80
v_mfma_f32_16x16x32_bf16 a[44:47], a[188:191], v[156:159], a[44:47]
ds_read_b128 a[156:159], v252 offset:3072
v_cvt_pk_bf16_f32 v141, v78, v79
v_mfma_f32_16x16x32_bf16 a[76:79], a[188:191], v[160:163], a[76:79]
v_exp_f32 v81, v81
v_mfma_f32_16x16x32_bf16 a[108:111], a[188:191], v[164:167], a[108:111]
v_exp_f32 v82, v82
v_mfma_f32_16x16x32_bf16 a[132:135], v[184:187], v[156:159], a[132:135]
s_waitcnt lgkmcnt(7)
buffer_load_dwordx4 v2, s[20:23], s59 offen offset:2048 sc1 lds
v_mfma_f32_16x16x32_bf16 v[128:131], a[160:163], v[16:19], v[176:179]
v_cvt_pk_bf16_f32 v144, v80, v81
v_mfma_f32_16x16x32_bf16 v[132:135], a[160:163], v[20:23], v[180:183]
ds_read_b128 a[188:191], v254 offset:11264
v_mfma_f32_16x16x32_bf16 a[16:19], a[192:195], v[152:155], a[16:19]
v_exp_f32 v83, v83
v_mfma_f32_16x16x32_bf16 a[48:51], a[192:195], v[156:159], a[48:51]
ds_read_b128 a[160:163], v252 offset:4096
v_mfma_f32_16x16x32_bf16 a[80:83], a[192:195], v[160:163], a[80:83]
v_exp_f32 v84, v84
v_mfma_f32_16x16x32_bf16 a[112:115], a[192:195], v[164:167], a[112:115]
v_cvt_pk_bf16_f32 v145, v82, v83
v_mfma_f32_16x16x32_bf16 v[128:131], a[164:167], v[32:35], v[128:131]
v_exp_f32 v85, v85
v_mfma_f32_16x16x32_bf16 v[132:135], a[164:167], v[36:39], v[132:135]
ds_read_b128 a[192:195], v254 offset:12288
v_mfma_f32_16x16x32_bf16 a[20:23], a[196:199], v[152:155], a[20:23]
v_exp_f32 v86, v86
v_mfma_f32_16x16x32_bf16 a[52:55], a[196:199], v[156:159], a[52:55]
ds_read_b128 a[164:167], v252 offset:5120
v_cvt_pk_bf16_f32 v148, v84, v85
v_mfma_f32_16x16x32_bf16 a[84:87], a[196:199], v[160:163], a[84:87]
v_exp_f32 v87, v87
v_mfma_f32_16x16x32_bf16 a[116:119], a[196:199], v[164:167], a[116:119]
buffer_load_dwordx4 v2, s[20:23], s59 offen offset:3072 sc1 lds
v_mov_b32 v138, 0
v_mfma_f32_16x16x32_bf16 a[136:139], v[184:187], v[160:163], a[136:139]
v_mov_b32 v139, 0
v_mfma_f32_16x16x32_bf16 v[128:131], a[168:171], v[48:51], v[128:131]
v_exp_f32 v92, v92
v_mfma_f32_16x16x32_bf16 v[132:135], a[168:171], v[52:55], v[132:135]
ds_read_b128 a[196:199], v254 offset:13312
v_cvt_pk_bf16_f32 v149, v86, v87
v_mfma_f32_16x16x32_bf16 a[24:27], a[200:203], v[152:155], a[24:27]
v_exp_f32 v93, v93
v_mfma_f32_16x16x32_bf16 a[56:59], a[200:203], v[156:159], a[56:59]
ds_read_b128 a[168:171], v252 offset:6144
v_mfma_f32_16x16x32_bf16 a[88:91], a[200:203], v[160:163], a[88:91]
v_exp_f32 v94, v94
v_mfma_f32_16x16x32_bf16 a[120:123], a[200:203], v[164:167], a[120:123]
v_cndmask_b32 v92, 0, v92, s[70:71]
v_cndmask_b32 v93, 0, v93, s[72:73]
v_mfma_f32_16x16x32_bf16 v[128:131], a[172:175], v[64:67], v[128:131]
v_cvt_pk_bf16_f32 v142, v92, v93
v_mfma_f32_16x16x32_bf16 v[132:135], a[172:175], v[68:71], v[132:135]
ds_read_b128 a[200:203], v254 offset:14336
v_mfma_f32_16x16x32_bf16 a[28:31], a[204:207], v[152:155], a[28:31]
v_exp_f32 v95, v95
v_mfma_f32_16x16x32_bf16 a[60:63], a[204:207], v[156:159], a[60:63]
ds_read_b128 a[172:175], v252 offset:7168
v_mfma_f32_16x16x32_bf16 a[92:95], a[204:207], v[160:163], a[92:95]
v_exp_f32 v96, v96
v_mfma_f32_16x16x32_bf16 a[124:127], a[204:207], v[164:167], a[124:127]
v_cndmask_b32 v94, 0, v94, s[74:75]
v_cndmask_b32 v95, 0, v95, s[76:77]
v_mfma_f32_16x16x32_bf16 a[140:143], v[184:187], v[164:167], a[140:143]
s_add_u32 s59, s59, 16384
v_cvt_pk_bf16_f32 v143, v94, v95
v_exp_f32 v97, v97
v_exp_f32 v98, v98
v_cvt_pk_bf16_f32 v146, v96, v97
v_exp_f32 v99, v99
v_exp_f32 v100, v100
v_cvt_pk_bf16_f32 v147, v98, v99
v_exp_f32 v101, v101
v_exp_f32 v102, v102
v_cvt_pk_bf16_f32 v150, v100, v101
v_exp_f32 v103, v103
s_nop 0
v_cvt_pk_bf16_f32 v151, v102, v103
s_waitcnt lgkmcnt(7)
v_mfma_f32_16x16x32_bf16 v[80:83], a[144:147], v[16:19], v[176:179]
s_and_b32 m0, s59, 0x1ffff
v_mfma_f32_16x16x32_bf16 v[84:87], a[144:147], v[20:23], v[180:183]
ds_read_b128 a[204:207], v254 offset:15360
v_mov_b32 v254, v252
v_mfma_f32_16x16x32_bf16 a[0:3], a[176:179], v[136:139], a[0:3]
v_add_u32 v252, 0x8000, v252
v_and_b32 v252, 0x1ffff, v252
v_mfma_f32_16x16x32_bf16 a[32:35], a[176:179], v[140:143], a[32:35]
ds_read_b128 a[144:147], v253 offset:0
buffer_load_dwordx4 v2, s[20:23], s59 offen offset:0 sc1 lds
v_mfma_f32_16x16x32_bf16 a[64:67], a[176:179], v[144:147], a[64:67]
v_exp_f32 v112, v112
v_mfma_f32_16x16x32_bf16 a[96:99], a[176:179], v[148:151], a[96:99]
v_exp_f32 v113, v113
v_mfma_f32_16x16x32_bf16 v[80:83], a[148:151], v[32:35], v[80:83]
v_exp_f32 v114, v114
v_mfma_f32_16x16x32_bf16 v[84:87], a[148:151], v[36:39], v[84:87]
ds_read_b128 a[176:179], v255 offset:8192
v_cvt_pk_bf16_f32 v160, v112, v113
v_mfma_f32_16x16x32_bf16 a[4:7], a[180:183], v[136:139], a[4:7]
v_exp_f32 v115, v115
v_mfma_f32_16x16x32_bf16 a[36:39], a[180:183], v[140:143], a[36:39]
ds_read_b128 a[148:151], v253 offset:1024
v_mfma_f32_16x16x32_bf16 a[68:71], a[180:183], v[144:147], a[68:71]
v_exp_f32 v116, v116
v_mfma_f32_16x16x32_bf16 a[100:103], a[180:183], v[148:151], a[100:103]
v_cvt_pk_bf16_f32 v161, v114, v115
v_mfma_f32_16x16x32_bf16 a[128:131], v[184:187], v[136:139], a[128:131]
v_exp_f32 v117, v117
v_mfma_f32_16x16x32_bf16 v[80:83], a[152:155], v[48:51], v[80:83]
buffer_load_dwordx4 v2, s[20:23], s59 offen offset:1024 sc1 lds
v_mfma_f32_16x16x32_bf16 v[84:87], a[152:155], v[52:55], v[84:87]
ds_read_b128 a[180:183], v255 offset:9216
v_mfma_f32_16x16x32_bf16 a[8:11], a[184:187], v[136:139], a[8:11]
v_exp_f32 v118, v118
v_mfma_f32_16x16x32_bf16 a[40:43], a[184:187], v[140:143], a[40:43]
ds_read_b128 a[152:155], v253 offset:2048
v_cvt_pk_bf16_f32 v164, v116, v117
v_mfma_f32_16x16x32_bf16 a[72:75], a[184:187], v[144:147], a[72:75]
v_exp_f32 v119, v119
v_mfma_f32_16x16x32_bf16 a[104:107], a[184:187], v[148:151], a[104:107]
v_exp_f32 v128, v128
v_mfma_f32_16x16x32_bf16 v[80:83], a[156:159], v[64:67], v[80:83]
v_cvt_pk_bf16_f32 v165, v118, v119
v_mfma_f32_16x16x32_bf16 v[84:87], a[156:159], v[68:71], v[84:87]
ds_read_b128 a[184:187], v255 offset:10240
v_mfma_f32_16x16x32_bf16 a[12:15], a[188:191], v[136:139], a[12:15]
v_exp_f32 v129, v129
v_mfma_f32_16x16x32_bf16 a[44:47], a[188:191], v[140:143], a[44:47]
ds_read_b128 a[156:159], v253 offset:3072
v_mfma_f32_16x16x32_bf16 a[76:79], a[188:191], v[144:147], a[76:79]
v_exp_f32 v130, v130
v_mfma_f32_16x16x32_bf16 a[108:111], a[188:191], v[148:151], a[108:111]
v_cvt_pk_bf16_f32 v162, v128, v129
v_mfma_f32_16x16x32_bf16 a[132:135], v[184:187], v[140:143], a[132:135]
s_waitcnt lgkmcnt(7)
buffer_load_dwordx4 v2, s[20:23], s59 offen offset:2048 sc1 lds
v_mfma_f32_16x16x32_bf16 v[96:99], a[160:163], v[16:19], v[176:179]
v_exp_f32 v131, v131
v_mfma_f32_16x16x32_bf16 v[100:103], a[160:163], v[20:23], v[180:183]
ds_read_b128 a[188:191], v255 offset:11264
v_mfma_f32_16x16x32_bf16 a[16:19], a[192:195], v[136:139], a[16:19]
v_exp_f32 v132, v132
v_mfma_f32_16x16x32_bf16 a[48:51], a[192:195], v[140:143], a[48:51]
ds_read_b128 a[160:163], v253 offset:4096
v_cvt_pk_bf16_f32 v163, v130, v131
v_mfma_f32_16x16x32_bf16 a[80:83], a[192:195], v[144:147], a[80:83]
v_exp_f32 v133, v133
v_mfma_f32_16x16x32_bf16 a[112:115], a[192:195], v[148:151], a[112:115]
v_exp_f32 v134, v134
v_mfma_f32_16x16x32_bf16 v[96:99], a[164:167], v[32:35], v[96:99]
v_cvt_pk_bf16_f32 v166, v132, v133
v_mfma_f32_16x16x32_bf16 v[100:103], a[164:167], v[36:39], v[100:103]
ds_read_b128 a[192:195], v255 offset:12288
v_mfma_f32_16x16x32_bf16 a[20:23], a[196:199], v[136:139], a[20:23]
v_exp_f32 v135, v135
v_mfma_f32_16x16x32_bf16 a[52:55], a[196:199], v[140:143], a[52:55]
ds_read_b128 a[164:167], v253 offset:5120
v_cvt_pk_bf16_f32 v167, v134, v135
v_mfma_f32_16x16x32_bf16 a[84:87], a[196:199], v[144:147], a[84:87]
v_mfma_f32_16x16x32_bf16 a[116:119], a[196:199], v[148:151], a[116:119]
buffer_load_dwordx4 v2, s[20:23], s59 offen offset:3072 sc1 lds
v_mfma_f32_16x16x32_bf16 a[136:139], v[184:187], v[144:147], a[136:139]
v_mfma_f32_16x16x32_bf16 v[96:99], a[168:171], v[48:51], v[96:99]
v_mfma_f32_16x16x32_bf16 v[100:103], a[168:171], v[52:55], v[100:103]
ds_read_b128 a[196:199], v255 offset:13312
v_mfma_f32_16x16x32_bf16 a[24:27], a[200:203], v[136:139], a[24:27]
v_mfma_f32_16x16x32_bf16 a[56:59], a[200:203], v[140:143], a[56:59]
ds_read_b128 a[168:171], v253 offset:6144
v_mfma_f32_16x16x32_bf16 a[88:91], a[200:203], v[144:147], a[88:91]
v_mfma_f32_16x16x32_bf16 a[120:123], a[200:203], v[148:151], a[120:123]
v_mfma_f32_16x16x32_bf16 v[96:99], a[172:175], v[64:67], v[96:99]
v_mfma_f32_16x16x32_bf16 v[100:103], a[172:175], v[68:71], v[100:103]
ds_read_b128 a[200:203], v255 offset:14336
v_mfma_f32_16x16x32_bf16 a[28:31], a[204:207], v[136:139], a[28:31]
v_mfma_f32_16x16x32_bf16 a[60:63], a[204:207], v[140:143], a[60:63]
ds_read_b128 a[172:175], v253 offset:7168
v_mfma_f32_16x16x32_bf16 a[92:95], a[204:207], v[144:147], a[92:95]
v_mfma_f32_16x16x32_bf16 a[124:127], a[204:207], v[148:151], a[124:127]
v_mfma_f32_16x16x32_bf16 a[140:143], v[184:187], v[148:151], a[140:143]
s_add_u32 s59, s59, 16384
s_waitcnt vmcnt(12)
s_barrier
s_branch KF_after_e
KF_trans_o:
s_waitcnt lgkmcnt(7)
v_mfma_f32_16x16x32_bf16 v[80:83], a[144:147], v[16:19], v[176:179]
s_and_b32 m0, s59, 0x1ffff
v_mfma_f32_16x16x32_bf16 v[84:87], a[144:147], v[20:23], v[180:183]
ds_read_b128 a[204:207], v254 offset:15360
v_mov_b32 v254, v252
v_mfma_f32_16x16x32_bf16 a[0:3], a[176:179], v[136:139], a[0:3]
v_add_u32 v252, 0x8000, v252
v_and_b32 v252, 0x1ffff, v252
v_mfma_f32_16x16x32_bf16 a[32:35], a[176:179], v[140:143], a[32:35]
ds_read_b128 a[144:147], v253 offset:0
buffer_load_dwordx4 v2, s[20:23], s59 offen offset:0 sc1 lds
v_mfma_f32_16x16x32_bf16 a[64:67], a[176:179], v[144:147], a[64:67]
v_exp_f32 v104, v104
v_mfma_f32_16x16x32_bf16 a[96:99], a[176:179], v[148:151], a[96:99]
v_exp_f32 v105, v105
v_mfma_f32_16x16x32_bf16 v[80:83], a[148:151], v[32:35], v[80:83]
v_exp_f32 v106, v106
v_mfma_f32_16x16x32_bf16 v[84:87], a[148:151], v[36:39], v[84:87]
ds_read_b128 a[176:179], v255 offset:8192
v_cndmask_b32 v104, 0, v104, s[70:71]
v_mfma_f32_16x16x32_bf16 a[4:7], a[180:183], v[136:139], a[4:7]
v_cndmask_b32 v105, 0, v105, s[72:73]
v_cvt_pk_bf16_f32 v152, v104, v105
v_mfma_f32_16x16x32_bf16 a[36:39], a[180:183], v[140:143], a[36:39]
ds_read_b128 a[148:151], v253 offset:1024
v_mfma_f32_16x16x32_bf16 a[68:71], a[180:183], v[144:147], a[68:71]
v_exp_f32 v107, v107
v_mfma_f32_16x16x32_bf16 a[100:103], a[180:183], v[148:151], a[100:103]
v_exp_f32 v108, v108
v_mfma_f32_16x16x32_bf16 a[128:131], v[184:187], v[136:139], a[128:131]
v_cndmask_b32 v106, 0, v106, s[74:75]
v_cndmask_b32 v107, 0, v107, s[76:77]
v_mfma_f32_16x16x32_bf16 v[80:83], a[152:155], v[48:51], v[80:83]
buffer_load_dwordx4 v2, s[20:23], s59 offen offset:1024 sc1 lds
v_cvt_pk_bf16_f32 v153, v106, v107
v_mfma_f32_16x16x32_bf16 v[84:87], a[152:155], v[52:55], v[84:87]
ds_read_b128 a[180:183], v255 offset:9216
v_mfma_f32_16x16x32_bf16 a[8:11], a[184:187], v[136:139], a[8:11]
v_exp_f32 v109, v109
v_mfma_f32_16x16x32_bf16 a[40:43], a[184:187], v[140:143], a[40:43]
ds_read_b128 a[152:155], v253 offset:2048
v_mfma_f32_16x16x32_bf16 a[72:75], a[184:187], v[144:147], a[72:75]
v_exp_f32 v110, v110
v_mfma_f32_16x16x32_bf16 a[104:107], a[184:187], v[148:151], a[104:107]
v_cvt_pk_bf16_f32 v156, v108, v109
v_mfma_f32_16x16x32_bf16 v[80:83], a[156:159], v[64:67], v[80:83]
v_exp_f32 v111, v111
v_mfma_f32_16x16x32_bf16 v[84:87], a[156:159], v[68:71], v[84:87]
ds_read_b128 a[184:187], v255 offset:10240
v_mfma_f32_16x16x32_bf16 a[12:15], a[188:191], v[136:139], a[12:15]
v_exp_f32 v112, v112
v_mfma_f32_16x16x32_bf16 a[44:47], a[188:191], v[140:143], a[44:47]
ds_read_b128 a[156:159], v253 offset:3072
v_cvt_pk_bf16_f32 v157, v110, v111
v_mfma_f32_16x16x32_bf16 a[76:79], a[188:191], v[144:147], a[76:79]
v_exp_f32 v113, v113
v_mfma_f32_16x16x32_bf16 a[108:111], a[188:191], v[148:151], a[108:111]
v_exp_f32 v114, v114
v_mfma_f32_16x16x32_bf16 a[132:135], v[184:187], v[140:143], a[132:135]
s_waitcnt lgkmcnt(7)
buffer_load_dwordx4 v2, s[20:23], s59 offen offset:2048 sc1 lds
v_mfma_f32_16x16x32_bf16 v[96:99], a[160:163], v[16:19], v[176:179]
v_cvt_pk_bf16_f32 v160, v112, v113
v_mfma_f32_16x16x32_bf16 v[100:103], a[160:163], v[20:23], v[180:183]
ds_read_b128 a[188:191], v255 offset:11264
v_mfma_f32_16x16x32_bf16 a[16:19], a[192:195], v[136:139], a[16:19]
v_exp_f32 v115, v115
v_mfma_f32_16x16x32_bf16 a[48:51], a[192:195], v[140:143], a[48:51]
ds_read_b128 a[160:163], v253 offset:4096
v_mfma_f32_16x16x32_bf16 a[80:83], a[192:195], v[144:147], a[80:83]
v_exp_f32 v116, v116
v_mfma_f32_16x16x32_bf16 a[112:115], a[192:195], v[148:151], a[112:115]
v_cvt_pk_bf16_f32 v161, v114, v115
v_mfma_f32_16x16x32_bf16 v[96:99], a[164:167], v[32:35], v[96:99]
v_exp_f32 v117, v117
v_mfma_f32_16x16x32_bf16 v[100:103], a[164:167], v[36:39], v[100:103]
ds_read_b128 a[192:195], v255 offset:12288
v_mfma_f32_16x16x32_bf16 a[20:23], a[196:199], v[136:139], a[20:23]
v_exp_f32 v118, v118
v_mfma_f32_16x16x32_bf16 a[52:55], a[196:199], v[140:143], a[52:55]
ds_read_b128 a[164:167], v253 offset:5120
v_cvt_pk_bf16_f32 v164, v116, v117
v_mfma_f32_16x16x32_bf16 a[84:87], a[196:199], v[144:147], a[84:87]
v_exp_f32 v119, v119
v_mfma_f32_16x16x32_bf16 a[116:119], a[196:199], v[148:151], a[116:119]
buffer_load_dwordx4 v2, s[20:23], s59 offen offset:3072 sc1 lds
v_mov_b32 v154, 0
v_mfma_f32_16x16x32_bf16 a[136:139], v[184:187], v[144:147], a[136:139]
v_mov_b32 v155, 0
v_mfma_f32_16x16x32_bf16 v[96:99], a[168:171], v[48:51], v[96:99]
v_exp_f32 v124, v124
v_mfma_f32_16x16x32_bf16 v[100:103], a[168:171], v[52:55], v[100:103]
ds_read_b128 a[196:199], v255 offset:13312
v_cvt_pk_bf16_f32 v165, v118, v119
v_mfma_f32_16x16x32_bf16 a[24:27], a[200:203], v[136:139], a[24:27]
v_exp_f32 v125, v125
v_mfma_f32_16x16x32_bf16 a[56:59], a[200:203], v[140:143], a[56:59]
ds_read_b128 a[168:171], v253 offset:6144
v_mfma_f32_16x16x32_bf16 a[88:91], a[200:203], v[144:147], a[88:91]
v_exp_f32 v126, v126
v_mfma_f32_16x16x32_bf16 a[120:123], a[200:203], v[148:151], a[120:123]
v_cndmask_b32 v124, 0, v124, s[70:71]
v_cndmask_b32 v125, 0, v125, s[72:73]
v_mfma_f32_16x16x32_bf16 v[96:99], a[172:175], v[64:67], v[96:99]
v_cvt_pk_bf16_f32 v158, v124, v125
v_mfma_f32_16x16x32_bf16 v[100:103], a[172:175], v[68:71], v[100:103]
ds_read_b128 a[200:203], v255 offset:14336
v_mfma_f32_16x16x32_bf16 a[28:31], a[204:207], v[136:139], a[28:31]
v_exp_f32 v127, v127
v_mfma_f32_16x16x32_bf16 a[60:63], a[204:207], v[140:143], a[60:63]
ds_read_b128 a[172:175], v253 offset:7168
v_mfma_f32_16x16x32_bf16 a[92:95], a[204:207], v[144:147], a[92:95]
v_exp_f32 v128, v128
v_mfma_f32_16x16x32_bf16 a[124:127], a[204:207], v[148:151], a[124:127]
v_cndmask_b32 v126, 0, v126, s[74:75]
v_cndmask_b32 v127, 0, v127, s[76:77]
v_mfma_f32_16x16x32_bf16 a[140:143], v[184:187], v[148:151], a[140:143]
s_add_u32 s59, s59, 16384
v_cvt_pk_bf16_f32 v159, v126, v127
v_exp_f32 v129, v129
v_exp_f32 v130, v130
v_cvt_pk_bf16_f32 v162, v128, v129
v_exp_f32 v131, v131
v_exp_f32 v132, v132
v_cvt_pk_bf16_f32 v163, v130, v131
v_exp_f32 v133, v133
v_exp_f32 v134, v134
v_cvt_pk_bf16_f32 v166, v132, v133
v_exp_f32 v135, v135
s_nop 0
v_cvt_pk_bf16_f32 v167, v134, v135
s_waitcnt vmcnt(12)
s_barrier
s_cmp_eq_u32 s45, 31
s_cbranch_scc1 KF_special
KF_trans_o2:
s_waitcnt lgkmcnt(7)
v_mfma_f32_16x16x32_bf16 v[112:115], a[144:147], v[16:19], v[176:179]
s_and_b32 m0, s59, 0x1ffff
v_mfma_f32_16x16x32_bf16 v[116:119], a[144:147], v[20:23], v[180:183]
ds_read_b128 a[204:207], v255 offset:15360
v_mov_b32 v255, v253
v_mfma_f32_16x16x32_bf16 a[0:3], a[176:179], v[152:155], a[0:3]
v_add_u32 v253, 0x8000, v253
v_and_b32 v253, 0x1ffff, v253
v_mfma_f32_16x16x32_bf16 a[32:35], a[176:179], v[156:159], a[32:35]
ds_read_b128 a[144:147], v252 offset:0
buffer_load_dwordx4 v2, s[20:23], s59 offen offset:0 sc1 lds
v_mfma_f32_16x16x32_bf16 a[64:67], a[176:179], v[160:163], a[64:67]
v_exp_f32 v80, v80
v_mfma_f32_16x16x32_bf16 a[96:99], a[176:179], v[164:167], a[96:99]
v_exp_f32 v81, v81
v_mfma_f32_16x16x32_bf16 v[112:115], a[148:151], v[32:35], v[112:115]
v_exp_f32 v82, v82
v_mfma_f32_16x16x32_bf16 v[116:119], a[148:151], v[36:39], v[116:119]
ds_read_b128 a[176:179], v254 offset:8192
v_cvt_pk_bf16_f32 v144, v80, v81
v_mfma_f32_16x16x32_bf16 a[4:7], a[180:183], v[152:155], a[4:7]
v_exp_f32 v83, v83
v_mfma_f32_16x16x32_bf16 a[36:39], a[180:183], v[156:159], a[36:39]
ds_read_b128 a[148:151], v252 offset:1024
v_mfma_f32_16x16x32_bf16 a[68:71], a[180:183], v[160:163], a[68:71]
v_exp_f32 v84, v84
v_mfma_f32_16x16x32_bf16 a[100:103], a[180:183], v[164:167], a[100:103]
v_cvt_pk_bf16_f32 v145, v82, v83
v_mfma_f32_16x16x32_bf16 a[128:131], v[184:187], v[152:155], a[128:131]
v_exp_f32 v85, v85
v_mfma_f32_16x16x32_bf16 v[112:115], a[152:155], v[48:51], v[112:115]
buffer_load_dwordx4 v2, s[20:23], s59 offen offset:1024 sc1 lds
v_mfma_f32_16x16x32_bf16 v[116:119], a[152:155], v[52:55], v[116:119]
ds_read_b128 a[180:183], v254 offset:9216
v_mfma_f32_16x16x32_bf16 a[8:11], a[184:187], v[152:155], a[8:11]
v_exp_f32 v86, v86
v_mfma_f32_16x16x32_bf16 a[40:43], a[184:187], v[156:159], a[40:43]
ds_read_b128 a[152:155], v252 offset:2048
v_cvt_pk_bf16_f32 v148, v84, v85
v_mfma_f32_16x16x32_bf16 a[72:75], a[184:187], v[160:163], a[72:75]
v_exp_f32 v87, v87
v_mfma_f32_16x16x32_bf16 a[104:107], a[184:187], v[164:167], a[104:107]
v_exp_f32 v96, v96
v_mfma_f32_16x16x32_bf16 v[112:115], a[156:159], v[64:67], v[112:115]
v_cvt_pk_bf16_f32 v149, v86, v87
v_mfma_f32_16x16x32_bf16 v[116:119], a[156:159], v[68:71], v[116:119]
ds_read_b128 a[184:187], v254 offset:10240
v_mfma_f32_16x16x32_bf16 a[12:15], a[188:191], v[152:155], a[12:15]
v_exp_f32 v97, v97
v_mfma_f32_16x16x32_bf16 a[44:47], a[188:191], v[156:159], a[44:47]
ds_read_b128 a[156:159], v252 offset:3072
v_mfma_f32_16x16x32_bf16 a[76:79], a[188:191], v[160:163], a[76:79]
v_exp_f32 v98, v98
v_mfma_f32_16x16x32_bf16 a[108:111], a[188:191], v[164:167], a[108:111]
v_cvt_pk_bf16_f32 v146, v96, v97
v_mfma_f32_16x16x32_bf16 a[132:135], v[184:187], v[156:159], a[132:135]
s_waitcnt lgkmcnt(7)
buffer_load_dwordx4 v2, s[20:23], s59 offen offset:2048 sc1 lds
v_mfma_f32_16x16x32_bf16 v[128:131], a[160:163], v[16:19], v[176:179]
v_exp_f32 v99, v99
v_mfma_f32_16x16x32_bf16 v[132:135], a[160:163], v[20:23], v[180:183]
ds_read_b128 a[188:191], v254 offset:11264
v_mfma_f32_16x16x32_bf16 a[16:19], a[192:195], v[152:155], a[16:19]
v_exp_f32 v100, v100
v_mfma_f32_16x16x32_bf16 a[48:51], a[192:195], v[156:159], a[48:51]
ds_read_b128 a[160:163], v252 offset:4096
v_cvt_pk_bf16_f32 v147, v98, v99
v_mfma_f32_16x16x32_bf16 a[80:83], a[192:195], v[160:163], a[80:83]
v_exp_f32 v101, v101
v_mfma_f32_16x16x32_bf16 a[112:115], a[192:195], v[164:167], a[112:115]
v_exp_f32 v102, v102
v_mfma_f32_16x16x32_bf16 v[128:131], a[164:167], v[32:35], v[128:131]
v_cvt_pk_bf16_f32 v150, v100, v101
v_mfma_f32_16x16x32_bf16 v[132:135], a[164:167], v[36:39], v[132:135]
ds_read_b128 a[192:195], v254 offset:12288
v_mfma_f32_16x16x32_bf16 a[20:23], a[196:199], v[152:155], a[20:23]
v_exp_f32 v103, v103
v_mfma_f32_16x16x32_bf16 a[52:55], a[196:199], v[156:159], a[52:55]
ds_read_b128 a[164:167], v252 offset:5120
v_cvt_pk_bf16_f32 v151, v102, v103
v_mfma_f32_16x16x32_bf16 a[84:87], a[196:199], v[160:163], a[84:87]
v_mfma_f32_16x16x32_bf16 a[116:119], a[196:199], v[164:167], a[116:119]
buffer_load_dwordx4 v2, s[20:23], s59 offen offset:3072 sc1 lds
v_mfma_f32_16x16x32_bf16 a[136:139], v[184:187], v[160:163], a[136:139]
v_mfma_f32_16x16x32_bf16 v[128:131], a[168:171], v[48:51], v[128:131]
v_mfma_f32_16x16x32_bf16 v[132:135], a[168:171], v[52:55], v[132:135]
ds_read_b128 a[196:199], v254 offset:13312
v_mfma_f32_16x16x32_bf16 a[24:27], a[200:203], v[152:155], a[24:27]
v_mfma_f32_16x16x32_bf16 a[56:59], a[200:203], v[156:159], a[56:59]
ds_read_b128 a[168:171], v252 offset:6144
v_mfma_f32_16x16x32_bf16 a[88:91], a[200:203], v[160:163], a[88:91]
v_mfma_f32_16x16x32_bf16 a[120:123], a[200:203], v[164:167], a[120:123]
v_mfma_f32_16x16x32_bf16 v[128:131], a[172:175], v[64:67], v[128:131]
v_mfma_f32_16x16x32_bf16 v[132:135], a[172:175], v[68:71], v[132:135]
ds_read_b128 a[200:203], v254 offset:14336
v_mfma_f32_16x16x32_bf16 a[28:31], a[204:207], v[152:155], a[28:31]
v_mfma_f32_16x16x32_bf16 a[60:63], a[204:207], v[156:159], a[60:63]
ds_read_b128 a[172:175], v252 offset:7168
v_mfma_f32_16x16x32_bf16 a[92:95], a[204:207], v[160:163], a[92:95]
v_mfma_f32_16x16x32_bf16 a[124:127], a[204:207], v[164:167], a[124:127]
v_mfma_f32_16x16x32_bf16 a[140:143], v[184:187], v[164:167], a[140:143]
s_add_u32 s59, s59, 16384
buffer_load_dword v244, v245, s[32:35], s69 offen sc1
s_branch KF_single_o
KF_after_e:
buffer_load_dword v244, v245, s[32:35], s69 offen sc1
s_mov_b32 s68, 0x53800000
s_cmp_lg_u32 s40, 0
s_cbranch_scc1 KF_nofin
v_accvgpr_read_b32 v188, a128
v_cmp_gt_f32 vcc, s68, v188
s_andn2_b64 s[78:79], exec, vcc
s_or_b32 s78, s78, s79
s_cmp_lg_u32 s78, 0
s_cselect_b32 s78, 1, 0
s_or_b32 s64, s64, s78
v_rcp_f32 v188, v188
v_accvgpr_read_b32 v190, a132
v_cmp_gt_f32 vcc, s68, v190
s_andn2_b64 s[78:79], exec, vcc
s_or_b32 s78, s78, s79
s_cmp_lg_u32 s78, 0
s_cselect_b32 s78, 1, 0
s_or_b32 s64, s64, s78
v_rcp_f32 v190, v190
s_add_u32 s67, s62, 0
v_accvgpr_read_b32 v192, a0
v_accvgpr_read_b32 v193, a1
v_accvgpr_read_b32 v194, a2
v_accvgpr_read_b32 v195, a3
v_accvgpr_read_b32 v196, a4
v_accvgpr_read_b32 v197, a5
v_accvgpr_read_b32 v198, a6
v_accvgpr_read_b32 v199, a7
v_pk_mul_f32 v[192:193], v[192:193], v[188:189] op_sel_hi:[1,0]
v_pk_mul_f32 v[194:195], v[194:195], v[188:189] op_sel_hi:[1,0]
v_pk_mul_f32 v[196:197], v[196:197], v[188:189] op_sel_hi:[1,0]
v_pk_mul_f32 v[198:199], v[198:199], v[188:189] op_sel_hi:[1,0]
v_cvt_pk_bf16_f32 v200, v192, v193
v_cvt_pk_bf16_f32 v201, v194, v195
v_cvt_pk_bf16_f32 v202, v196, v197
v_cvt_pk_bf16_f32 v203, v198, v199
buffer_store_dwordx4 v[200:203], v2, s[28:31], s67 offen offset:0 sc1
v_accvgpr_read_b32 v204, a8
v_accvgpr_read_b32 v205, a9
v_accvgpr_read_b32 v206, a10
v_accvgpr_read_b32 v207, a11
v_accvgpr_read_b32 v208, a12
v_accvgpr_read_b32 v209, a13
v_accvgpr_read_b32 v210, a14
v_accvgpr_read_b32 v211, a15
v_pk_mul_f32 v[204:205], v[204:205], v[188:189] op_sel_hi:[1,0]
v_pk_mul_f32 v[206:207], v[206:207], v[188:189] op_sel_hi:[1,0]
v_pk_mul_f32 v[208:209], v[208:209], v[188:189] op_sel_hi:[1,0]
v_pk_mul_f32 v[210:211], v[210:211], v[188:189] op_sel_hi:[1,0]
v_cvt_pk_bf16_f32 v212, v204, v205
v_cvt_pk_bf16_f32 v213, v206, v207
v_cvt_pk_bf16_f32 v214, v208, v209
v_cvt_pk_bf16_f32 v215, v210, v211
buffer_store_dwordx4 v[212:215], v2, s[28:31], s67 offen offset:1024 sc1
v_accvgpr_read_b32 v192, a16
v_accvgpr_read_b32 v193, a17
v_accvgpr_read_b32 v194, a18
v_accvgpr_read_b32 v195, a19
v_accvgpr_read_b32 v196, a20
v_accvgpr_read_b32 v197, a21
v_accvgpr_read_b32 v198, a22
v_accvgpr_read_b32 v199, a23
v_pk_mul_f32 v[192:193], v[192:193], v[188:189] op_sel_hi:[1,0]
v_pk_mul_f32 v[194:195], v[194:195], v[188:189] op_sel_hi:[1,0]
v_pk_mul_f32 v[196:197], v[196:197], v[188:189] op_sel_hi:[1,0]
v_pk_mul_f32 v[198:199], v[198:199], v[188:189] op_sel_hi:[1,0]
v_cvt_pk_bf16_f32 v200, v192, v193
v_cvt_pk_bf16_f32 v201, v194, v195
v_cvt_pk_bf16_f32 v202, v196, v197
v_cvt_pk_bf16_f32 v203, v198, v199
buffer_store_dwordx4 v[200:203], v2, s[28:31], s67 offen offset:2048 sc1
v_accvgpr_read_b32 v204, a24
v_accvgpr_read_b32 v205, a25
v_accvgpr_read_b32 v206, a26
v_accvgpr_read_b32 v207, a27
v_accvgpr_read_b32 v208, a28
v_accvgpr_read_b32 v209, a29
v_accvgpr_read_b32 v210, a30
v_accvgpr_read_b32 v211, a31
v_pk_mul_f32 v[204:205], v[204:205], v[188:189] op_sel_hi:[1,0]
v_pk_mul_f32 v[206:207], v[206:207], v[188:189] op_sel_hi:[1,0]
v_pk_mul_f32 v[208:209], v[208:209], v[188:189] op_sel_hi:[1,0]
v_pk_mul_f32 v[210:211], v[210:211], v[188:189] op_sel_hi:[1,0]
v_cvt_pk_bf16_f32 v212, v204, v205
v_cvt_pk_bf16_f32 v213, v206, v207
v_cvt_pk_bf16_f32 v214, v208, v209
v_cvt_pk_bf16_f32 v215, v210, v211
buffer_store_dwordx4 v[212:215], v2, s[28:31], s67 offen offset:3072 sc1
s_add_u32 s67, s62, 131072
v_accvgpr_read_b32 v192, a32
v_accvgpr_read_b32 v193, a33
v_accvgpr_read_b32 v194, a34
v_accvgpr_read_b32 v195, a35
v_accvgpr_read_b32 v196, a36
v_accvgpr_read_b32 v197, a37
v_accvgpr_read_b32 v198, a38
v_accvgpr_read_b32 v199, a39
v_pk_mul_f32 v[192:193], v[192:193], v[190:191] op_sel_hi:[1,0]
v_pk_mul_f32 v[194:195], v[194:195], v[190:191] op_sel_hi:[1,0]
v_pk_mul_f32 v[196:197], v[196:197], v[190:191] op_sel_hi:[1,0]
v_pk_mul_f32 v[198:199], v[198:199], v[190:191] op_sel_hi:[1,0]
v_cvt_pk_bf16_f32 v200, v192, v193
v_cvt_pk_bf16_f32 v201, v194, v195
v_cvt_pk_bf16_f32 v202, v196, v197
v_cvt_pk_bf16_f32 v203, v198, v199
buffer_store_dwordx4 v[200:203], v2, s[28:31], s67 offen offset:0 sc1
v_accvgpr_read_b32 v204, a40
v_accvgpr_read_b32 v205, a41
v_accvgpr_read_b32 v206, a42
v_accvgpr_read_b32 v207, a43
v_accvgpr_read_b32 v208, a44
v_accvgpr_read_b32 v209, a45
v_accvgpr_read_b32 v210, a46
v_accvgpr_read_b32 v211, a47
v_pk_mul_f32 v[204:205], v[204:205], v[190:191] op_sel_hi:[1,0]
v_pk_mul_f32 v[206:207], v[206:207], v[190:191] op_sel_hi:[1,0]
v_pk_mul_f32 v[208:209], v[208:209], v[190:191] op_sel_hi:[1,0]
v_pk_mul_f32 v[210:211], v[210:211], v[190:191] op_sel_hi:[1,0]
v_cvt_pk_bf16_f32 v212, v204, v205
v_cvt_pk_bf16_f32 v213, v206, v207
v_cvt_pk_bf16_f32 v214, v208, v209
v_cvt_pk_bf16_f32 v215, v210, v211
buffer_store_dwordx4 v[212:215], v2, s[28:31], s67 offen offset:1024 sc1
v_accvgpr_read_b32 v192, a48
v_accvgpr_read_b32 v193, a49
v_accvgpr_read_b32 v194, a50
v_accvgpr_read_b32 v195, a51
v_accvgpr_read_b32 v196, a52
v_accvgpr_read_b32 v197, a53
v_accvgpr_read_b32 v198, a54
v_accvgpr_read_b32 v199, a55
v_pk_mul_f32 v[192:193], v[192:193], v[190:191] op_sel_hi:[1,0]
v_pk_mul_f32 v[194:195], v[194:195], v[190:191] op_sel_hi:[1,0]
v_pk_mul_f32 v[196:197], v[196:197], v[190:191] op_sel_hi:[1,0]
v_pk_mul_f32 v[198:199], v[198:199], v[190:191] op_sel_hi:[1,0]
v_cvt_pk_bf16_f32 v200, v192, v193
v_cvt_pk_bf16_f32 v201, v194, v195
v_cvt_pk_bf16_f32 v202, v196, v197
v_cvt_pk_bf16_f32 v203, v198, v199
buffer_store_dwordx4 v[200:203], v2, s[28:31], s67 offen offset:2048 sc1
v_accvgpr_read_b32 v204, a56
v_accvgpr_read_b32 v205, a57
v_accvgpr_read_b32 v206, a58
v_accvgpr_read_b32 v207, a59
v_accvgpr_read_b32 v208, a60
v_accvgpr_read_b32 v209, a61
v_accvgpr_read_b32 v210, a62
v_accvgpr_read_b32 v211, a63
v_pk_mul_f32 v[204:205], v[204:205], v[190:191] op_sel_hi:[1,0]
v_pk_mul_f32 v[206:207], v[206:207], v[190:191] op_sel_hi:[1,0]
v_pk_mul_f32 v[208:209], v[208:209], v[190:191] op_sel_hi:[1,0]
v_pk_mul_f32 v[210:211], v[210:211], v[190:191] op_sel_hi:[1,0]
v_cvt_pk_bf16_f32 v212, v204, v205
v_cvt_pk_bf16_f32 v213, v206, v207
v_cvt_pk_bf16_f32 v214, v208, v209
v_cvt_pk_bf16_f32 v215, v210, v211
buffer_store_dwordx4 v[212:215], v2, s[28:31], s67 offen offset:3072 sc1
KF_nofin:
s_cmp_ge_u32 s59, s61
s_cbranch_scc1 KF_tails
KF_single:
s_cmp_ge_u32 s59, s84
s_cbranch_scc1 KF_wd
KF_wd_back:
s_waitcnt lgkmcnt(7)
v_mfma_f32_16x16x32_bf16 v[112:115], a[144:147], v[16:19], v[176:179]
v_exp_f32 v80, v80
v_mfma_f32_16x16x32_bf16 v[116:119], a[144:147], v[20:23], v[180:183]
ds_read_b128 a[204:207], v255 offset:15360
s_and_b32 m0, s59, 0x1ffff
v_mfma_f32_16x16x32_bf16 a[64:67], a[176:179], v[160:163], a[64:67]
v_exp_f32 v81, v81
v_mfma_f32_16x16x32_bf16 a[96:99], a[176:179], v[164:167], a[96:99]
ds_read_b128 a[144:147], v252 offset:0
v_cvt_pk_bf16_f32 v144, v80, v81
v_mfma_f32_16x16x32_bf16 v[112:115], a[148:151], v[32:35], v[112:115]
v_exp_f32 v82, v82
v_mfma_f32_16x16x32_bf16 v[116:119], a[148:151], v[36:39], v[116:119]
ds_read_b128 a[176:179], v254 offset:8192
buffer_load_dwordx4 v2, s[20:23], s59 offen offset:0 sc1 lds
v_mfma_f32_16x16x32_bf16 a[68:71], a[180:183], v[160:163], a[68:71]
v_exp_f32 v83, v83
v_mfma_f32_16x16x32_bf16 a[100:103], a[180:183], v[164:167], a[100:103]
ds_read_b128 a[148:151], v252 offset:1024
v_cvt_pk_bf16_f32 v145, v82, v83
v_mfma_f32_16x16x32_bf16 v[112:115], a[152:155], v[48:51], v[112:115]
v_exp_f32 v84, v84
v_mfma_f32_16x16x32_bf16 v[116:119], a[152:155], v[52:55], v[116:119]
ds_read_b128 a[180:183], v254 offset:9216
v_mov_b32 v255, v253
v_mfma_f32_16x16x32_bf16 a[72:75], a[184:187], v[160:163], a[72:75]
v_exp_f32 v85, v85
v_mfma_f32_16x16x32_bf16 a[104:107], a[184:187], v[164:167], a[104:107]
ds_read_b128 a[152:155], v252 offset:2048
v_cvt_pk_bf16_f32 v148, v84, v85
v_mfma_f32_16x16x32_bf16 v[112:115], a[156:159], v[64:67], v[112:115]
v_exp_f32 v86, v86
v_mfma_f32_16x16x32_bf16 v[116:119], a[156:159], v[68:71], v[116:119]
ds_read_b128 a[184:187], v254 offset:10240
buffer_load_dwordx4 v2, s[20:23], s59 offen offset:1024 sc1 lds
v_mfma_f32_16x16x32_bf16 a[76:79], a[188:191], v[160:163], a[76:79]
v_exp_f32 v87, v87
v_mfma_f32_16x16x32_bf16 a[108:111], a[188:191], v[164:167], a[108:111]
ds_read_b128 a[156:159], v252 offset:3072
v_cvt_pk_bf16_f32 v149, v86, v87
v_mfma_f32_16x16x32_bf16 a[136:139], v[184:187], v[160:163], a[136:139]
s_waitcnt lgkmcnt(7)
v_mfma_f32_16x16x32_bf16 v[128:131], a[160:163], v[16:19], v[176:179]
v_exp_f32 v96, v96
v_mfma_f32_16x16x32_bf16 v[132:135], a[160:163], v[20:23], v[180:183]
ds_read_b128 a[188:191], v254 offset:11264
v_add_u32 v253, 0x8000, v253
v_mfma_f32_16x16x32_bf16 a[80:83], a[192:195], v[160:163], a[80:83]
v_exp_f32 v97, v97
v_mfma_f32_16x16x32_bf16 a[112:115], a[192:195], v[164:167], a[112:115]
ds_read_b128 a[160:163], v252 offset:4096
v_cvt_pk_bf16_f32 v146, v96, v97
v_mfma_f32_16x16x32_bf16 v[128:131], a[164:167], v[32:35], v[128:131]
v_exp_f32 v98, v98
v_mfma_f32_16x16x32_bf16 v[132:135], a[164:167], v[36:39], v[132:135]
ds_read_b128 a[192:195], v254 offset:12288
buffer_load_dwordx4 v2, s[20:23], s59 offen offset:2048 sc1 lds
v_mfma_f32_16x16x32_bf16 a[84:87], a[196:199], v[160:163], a[84:87]
v_exp_f32 v99, v99
v_mfma_f32_16x16x32_bf16 a[116:119], a[196:199], v[164:167], a[116:119]
ds_read_b128 a[164:167], v252 offset:5120
v_cvt_pk_bf16_f32 v147, v98, v99
v_mfma_f32_16x16x32_bf16 v[128:131], a[168:171], v[48:51], v[128:131]
v_exp_f32 v100, v100
v_mfma_f32_16x16x32_bf16 v[132:135], a[168:171], v[52:55], v[132:135]
ds_read_b128 a[196:199], v254 offset:13312
v_and_b32 v253, 0x1ffff, v253
v_mfma_f32_16x16x32_bf16 a[88:91], a[200:203], v[160:163], a[88:91]
v_exp_f32 v101, v101
v_mfma_f32_16x16x32_bf16 a[120:123], a[200:203], v[164:167], a[120:123]
ds_read_b128 a[168:171], v252 offset:6144
v_cvt_pk_bf16_f32 v150, v100, v101
v_mfma_f32_16x16x32_bf16 v[128:131], a[172:175], v[64:67], v[128:131]
v_exp_f32 v102, v102
v_mfma_f32_16x16x32_bf16 v[132:135], a[172:175], v[68:71], v[132:135]
ds_read_b128 a[200:203], v254 offset:14336
buffer_load_dwordx4 v2, s[20:23], s59 offen offset:3072 sc1 lds
v_mfma_f32_16x16x32_bf16 a[92:95], a[204:207], v[160:163], a[92:95]
v_exp_f32 v103, v103
v_mfma_f32_16x16x32_bf16 a[124:127], a[204:207], v[164:167], a[124:127]
ds_read_b128 a[172:175], v252 offset:7168
v_cvt_pk_bf16_f32 v151, v102, v103
v_mfma_f32_16x16x32_bf16 a[140:143], v[184:187], v[164:167], a[140:143]
s_add_u32 s59, s59, 16384
KF_single_o:
s_waitcnt lgkmcnt(7)
v_mfma_f32_16x16x32_bf16 v[80:83], a[144:147], v[16:19], v[176:179]
v_exp_f32 v112, v112
v_mfma_f32_16x16x32_bf16 v[84:87], a[144:147], v[20:23], v[180:183]
ds_read_b128 a[204:207], v254 offset:15360
s_and_b32 m0, s59, 0x1ffff
v_mfma_f32_16x16x32_bf16 a[64:67], a[176:179], v[144:147], a[64:67]
v_exp_f32 v113, v113
v_mfma_f32_16x16x32_bf16 a[96:99], a[176:179], v[148:151], a[96:99]
ds_read_b128 a[144:147], v253 offset:0
v_cvt_pk_bf16_f32 v160, v112, v113
v_mfma_f32_16x16x32_bf16 v[80:83], a[148:151], v[32:35], v[80:83]
v_exp_f32 v114, v114
v_mfma_f32_16x16x32_bf16 v[84:87], a[148:151], v[36:39], v[84:87]
ds_read_b128 a[176:179], v255 offset:8192
buffer_load_dwordx4 v2, s[20:23], s59 offen offset:0 sc1 lds
v_mfma_f32_16x16x32_bf16 a[68:71], a[180:183], v[144:147], a[68:71]
v_exp_f32 v115, v115
v_mfma_f32_16x16x32_bf16 a[100:103], a[180:183], v[148:151], a[100:103]
ds_read_b128 a[148:151], v253 offset:1024
v_cvt_pk_bf16_f32 v161, v114, v115
v_mfma_f32_16x16x32_bf16 v[80:83], a[152:155], v[48:51], v[80:83]
v_exp_f32 v116, v116
v_mfma_f32_16x16x32_bf16 v[84:87], a[152:155], v[52:55], v[84:87]
ds_read_b128 a[180:183], v255 offset:9216
v_mov_b32 v254, v252
v_mfma_f32_16x16x32_bf16 a[72:75], a[184:187], v[144:147], a[72:75]
v_exp_f32 v117, v117
v_mfma_f32_16x16x32_bf16 a[104:107], a[184:187], v[148:151], a[104:107]
ds_read_b128 a[152:155], v253 offset:2048
v_cvt_pk_bf16_f32 v164, v116, v117
v_mfma_f32_16x16x32_bf16 v[80:83], a[156:159], v[64:67], v[80:83]
v_exp_f32 v118, v118
v_mfma_f32_16x16x32_bf16 v[84:87], a[156:159], v[68:71], v[84:87]
ds_read_b128 a[184:187], v255 offset:10240
buffer_load_dwordx4 v2, s[20:23], s59 offen offset:1024 sc1 lds
v_mfma_f32_16x16x32_bf16 a[76:79], a[188:191], v[144:147], a[76:79]
v_exp_f32 v119, v119
v_mfma_f32_16x16x32_bf16 a[108:111], a[188:191], v[148:151], a[108:111]
ds_read_b128 a[156:159], v253 offset:3072
v_cvt_pk_bf16_f32 v165, v118, v119
v_mfma_f32_16x16x32_bf16 a[136:139], v[184:187], v[144:147], a[136:139]
s_waitcnt lgkmcnt(7)
v_mfma_f32_16x16x32_bf16 v[96:99], a[160:163], v[16:19], v[176:179]
v_exp_f32 v128, v128
v_mfma_f32_16x16x32_bf16 v[100:103], a[160:163], v[20:23], v[180:183]
ds_read_b128 a[188:191], v255 offset:11264
v_add_u32 v252, 0x8000, v252
v_mfma_f32_16x16x32_bf16 a[80:83], a[192:195], v[144:147], a[80:83]
v_exp_f32 v129, v129
v_mfma_f32_16x16x32_bf16 a[112:115], a[192:195], v[148:151], a[112:115]
ds_read_b128 a[160:163], v253 offset:4096
v_cvt_pk_bf16_f32 v162, v128, v129
v_mfma_f32_16x16x32_bf16 v[96:99], a[164:167], v[32:35], v[96:99]
v_exp_f32 v130, v130
v_mfma_f32_16x16x32_bf16 v[100:103], a[164:167], v[36:39], v[100:103]
ds_read_b128 a[192:195], v255 offset:12288
buffer_load_dwordx4 v2, s[20:23], s59 offen offset:2048 sc1 lds
v_mfma_f32_16x16x32_bf16 a[84:87], a[196:199], v[144:147], a[84:87]
v_exp_f32 v131, v131
v_mfma_f32_16x16x32_bf16 a[116:119], a[196:199], v[148:151], a[116:119]
ds_read_b128 a[164:167], v253 offset:5120
v_cvt_pk_bf16_f32 v163, v130, v131
v_mfma_f32_16x16x32_bf16 v[96:99], a[168:171], v[48:51], v[96:99]
v_exp_f32 v132, v132
v_mfma_f32_16x16x32_bf16 v[100:103], a[168:171], v[52:55], v[100:103]
ds_read_b128 a[196:199], v255 offset:13312
v_and_b32 v252, 0x1ffff, v252
v_mfma_f32_16x16x32_bf16 a[88:91], a[200:203], v[144:147], a[88:91]
v_exp_f32 v133, v133
v_mfma_f32_16x16x32_bf16 a[120:123], a[200:203], v[148:151], a[120:123]
ds_read_b128 a[168:171], v253 offset:6144
v_cvt_pk_bf16_f32 v166, v132, v133
v_mfma_f32_16x16x32_bf16 v[96:99], a[172:175], v[64:67], v[96:99]
v_exp_f32 v134, v134
v_mfma_f32_16x16x32_bf16 v[100:103], a[172:175], v[68:71], v[100:103]
ds_read_b128 a[200:203], v255 offset:14336
buffer_load_dwordx4 v2, s[20:23], s59 offen offset:3072 sc1 lds
v_mfma_f32_16x16x32_bf16 a[92:95], a[204:207], v[144:147], a[92:95]
v_exp_f32 v135, v135
v_mfma_f32_16x16x32_bf16 a[124:127], a[204:207], v[148:151], a[124:127]
ds_read_b128 a[172:175], v253 offset:7168
v_cvt_pk_bf16_f32 v167, v134, v135
v_mfma_f32_16x16x32_bf16 a[140:143], v[184:187], v[148:151], a[140:143]
s_add_u32 s59, s59, 16384
s_waitcnt vmcnt(12)
s_barrier
s_cmp_ge_u32 s59, s61
s_cbranch_scc0 KF_single
KF_tails:
s_waitcnt vmcnt(0)
v_cmp_le_u32 vcc, 32, v244
s_cmp_eq_u64 vcc, exec
s_cbranch_scc0 KF_h_spin
KF_h_back:
s_cmp_eq_u32 s40, 3
s_cbranch_scc1 KF_tail3
s_waitcnt lgkmcnt(7)
v_mfma_f32_16x16x32_bf16 v[112:115], a[144:147], v[16:19], v[176:179]
v_exp_f32 v80, v80
v_mfma_f32_16x16x32_bf16 v[116:119], a[144:147], v[20:23], v[180:183]
ds_read_b128 a[204:207], v255 offset:15360
v_mfma_f32_16x16x32_bf16 a[64:67], a[176:179], v[160:163], a[64:67]
v_exp_f32 v81, v81
v_mfma_f32_16x16x32_bf16 a[96:99], a[176:179], v[164:167], a[96:99]
ds_read_b128 a[144:147], v252 offset:0
v_cvt_pk_bf16_f32 v144, v80, v81
v_mfma_f32_16x16x32_bf16 v[112:115], a[148:151], v[32:35], v[112:115]
v_exp_f32 v82, v82
v_mfma_f32_16x16x32_bf16 v[116:119], a[148:151], v[36:39], v[116:119]
ds_read_b128 a[176:179], v254 offset:8192
v_mfma_f32_16x16x32_bf16 a[68:71], a[180:183], v[160:163], a[68:71]
v_exp_f32 v83, v83
v_mfma_f32_16x16x32_bf16 a[100:103], a[180:183], v[164:167], a[100:103]
ds_read_b128 a[148:151], v252 offset:1024
v_cvt_pk_bf16_f32 v145, v82, v83
v_mfma_f32_16x16x32_bf16 v[112:115], a[152:155], v[48:51], v[112:115]
v_exp_f32 v84, v84
v_mfma_f32_16x16x32_bf16 v[116:119], a[152:155], v[52:55], v[116:119]
ds_read_b128 a[180:183], v254 offset:9216
v_mov_b32 v255, v253
v_mfma_f32_16x16x32_bf16 a[72:75], a[184:187], v[160:163], a[72:75]
v_exp_f32 v85, v85
v_mfma_f32_16x16x32_bf16 a[104:107], a[184:187], v[164:167], a[104:107]
ds_read_b128 a[152:155], v252 offset:2048
v_cvt_pk_bf16_f32 v148, v84, v85
v_mfma_f32_16x16x32_bf16 v[112:115], a[156:159], v[64:67], v[112:115]
v_exp_f32 v86, v86
v_mfma_f32_16x16x32_bf16 v[116:119], a[156:159], v[68:71], v[116:119]
ds_read_b128 a[184:187], v254 offset:10240
v_mfma_f32_16x16x32_bf16 a[76:79], a[188:191], v[160:163], a[76:79]
v_exp_f32 v87, v87
v_mfma_f32_16x16x32_bf16 a[108:111], a[188:191], v[164:167], a[108:111]
ds_read_b128 a[156:159], v252 offset:3072
v_cvt_pk_bf16_f32 v149, v86, v87
v_mfma_f32_16x16x32_bf16 a[136:139], v[184:187], v[160:163], a[136:139]
s_waitcnt lgkmcnt(7)
v_mfma_f32_16x16x32_bf16 v[128:131], a[160:163], v[16:19], v[176:179]
v_exp_f32 v96, v96
v_mfma_f32_16x16x32_bf16 v[132:135], a[160:163], v[20:23], v[180:183]
ds_read_b128 a[188:191], v254 offset:11264
v_add_u32 v253, 0x8000, v253
v_mfma_f32_16x16x32_bf16 a[80:83], a[192:195], v[160:163], a[80:83]
v_exp_f32 v97, v97
v_mfma_f32_16x16x32_bf16 a[112:115], a[192:195], v[164:167], a[112:115]
ds_read_b128 a[160:163], v252 offset:4096
v_cvt_pk_bf16_f32 v146, v96, v97
v_mfma_f32_16x16x32_bf16 v[128:131], a[164:167], v[32:35], v[128:131]
v_exp_f32 v98, v98
v_mfma_f32_16x16x32_bf16 v[132:135], a[164:167], v[36:39], v[132:135]
ds_read_b128 a[192:195], v254 offset:12288
v_mfma_f32_16x16x32_bf16 a[84:87], a[196:199], v[160:163], a[84:87]
v_exp_f32 v99, v99
v_mfma_f32_16x16x32_bf16 a[116:119], a[196:199], v[164:167], a[116:119]
ds_read_b128 a[164:167], v252 offset:5120
v_cvt_pk_bf16_f32 v147, v98, v99
v_mfma_f32_16x16x32_bf16 v[128:131], a[168:171], v[48:51], v[128:131]
v_exp_f32 v100, v100
v_mfma_f32_16x16x32_bf16 v[132:135], a[168:171], v[52:55], v[132:135]
ds_read_b128 a[196:199], v254 offset:13312
v_and_b32 v253, 0x1ffff, v253
v_mfma_f32_16x16x32_bf16 a[88:91], a[200:203], v[160:163], a[88:91]
v_exp_f32 v101, v101
v_mfma_f32_16x16x32_bf16 a[120:123], a[200:203], v[164:167], a[120:123]
ds_read_b128 a[168:171], v252 offset:6144
v_cvt_pk_bf16_f32 v150, v100, v101
v_mfma_f32_16x16x32_bf16 v[128:131], a[172:175], v[64:67], v[128:131]
v_exp_f32 v102, v102
v_mfma_f32_16x16x32_bf16 v[132:135], a[172:175], v[68:71], v[132:135]
ds_read_b128 a[200:203], v254 offset:14336
v_mfma_f32_16x16x32_bf16 a[92:95], a[204:207], v[160:163], a[92:95]
v_exp_f32 v103, v103
v_mfma_f32_16x16x32_bf16 a[124:127], a[204:207], v[164:167], a[124:127]
ds_read_b128 a[172:175], v252 offset:7168
v_cvt_pk_bf16_f32 v151, v102, v103
v_mfma_f32_16x16x32_bf16 a[140:143], v[184:187], v[164:167], a[140:143]
s_waitcnt vmcnt(0)
s_barrier
s_cmp_eq_u32 s40, 2
s_cbranch_scc1 KF_tail2
s_waitcnt lgkmcnt(7)
v_mfma_f32_16x16x32_bf16 v[80:83], a[144:147], v[16:19], v[176:179]
v_exp_f32 v112, v112
v_mfma_f32_16x16x32_bf16 v[84:87], a[144:147], v[20:23], v[180:183]
ds_read_b128 a[204:207], v254 offset:15360
s_add_u32 m0, s41, 131072
v_mfma_f32_16x16x32_bf16 a[64:67], a[176:179], v[144:147], a[64:67]
v_exp_f32 v113, v113
v_mfma_f32_16x16x32_bf16 a[96:99], a[176:179], v[148:151], a[96:99]
ds_read_b128 a[144:147], v253 offset:0
v_cvt_pk_bf16_f32 v160, v112, v113
v_mfma_f32_16x16x32_bf16 v[80:83], a[148:151], v[32:35], v[80:83]
v_exp_f32 v114, v114
v_mfma_f32_16x16x32_bf16 v[84:87], a[148:151], v[36:39], v[84:87]
ds_read_b128 a[176:179], v255 offset:8192
s_add_u32 s65, s47, 0
v_mfma_f32_16x16x32_bf16 a[68:71], a[180:183], v[144:147], a[68:71]
v_exp_f32 v115, v115
buffer_load_dwordx4 v236, s[24:27], s65 offen offset:0 sc1 lds
v_mfma_f32_16x16x32_bf16 a[100:103], a[180:183], v[148:151], a[100:103]
ds_read_b128 a[148:151], v253 offset:1024
v_cvt_pk_bf16_f32 v161, v114, v115
v_mfma_f32_16x16x32_bf16 v[80:83], a[152:155], v[48:51], v[80:83]
v_exp_f32 v116, v116
v_mfma_f32_16x16x32_bf16 v[84:87], a[152:155], v[52:55], v[84:87]
ds_read_b128 a[180:183], v255 offset:9216
v_mov_b32 v254, v252
v_mfma_f32_16x16x32_bf16 a[72:75], a[184:187], v[144:147], a[72:75]
v_exp_f32 v117, v117
buffer_load_dwordx4 v237, s[24:27], s65 offen offset:1024 sc1 lds
v_mfma_f32_16x16x32_bf16 a[104:107], a[184:187], v[148:151], a[104:107]
ds_read_b128 a[152:155], v253 offset:2048
v_cvt_pk_bf16_f32 v164, v116, v117
v_mfma_f32_16x16x32_bf16 v[80:83], a[156:159], v[64:67], v[80:83]
v_exp_f32 v118, v118
v_mfma_f32_16x16x32_bf16 v[84:87], a[156:159], v[68:71], v[84:87]
ds_read_b128 a[184:187], v255 offset:10240
s_add_u32 m0, s41, 133120
v_mfma_f32_16x16x32_bf16 a[76:79], a[188:191], v[144:147], a[76:79]
v_exp_f32 v119, v119
v_mfma_f32_16x16x32_bf16 a[108:111], a[188:191], v[148:151], a[108:111]
ds_read_b128 a[156:159], v253 offset:3072
v_cvt_pk_bf16_f32 v165, v118, v119
v_mfma_f32_16x16x32_bf16 a[136:139], v[184:187], v[144:147], a[136:139]
s_waitcnt lgkmcnt(7)
s_add_u32 s66, s49, 0
v_mfma_f32_16x16x32_bf16 v[96:99], a[160:163], v[16:19], v[176:179]
v_exp_f32 v128, v128
v_mfma_f32_16x16x32_bf16 v[100:103], a[160:163], v[20:23], v[180:183]
ds_read_b128 a[188:191], v255 offset:11264
v_add_u32 v252, 0x8000, v252
buffer_load_dwordx4 v238, s[8:11], s66 offen offset:0 lds
v_mfma_f32_16x16x32_bf16 a[80:83], a[192:195], v[144:147], a[80:83]
v_exp_f32 v129, v129
v_mfma_f32_16x16x32_bf16 a[112:115], a[192:195], v[148:151], a[112:115]
ds_read_b128 a[160:163], v253 offset:4096
v_cvt_pk_bf16_f32 v162, v128, v129
v_mfma_f32_16x16x32_bf16 v[96:99], a[164:167], v[32:35], v[96:99]
v_exp_f32 v130, v130
v_mfma_f32_16x16x32_bf16 v[100:103], a[164:167], v[36:39], v[100:103]
ds_read_b128 a[192:195], v255 offset:12288
buffer_load_dwordx4 v239, s[8:11], s66 offen offset:1024 lds
v_mfma_f32_16x16x32_bf16 a[84:87], a[196:199], v[144:147], a[84:87]
v_exp_f32 v131, v131
v_mfma_f32_16x16x32_bf16 a[116:119], a[196:199], v[148:151], a[116:119]
ds_read_b128 a[164:167], v253 offset:5120
v_cvt_pk_bf16_f32 v163, v130, v131
v_mfma_f32_16x16x32_bf16 v[96:99], a[168:171], v[48:51], v[96:99]
v_exp_f32 v132, v132
v_mfma_f32_16x16x32_bf16 v[100:103], a[168:171], v[52:55], v[100:103]
ds_read_b128 a[196:199], v255 offset:13312
v_and_b32 v252, 0x1ffff, v252
v_mfma_f32_16x16x32_bf16 a[88:91], a[200:203], v[144:147], a[88:91]
v_exp_f32 v133, v133
v_mfma_f32_16x16x32_bf16 a[120:123], a[200:203], v[148:151], a[120:123]
ds_read_b128 a[168:171], v253 offset:6144
v_cvt_pk_bf16_f32 v166, v132, v133
v_mfma_f32_16x16x32_bf16 v[96:99], a[172:175], v[64:67], v[96:99]
v_exp_f32 v134, v134
v_mfma_f32_16x16x32_bf16 v[100:103], a[172:175], v[68:71], v[100:103]
ds_read_b128 a[200:203], v255 offset:14336
s_add_u32 m0, s41, 147456
v_mfma_f32_16x16x32_bf16 a[92:95], a[204:207], v[144:147], a[92:95]
v_exp_f32 v135, v135
v_mfma_f32_16x16x32_bf16 a[124:127], a[204:207], v[148:151], a[124:127]
ds_read_b128 a[172:175], v253 offset:7168
v_cvt_pk_bf16_f32 v167, v134, v135
s_add_u32 s65, s47, 1024
buffer_load_dwordx4 v236, s[24:27], s65 offen offset:0 sc1 lds
buffer_load_dwordx4 v237, s[24:27], s65 offen offset:1024 sc1 lds
s_add_u32 m0, s41, 149504
s_add_u32 s66, s49, 32768
buffer_load_dwordx4 v238, s[8:11], s66 offen offset:0 lds
buffer_load_dwordx4 v239, s[8:11], s66 offen offset:1024 lds
v_mfma_f32_16x16x32_bf16 a[140:143], v[184:187], v[148:151], a[140:143]
s_cmp_eq_u32 s40, 1
s_cbranch_scc1 KF_tail1
s_waitcnt lgkmcnt(7)
v_mfma_f32_16x16x32_bf16 v[112:115], a[144:147], v[16:19], v[176:179]
v_exp_f32 v80, v80
v_mfma_f32_16x16x32_bf16 v[116:119], a[144:147], v[20:23], v[180:183]
ds_read_b128 a[204:207], v255 offset:15360
s_add_u32 m0, s51, 0
v_mfma_f32_16x16x32_bf16 a[64:67], a[176:179], v[160:163], a[64:67]
v_exp_f32 v81, v81
v_mfma_f32_16x16x32_bf16 a[96:99], a[176:179], v[164:167], a[96:99]
v_cvt_pk_bf16_f32 v144, v80, v81
s_add_u32 s65, s47, 2048
v_mfma_f32_16x16x32_bf16 v[112:115], a[148:151], v[32:35], v[112:115]
v_exp_f32 v82, v82
v_mfma_f32_16x16x32_bf16 v[116:119], a[148:151], v[36:39], v[116:119]
ds_read_b128 a[176:179], v254 offset:8192
v_mfma_f32_16x16x32_bf16 a[68:71], a[180:183], v[160:163], a[68:71]
v_exp_f32 v83, v83
buffer_load_dwordx4 v236, s[24:27], s65 offen offset:0 sc1 lds
v_mfma_f32_16x16x32_bf16 a[100:103], a[180:183], v[164:167], a[100:103]
v_cvt_pk_bf16_f32 v145, v82, v83
v_mfma_f32_16x16x32_bf16 v[112:115], a[152:155], v[48:51], v[112:115]
v_exp_f32 v84, v84
v_mfma_f32_16x16x32_bf16 v[116:119], a[152:155], v[52:55], v[116:119]
ds_read_b128 a[180:183], v254 offset:9216
v_mov_b32 v255, v253
v_mfma_f32_16x16x32_bf16 a[72:75], a[184:187], v[160:163], a[72:75]
v_exp_f32 v85, v85
buffer_load_dwordx4 v237, s[24:27], s65 offen offset:1024 sc1 lds
v_mfma_f32_16x16x32_bf16 a[104:107], a[184:187], v[164:167], a[104:107]
v_cvt_pk_bf16_f32 v148, v84, v85
s_add_u32 m0, s51, 2048
v_mfma_f32_16x16x32_bf16 v[112:115], a[156:159], v[64:67], v[112:115]
v_exp_f32 v86, v86
v_mfma_f32_16x16x32_bf16 v[116:119], a[156:159], v[68:71], v[116:119]
ds_read_b128 a[184:187], v254 offset:10240
s_add_u32 s66, s49, 65536
v_mfma_f32_16x16x32_bf16 a[76:79], a[188:191], v[160:163], a[76:79]
v_exp_f32 v87, v87
buffer_load_dwordx4 v238, s[8:11], s66 offen offset:0 lds
v_mfma_f32_16x16x32_bf16 a[108:111], a[188:191], v[164:167], a[108:111]
v_cvt_pk_bf16_f32 v149, v86, v87
v_mfma_f32_16x16x32_bf16 a[136:139], v[184:187], v[160:163], a[136:139]
s_waitcnt lgkmcnt(3)
v_mfma_f32_16x16x32_bf16 v[128:131], a[160:163], v[16:19], v[176:179]
v_exp_f32 v96, v96
v_mfma_f32_16x16x32_bf16 v[132:135], a[160:163], v[20:23], v[180:183]
ds_read_b128 a[188:191], v254 offset:11264
v_add_u32 v253, 0x8000, v253
buffer_load_dwordx4 v239, s[8:11], s66 offen offset:1024 lds
v_mfma_f32_16x16x32_bf16 a[80:83], a[192:195], v[160:163], a[80:83]
v_exp_f32 v97, v97
v_mfma_f32_16x16x32_bf16 a[112:115], a[192:195], v[164:167], a[112:115]
v_cvt_pk_bf16_f32 v146, v96, v97
v_mfma_f32_16x16x32_bf16 v[128:131], a[164:167], v[32:35], v[128:131]
v_exp_f32 v98, v98
v_mfma_f32_16x16x32_bf16 v[132:135], a[164:167], v[36:39], v[132:135]
ds_read_b128 a[192:195], v254 offset:12288
v_mfma_f32_16x16x32_bf16 a[84:87], a[196:199], v[160:163], a[84:87]
v_exp_f32 v99, v99
v_mfma_f32_16x16x32_bf16 a[116:119], a[196:199], v[164:167], a[116:119]
v_cvt_pk_bf16_f32 v147, v98, v99
v_mfma_f32_16x16x32_bf16 v[128:131], a[168:171], v[48:51], v[128:131]
v_exp_f32 v100, v100
v_mfma_f32_16x16x32_bf16 v[132:135], a[168:171], v[52:55], v[132:135]
ds_read_b128 a[196:199], v254 offset:13312
v_and_b32 v253, 0x1ffff, v253
v_mfma_f32_16x16x32_bf16 a[88:91], a[200:203], v[160:163], a[88:91]
v_exp_f32 v101, v101
v_mfma_f32_16x16x32_bf16 a[120:123], a[200:203], v[164:167], a[120:123]
v_cvt_pk_bf16_f32 v150, v100, v101
v_mfma_f32_16x16x32_bf16 v[128:131], a[172:175], v[64:67], v[128:131]
v_exp_f32 v102, v102
v_mfma_f32_16x16x32_bf16 v[132:135], a[172:175], v[68:71], v[132:135]
ds_read_b128 a[200:203], v254 offset:14336
v_mfma_f32_16x16x32_bf16 a[92:95], a[204:207], v[160:163], a[92:95]
v_exp_f32 v103, v103
v_mfma_f32_16x16x32_bf16 a[124:127], a[204:207], v[164:167], a[124:127]
v_cvt_pk_bf16_f32 v151, v102, v103
v_mfma_f32_16x16x32_bf16 a[140:143], v[184:187], v[164:167], a[140:143]
s_waitcnt lgkmcnt(3)
v_mfma_f32_16x16x32_bf16 a[64:67], a[176:179], v[144:147], a[64:67]
ds_read_b128 a[204:207], v254 offset:15360
v_mov_b32 v254, v252
v_mfma_f32_16x16x32_bf16 a[96:99], a[176:179], v[148:151], a[96:99]
v_add_u32 v252, 0x8000, v252
v_and_b32 v252, 0x1ffff, v252
v_mfma_f32_16x16x32_bf16 a[68:71], a[180:183], v[144:147], a[68:71]
ds_read_b128 a[176:179], v255 offset:8192
s_add_u32 m0, s51, 16384
v_mfma_f32_16x16x32_bf16 a[100:103], a[180:183], v[148:151], a[100:103]
v_exp_f32 v112, v112
v_mfma_f32_16x16x32_bf16 a[72:75], a[184:187], v[144:147], a[72:75]
ds_read_b128 a[180:183], v255 offset:9216
s_add_u32 s65, s47, 3072
v_mfma_f32_16x16x32_bf16 a[104:107], a[184:187], v[148:151], a[104:107]
v_exp_f32 v113, v113
v_mfma_f32_16x16x32_bf16 a[76:79], a[188:191], v[144:147], a[76:79]
ds_read_b128 a[184:187], v255 offset:10240
buffer_load_dwordx4 v236, s[24:27], s65 offen offset:0 sc1 lds
v_mfma_f32_16x16x32_bf16 a[108:111], a[188:191], v[148:151], a[108:111]
v_exp_f32 v114, v114
v_mfma_f32_16x16x32_bf16 a[136:139], v[184:187], v[144:147], a[136:139]
s_waitcnt lgkmcnt(3)
v_cndmask_b32 v112, 0, v112, s[70:71]
v_mfma_f32_16x16x32_bf16 a[80:83], a[192:195], v[144:147], a[80:83]
ds_read_b128 a[188:191], v255 offset:11264
v_cndmask_b32 v113, 0, v113, s[72:73]
v_mfma_f32_16x16x32_bf16 a[112:115], a[192:195], v[148:151], a[112:115]
v_cvt_pk_bf16_f32 v160, v112, v113
buffer_load_dwordx4 v237, s[24:27], s65 offen offset:1024 sc1 lds
v_mfma_f32_16x16x32_bf16 a[84:87], a[196:199], v[144:147], a[84:87]
ds_read_b128 a[192:195], v255 offset:12288
s_add_u32 m0, s51, 18432
v_mfma_f32_16x16x32_bf16 a[116:119], a[196:199], v[148:151], a[116:119]
v_exp_f32 v115, v115
v_mfma_f32_16x16x32_bf16 a[88:91], a[200:203], v[144:147], a[88:91]
ds_read_b128 a[196:199], v255 offset:13312
s_add_u32 s66, s49, 98304
v_mfma_f32_16x16x32_bf16 a[120:123], a[200:203], v[148:151], a[120:123]
v_exp_f32 v116, v116
buffer_load_dwordx4 v238, s[8:11], s66 offen offset:0 lds
buffer_load_dwordx4 v239, s[8:11], s66 offen offset:1024 lds
v_mfma_f32_16x16x32_bf16 a[92:95], a[204:207], v[144:147], a[92:95]
ds_read_b128 a[200:203], v255 offset:14336
v_cndmask_b32 v114, 0, v114, s[74:75]
v_mfma_f32_16x16x32_bf16 a[124:127], a[204:207], v[148:151], a[124:127]
v_cndmask_b32 v115, 0, v115, s[76:77]
v_cvt_pk_bf16_f32 v161, v114, v115
v_mfma_f32_16x16x32_bf16 a[140:143], v[184:187], v[148:151], a[140:143]
v_exp_f32 v117, v117
v_exp_f32 v118, v118
v_cvt_pk_bf16_f32 v164, v116, v117
v_exp_f32 v119, v119
v_mov_b32 v162, 0
v_mov_b32 v163, 0
v_exp_f32 v132, v132
v_cvt_pk_bf16_f32 v165, v118, v119
v_exp_f32 v133, v133
v_exp_f32 v134, v134
v_cndmask_b32 v132, 0, v132, s[70:71]
v_cndmask_b32 v133, 0, v133, s[72:73]
v_cvt_pk_bf16_f32 v166, v132, v133
v_exp_f32 v135, v135
v_cndmask_b32 v134, 0, v134, s[74:75]
v_cndmask_b32 v135, 0, v135, s[76:77]
v_cvt_pk_bf16_f32 v167, v134, v135
s_waitcnt lgkmcnt(3)
v_mfma_f32_16x16x32_bf16 a[64:67], a[176:179], v[160:163], a[64:67]
ds_read_b128 a[204:207], v255 offset:15360
v_mov_b32 v255, v253
v_mfma_f32_16x16x32_bf16 a[96:99], a[176:179], v[164:167], a[96:99]
v_add_u32 v253, 0x8000, v253
v_and_b32 v253, 0x1ffff, v253
v_mfma_f32_16x16x32_bf16 a[68:71], a[180:183], v[160:163], a[68:71]
s_add_u32 m0, s51, 32768
s_add_u32 s65, s47, 4096
v_mfma_f32_16x16x32_bf16 a[100:103], a[180:183], v[164:167], a[100:103]
v_mfma_f32_16x16x32_bf16 a[72:75], a[184:187], v[160:163], a[72:75]
v_mfma_f32_16x16x32_bf16 a[104:107], a[184:187], v[164:167], a[104:107]
v_mfma_f32_16x16x32_bf16 a[76:79], a[188:191], v[160:163], a[76:79]
buffer_load_dwordx4 v236, s[24:27], s65 offen offset:0 sc1 lds
v_mfma_f32_16x16x32_bf16 a[108:111], a[188:191], v[164:167], a[108:111]
v_mfma_f32_16x16x32_bf16 a[136:139], v[184:187], v[160:163], a[136:139]
s_waitcnt lgkmcnt(0)
v_mfma_f32_16x16x32_bf16 a[80:83], a[192:195], v[160:163], a[80:83]
v_mfma_f32_16x16x32_bf16 a[112:115], a[192:195], v[164:167], a[112:115]
buffer_load_dwordx4 v237, s[24:27], s65 offen offset:1024 sc1 lds
s_add_u32 m0, s51, 34816
v_mfma_f32_16x16x32_bf16 a[84:87], a[196:199], v[160:163], a[84:87]
s_add_u32 s66, s49, 131072
v_mfma_f32_16x16x32_bf16 a[116:119], a[196:199], v[164:167], a[116:119]
v_mfma_f32_16x16x32_bf16 a[88:91], a[200:203], v[160:163], a[88:91]
v_mfma_f32_16x16x32_bf16 a[120:123], a[200:203], v[164:167], a[120:123]
buffer_load_dwordx4 v238, s[8:11], s66 offen offset:0 lds
buffer_load_dwordx4 v239, s[8:11], s66 offen offset:1024 lds
v_mfma_f32_16x16x32_bf16 a[92:95], a[204:207], v[160:163], a[92:95]
s_lshr_b32 s66, s40, 1
s_lshl_b32 s66, s66, 13
v_mfma_f32_16x16x32_bf16 a[124:127], a[204:207], v[164:167], a[124:127]
s_add_u32 s66, s66, 0x20000
v_add_u32 v230, s66, v2
v_lshlrev_b32 v246, 3, v1
v_add_u32 v233, s66, v246
v_lshrrev_b32 v246, 5, v1
v_lshlrev_b32 v246, 10, v246
v_bfe_u32 v247, v1, 2, 3
v_lshl_add_u32 v246, v247, 7, v246
v_and_b32 v247, 3, v1
v_lshl_add_u32 v246, v247, 3, v246
s_and_b32 s66, s40, 1
s_lshl_b32 s66, s66, 13
s_add_u32 s66, s66, 0x20800
v_add_u32 v246, s66, v246
v_bfe_u32 v247, v1, 3, 2
v_lshl_add_u32 v224, v247, 5, v246
v_xor_b32 v225, 32, v224
v_xor_b32 v226, 64, v224
v_xor_b32 v227, 96, v224
v_mfma_f32_16x16x32_bf16 a[140:143], v[184:187], v[164:167], a[140:143]
s_mov_b32 s68, 0x53800000
s_branch KF_fin_long
KF_tail1:
s_waitcnt lgkmcnt(7)
v_mfma_f32_16x16x32_bf16 a[64:67], a[176:179], v[160:163], a[64:67]
ds_read_b128 a[204:207], v255 offset:15360
v_mov_b32 v255, v253
v_mfma_f32_16x16x32_bf16 a[96:99], a[176:179], v[164:167], a[96:99]
v_add_u32 v253, 0x8000, v253
v_and_b32 v253, 0x1ffff, v253
v_mfma_f32_16x16x32_bf16 a[68:71], a[180:183], v[160:163], a[68:71]
ds_read_b128 a[176:179], v254 offset:8192
s_add_u32 m0, s51, 0
v_mfma_f32_16x16x32_bf16 a[100:103], a[180:183], v[164:167], a[100:103]
v_exp_f32 v80, v80
v_mfma_f32_16x16x32_bf16 a[72:75], a[184:187], v[160:163], a[72:75]
ds_read_b128 a[180:183], v254 offset:9216
s_add_u32 s65, s47, 2048
v_mfma_f32_16x16x32_bf16 a[104:107], a[184:187], v[164:167], a[104:107]
v_exp_f32 v81, v81
v_mfma_f32_16x16x32_bf16 a[76:79], a[188:191], v[160:163], a[76:79]
ds_read_b128 a[184:187], v254 offset:10240
buffer_load_dwordx4 v236, s[24:27], s65 offen offset:0 sc1 lds
v_mfma_f32_16x16x32_bf16 a[108:111], a[188:191], v[164:167], a[108:111]
v_exp_f32 v82, v82
v_mfma_f32_16x16x32_bf16 a[136:139], v[184:187], v[160:163], a[136:139]
s_waitcnt lgkmcnt(3)
v_cndmask_b32 v80, 0, v80, s[70:71]
v_mfma_f32_16x16x32_bf16 a[80:83], a[192:195], v[160:163], a[80:83]
ds_read_b128 a[188:191], v254 offset:11264
v_cndmask_b32 v81, 0, v81, s[72:73]
v_mfma_f32_16x16x32_bf16 a[112:115], a[192:195], v[164:167], a[112:115]
v_cvt_pk_bf16_f32 v144, v80, v81
buffer_load_dwordx4 v237, s[24:27], s65 offen offset:1024 sc1 lds
v_mfma_f32_16x16x32_bf16 a[84:87], a[196:199], v[160:163], a[84:87]
ds_read_b128 a[192:195], v254 offset:12288
s_add_u32 m0, s51, 2048
v_mfma_f32_16x16x32_bf16 a[116:119], a[196:199], v[164:167], a[116:119]
v_exp_f32 v83, v83
v_mfma_f32_16x16x32_bf16 a[88:91], a[200:203], v[160:163], a[88:91]
ds_read_b128 a[196:199], v254 offset:13312
s_add_u32 s66, s49, 65536
v_mfma_f32_16x16x32_bf16 a[120:123], a[200:203], v[164:167], a[120:123]
v_exp_f32 v84, v84
buffer_load_dwordx4 v238, s[8:11], s66 offen offset:0 lds
buffer_load_dwordx4 v239, s[8:11], s66 offen offset:1024 lds
v_mfma_f32_16x16x32_bf16 a[92:95], a[204:207], v[160:163], a[92:95]
ds_read_b128 a[200:203], v254 offset:14336
v_cndmask_b32 v82, 0, v82, s[74:75]
v_mfma_f32_16x16x32_bf16 a[124:127], a[204:207], v[164:167], a[124:127]
v_cndmask_b32 v83, 0, v83, s[76:77]
v_cvt_pk_bf16_f32 v145, v82, v83
s_add_u32 m0, s51, 16384
s_add_u32 s65, s47, 3072
buffer_load_dwordx4 v236, s[24:27], s65 offen offset:0 sc1 lds
buffer_load_dwordx4 v237, s[24:27], s65 offen offset:1024 sc1 lds
s_add_u32 m0, s51, 18432
s_add_u32 s66, s49, 98304
buffer_load_dwordx4 v238, s[8:11], s66 offen offset:0 lds
buffer_load_dwordx4 v239, s[8:11], s66 offen offset:1024 lds
v_mfma_f32_16x16x32_bf16 a[140:143], v[184:187], v[164:167], a[140:143]
v_exp_f32 v85, v85
v_exp_f32 v86, v86
v_cvt_pk_bf16_f32 v148, v84, v85
v_exp_f32 v87, v87
v_mov_b32 v146, 0
v_mov_b32 v147, 0
v_exp_f32 v100, v100
v_cvt_pk_bf16_f32 v149, v86, v87
v_exp_f32 v101, v101
v_exp_f32 v102, v102
v_cndmask_b32 v100, 0, v100, s[70:71]
v_cndmask_b32 v101, 0, v101, s[72:73]
v_cvt_pk_bf16_f32 v150, v100, v101
v_exp_f32 v103, v103
v_cndmask_b32 v102, 0, v102, s[74:75]
v_cndmask_b32 v103, 0, v103, s[76:77]
v_cvt_pk_bf16_f32 v151, v102, v103
s_waitcnt lgkmcnt(3)
v_mfma_f32_16x16x32_bf16 a[64:67], a[176:179], v[144:147], a[64:67]
ds_read_b128 a[204:207], v254 offset:15360
v_mov_b32 v254, v252
v_mfma_f32_16x16x32_bf16 a[96:99], a[176:179], v[148:151], a[96:99]
v_add_u32 v252, 0x8000, v252
v_and_b32 v252, 0x1ffff, v252
v_mfma_f32_16x16x32_bf16 a[68:71], a[180:183], v[144:147], a[68:71]
s_add_u32 m0, s51, 32768
s_add_u32 s65, s47, 4096
v_mfma_f32_16x16x32_bf16 a[100:103], a[180:183], v[148:151], a[100:103]
v_mfma_f32_16x16x32_bf16 a[72:75], a[184:187], v[144:147], a[72:75]
v_mfma_f32_16x16x32_bf16 a[104:107], a[184:187], v[148:151], a[104:107]
v_mfma_f32_16x16x32_bf16 a[76:79], a[188:191], v[144:147], a[76:79]
buffer_load_dwordx4 v236, s[24:27], s65 offen offset:0 sc1 lds
v_mfma_f32_16x16x32_bf16 a[108:111], a[188:191], v[148:151], a[108:111]
v_mfma_f32_16x16x32_bf16 a[136:139], v[184:187], v[144:147], a[136:139]
s_waitcnt lgkmcnt(0)
v_mfma_f32_16x16x32_bf16 a[80:83], a[192:195], v[144:147], a[80:83]
v_mfma_f32_16x16x32_bf16 a[112:115], a[192:195], v[148:151], a[112:115]
buffer_load_dwordx4 v237, s[24:27], s65 offen offset:1024 sc1 lds
s_add_u32 m0, s51, 34816
v_mfma_f32_16x16x32_bf16 a[84:87], a[196:199], v[144:147], a[84:87]
s_add_u32 s66, s49, 131072
v_mfma_f32_16x16x32_bf16 a[116:119], a[196:199], v[148:151], a[116:119]
v_mfma_f32_16x16x32_bf16 a[88:91], a[200:203], v[144:147], a[88:91]
v_mfma_f32_16x16x32_bf16 a[120:123], a[200:203], v[148:151], a[120:123]
buffer_load_dwordx4 v238, s[8:11], s66 offen offset:0 lds
buffer_load_dwordx4 v239, s[8:11], s66 offen offset:1024 lds
v_mfma_f32_16x16x32_bf16 a[92:95], a[204:207], v[144:147], a[92:95]
s_lshr_b32 s66, s40, 1
s_lshl_b32 s66, s66, 13
v_mfma_f32_16x16x32_bf16 a[124:127], a[204:207], v[148:151], a[124:127]
s_add_u32 s66, s66, 0x20000
v_add_u32 v230, s66, v2
v_lshlrev_b32 v246, 3, v1
v_add_u32 v233, s66, v246
v_lshrrev_b32 v246, 5, v1
v_lshlrev_b32 v246, 10, v246
v_bfe_u32 v247, v1, 2, 3
v_lshl_add_u32 v246, v247, 7, v246
v_and_b32 v247, 3, v1
v_lshl_add_u32 v246, v247, 3, v246
s_and_b32 s66, s40, 1
s_lshl_b32 s66, s66, 13
s_add_u32 s66, s66, 0x20800
v_add_u32 v246, s66, v246
v_bfe_u32 v247, v1, 3, 2
v_lshl_add_u32 v224, v247, 5, v246
v_xor_b32 v225, 32, v224
v_xor_b32 v226, 64, v224
v_xor_b32 v227, 96, v224
v_mfma_f32_16x16x32_bf16 a[140:143], v[184:187], v[148:151], a[140:143]
s_branch KF_fin_both
KF_tail2:
s_waitcnt lgkmcnt(7)
v_mfma_f32_16x16x32_bf16 a[64:67], a[176:179], v[144:147], a[64:67]
ds_read_b128 a[204:207], v254 offset:15360
v_mov_b32 v254, v252
v_mfma_f32_16x16x32_bf16 a[96:99], a[176:179], v[148:151], a[96:99]
v_add_u32 v252, 0x8000, v252
v_and_b32 v252, 0x1ffff, v252
v_mfma_f32_16x16x32_bf16 a[68:71], a[180:183], v[144:147], a[68:71]
ds_read_b128 a[176:179], v255 offset:8192
s_add_u32 m0, s41, 131072
v_mfma_f32_16x16x32_bf16 a[100:103], a[180:183], v[148:151], a[100:103]
v_exp_f32 v112, v112
v_mfma_f32_16x16x32_bf16 a[72:75], a[184:187], v[144:147], a[72:75]
ds_read_b128 a[180:183], v255 offset:9216
s_add_u32 s65, s47, 0
v_mfma_f32_16x16x32_bf16 a[104:107], a[184:187], v[148:151], a[104:107]
v_exp_f32 v113, v113
v_mfma_f32_16x16x32_bf16 a[76:79], a[188:191], v[144:147], a[76:79]
ds_read_b128 a[184:187], v255 offset:10240
buffer_load_dwordx4 v236, s[24:27], s65 offen offset:0 sc1 lds
v_mfma_f32_16x16x32_bf16 a[108:111], a[188:191], v[148:151], a[108:111]
v_exp_f32 v114, v114
v_mfma_f32_16x16x32_bf16 a[136:139], v[184:187], v[144:147], a[136:139]
s_waitcnt lgkmcnt(3)
v_cndmask_b32 v112, 0, v112, s[70:71]
v_mfma_f32_16x16x32_bf16 a[80:83], a[192:195], v[144:147], a[80:83]
ds_read_b128 a[188:191], v255 offset:11264
v_cndmask_b32 v113, 0, v113, s[72:73]
v_mfma_f32_16x16x32_bf16 a[112:115], a[192:195], v[148:151], a[112:115]
v_cvt_pk_bf16_f32 v160, v112, v113
buffer_load_dwordx4 v237, s[24:27], s65 offen offset:1024 sc1 lds
v_mfma_f32_16x16x32_bf16 a[84:87], a[196:199], v[144:147], a[84:87]
ds_read_b128 a[192:195], v255 offset:12288
s_add_u32 m0, s41, 133120
v_mfma_f32_16x16x32_bf16 a[116:119], a[196:199], v[148:151], a[116:119]
v_exp_f32 v115, v115
v_mfma_f32_16x16x32_bf16 a[88:91], a[200:203], v[144:147], a[88:91]
ds_read_b128 a[196:199], v255 offset:13312
s_add_u32 s66, s49, 0
v_mfma_f32_16x16x32_bf16 a[120:123], a[200:203], v[148:151], a[120:123]
v_exp_f32 v116, v116
buffer_load_dwordx4 v238, s[8:11], s66 offen offset:0 lds
buffer_load_dwordx4 v239, s[8:11], s66 offen offset:1024 lds
v_mfma_f32_16x16x32_bf16 a[92:95], a[204:207], v[144:147], a[92:95]
ds_read_b128 a[200:203], v255 offset:14336
v_cndmask_b32 v114, 0, v114, s[74:75]
v_mfma_f32_16x16x32_bf16 a[124:127], a[204:207], v[148:151], a[124:127]
v_cndmask_b32 v115, 0, v115, s[76:77]
v_cvt_pk_bf16_f32 v161, v114, v115
s_add_u32 m0, s41, 147456
s_add_u32 s65, s47, 1024
buffer_load_dwordx4 v236, s[24:27], s65 offen offset:0 sc1 lds
buffer_load_dwordx4 v237, s[24:27], s65 offen offset:1024 sc1 lds
s_add_u32 m0, s41, 149504
s_add_u32 s66, s49, 32768
buffer_load_dwordx4 v238, s[8:11], s66 offen offset:0 lds
buffer_load_dwordx4 v239, s[8:11], s66 offen offset:1024 lds
s_add_u32 m0, s51, 0
s_add_u32 s65, s47, 2048
buffer_load_dwordx4 v236, s[24:27], s65 offen offset:0 sc1 lds
buffer_load_dwordx4 v237, s[24:27], s65 offen offset:1024 sc1 lds
s_add_u32 m0, s51, 2048
s_add_u32 s66, s49, 65536
buffer_load_dwordx4 v238, s[8:11], s66 offen offset:0 lds
buffer_load_dwordx4 v239, s[8:11], s66 offen offset:1024 lds
v_mfma_f32_16x16x32_bf16 a[140:143], v[184:187], v[148:151], a[140:143]
v_exp_f32 v117, v117
v_exp_f32 v118, v118
v_cvt_pk_bf16_f32 v164, v116, v117
v_exp_f32 v119, v119
v_mov_b32 v162, 0
v_mov_b32 v163, 0
v_exp_f32 v132, v132
v_cvt_pk_bf16_f32 v165, v118, v119
v_exp_f32 v133, v133
v_exp_f32 v134, v134
v_cndmask_b32 v132, 0, v132, s[70:71]
v_cndmask_b32 v133, 0, v133, s[72:73]
v_cvt_pk_bf16_f32 v166, v132, v133
v_exp_f32 v135, v135
v_cndmask_b32 v134, 0, v134, s[74:75]
v_cndmask_b32 v135, 0, v135, s[76:77]
v_cvt_pk_bf16_f32 v167, v134, v135
s_waitcnt lgkmcnt(3)
v_mfma_f32_16x16x32_bf16 a[64:67], a[176:179], v[160:163], a[64:67]
ds_read_b128 a[204:207], v255 offset:15360
v_mov_b32 v255, v253
v_mfma_f32_16x16x32_bf16 a[96:99], a[176:179], v[164:167], a[96:99]
v_add_u32 v253, 0x8000, v253
v_and_b32 v253, 0x1ffff, v253
v_mfma_f32_16x16x32_bf16 a[68:71], a[180:183], v[160:163], a[68:71]
s_add_u32 m0, s51, 16384
s_add_u32 s65, s47, 3072
v_mfma_f32_16x16x32_bf16 a[100:103], a[180:183], v[164:167], a[100:103]
v_mfma_f32_16x16x32_bf16 a[72:75], a[184:187], v[160:163], a[72:75]
v_mfma_f32_16x16x32_bf16 a[104:107], a[184:187], v[164:167], a[104:107]
v_mfma_f32_16x16x32_bf16 a[76:79], a[188:191], v[160:163], a[76:79]
buffer_load_dwordx4 v236, s[24:27], s65 offen offset:0 sc1 lds
v_mfma_f32_16x16x32_bf16 a[108:111], a[188:191], v[164:167], a[108:111]
v_mfma_f32_16x16x32_bf16 a[136:139], v[184:187], v[160:163], a[136:139]
s_waitcnt lgkmcnt(0)
v_mfma_f32_16x16x32_bf16 a[80:83], a[192:195], v[160:163], a[80:83]
v_mfma_f32_16x16x32_bf16 a[112:115], a[192:195], v[164:167], a[112:115]
buffer_load_dwordx4 v237, s[24:27], s65 offen offset:1024 sc1 lds
s_add_u32 m0, s51, 18432
v_mfma_f32_16x16x32_bf16 a[84:87], a[196:199], v[160:163], a[84:87]
s_add_u32 s66, s49, 98304
v_mfma_f32_16x16x32_bf16 a[116:119], a[196:199], v[164:167], a[116:119]
v_mfma_f32_16x16x32_bf16 a[88:91], a[200:203], v[160:163], a[88:91]
v_mfma_f32_16x16x32_bf16 a[120:123], a[200:203], v[164:167], a[120:123]
buffer_load_dwordx4 v238, s[8:11], s66 offen offset:0 lds
buffer_load_dwordx4 v239, s[8:11], s66 offen offset:1024 lds
v_mfma_f32_16x16x32_bf16 a[92:95], a[204:207], v[160:163], a[92:95]
s_add_u32 m0, s51, 32768
s_add_u32 s65, s47, 4096
v_mfma_f32_16x16x32_bf16 a[124:127], a[204:207], v[164:167], a[124:127]
buffer_load_dwordx4 v236, s[24:27], s65 offen offset:0 sc1 lds
buffer_load_dwordx4 v237, s[24:27], s65 offen offset:1024 sc1 lds
s_add_u32 m0, s51, 34816
s_add_u32 s66, s49, 131072
buffer_load_dwordx4 v238, s[8:11], s66 offen offset:0 lds
buffer_load_dwordx4 v239, s[8:11], s66 offen offset:1024 lds
s_lshr_b32 s66, s40, 1
s_lshl_b32 s66, s66, 13
s_add_u32 s66, s66, 0x20000
v_add_u32 v230, s66, v2
v_lshlrev_b32 v246, 3, v1
v_add_u32 v233, s66, v246
v_lshrrev_b32 v246, 5, v1
v_lshlrev_b32 v246, 10, v246
v_bfe_u32 v247, v1, 2, 3
v_lshl_add_u32 v246, v247, 7, v246
v_and_b32 v247, 3, v1
v_lshl_add_u32 v246, v247, 3, v246
s_and_b32 s66, s40, 1
s_lshl_b32 s66, s66, 13
s_add_u32 s66, s66, 0x20800
v_add_u32 v246, s66, v246
v_bfe_u32 v247, v1, 3, 2
v_lshl_add_u32 v224, v247, 5, v246
v_xor_b32 v225, 32, v224
v_xor_b32 v226, 64, v224
v_xor_b32 v227, 96, v224
v_mfma_f32_16x16x32_bf16 a[140:143], v[184:187], v[164:167], a[140:143]
s_branch KF_fin_both
KF_special:
buffer_load_dword v244, v245, s[32:35], s69 offen sc1
s_waitcnt vmcnt(0)
v_cmp_le_u32 vcc, 32, v244
s_cmp_eq_u64 vcc, exec
s_cbranch_scc0 KF_h2_spin
KF_h2_back:
s_waitcnt lgkmcnt(7)
v_mfma_f32_16x16x32_bf16 a[0:3], a[176:179], v[152:155], a[0:3]
ds_read_b128 a[204:207], v255 offset:15360
v_mov_b32 v255, v253
v_mfma_f32_16x16x32_bf16 a[32:35], a[176:179], v[156:159], a[32:35]
v_add_u32 v253, 0x8000, v253
v_and_b32 v253, 0x1ffff, v253
v_mfma_f32_16x16x32_bf16 a[64:67], a[176:179], v[160:163], a[64:67]
v_exp_f32 v80, v80
v_mfma_f32_16x16x32_bf16 a[96:99], a[176:179], v[164:167], a[96:99]
v_exp_f32 v81, v81
v_mfma_f32_16x16x32_bf16 a[4:7], a[180:183], v[152:155], a[4:7]
ds_read_b128 a[176:179], v254 offset:8192
v_mfma_f32_16x16x32_bf16 a[36:39], a[180:183], v[156:159], a[36:39]
v_exp_f32 v82, v82
v_mfma_f32_16x16x32_bf16 a[68:71], a[180:183], v[160:163], a[68:71]
v_cndmask_b32 v80, 0, v80, s[70:71]
v_cndmask_b32 v81, 0, v81, s[72:73]
v_mfma_f32_16x16x32_bf16 a[100:103], a[180:183], v[164:167], a[100:103]
v_cvt_pk_bf16_f32 v144, v80, v81
v_mfma_f32_16x16x32_bf16 a[128:131], v[184:187], v[152:155], a[128:131]
v_exp_f32 v83, v83
v_mfma_f32_16x16x32_bf16 a[8:11], a[184:187], v[152:155], a[8:11]
ds_read_b128 a[180:183], v254 offset:9216
v_mfma_f32_16x16x32_bf16 a[40:43], a[184:187], v[156:159], a[40:43]
v_exp_f32 v84, v84
v_mfma_f32_16x16x32_bf16 a[72:75], a[184:187], v[160:163], a[72:75]
v_cndmask_b32 v82, 0, v82, s[74:75]
v_cndmask_b32 v83, 0, v83, s[76:77]
v_mfma_f32_16x16x32_bf16 a[104:107], a[184:187], v[164:167], a[104:107]
v_cvt_pk_bf16_f32 v145, v82, v83
v_mfma_f32_16x16x32_bf16 a[12:15], a[188:191], v[152:155], a[12:15]
ds_read_b128 a[184:187], v254 offset:10240
v_mfma_f32_16x16x32_bf16 a[44:47], a[188:191], v[156:159], a[44:47]
v_exp_f32 v85, v85
v_mfma_f32_16x16x32_bf16 a[76:79], a[188:191], v[160:163], a[76:79]
v_exp_f32 v86, v86
v_mfma_f32_16x16x32_bf16 a[108:111], a[188:191], v[164:167], a[108:111]
v_cvt_pk_bf16_f32 v148, v84, v85
v_mfma_f32_16x16x32_bf16 a[132:135], v[184:187], v[156:159], a[132:135]
s_waitcnt lgkmcnt(3)
v_mfma_f32_16x16x32_bf16 a[16:19], a[192:195], v[152:155], a[16:19]
ds_read_b128 a[188:191], v254 offset:11264
v_mfma_f32_16x16x32_bf16 a[48:51], a[192:195], v[156:159], a[48:51]
v_exp_f32 v87, v87
v_mfma_f32_16x16x32_bf16 a[80:83], a[192:195], v[160:163], a[80:83]
v_mov_b32 v146, 0
v_mov_b32 v147, 0
v_mfma_f32_16x16x32_bf16 a[112:115], a[192:195], v[164:167], a[112:115]
v_exp_f32 v100, v100
v_mfma_f32_16x16x32_bf16 a[20:23], a[196:199], v[152:155], a[20:23]
ds_read_b128 a[192:195], v254 offset:12288
v_cvt_pk_bf16_f32 v149, v86, v87
v_mfma_f32_16x16x32_bf16 a[52:55], a[196:199], v[156:159], a[52:55]
v_exp_f32 v101, v101
v_mfma_f32_16x16x32_bf16 a[84:87], a[196:199], v[160:163], a[84:87]
v_exp_f32 v102, v102
v_mfma_f32_16x16x32_bf16 a[116:119], a[196:199], v[164:167], a[116:119]
v_cndmask_b32 v100, 0, v100, s[70:71]
v_cndmask_b32 v101, 0, v101, s[72:73]
v_mfma_f32_16x16x32_bf16 a[136:139], v[184:187], v[160:163], a[136:139]
v_cvt_pk_bf16_f32 v150, v100, v101
v_mfma_f32_16x16x32_bf16 a[24:27], a[200:203], v[152:155], a[24:27]
ds_read_b128 a[196:199], v254 offset:13312
v_mfma_f32_16x16x32_bf16 a[56:59], a[200:203], v[156:159], a[56:59]
v_exp_f32 v103, v103
v_mfma_f32_16x16x32_bf16 a[88:91], a[200:203], v[160:163], a[88:91]
v_cndmask_b32 v102, 0, v102, s[74:75]
v_cndmask_b32 v103, 0, v103, s[76:77]
v_mfma_f32_16x16x32_bf16 a[120:123], a[200:203], v[164:167], a[120:123]
v_cvt_pk_bf16_f32 v151, v102, v103
v_mfma_f32_16x16x32_bf16 a[28:31], a[204:207], v[152:155], a[28:31]
ds_read_b128 a[200:203], v254 offset:14336
v_mfma_f32_16x16x32_bf16 a[60:63], a[204:207], v[156:159], a[60:63]
v_mfma_f32_16x16x32_bf16 a[92:95], a[204:207], v[160:163], a[92:95]
v_mfma_f32_16x16x32_bf16 a[124:127], a[204:207], v[164:167], a[124:127]
v_mfma_f32_16x16x32_bf16 a[140:143], v[184:187], v[164:167], a[140:143]
s_waitcnt vmcnt(0)
s_barrier
s_branch KF_tail3b
KF_tail3:
s_waitcnt lgkmcnt(7)
v_mfma_f32_16x16x32_bf16 a[64:67], a[176:179], v[160:163], a[64:67]
ds_read_b128 a[204:207], v255 offset:15360
v_mov_b32 v255, v253
v_mfma_f32_16x16x32_bf16 a[96:99], a[176:179], v[164:167], a[96:99]
v_add_u32 v253, 0x8000, v253
v_and_b32 v253, 0x1ffff, v253
v_mfma_f32_16x16x32_bf16 a[68:71], a[180:183], v[160:163], a[68:71]
ds_read_b128 a[176:179], v254 offset:8192
v_mfma_f32_16x16x32_bf16 a[100:103], a[180:183], v[164:167], a[100:103]
v_exp_f32 v80, v80
v_mfma_f32_16x16x32_bf16 a[72:75], a[184:187], v[160:163], a[72:75]
ds_read_b128 a[180:183], v254 offset:9216
v_mfma_f32_16x16x32_bf16 a[104:107], a[184:187], v[164:167], a[104:107]
v_exp_f32 v81, v81
v_mfma_f32_16x16x32_bf16 a[76:79], a[188:191], v[160:163], a[76:79]
ds_read_b128 a[184:187], v254 offset:10240
v_mfma_f32_16x16x32_bf16 a[108:111], a[188:191], v[164:167], a[108:111]
v_exp_f32 v82, v82
v_mfma_f32_16x16x32_bf16 a[136:139], v[184:187], v[160:163], a[136:139]
s_waitcnt lgkmcnt(3)
v_cndmask_b32 v80, 0, v80, s[70:71]
v_mfma_f32_16x16x32_bf16 a[80:83], a[192:195], v[160:163], a[80:83]
ds_read_b128 a[188:191], v254 offset:11264
v_cndmask_b32 v81, 0, v81, s[72:73]
v_mfma_f32_16x16x32_bf16 a[112:115], a[192:195], v[164:167], a[112:115]
v_cvt_pk_bf16_f32 v144, v80, v81
v_mfma_f32_16x16x32_bf16 a[84:87], a[196:199], v[160:163], a[84:87]
ds_read_b128 a[192:195], v254 offset:12288
v_mfma_f32_16x16x32_bf16 a[116:119], a[196:199], v[164:167], a[116:119]
v_exp_f32 v83, v83
v_mfma_f32_16x16x32_bf16 a[88:91], a[200:203], v[160:163], a[88:91]
ds_read_b128 a[196:199], v254 offset:13312
v_mfma_f32_16x16x32_bf16 a[120:123], a[200:203], v[164:167], a[120:123]
v_exp_f32 v84, v84
v_mfma_f32_16x16x32_bf16 a[92:95], a[204:207], v[160:163], a[92:95]
ds_read_b128 a[200:203], v254 offset:14336
v_cndmask_b32 v82, 0, v82, s[74:75]
v_mfma_f32_16x16x32_bf16 a[124:127], a[204:207], v[164:167], a[124:127]
v_cndmask_b32 v83, 0, v83, s[76:77]
v_cvt_pk_bf16_f32 v145, v82, v83
v_mfma_f32_16x16x32_bf16 a[140:143], v[184:187], v[164:167], a[140:143]
v_exp_f32 v85, v85
v_exp_f32 v86, v86
v_cvt_pk_bf16_f32 v148, v84, v85
v_exp_f32 v87, v87
v_mov_b32 v146, 0
v_mov_b32 v147, 0
v_exp_f32 v100, v100
v_cvt_pk_bf16_f32 v149, v86, v87
v_exp_f32 v101, v101
v_exp_f32 v102, v102
v_cndmask_b32 v100, 0, v100, s[70:71]
v_cndmask_b32 v101, 0, v101, s[72:73]
v_cvt_pk_bf16_f32 v150, v100, v101
v_exp_f32 v103, v103
v_cndmask_b32 v102, 0, v102, s[74:75]
v_cndmask_b32 v103, 0, v103, s[76:77]
v_cvt_pk_bf16_f32 v151, v102, v103
s_waitcnt vmcnt(0)
s_barrier
KF_tail3b:
s_waitcnt lgkmcnt(3)
v_mfma_f32_16x16x32_bf16 a[64:67], a[176:179], v[144:147], a[64:67]
ds_read_b128 a[204:207], v254 offset:15360
v_mov_b32 v254, v252
v_mfma_f32_16x16x32_bf16 a[96:99], a[176:179], v[148:151], a[96:99]
v_add_u32 v252, 0x8000, v252
v_and_b32 v252, 0x1ffff, v252
v_mfma_f32_16x16x32_bf16 a[68:71], a[180:183], v[144:147], a[68:71]
s_add_u32 m0, s41, 131072
s_add_u32 s65, s47, 0
v_mfma_f32_16x16x32_bf16 a[100:103], a[180:183], v[148:151], a[100:103]
v_mfma_f32_16x16x32_bf16 a[72:75], a[184:187], v[144:147], a[72:75]
v_mfma_f32_16x16x32_bf16 a[104:107], a[184:187], v[148:151], a[104:107]
v_mfma_f32_16x16x32_bf16 a[76:79], a[188:191], v[144:147], a[76:79]
buffer_load_dwordx4 v236, s[24:27], s65 offen offset:0 sc1 lds
v_mfma_f32_16x16x32_bf16 a[108:111], a[188:191], v[148:151], a[108:111]
v_mfma_f32_16x16x32_bf16 a[136:139], v[184:187], v[144:147], a[136:139]
s_waitcnt lgkmcnt(0)
v_mfma_f32_16x16x32_bf16 a[80:83], a[192:195], v[144:147], a[80:83]
v_mfma_f32_16x16x32_bf16 a[112:115], a[192:195], v[148:151], a[112:115]
buffer_load_dwordx4 v237, s[24:27], s65 offen offset:1024 sc1 lds
s_add_u32 m0, s41, 133120
v_mfma_f32_16x16x32_bf16 a[84:87], a[196:199], v[144:147], a[84:87]
s_add_u32 s66, s49, 0
v_mfma_f32_16x16x32_bf16 a[116:119], a[196:199], v[148:151], a[116:119]
v_mfma_f32_16x16x32_bf16 a[88:91], a[200:203], v[144:147], a[88:91]
v_mfma_f32_16x16x32_bf16 a[120:123], a[200:203], v[148:151], a[120:123]
buffer_load_dwordx4 v238, s[8:11], s66 offen offset:0 lds
buffer_load_dwordx4 v239, s[8:11], s66 offen offset:1024 lds
v_mfma_f32_16x16x32_bf16 a[92:95], a[204:207], v[144:147], a[92:95]
s_add_u32 m0, s41, 147456
s_add_u32 s65, s47, 1024
v_mfma_f32_16x16x32_bf16 a[124:127], a[204:207], v[148:151], a[124:127]
buffer_load_dwordx4 v236, s[24:27], s65 offen offset:0 sc1 lds
buffer_load_dwordx4 v237, s[24:27], s65 offen offset:1024 sc1 lds
s_add_u32 m0, s41, 149504
s_add_u32 s66, s49, 32768
buffer_load_dwordx4 v238, s[8:11], s66 offen offset:0 lds
buffer_load_dwordx4 v239, s[8:11], s66 offen offset:1024 lds
s_add_u32 m0, s51, 0
s_add_u32 s65, s47, 2048
buffer_load_dwordx4 v236, s[24:27], s65 offen offset:0 sc1 lds
buffer_load_dwordx4 v237, s[24:27], s65 offen offset:1024 sc1 lds
s_add_u32 m0, s51, 2048
s_add_u32 s66, s49, 65536
buffer_load_dwordx4 v238, s[8:11], s66 offen offset:0 lds
buffer_load_dwordx4 v239, s[8:11], s66 offen offset:1024 lds
s_add_u32 m0, s51, 16384
s_add_u32 s65, s47, 3072
buffer_load_dwordx4 v236, s[24:27], s65 offen offset:0 sc1 lds
buffer_load_dwordx4 v237, s[24:27], s65 offen offset:1024 sc1 lds
s_add_u32 m0, s51, 18432
s_add_u32 s66, s49, 98304
buffer_load_dwordx4 v238, s[8:11], s66 offen offset:0 lds
buffer_load_dwordx4 v239, s[8:11], s66 offen offset:1024 lds
s_add_u32 m0, s51, 32768
s_add_u32 s65, s47, 4096
buffer_load_dwordx4 v236, s[24:27], s65 offen offset:0 sc1 lds
buffer_load_dwordx4 v237, s[24:27], s65 offen offset:1024 sc1 lds
s_add_u32 m0, s51, 34816
s_add_u32 s66, s49, 131072
buffer_load_dwordx4 v238, s[8:11], s66 offen offset:0 lds
buffer_load_dwordx4 v239, s[8:11], s66 offen offset:1024 lds
s_lshr_b32 s66, s40, 1
s_lshl_b32 s66, s66, 13
s_add_u32 s66, s66, 0x20000
v_add_u32 v230, s66, v2
v_lshlrev_b32 v246, 3, v1
v_add_u32 v233, s66, v246
v_lshrrev_b32 v246, 5, v1
v_lshlrev_b32 v246, 10, v246
v_bfe_u32 v247, v1, 2, 3
v_lshl_add_u32 v246, v247, 7, v246
v_and_b32 v247, 3, v1
v_lshl_add_u32 v246, v247, 3, v246
s_and_b32 s66, s40, 1
s_lshl_b32 s66, s66, 13
s_add_u32 s66, s66, 0x20800
v_add_u32 v246, s66, v246
v_bfe_u32 v247, v1, 3, 2
v_lshl_add_u32 v224, v247, 5, v246
v_xor_b32 v225, 32, v224
v_xor_b32 v226, 64, v224
v_xor_b32 v227, 96, v224
v_mfma_f32_16x16x32_bf16 a[140:143], v[184:187], v[148:151], a[140:143]
KF_fin_both:
s_mov_b32 s68, 0x53800000
v_accvgpr_read_b32 v188, a128
v_cmp_gt_f32 vcc, s68, v188
s_andn2_b64 s[78:79], exec, vcc
s_or_b32 s78, s78, s79
s_cmp_lg_u32 s78, 0
s_cselect_b32 s78, 1, 0
s_or_b32 s64, s64, s78
v_rcp_f32 v188, v188
v_accvgpr_read_b32 v190, a132
v_cmp_gt_f32 vcc, s68, v190
s_andn2_b64 s[78:79], exec, vcc
s_or_b32 s78, s78, s79
s_cmp_lg_u32 s78, 0
s_cselect_b32 s78, 1, 0
s_or_b32 s64, s64, s78
v_rcp_f32 v190, v190
s_add_u32 s67, s62, 0
v_accvgpr_read_b32 v192, a0
v_accvgpr_read_b32 v193, a1
v_accvgpr_read_b32 v194, a2
v_accvgpr_read_b32 v195, a3
v_accvgpr_read_b32 v196, a4
v_accvgpr_read_b32 v197, a5
v_accvgpr_read_b32 v198, a6
v_accvgpr_read_b32 v199, a7
v_pk_mul_f32 v[192:193], v[192:193], v[188:189] op_sel_hi:[1,0]
v_pk_mul_f32 v[194:195], v[194:195], v[188:189] op_sel_hi:[1,0]
v_pk_mul_f32 v[196:197], v[196:197], v[188:189] op_sel_hi:[1,0]
v_pk_mul_f32 v[198:199], v[198:199], v[188:189] op_sel_hi:[1,0]
v_cvt_pk_bf16_f32 v200, v192, v193
v_cvt_pk_bf16_f32 v201, v194, v195
v_cvt_pk_bf16_f32 v202, v196, v197
v_cvt_pk_bf16_f32 v203, v198, v199
buffer_store_dwordx4 v[200:203], v2, s[28:31], s67 offen offset:0 sc1
v_accvgpr_read_b32 v204, a8
v_accvgpr_read_b32 v205, a9
v_accvgpr_read_b32 v206, a10
v_accvgpr_read_b32 v207, a11
v_accvgpr_read_b32 v208, a12
v_accvgpr_read_b32 v209, a13
v_accvgpr_read_b32 v210, a14
v_accvgpr_read_b32 v211, a15
v_pk_mul_f32 v[204:205], v[204:205], v[188:189] op_sel_hi:[1,0]
v_pk_mul_f32 v[206:207], v[206:207], v[188:189] op_sel_hi:[1,0]
v_pk_mul_f32 v[208:209], v[208:209], v[188:189] op_sel_hi:[1,0]
v_pk_mul_f32 v[210:211], v[210:211], v[188:189] op_sel_hi:[1,0]
v_cvt_pk_bf16_f32 v212, v204, v205
v_cvt_pk_bf16_f32 v213, v206, v207
v_cvt_pk_bf16_f32 v214, v208, v209
v_cvt_pk_bf16_f32 v215, v210, v211
buffer_store_dwordx4 v[212:215], v2, s[28:31], s67 offen offset:1024 sc1
v_accvgpr_read_b32 v192, a16
v_accvgpr_read_b32 v193, a17
v_accvgpr_read_b32 v194, a18
v_accvgpr_read_b32 v195, a19
v_accvgpr_read_b32 v196, a20
v_accvgpr_read_b32 v197, a21
v_accvgpr_read_b32 v198, a22
v_accvgpr_read_b32 v199, a23
v_pk_mul_f32 v[192:193], v[192:193], v[188:189] op_sel_hi:[1,0]
v_pk_mul_f32 v[194:195], v[194:195], v[188:189] op_sel_hi:[1,0]
v_pk_mul_f32 v[196:197], v[196:197], v[188:189] op_sel_hi:[1,0]
v_pk_mul_f32 v[198:199], v[198:199], v[188:189] op_sel_hi:[1,0]
v_cvt_pk_bf16_f32 v200, v192, v193
v_cvt_pk_bf16_f32 v201, v194, v195
v_cvt_pk_bf16_f32 v202, v196, v197
v_cvt_pk_bf16_f32 v203, v198, v199
buffer_store_dwordx4 v[200:203], v2, s[28:31], s67 offen offset:2048 sc1
v_accvgpr_read_b32 v204, a24
v_accvgpr_read_b32 v205, a25
v_accvgpr_read_b32 v206, a26
v_accvgpr_read_b32 v207, a27
v_accvgpr_read_b32 v208, a28
v_accvgpr_read_b32 v209, a29
v_accvgpr_read_b32 v210, a30
v_accvgpr_read_b32 v211, a31
v_pk_mul_f32 v[204:205], v[204:205], v[188:189] op_sel_hi:[1,0]
v_pk_mul_f32 v[206:207], v[206:207], v[188:189] op_sel_hi:[1,0]
v_pk_mul_f32 v[208:209], v[208:209], v[188:189] op_sel_hi:[1,0]
v_pk_mul_f32 v[210:211], v[210:211], v[188:189] op_sel_hi:[1,0]
v_cvt_pk_bf16_f32 v212, v204, v205
v_cvt_pk_bf16_f32 v213, v206, v207
v_cvt_pk_bf16_f32 v214, v208, v209
v_cvt_pk_bf16_f32 v215, v210, v211
buffer_store_dwordx4 v[212:215], v2, s[28:31], s67 offen offset:3072 sc1
s_add_u32 s67, s62, 131072
v_accvgpr_read_b32 v192, a32
v_accvgpr_read_b32 v193, a33
v_accvgpr_read_b32 v194, a34
v_accvgpr_read_b32 v195, a35
v_accvgpr_read_b32 v196, a36
v_accvgpr_read_b32 v197, a37
v_accvgpr_read_b32 v198, a38
v_accvgpr_read_b32 v199, a39
v_pk_mul_f32 v[192:193], v[192:193], v[190:191] op_sel_hi:[1,0]
v_pk_mul_f32 v[194:195], v[194:195], v[190:191] op_sel_hi:[1,0]
v_pk_mul_f32 v[196:197], v[196:197], v[190:191] op_sel_hi:[1,0]
v_pk_mul_f32 v[198:199], v[198:199], v[190:191] op_sel_hi:[1,0]
v_cvt_pk_bf16_f32 v200, v192, v193
v_cvt_pk_bf16_f32 v201, v194, v195
v_cvt_pk_bf16_f32 v202, v196, v197
v_cvt_pk_bf16_f32 v203, v198, v199
buffer_store_dwordx4 v[200:203], v2, s[28:31], s67 offen offset:0 sc1
v_accvgpr_read_b32 v204, a40
v_accvgpr_read_b32 v205, a41
v_accvgpr_read_b32 v206, a42
v_accvgpr_read_b32 v207, a43
v_accvgpr_read_b32 v208, a44
v_accvgpr_read_b32 v209, a45
v_accvgpr_read_b32 v210, a46
v_accvgpr_read_b32 v211, a47
v_pk_mul_f32 v[204:205], v[204:205], v[190:191] op_sel_hi:[1,0]
v_pk_mul_f32 v[206:207], v[206:207], v[190:191] op_sel_hi:[1,0]
v_pk_mul_f32 v[208:209], v[208:209], v[190:191] op_sel_hi:[1,0]
v_pk_mul_f32 v[210:211], v[210:211], v[190:191] op_sel_hi:[1,0]
v_cvt_pk_bf16_f32 v212, v204, v205
v_cvt_pk_bf16_f32 v213, v206, v207
v_cvt_pk_bf16_f32 v214, v208, v209
v_cvt_pk_bf16_f32 v215, v210, v211
buffer_store_dwordx4 v[212:215], v2, s[28:31], s67 offen offset:1024 sc1
v_accvgpr_read_b32 v192, a48
v_accvgpr_read_b32 v193, a49
v_accvgpr_read_b32 v194, a50
v_accvgpr_read_b32 v195, a51
v_accvgpr_read_b32 v196, a52
v_accvgpr_read_b32 v197, a53
v_accvgpr_read_b32 v198, a54
v_accvgpr_read_b32 v199, a55
v_pk_mul_f32 v[192:193], v[192:193], v[190:191] op_sel_hi:[1,0]
v_pk_mul_f32 v[194:195], v[194:195], v[190:191] op_sel_hi:[1,0]
v_pk_mul_f32 v[196:197], v[196:197], v[190:191] op_sel_hi:[1,0]
v_pk_mul_f32 v[198:199], v[198:199], v[190:191] op_sel_hi:[1,0]
v_cvt_pk_bf16_f32 v200, v192, v193
v_cvt_pk_bf16_f32 v201, v194, v195
v_cvt_pk_bf16_f32 v202, v196, v197
v_cvt_pk_bf16_f32 v203, v198, v199
buffer_store_dwordx4 v[200:203], v2, s[28:31], s67 offen offset:2048 sc1
v_accvgpr_read_b32 v204, a56
v_accvgpr_read_b32 v205, a57
v_accvgpr_read_b32 v206, a58
v_accvgpr_read_b32 v207, a59
v_accvgpr_read_b32 v208, a60
v_accvgpr_read_b32 v209, a61
v_accvgpr_read_b32 v210, a62
v_accvgpr_read_b32 v211, a63
v_pk_mul_f32 v[204:205], v[204:205], v[190:191] op_sel_hi:[1,0]
v_pk_mul_f32 v[206:207], v[206:207], v[190:191] op_sel_hi:[1,0]
v_pk_mul_f32 v[208:209], v[208:209], v[190:191] op_sel_hi:[1,0]
v_pk_mul_f32 v[210:211], v[210:211], v[190:191] op_sel_hi:[1,0]
v_cvt_pk_bf16_f32 v212, v204, v205
v_cvt_pk_bf16_f32 v213, v206, v207
v_cvt_pk_bf16_f32 v214, v208, v209
v_cvt_pk_bf16_f32 v215, v210, v211
buffer_store_dwordx4 v[212:215], v2, s[28:31], s67 offen offset:3072 sc1
KF_fin_long:
v_accvgpr_read_b32 v188, a136
v_cmp_gt_f32 vcc, s68, v188
s_andn2_b64 s[78:79], exec, vcc
s_or_b32 s78, s78, s79
s_cmp_lg_u32 s78, 0
s_cselect_b32 s78, 2, 0
s_or_b32 s64, s64, s78
v_rcp_f32 v188, v188
v_accvgpr_read_b32 v190, a140
v_cmp_gt_f32 vcc, s68, v190
s_andn2_b64 s[78:79], exec, vcc
s_or_b32 s78, s78, s79
s_cmp_lg_u32 s78, 0
s_cselect_b32 s78, 2, 0
s_or_b32 s64, s64, s78
v_rcp_f32 v190, v190
s_add_u32 s67, s63, 0
v_accvgpr_read_b32 v192, a64
v_accvgpr_read_b32 v193, a65
v_accvgpr_read_b32 v194, a66
v_accvgpr_read_b32 v195, a67
v_accvgpr_read_b32 v196, a68
v_accvgpr_read_b32 v197, a69
v_accvgpr_read_b32 v198, a70
v_accvgpr_read_b32 v199, a71
v_pk_mul_f32 v[192:193], v[192:193], v[188:189] op_sel_hi:[1,0]
v_pk_mul_f32 v[194:195], v[194:195], v[188:189] op_sel_hi:[1,0]
v_pk_mul_f32 v[196:197], v[196:197], v[188:189] op_sel_hi:[1,0]
v_pk_mul_f32 v[198:199], v[198:199], v[188:189] op_sel_hi:[1,0]
v_cvt_pk_bf16_f32 v200, v192, v193
v_cvt_pk_bf16_f32 v201, v194, v195
v_cvt_pk_bf16_f32 v202, v196, v197
v_cvt_pk_bf16_f32 v203, v198, v199
buffer_store_dwordx4 v[200:203], v2, s[28:31], s67 offen offset:0 sc1
v_accvgpr_read_b32 v204, a72
v_accvgpr_read_b32 v205, a73
v_accvgpr_read_b32 v206, a74
v_accvgpr_read_b32 v207, a75
v_accvgpr_read_b32 v208, a76
v_accvgpr_read_b32 v209, a77
v_accvgpr_read_b32 v210, a78
v_accvgpr_read_b32 v211, a79
v_pk_mul_f32 v[204:205], v[204:205], v[188:189] op_sel_hi:[1,0]
v_pk_mul_f32 v[206:207], v[206:207], v[188:189] op_sel_hi:[1,0]
v_pk_mul_f32 v[208:209], v[208:209], v[188:189] op_sel_hi:[1,0]
v_pk_mul_f32 v[210:211], v[210:211], v[188:189] op_sel_hi:[1,0]
v_cvt_pk_bf16_f32 v212, v204, v205
v_cvt_pk_bf16_f32 v213, v206, v207
v_cvt_pk_bf16_f32 v214, v208, v209
v_cvt_pk_bf16_f32 v215, v210, v211
buffer_store_dwordx4 v[212:215], v2, s[28:31], s67 offen offset:1024 sc1
v_accvgpr_read_b32 v192, a80
v_accvgpr_read_b32 v193, a81
v_accvgpr_read_b32 v194, a82
v_accvgpr_read_b32 v195, a83
v_accvgpr_read_b32 v196, a84
v_accvgpr_read_b32 v197, a85
v_accvgpr_read_b32 v198, a86
v_accvgpr_read_b32 v199, a87
v_pk_mul_f32 v[192:193], v[192:193], v[188:189] op_sel_hi:[1,0]
v_pk_mul_f32 v[194:195], v[194:195], v[188:189] op_sel_hi:[1,0]
v_pk_mul_f32 v[196:197], v[196:197], v[188:189] op_sel_hi:[1,0]
v_pk_mul_f32 v[198:199], v[198:199], v[188:189] op_sel_hi:[1,0]
v_cvt_pk_bf16_f32 v200, v192, v193
v_cvt_pk_bf16_f32 v201, v194, v195
v_cvt_pk_bf16_f32 v202, v196, v197
v_cvt_pk_bf16_f32 v203, v198, v199
buffer_store_dwordx4 v[200:203], v2, s[28:31], s67 offen offset:2048 sc1
v_accvgpr_read_b32 v204, a88
v_accvgpr_read_b32 v205, a89
v_accvgpr_read_b32 v206, a90
v_accvgpr_read_b32 v207, a91
v_accvgpr_read_b32 v208, a92
v_accvgpr_read_b32 v209, a93
v_accvgpr_read_b32 v210, a94
v_accvgpr_read_b32 v211, a95
v_pk_mul_f32 v[204:205], v[204:205], v[188:189] op_sel_hi:[1,0]
v_pk_mul_f32 v[206:207], v[206:207], v[188:189] op_sel_hi:[1,0]
v_pk_mul_f32 v[208:209], v[208:209], v[188:189] op_sel_hi:[1,0]
v_pk_mul_f32 v[210:211], v[210:211], v[188:189] op_sel_hi:[1,0]
v_cvt_pk_bf16_f32 v212, v204, v205
v_cvt_pk_bf16_f32 v213, v206, v207
v_cvt_pk_bf16_f32 v214, v208, v209
v_cvt_pk_bf16_f32 v215, v210, v211
buffer_store_dwordx4 v[212:215], v2, s[28:31], s67 offen offset:3072 sc1
s_add_u32 s67, s63, 131072
v_accvgpr_read_b32 v192, a96
v_accvgpr_read_b32 v193, a97
v_accvgpr_read_b32 v194, a98
v_accvgpr_read_b32 v195, a99
v_accvgpr_read_b32 v196, a100
v_accvgpr_read_b32 v197, a101
v_accvgpr_read_b32 v198, a102
v_accvgpr_read_b32 v199, a103
v_pk_mul_f32 v[192:193], v[192:193], v[190:191] op_sel_hi:[1,0]
v_pk_mul_f32 v[194:195], v[194:195], v[190:191] op_sel_hi:[1,0]
v_pk_mul_f32 v[196:197], v[196:197], v[190:191] op_sel_hi:[1,0]
v_pk_mul_f32 v[198:199], v[198:199], v[190:191] op_sel_hi:[1,0]
v_cvt_pk_bf16_f32 v200, v192, v193
v_cvt_pk_bf16_f32 v201, v194, v195
v_cvt_pk_bf16_f32 v202, v196, v197
v_cvt_pk_bf16_f32 v203, v198, v199
buffer_store_dwordx4 v[200:203], v2, s[28:31], s67 offen offset:0 sc1
v_accvgpr_read_b32 v204, a104
v_accvgpr_read_b32 v205, a105
v_accvgpr_read_b32 v206, a106
v_accvgpr_read_b32 v207, a107
v_accvgpr_read_b32 v208, a108
v_accvgpr_read_b32 v209, a109
v_accvgpr_read_b32 v210, a110
v_accvgpr_read_b32 v211, a111
v_pk_mul_f32 v[204:205], v[204:205], v[190:191] op_sel_hi:[1,0]
v_pk_mul_f32 v[206:207], v[206:207], v[190:191] op_sel_hi:[1,0]
v_pk_mul_f32 v[208:209], v[208:209], v[190:191] op_sel_hi:[1,0]
v_pk_mul_f32 v[210:211], v[210:211], v[190:191] op_sel_hi:[1,0]
v_cvt_pk_bf16_f32 v212, v204, v205
v_cvt_pk_bf16_f32 v213, v206, v207
v_cvt_pk_bf16_f32 v214, v208, v209
v_cvt_pk_bf16_f32 v215, v210, v211
buffer_store_dwordx4 v[212:215], v2, s[28:31], s67 offen offset:1024 sc1
v_accvgpr_read_b32 v192, a112
v_accvgpr_read_b32 v193, a113
v_accvgpr_read_b32 v194, a114
v_accvgpr_read_b32 v195, a115
v_accvgpr_read_b32 v196, a116
v_accvgpr_read_b32 v197, a117
v_accvgpr_read_b32 v198, a118
v_accvgpr_read_b32 v199, a119
v_pk_mul_f32 v[192:193], v[192:193], v[190:191] op_sel_hi:[1,0]
v_pk_mul_f32 v[194:195], v[194:195], v[190:191] op_sel_hi:[1,0]
v_pk_mul_f32 v[196:197], v[196:197], v[190:191] op_sel_hi:[1,0]
v_pk_mul_f32 v[198:199], v[198:199], v[190:191] op_sel_hi:[1,0]
v_cvt_pk_bf16_f32 v200, v192, v193
v_cvt_pk_bf16_f32 v201, v194, v195
v_cvt_pk_bf16_f32 v202, v196, v197
v_cvt_pk_bf16_f32 v203, v198, v199
buffer_store_dwordx4 v[200:203], v2, s[28:31], s67 offen offset:2048 sc1
v_accvgpr_read_b32 v204, a120
v_accvgpr_read_b32 v205, a121
v_accvgpr_read_b32 v206, a122
v_accvgpr_read_b32 v207, a123
v_accvgpr_read_b32 v208, a124
v_accvgpr_read_b32 v209, a125
v_accvgpr_read_b32 v210, a126
v_accvgpr_read_b32 v211, a127
v_pk_mul_f32 v[204:205], v[204:205], v[190:191] op_sel_hi:[1,0]
v_pk_mul_f32 v[206:207], v[206:207], v[190:191] op_sel_hi:[1,0]
v_pk_mul_f32 v[208:209], v[208:209], v[190:191] op_sel_hi:[1,0]
v_pk_mul_f32 v[210:211], v[210:211], v[190:191] op_sel_hi:[1,0]
v_cvt_pk_bf16_f32 v212, v204, v205
v_cvt_pk_bf16_f32 v213, v206, v207
v_cvt_pk_bf16_f32 v214, v208, v209
v_cvt_pk_bf16_f32 v215, v210, v211
buffer_store_dwordx4 v[212:215], v2, s[28:31], s67 offen offset:3072 sc1
s_bitcmp1_b32 s64, 0
s_cbranch_scc0 KF_nofb0
s_waitcnt vmcnt(0)
v_mov_b32 v72, 0
v_mov_b32 v73, 0
v_mov_b32 v74, 0
v_mov_b32 v75, 0
v_mov_b32 v76, 0
v_mov_b32 v77, 0
v_mov_b32 v78, 0
v_mov_b32 v79, 0
v_mov_b32 v80, 0
v_mov_b32 v81, 0
v_mov_b32 v82, 0
v_mov_b32 v83, 0
v_mov_b32 v84, 0
v_mov_b32 v85, 0
v_mov_b32 v86, 0
v_mov_b32 v87, 0
v_mov_b32 v88, 0
v_mov_b32 v89, 0
v_mov_b32 v90, 0
v_mov_b32 v91, 0
v_mov_b32 v92, 0
v_mov_b32 v93, 0
v_mov_b32 v94, 0
v_mov_b32 v95, 0
v_mov_b32 v96, 0
v_mov_b32 v97, 0
v_mov_b32 v98, 0
v_mov_b32 v99, 0
v_mov_b32 v100, 0
v_mov_b32 v101, 0
v_mov_b32 v102, 0
v_mov_b32 v103, 0
v_mov_b32 v104, 0
v_mov_b32 v105, 0
v_mov_b32 v106, 0
v_mov_b32 v107, 0
v_mov_b32 v108, 0
v_mov_b32 v109, 0
v_mov_b32 v110, 0
v_mov_b32 v111, 0
v_mov_b32 v112, 0
v_mov_b32 v113, 0
v_mov_b32 v114, 0
v_mov_b32 v115, 0
v_mov_b32 v116, 0
v_mov_b32 v117, 0
v_mov_b32 v118, 0
v_mov_b32 v119, 0
v_mov_b32 v120, 0
v_mov_b32 v121, 0
v_mov_b32 v122, 0
v_mov_b32 v123, 0
v_mov_b32 v124, 0
v_mov_b32 v125, 0
v_mov_b32 v126, 0
v_mov_b32 v127, 0
v_mov_b32 v128, 0
v_mov_b32 v129, 0
v_mov_b32 v130, 0
v_mov_b32 v131, 0
v_mov_b32 v132, 0
v_mov_b32 v133, 0
v_mov_b32 v134, 0
v_mov_b32 v135, 0
v_mov_b32 v136, 0xff800000
v_mov_b32 v138, 0
v_mov_b32 v137, 0xff800000
v_mov_b32 v139, 0
s_mov_b32 s65, 0
s_mov_b32 s66, 0
KF_fb0_loop:
s_add_u32 s67, s66, 0
buffer_load_dwordx4 a[0:3], v2, s[20:23], s67 offen offset:0 sc1
buffer_load_dwordx4 a[4:7], v2, s[20:23], s67 offen offset:1024 sc1
buffer_load_dwordx4 a[8:11], v2, s[20:23], s67 offen offset:2048 sc1
buffer_load_dwordx4 a[12:15], v2, s[20:23], s67 offen offset:3072 sc1
s_add_u32 s67, s66, 4096
buffer_load_dwordx4 a[16:19], v2, s[20:23], s67 offen offset:0 sc1
buffer_load_dwordx4 a[20:23], v2, s[20:23], s67 offen offset:1024 sc1
buffer_load_dwordx4 a[24:27], v2, s[20:23], s67 offen offset:2048 sc1
buffer_load_dwordx4 a[28:31], v2, s[20:23], s67 offen offset:3072 sc1
s_add_u32 s67, s66, 8192
buffer_load_dwordx4 a[32:35], v2, s[20:23], s67 offen offset:0 sc1
buffer_load_dwordx4 a[36:39], v2, s[20:23], s67 offen offset:1024 sc1
buffer_load_dwordx4 a[40:43], v2, s[20:23], s67 offen offset:2048 sc1
buffer_load_dwordx4 a[44:47], v2, s[20:23], s67 offen offset:3072 sc1
s_add_u32 s67, s66, 12288
buffer_load_dwordx4 a[48:51], v2, s[20:23], s67 offen offset:0 sc1
buffer_load_dwordx4 a[52:55], v2, s[20:23], s67 offen offset:1024 sc1
buffer_load_dwordx4 a[56:59], v2, s[20:23], s67 offen offset:2048 sc1
buffer_load_dwordx4 a[60:63], v2, s[20:23], s67 offen offset:3072 sc1
s_waitcnt vmcnt(15)
v_mfma_f32_16x16x32_bf16 v[140:143], a[0:3], v[8:11], 0
s_waitcnt vmcnt(14)
v_mfma_f32_16x16x32_bf16 v[140:143], a[4:7], v[24:27], v[140:143]
s_waitcnt vmcnt(13)
v_mfma_f32_16x16x32_bf16 v[140:143], a[8:11], v[40:43], v[140:143]
s_waitcnt vmcnt(12)
v_mfma_f32_16x16x32_bf16 v[140:143], a[12:15], v[56:59], v[140:143]
v_mfma_f32_16x16x32_bf16 v[144:147], a[0:3], v[12:15], 0
v_mfma_f32_16x16x32_bf16 v[144:147], a[4:7], v[28:31], v[144:147]
v_mfma_f32_16x16x32_bf16 v[144:147], a[8:11], v[44:47], v[144:147]
v_mfma_f32_16x16x32_bf16 v[144:147], a[12:15], v[60:63], v[144:147]
s_waitcnt vmcnt(11)
v_mfma_f32_16x16x32_bf16 v[148:151], a[16:19], v[8:11], 0
s_waitcnt vmcnt(10)
v_mfma_f32_16x16x32_bf16 v[148:151], a[20:23], v[24:27], v[148:151]
s_waitcnt vmcnt(9)
v_mfma_f32_16x16x32_bf16 v[148:151], a[24:27], v[40:43], v[148:151]
s_waitcnt vmcnt(8)
v_mfma_f32_16x16x32_bf16 v[148:151], a[28:31], v[56:59], v[148:151]
v_mfma_f32_16x16x32_bf16 v[152:155], a[16:19], v[12:15], 0
v_mfma_f32_16x16x32_bf16 v[152:155], a[20:23], v[28:31], v[152:155]
v_mfma_f32_16x16x32_bf16 v[152:155], a[24:27], v[44:47], v[152:155]
v_mfma_f32_16x16x32_bf16 v[152:155], a[28:31], v[60:63], v[152:155]
s_cmp_lg_u32 s65, s45
s_cbranch_scc1 KF_fb0_nomask
v_mov_b32 v164, 0xff800000
v_cndmask_b32 v140, v164, v140, s[70:71]
v_mov_b32 v148, v164
s_nop 2
v_cndmask_b32 v152, v164, v152, s[70:71]
v_cndmask_b32 v141, v164, v141, s[72:73]
v_mov_b32 v149, v164
v_cndmask_b32 v153, v164, v153, s[72:73]
v_cndmask_b32 v142, v164, v142, s[74:75]
v_mov_b32 v150, v164
v_cndmask_b32 v154, v164, v154, s[74:75]
v_cndmask_b32 v143, v164, v143, s[76:77]
v_mov_b32 v151, v164
v_cndmask_b32 v155, v164, v155, s[76:77]
KF_fb0_nomask:
v_max3_f32 v164, v140, v141, v142
s_nop 0
v_max3_f32 v164, v164, v143, v148
v_max3_f32 v164, v164, v149, v150
v_max3_f32 v164, v164, v151, v136
v_mov_b32 v165, v164
s_nop 1
v_permlane16_swap_b32 v164, v165
v_max_f32 v164, v164, v165
v_mov_b32 v165, v164
s_nop 1
v_permlane32_swap_b32 v164, v165
v_max_f32 v164, v164, v165
v_sub_f32 v166, v136, v164
v_exp_f32 v166, v166
v_mov_b32 v136, v164
v_mul_f32 v138, v138, v166
v_sub_f32 v140, v140, v164
v_exp_f32 v140, v140
v_sub_f32 v141, v141, v164
v_exp_f32 v141, v141
v_sub_f32 v142, v142, v164
v_exp_f32 v142, v142
v_sub_f32 v143, v143, v164
v_exp_f32 v143, v143
v_sub_f32 v148, v148, v164
v_exp_f32 v148, v148
v_sub_f32 v149, v149, v164
v_exp_f32 v149, v149
v_sub_f32 v150, v150, v164
v_exp_f32 v150, v150
v_sub_f32 v151, v151, v164
v_exp_f32 v151, v151
v_cvt_pk_bf16_f32 v156, v140, v141
v_cvt_pk_bf16_f32 v157, v142, v143
v_cvt_pk_bf16_f32 v158, v148, v149
v_cvt_pk_bf16_f32 v159, v150, v151
v_lshlrev_b32 v165, 16, v156
v_add_f32 v138, v138, v165
v_and_b32 v165, 0xffff0000, v156
v_add_f32 v138, v138, v165
v_lshlrev_b32 v165, 16, v157
v_add_f32 v138, v138, v165
v_and_b32 v165, 0xffff0000, v157
v_add_f32 v138, v138, v165
v_lshlrev_b32 v165, 16, v158
v_add_f32 v138, v138, v165
v_and_b32 v165, 0xffff0000, v158
v_add_f32 v138, v138, v165
v_lshlrev_b32 v165, 16, v159
v_add_f32 v138, v138, v165
v_and_b32 v165, 0xffff0000, v159
v_add_f32 v138, v138, v165
v_mul_f32 v72, v72, v166
v_mul_f32 v73, v73, v166
v_mul_f32 v74, v74, v166
v_mul_f32 v75, v75, v166
v_mul_f32 v76, v76, v166
v_mul_f32 v77, v77, v166
v_mul_f32 v78, v78, v166
v_mul_f32 v79, v79, v166
v_mul_f32 v80, v80, v166
v_mul_f32 v81, v81, v166
v_mul_f32 v82, v82, v166
v_mul_f32 v83, v83, v166
v_mul_f32 v84, v84, v166
v_mul_f32 v85, v85, v166
v_mul_f32 v86, v86, v166
v_mul_f32 v87, v87, v166
v_mul_f32 v88, v88, v166
v_mul_f32 v89, v89, v166
v_mul_f32 v90, v90, v166
v_mul_f32 v91, v91, v166
v_mul_f32 v92, v92, v166
v_mul_f32 v93, v93, v166
v_mul_f32 v94, v94, v166
v_mul_f32 v95, v95, v166
v_mul_f32 v96, v96, v166
v_mul_f32 v97, v97, v166
v_mul_f32 v98, v98, v166
v_mul_f32 v99, v99, v166
v_mul_f32 v100, v100, v166
v_mul_f32 v101, v101, v166
v_mul_f32 v102, v102, v166
v_mul_f32 v103, v103, v166
v_max3_f32 v168, v144, v145, v146
v_max3_f32 v168, v168, v147, v152
v_max3_f32 v168, v168, v153, v154
v_max3_f32 v168, v168, v155, v137
v_mov_b32 v169, v168
s_nop 1
v_permlane16_swap_b32 v168, v169
v_max_f32 v168, v168, v169
v_mov_b32 v169, v168
s_nop 1
v_permlane32_swap_b32 v168, v169
v_max_f32 v168, v168, v169
v_sub_f32 v170, v137, v168
v_exp_f32 v170, v170
v_mov_b32 v137, v168
v_mul_f32 v139, v139, v170
v_sub_f32 v144, v144, v168
v_exp_f32 v144, v144
v_sub_f32 v145, v145, v168
v_exp_f32 v145, v145
v_sub_f32 v146, v146, v168
v_exp_f32 v146, v146
v_sub_f32 v147, v147, v168
v_exp_f32 v147, v147
v_sub_f32 v152, v152, v168
v_exp_f32 v152, v152
v_sub_f32 v153, v153, v168
v_exp_f32 v153, v153
v_sub_f32 v154, v154, v168
v_exp_f32 v154, v154
v_sub_f32 v155, v155, v168
v_exp_f32 v155, v155
v_cvt_pk_bf16_f32 v160, v144, v145
v_cvt_pk_bf16_f32 v161, v146, v147
v_cvt_pk_bf16_f32 v162, v152, v153
v_cvt_pk_bf16_f32 v163, v154, v155
v_lshlrev_b32 v169, 16, v160
v_add_f32 v139, v139, v169
v_and_b32 v169, 0xffff0000, v160
v_add_f32 v139, v139, v169
v_lshlrev_b32 v169, 16, v161
v_add_f32 v139, v139, v169
v_and_b32 v169, 0xffff0000, v161
v_add_f32 v139, v139, v169
v_lshlrev_b32 v169, 16, v162
v_add_f32 v139, v139, v169
v_and_b32 v169, 0xffff0000, v162
v_add_f32 v139, v139, v169
v_lshlrev_b32 v169, 16, v163
v_add_f32 v139, v139, v169
v_and_b32 v169, 0xffff0000, v163
v_add_f32 v139, v139, v169
v_mul_f32 v104, v104, v170
v_mul_f32 v105, v105, v170
v_mul_f32 v106, v106, v170
v_mul_f32 v107, v107, v170
v_mul_f32 v108, v108, v170
v_mul_f32 v109, v109, v170
v_mul_f32 v110, v110, v170
v_mul_f32 v111, v111, v170
v_mul_f32 v112, v112, v170
v_mul_f32 v113, v113, v170
v_mul_f32 v114, v114, v170
v_mul_f32 v115, v115, v170
v_mul_f32 v116, v116, v170
v_mul_f32 v117, v117, v170
v_mul_f32 v118, v118, v170
v_mul_f32 v119, v119, v170
v_mul_f32 v120, v120, v170
v_mul_f32 v121, v121, v170
v_mul_f32 v122, v122, v170
v_mul_f32 v123, v123, v170
v_mul_f32 v124, v124, v170
v_mul_f32 v125, v125, v170
v_mul_f32 v126, v126, v170
v_mul_f32 v127, v127, v170
v_mul_f32 v128, v128, v170
v_mul_f32 v129, v129, v170
v_mul_f32 v130, v130, v170
v_mul_f32 v131, v131, v170
v_mul_f32 v132, v132, v170
v_mul_f32 v133, v133, v170
v_mul_f32 v134, v134, v170
v_mul_f32 v135, v135, v170
s_waitcnt vmcnt(7)
v_mfma_f32_16x16x32_bf16 v[72:75], a[32:35], v[156:159], v[72:75]
v_mfma_f32_16x16x32_bf16 v[104:107], a[32:35], v[160:163], v[104:107]
s_waitcnt vmcnt(6)
v_mfma_f32_16x16x32_bf16 v[76:79], a[36:39], v[156:159], v[76:79]
v_mfma_f32_16x16x32_bf16 v[108:111], a[36:39], v[160:163], v[108:111]
s_waitcnt vmcnt(5)
v_mfma_f32_16x16x32_bf16 v[80:83], a[40:43], v[156:159], v[80:83]
v_mfma_f32_16x16x32_bf16 v[112:115], a[40:43], v[160:163], v[112:115]
s_waitcnt vmcnt(4)
v_mfma_f32_16x16x32_bf16 v[84:87], a[44:47], v[156:159], v[84:87]
v_mfma_f32_16x16x32_bf16 v[116:119], a[44:47], v[160:163], v[116:119]
s_waitcnt vmcnt(3)
v_mfma_f32_16x16x32_bf16 v[88:91], a[48:51], v[156:159], v[88:91]
v_mfma_f32_16x16x32_bf16 v[120:123], a[48:51], v[160:163], v[120:123]
s_waitcnt vmcnt(2)
v_mfma_f32_16x16x32_bf16 v[92:95], a[52:55], v[156:159], v[92:95]
v_mfma_f32_16x16x32_bf16 v[124:127], a[52:55], v[160:163], v[124:127]
s_waitcnt vmcnt(1)
v_mfma_f32_16x16x32_bf16 v[96:99], a[56:59], v[156:159], v[96:99]
v_mfma_f32_16x16x32_bf16 v[128:131], a[56:59], v[160:163], v[128:131]
s_waitcnt vmcnt(0)
v_mfma_f32_16x16x32_bf16 v[100:103], a[60:63], v[156:159], v[100:103]
v_mfma_f32_16x16x32_bf16 v[132:135], a[60:63], v[160:163], v[132:135]
s_add_u32 s65, s65, 1
s_add_u32 s66, s66, 16384
s_cmp_le_u32 s65, s45
s_cbranch_scc1 KF_fb0_loop
v_mov_b32 v164, v138
s_nop 1
v_permlane16_swap_b32 v138, v164
v_add_f32 v138, v138, v164
v_mov_b32 v164, v138
s_nop 1
v_permlane32_swap_b32 v138, v164
v_add_f32 v138, v138, v164
v_mov_b32 v165, v139
s_nop 1
v_permlane16_swap_b32 v139, v165
v_add_f32 v139, v139, v165
v_mov_b32 v165, v139
s_nop 1
v_permlane32_swap_b32 v139, v165
v_add_f32 v139, v139, v165
v_rcp_f32 v188, v138
v_rcp_f32 v190, v139
s_add_u32 s67, s62, 0
v_pk_mul_f32 v[192:193], v[72:73], v[188:189] op_sel_hi:[1,0]
v_pk_mul_f32 v[194:195], v[74:75], v[188:189] op_sel_hi:[1,0]
v_pk_mul_f32 v[196:197], v[76:77], v[188:189] op_sel_hi:[1,0]
v_pk_mul_f32 v[198:199], v[78:79], v[188:189] op_sel_hi:[1,0]
v_cvt_pk_bf16_f32 v200, v192, v193
v_cvt_pk_bf16_f32 v201, v194, v195
v_cvt_pk_bf16_f32 v202, v196, v197
v_cvt_pk_bf16_f32 v203, v198, v199
buffer_store_dwordx4 v[200:203], v2, s[28:31], s67 offen offset:0 sc1
v_pk_mul_f32 v[204:205], v[80:81], v[188:189] op_sel_hi:[1,0]
v_pk_mul_f32 v[206:207], v[82:83], v[188:189] op_sel_hi:[1,0]
v_pk_mul_f32 v[208:209], v[84:85], v[188:189] op_sel_hi:[1,0]
v_pk_mul_f32 v[210:211], v[86:87], v[188:189] op_sel_hi:[1,0]
v_cvt_pk_bf16_f32 v212, v204, v205
v_cvt_pk_bf16_f32 v213, v206, v207
v_cvt_pk_bf16_f32 v214, v208, v209
v_cvt_pk_bf16_f32 v215, v210, v211
buffer_store_dwordx4 v[212:215], v2, s[28:31], s67 offen offset:1024 sc1
v_pk_mul_f32 v[192:193], v[88:89], v[188:189] op_sel_hi:[1,0]
v_pk_mul_f32 v[194:195], v[90:91], v[188:189] op_sel_hi:[1,0]
v_pk_mul_f32 v[196:197], v[92:93], v[188:189] op_sel_hi:[1,0]
v_pk_mul_f32 v[198:199], v[94:95], v[188:189] op_sel_hi:[1,0]
v_cvt_pk_bf16_f32 v200, v192, v193
v_cvt_pk_bf16_f32 v201, v194, v195
v_cvt_pk_bf16_f32 v202, v196, v197
v_cvt_pk_bf16_f32 v203, v198, v199
buffer_store_dwordx4 v[200:203], v2, s[28:31], s67 offen offset:2048 sc1
v_pk_mul_f32 v[204:205], v[96:97], v[188:189] op_sel_hi:[1,0]
v_pk_mul_f32 v[206:207], v[98:99], v[188:189] op_sel_hi:[1,0]
v_pk_mul_f32 v[208:209], v[100:101], v[188:189] op_sel_hi:[1,0]
v_pk_mul_f32 v[210:211], v[102:103], v[188:189] op_sel_hi:[1,0]
v_cvt_pk_bf16_f32 v212, v204, v205
v_cvt_pk_bf16_f32 v213, v206, v207
v_cvt_pk_bf16_f32 v214, v208, v209
v_cvt_pk_bf16_f32 v215, v210, v211
buffer_store_dwordx4 v[212:215], v2, s[28:31], s67 offen offset:3072 sc1
s_add_u32 s67, s62, 131072
v_pk_mul_f32 v[192:193], v[104:105], v[190:191] op_sel_hi:[1,0]
v_pk_mul_f32 v[194:195], v[106:107], v[190:191] op_sel_hi:[1,0]
v_pk_mul_f32 v[196:197], v[108:109], v[190:191] op_sel_hi:[1,0]
v_pk_mul_f32 v[198:199], v[110:111], v[190:191] op_sel_hi:[1,0]
v_cvt_pk_bf16_f32 v200, v192, v193
v_cvt_pk_bf16_f32 v201, v194, v195
v_cvt_pk_bf16_f32 v202, v196, v197
v_cvt_pk_bf16_f32 v203, v198, v199
buffer_store_dwordx4 v[200:203], v2, s[28:31], s67 offen offset:0 sc1
v_pk_mul_f32 v[204:205], v[112:113], v[190:191] op_sel_hi:[1,0]
v_pk_mul_f32 v[206:207], v[114:115], v[190:191] op_sel_hi:[1,0]
v_pk_mul_f32 v[208:209], v[116:117], v[190:191] op_sel_hi:[1,0]
v_pk_mul_f32 v[210:211], v[118:119], v[190:191] op_sel_hi:[1,0]
v_cvt_pk_bf16_f32 v212, v204, v205
v_cvt_pk_bf16_f32 v213, v206, v207
v_cvt_pk_bf16_f32 v214, v208, v209
v_cvt_pk_bf16_f32 v215, v210, v211
buffer_store_dwordx4 v[212:215], v2, s[28:31], s67 offen offset:1024 sc1
v_pk_mul_f32 v[192:193], v[120:121], v[190:191] op_sel_hi:[1,0]
v_pk_mul_f32 v[194:195], v[122:123], v[190:191] op_sel_hi:[1,0]
v_pk_mul_f32 v[196:197], v[124:125], v[190:191] op_sel_hi:[1,0]
v_pk_mul_f32 v[198:199], v[126:127], v[190:191] op_sel_hi:[1,0]
v_cvt_pk_bf16_f32 v200, v192, v193
v_cvt_pk_bf16_f32 v201, v194, v195
v_cvt_pk_bf16_f32 v202, v196, v197
v_cvt_pk_bf16_f32 v203, v198, v199
buffer_store_dwordx4 v[200:203], v2, s[28:31], s67 offen offset:2048 sc1
v_pk_mul_f32 v[204:205], v[128:129], v[190:191] op_sel_hi:[1,0]
v_pk_mul_f32 v[206:207], v[130:131], v[190:191] op_sel_hi:[1,0]
v_pk_mul_f32 v[208:209], v[132:133], v[190:191] op_sel_hi:[1,0]
v_pk_mul_f32 v[210:211], v[134:135], v[190:191] op_sel_hi:[1,0]
v_cvt_pk_bf16_f32 v212, v204, v205
v_cvt_pk_bf16_f32 v213, v206, v207
v_cvt_pk_bf16_f32 v214, v208, v209
v_cvt_pk_bf16_f32 v215, v210, v211
buffer_store_dwordx4 v[212:215], v2, s[28:31], s67 offen offset:3072 sc1
KF_nofb0:
s_bitcmp1_b32 s64, 1
s_cbranch_scc0 KF_nofb1
s_waitcnt vmcnt(0)
v_mov_b32 v72, 0
v_mov_b32 v73, 0
v_mov_b32 v74, 0
v_mov_b32 v75, 0
v_mov_b32 v76, 0
v_mov_b32 v77, 0
v_mov_b32 v78, 0
v_mov_b32 v79, 0
v_mov_b32 v80, 0
v_mov_b32 v81, 0
v_mov_b32 v82, 0
v_mov_b32 v83, 0
v_mov_b32 v84, 0
v_mov_b32 v85, 0
v_mov_b32 v86, 0
v_mov_b32 v87, 0
v_mov_b32 v88, 0
v_mov_b32 v89, 0
v_mov_b32 v90, 0
v_mov_b32 v91, 0
v_mov_b32 v92, 0
v_mov_b32 v93, 0
v_mov_b32 v94, 0
v_mov_b32 v95, 0
v_mov_b32 v96, 0
v_mov_b32 v97, 0
v_mov_b32 v98, 0
v_mov_b32 v99, 0
v_mov_b32 v100, 0
v_mov_b32 v101, 0
v_mov_b32 v102, 0
v_mov_b32 v103, 0
v_mov_b32 v104, 0
v_mov_b32 v105, 0
v_mov_b32 v106, 0
v_mov_b32 v107, 0
v_mov_b32 v108, 0
v_mov_b32 v109, 0
v_mov_b32 v110, 0
v_mov_b32 v111, 0
v_mov_b32 v112, 0
v_mov_b32 v113, 0
v_mov_b32 v114, 0
v_mov_b32 v115, 0
v_mov_b32 v116, 0
v_mov_b32 v117, 0
v_mov_b32 v118, 0
v_mov_b32 v119, 0
v_mov_b32 v120, 0
v_mov_b32 v121, 0
v_mov_b32 v122, 0
v_mov_b32 v123, 0
v_mov_b32 v124, 0
v_mov_b32 v125, 0
v_mov_b32 v126, 0
v_mov_b32 v127, 0
v_mov_b32 v128, 0
v_mov_b32 v129, 0
v_mov_b32 v130, 0
v_mov_b32 v131, 0
v_mov_b32 v132, 0
v_mov_b32 v133, 0
v_mov_b32 v134, 0
v_mov_b32 v135, 0
v_mov_b32 v136, 0xff800000
v_mov_b32 v138, 0
v_mov_b32 v137, 0xff800000
v_mov_b32 v139, 0
s_mov_b32 s65, 0
s_mov_b32 s66, 0
KF_fb1_loop:
s_add_u32 s67, s66, 0
buffer_load_dwordx4 a[0:3], v2, s[20:23], s67 offen offset:0 sc1
buffer_load_dwordx4 a[4:7], v2, s[20:23], s67 offen offset:1024 sc1
buffer_load_dwordx4 a[8:11], v2, s[20:23], s67 offen offset:2048 sc1
buffer_load_dwordx4 a[12:15], v2, s[20:23], s67 offen offset:3072 sc1
s_add_u32 s67, s66, 4096
buffer_load_dwordx4 a[16:19], v2, s[20:23], s67 offen offset:0 sc1
buffer_load_dwordx4 a[20:23], v2, s[20:23], s67 offen offset:1024 sc1
buffer_load_dwordx4 a[24:27], v2, s[20:23], s67 offen offset:2048 sc1
buffer_load_dwordx4 a[28:31], v2, s[20:23], s67 offen offset:3072 sc1
s_add_u32 s67, s66, 8192
buffer_load_dwordx4 a[32:35], v2, s[20:23], s67 offen offset:0 sc1
buffer_load_dwordx4 a[36:39], v2, s[20:23], s67 offen offset:1024 sc1
buffer_load_dwordx4 a[40:43], v2, s[20:23], s67 offen offset:2048 sc1
buffer_load_dwordx4 a[44:47], v2, s[20:23], s67 offen offset:3072 sc1
s_add_u32 s67, s66, 12288
buffer_load_dwordx4 a[48:51], v2, s[20:23], s67 offen offset:0 sc1
buffer_load_dwordx4 a[52:55], v2, s[20:23], s67 offen offset:1024 sc1
buffer_load_dwordx4 a[56:59], v2, s[20:23], s67 offen offset:2048 sc1
buffer_load_dwordx4 a[60:63], v2, s[20:23], s67 offen offset:3072 sc1
s_waitcnt vmcnt(15)
v_mfma_f32_16x16x32_bf16 v[140:143], a[0:3], v[16:19], 0
s_waitcnt vmcnt(14)
v_mfma_f32_16x16x32_bf16 v[140:143], a[4:7], v[32:35], v[140:143]
s_waitcnt vmcnt(13)
v_mfma_f32_16x16x32_bf16 v[140:143], a[8:11], v[48:51], v[140:143]
s_waitcnt vmcnt(12)
v_mfma_f32_16x16x32_bf16 v[140:143], a[12:15], v[64:67], v[140:143]
v_mfma_f32_16x16x32_bf16 v[144:147], a[0:3], v[20:23], 0
v_mfma_f32_16x16x32_bf16 v[144:147], a[4:7], v[36:39], v[144:147]
v_mfma_f32_16x16x32_bf16 v[144:147], a[8:11], v[52:55], v[144:147]
v_mfma_f32_16x16x32_bf16 v[144:147], a[12:15], v[68:71], v[144:147]
s_waitcnt vmcnt(11)
v_mfma_f32_16x16x32_bf16 v[148:151], a[16:19], v[16:19], 0
s_waitcnt vmcnt(10)
v_mfma_f32_16x16x32_bf16 v[148:151], a[20:23], v[32:35], v[148:151]
s_waitcnt vmcnt(9)
v_mfma_f32_16x16x32_bf16 v[148:151], a[24:27], v[48:51], v[148:151]
s_waitcnt vmcnt(8)
v_mfma_f32_16x16x32_bf16 v[148:151], a[28:31], v[64:67], v[148:151]
v_mfma_f32_16x16x32_bf16 v[152:155], a[16:19], v[20:23], 0
v_mfma_f32_16x16x32_bf16 v[152:155], a[20:23], v[36:39], v[152:155]
v_mfma_f32_16x16x32_bf16 v[152:155], a[24:27], v[52:55], v[152:155]
v_mfma_f32_16x16x32_bf16 v[152:155], a[28:31], v[68:71], v[152:155]
s_cmp_lg_u32 s65, s46
s_cbranch_scc1 KF_fb1_nomask
v_mov_b32 v164, 0xff800000
v_cndmask_b32 v140, v164, v140, s[70:71]
v_mov_b32 v148, v164
s_nop 2
v_cndmask_b32 v152, v164, v152, s[70:71]
v_cndmask_b32 v141, v164, v141, s[72:73]
v_mov_b32 v149, v164
v_cndmask_b32 v153, v164, v153, s[72:73]
v_cndmask_b32 v142, v164, v142, s[74:75]
v_mov_b32 v150, v164
v_cndmask_b32 v154, v164, v154, s[74:75]
v_cndmask_b32 v143, v164, v143, s[76:77]
v_mov_b32 v151, v164
v_cndmask_b32 v155, v164, v155, s[76:77]
KF_fb1_nomask:
v_max3_f32 v164, v140, v141, v142
s_nop 0
v_max3_f32 v164, v164, v143, v148
v_max3_f32 v164, v164, v149, v150
v_max3_f32 v164, v164, v151, v136
v_mov_b32 v165, v164
s_nop 1
v_permlane16_swap_b32 v164, v165
v_max_f32 v164, v164, v165
v_mov_b32 v165, v164
s_nop 1
v_permlane32_swap_b32 v164, v165
v_max_f32 v164, v164, v165
v_sub_f32 v166, v136, v164
v_exp_f32 v166, v166
v_mov_b32 v136, v164
v_mul_f32 v138, v138, v166
v_sub_f32 v140, v140, v164
v_exp_f32 v140, v140
v_sub_f32 v141, v141, v164
v_exp_f32 v141, v141
v_sub_f32 v142, v142, v164
v_exp_f32 v142, v142
v_sub_f32 v143, v143, v164
v_exp_f32 v143, v143
v_sub_f32 v148, v148, v164
v_exp_f32 v148, v148
v_sub_f32 v149, v149, v164
v_exp_f32 v149, v149
v_sub_f32 v150, v150, v164
v_exp_f32 v150, v150
v_sub_f32 v151, v151, v164
v_exp_f32 v151, v151
v_cvt_pk_bf16_f32 v156, v140, v141
v_cvt_pk_bf16_f32 v157, v142, v143
v_cvt_pk_bf16_f32 v158, v148, v149
v_cvt_pk_bf16_f32 v159, v150, v151
v_lshlrev_b32 v165, 16, v156
v_add_f32 v138, v138, v165
v_and_b32 v165, 0xffff0000, v156
v_add_f32 v138, v138, v165
v_lshlrev_b32 v165, 16, v157
v_add_f32 v138, v138, v165
v_and_b32 v165, 0xffff0000, v157
v_add_f32 v138, v138, v165
v_lshlrev_b32 v165, 16, v158
v_add_f32 v138, v138, v165
v_and_b32 v165, 0xffff0000, v158
v_add_f32 v138, v138, v165
v_lshlrev_b32 v165, 16, v159
v_add_f32 v138, v138, v165
v_and_b32 v165, 0xffff0000, v159
v_add_f32 v138, v138, v165
v_mul_f32 v72, v72, v166
v_mul_f32 v73, v73, v166
v_mul_f32 v74, v74, v166
v_mul_f32 v75, v75, v166
v_mul_f32 v76, v76, v166
v_mul_f32 v77, v77, v166
v_mul_f32 v78, v78, v166
v_mul_f32 v79, v79, v166
v_mul_f32 v80, v80, v166
v_mul_f32 v81, v81, v166
v_mul_f32 v82, v82, v166
v_mul_f32 v83, v83, v166
v_mul_f32 v84, v84, v166
v_mul_f32 v85, v85, v166
v_mul_f32 v86, v86, v166
v_mul_f32 v87, v87, v166
v_mul_f32 v88, v88, v166
v_mul_f32 v89, v89, v166
v_mul_f32 v90, v90, v166
v_mul_f32 v91, v91, v166
v_mul_f32 v92, v92, v166
v_mul_f32 v93, v93, v166
v_mul_f32 v94, v94, v166
v_mul_f32 v95, v95, v166
v_mul_f32 v96, v96, v166
v_mul_f32 v97, v97, v166
v_mul_f32 v98, v98, v166
v_mul_f32 v99, v99, v166
v_mul_f32 v100, v100, v166
v_mul_f32 v101, v101, v166
v_mul_f32 v102, v102, v166
v_mul_f32 v103, v103, v166
v_max3_f32 v168, v144, v145, v146
v_max3_f32 v168, v168, v147, v152
v_max3_f32 v168, v168, v153, v154
v_max3_f32 v168, v168, v155, v137
v_mov_b32 v169, v168
s_nop 1
v_permlane16_swap_b32 v168, v169
v_max_f32 v168, v168, v169
v_mov_b32 v169, v168
s_nop 1
v_permlane32_swap_b32 v168, v169
v_max_f32 v168, v168, v169
v_sub_f32 v170, v137, v168
v_exp_f32 v170, v170
v_mov_b32 v137, v168
v_mul_f32 v139, v139, v170
v_sub_f32 v144, v144, v168
v_exp_f32 v144, v144
v_sub_f32 v145, v145, v168
v_exp_f32 v145, v145
v_sub_f32 v146, v146, v168
v_exp_f32 v146, v146
v_sub_f32 v147, v147, v168
v_exp_f32 v147, v147
v_sub_f32 v152, v152, v168
v_exp_f32 v152, v152
v_sub_f32 v153, v153, v168
v_exp_f32 v153, v153
v_sub_f32 v154, v154, v168
v_exp_f32 v154, v154
v_sub_f32 v155, v155, v168
v_exp_f32 v155, v155
v_cvt_pk_bf16_f32 v160, v144, v145
v_cvt_pk_bf16_f32 v161, v146, v147
v_cvt_pk_bf16_f32 v162, v152, v153
v_cvt_pk_bf16_f32 v163, v154, v155
v_lshlrev_b32 v169, 16, v160
v_add_f32 v139, v139, v169
v_and_b32 v169, 0xffff0000, v160
v_add_f32 v139, v139, v169
v_lshlrev_b32 v169, 16, v161
v_add_f32 v139, v139, v169
v_and_b32 v169, 0xffff0000, v161
v_add_f32 v139, v139, v169
v_lshlrev_b32 v169, 16, v162
v_add_f32 v139, v139, v169
v_and_b32 v169, 0xffff0000, v162
v_add_f32 v139, v139, v169
v_lshlrev_b32 v169, 16, v163
v_add_f32 v139, v139, v169
v_and_b32 v169, 0xffff0000, v163
v_add_f32 v139, v139, v169
v_mul_f32 v104, v104, v170
v_mul_f32 v105, v105, v170
v_mul_f32 v106, v106, v170
v_mul_f32 v107, v107, v170
v_mul_f32 v108, v108, v170
v_mul_f32 v109, v109, v170
v_mul_f32 v110, v110, v170
v_mul_f32 v111, v111, v170
v_mul_f32 v112, v112, v170
v_mul_f32 v113, v113, v170
v_mul_f32 v114, v114, v170
v_mul_f32 v115, v115, v170
v_mul_f32 v116, v116, v170
v_mul_f32 v117, v117, v170
v_mul_f32 v118, v118, v170
v_mul_f32 v119, v119, v170
v_mul_f32 v120, v120, v170
v_mul_f32 v121, v121, v170
v_mul_f32 v122, v122, v170
v_mul_f32 v123, v123, v170
v_mul_f32 v124, v124, v170
v_mul_f32 v125, v125, v170
v_mul_f32 v126, v126, v170
v_mul_f32 v127, v127, v170
v_mul_f32 v128, v128, v170
v_mul_f32 v129, v129, v170
v_mul_f32 v130, v130, v170
v_mul_f32 v131, v131, v170
v_mul_f32 v132, v132, v170
v_mul_f32 v133, v133, v170
v_mul_f32 v134, v134, v170
v_mul_f32 v135, v135, v170
s_waitcnt vmcnt(7)
v_mfma_f32_16x16x32_bf16 v[72:75], a[32:35], v[156:159], v[72:75]
v_mfma_f32_16x16x32_bf16 v[104:107], a[32:35], v[160:163], v[104:107]
s_waitcnt vmcnt(6)
v_mfma_f32_16x16x32_bf16 v[76:79], a[36:39], v[156:159], v[76:79]
v_mfma_f32_16x16x32_bf16 v[108:111], a[36:39], v[160:163], v[108:111]
s_waitcnt vmcnt(5)
v_mfma_f32_16x16x32_bf16 v[80:83], a[40:43], v[156:159], v[80:83]
v_mfma_f32_16x16x32_bf16 v[112:115], a[40:43], v[160:163], v[112:115]
s_waitcnt vmcnt(4)
v_mfma_f32_16x16x32_bf16 v[84:87], a[44:47], v[156:159], v[84:87]
v_mfma_f32_16x16x32_bf16 v[116:119], a[44:47], v[160:163], v[116:119]
s_waitcnt vmcnt(3)
v_mfma_f32_16x16x32_bf16 v[88:91], a[48:51], v[156:159], v[88:91]
v_mfma_f32_16x16x32_bf16 v[120:123], a[48:51], v[160:163], v[120:123]
s_waitcnt vmcnt(2)
v_mfma_f32_16x16x32_bf16 v[92:95], a[52:55], v[156:159], v[92:95]
v_mfma_f32_16x16x32_bf16 v[124:127], a[52:55], v[160:163], v[124:127]
s_waitcnt vmcnt(1)
v_mfma_f32_16x16x32_bf16 v[96:99], a[56:59], v[156:159], v[96:99]
v_mfma_f32_16x16x32_bf16 v[128:131], a[56:59], v[160:163], v[128:131]
s_waitcnt vmcnt(0)
v_mfma_f32_16x16x32_bf16 v[100:103], a[60:63], v[156:159], v[100:103]
v_mfma_f32_16x16x32_bf16 v[132:135], a[60:63], v[160:163], v[132:135]
s_add_u32 s65, s65, 1
s_add_u32 s66, s66, 16384
s_cmp_le_u32 s65, s46
s_cbranch_scc1 KF_fb1_loop
v_mov_b32 v164, v138
s_nop 1
v_permlane16_swap_b32 v138, v164
v_add_f32 v138, v138, v164
v_mov_b32 v164, v138
s_nop 1
v_permlane32_swap_b32 v138, v164
v_add_f32 v138, v138, v164
v_mov_b32 v165, v139
s_nop 1
v_permlane16_swap_b32 v139, v165
v_add_f32 v139, v139, v165
v_mov_b32 v165, v139
s_nop 1
v_permlane32_swap_b32 v139, v165
v_add_f32 v139, v139, v165
v_rcp_f32 v188, v138
v_rcp_f32 v190, v139
s_add_u32 s67, s63, 0
v_pk_mul_f32 v[192:193], v[72:73], v[188:189] op_sel_hi:[1,0]
v_pk_mul_f32 v[194:195], v[74:75], v[188:189] op_sel_hi:[1,0]
v_pk_mul_f32 v[196:197], v[76:77], v[188:189] op_sel_hi:[1,0]
v_pk_mul_f32 v[198:199], v[78:79], v[188:189] op_sel_hi:[1,0]
v_cvt_pk_bf16_f32 v200, v192, v193
v_cvt_pk_bf16_f32 v201, v194, v195
v_cvt_pk_bf16_f32 v202, v196, v197
v_cvt_pk_bf16_f32 v203, v198, v199
buffer_store_dwordx4 v[200:203], v2, s[28:31], s67 offen offset:0 sc1
v_pk_mul_f32 v[204:205], v[80:81], v[188:189] op_sel_hi:[1,0]
v_pk_mul_f32 v[206:207], v[82:83], v[188:189] op_sel_hi:[1,0]
v_pk_mul_f32 v[208:209], v[84:85], v[188:189] op_sel_hi:[1,0]
v_pk_mul_f32 v[210:211], v[86:87], v[188:189] op_sel_hi:[1,0]
v_cvt_pk_bf16_f32 v212, v204, v205
v_cvt_pk_bf16_f32 v213, v206, v207
v_cvt_pk_bf16_f32 v214, v208, v209
v_cvt_pk_bf16_f32 v215, v210, v211
buffer_store_dwordx4 v[212:215], v2, s[28:31], s67 offen offset:1024 sc1
v_pk_mul_f32 v[192:193], v[88:89], v[188:189] op_sel_hi:[1,0]
v_pk_mul_f32 v[194:195], v[90:91], v[188:189] op_sel_hi:[1,0]
v_pk_mul_f32 v[196:197], v[92:93], v[188:189] op_sel_hi:[1,0]
v_pk_mul_f32 v[198:199], v[94:95], v[188:189] op_sel_hi:[1,0]
v_cvt_pk_bf16_f32 v200, v192, v193
v_cvt_pk_bf16_f32 v201, v194, v195
v_cvt_pk_bf16_f32 v202, v196, v197
v_cvt_pk_bf16_f32 v203, v198, v199
buffer_store_dwordx4 v[200:203], v2, s[28:31], s67 offen offset:2048 sc1
v_pk_mul_f32 v[204:205], v[96:97], v[188:189] op_sel_hi:[1,0]
v_pk_mul_f32 v[206:207], v[98:99], v[188:189] op_sel_hi:[1,0]
v_pk_mul_f32 v[208:209], v[100:101], v[188:189] op_sel_hi:[1,0]
v_pk_mul_f32 v[210:211], v[102:103], v[188:189] op_sel_hi:[1,0]
v_cvt_pk_bf16_f32 v212, v204, v205
v_cvt_pk_bf16_f32 v213, v206, v207
v_cvt_pk_bf16_f32 v214, v208, v209
v_cvt_pk_bf16_f32 v215, v210, v211
buffer_store_dwordx4 v[212:215], v2, s[28:31], s67 offen offset:3072 sc1
s_add_u32 s67, s63, 131072
v_pk_mul_f32 v[192:193], v[104:105], v[190:191] op_sel_hi:[1,0]
v_pk_mul_f32 v[194:195], v[106:107], v[190:191] op_sel_hi:[1,0]
v_pk_mul_f32 v[196:197], v[108:109], v[190:191] op_sel_hi:[1,0]
v_pk_mul_f32 v[198:199], v[110:111], v[190:191] op_sel_hi:[1,0]
v_cvt_pk_bf16_f32 v200, v192, v193
v_cvt_pk_bf16_f32 v201, v194, v195
v_cvt_pk_bf16_f32 v202, v196, v197
v_cvt_pk_bf16_f32 v203, v198, v199
buffer_store_dwordx4 v[200:203], v2, s[28:31], s67 offen offset:0 sc1
v_pk_mul_f32 v[204:205], v[112:113], v[190:191] op_sel_hi:[1,0]
v_pk_mul_f32 v[206:207], v[114:115], v[190:191] op_sel_hi:[1,0]
v_pk_mul_f32 v[208:209], v[116:117], v[190:191] op_sel_hi:[1,0]
v_pk_mul_f32 v[210:211], v[118:119], v[190:191] op_sel_hi:[1,0]
v_cvt_pk_bf16_f32 v212, v204, v205
v_cvt_pk_bf16_f32 v213, v206, v207
v_cvt_pk_bf16_f32 v214, v208, v209
v_cvt_pk_bf16_f32 v215, v210, v211
buffer_store_dwordx4 v[212:215], v2, s[28:31], s67 offen offset:1024 sc1
v_pk_mul_f32 v[192:193], v[120:121], v[190:191] op_sel_hi:[1,0]
v_pk_mul_f32 v[194:195], v[122:123], v[190:191] op_sel_hi:[1,0]
v_pk_mul_f32 v[196:197], v[124:125], v[190:191] op_sel_hi:[1,0]
v_pk_mul_f32 v[198:199], v[126:127], v[190:191] op_sel_hi:[1,0]
v_cvt_pk_bf16_f32 v200, v192, v193
v_cvt_pk_bf16_f32 v201, v194, v195
v_cvt_pk_bf16_f32 v202, v196, v197
v_cvt_pk_bf16_f32 v203, v198, v199
buffer_store_dwordx4 v[200:203], v2, s[28:31], s67 offen offset:2048 sc1
v_pk_mul_f32 v[204:205], v[128:129], v[190:191] op_sel_hi:[1,0]
v_pk_mul_f32 v[206:207], v[130:131], v[190:191] op_sel_hi:[1,0]
v_pk_mul_f32 v[208:209], v[132:133], v[190:191] op_sel_hi:[1,0]
v_pk_mul_f32 v[210:211], v[134:135], v[190:191] op_sel_hi:[1,0]
v_cvt_pk_bf16_f32 v212, v204, v205
v_cvt_pk_bf16_f32 v213, v206, v207
v_cvt_pk_bf16_f32 v214, v208, v209
v_cvt_pk_bf16_f32 v215, v210, v211
buffer_store_dwordx4 v[212:215], v2, s[28:31], s67 offen offset:3072 sc1
KF_nofb1:
s_waitcnt vmcnt(8)
s_barrier
ds_read_b64_tr_b16 v[168:169], v224 offset:0
ds_read_b64_tr_b16 v[170:171], v224 offset:4096
ds_read_b64 v[136:137], v233 offset:0
ds_read_b64 v[138:139], v233 offset:512
ds_read_b64 v[140:141], v233 offset:1024
ds_read_b64 v[142:143], v233 offset:1536
ds_read_b64 v[144:145], v233 offset:4096
ds_read_b64 v[146:147], v233 offset:4608
ds_read_b64 v[148:149], v233 offset:5120
ds_read_b64 v[150:151], v233 offset:5632
ds_read_b64_tr_b16 v[172:173], v225 offset:0
ds_read_b64_tr_b16 v[174:175], v225 offset:4096
ds_read_b64_tr_b16 v[176:177], v226 offset:0
ds_read_b64_tr_b16 v[178:179], v226 offset:4096
ds_read_b64_tr_b16 v[180:181], v227 offset:0
ds_read_b64_tr_b16 v[182:183], v227 offset:4096
s_waitcnt lgkmcnt(12)
v_mfma_f32_16x16x32_bf16 v[72:75], v[168:171], v[136:139], 0
ds_read_b64_tr_b16 v[184:185], v224 offset:16384
s_add_u32 m0, s52, 0
s_waitcnt lgkmcnt(11)
v_mfma_f32_16x16x32_bf16 v[76:79], v[168:171], v[140:143], 0
ds_read_b64_tr_b16 v[186:187], v224 offset:20480
s_add_u32 s65, s47, 6144
s_waitcnt lgkmcnt(10)
v_mfma_f32_16x16x32_bf16 v[80:83], v[168:171], v[144:147], 0
ds_read_b64 v[152:153], v233 offset:16384
buffer_load_dwordx4 v236, s[24:27], s65 offen offset:0 sc1 lds
s_waitcnt lgkmcnt(9)
v_mfma_f32_16x16x32_bf16 v[84:87], v[168:171], v[148:151], 0
ds_read_b64 v[154:155], v233 offset:16896
s_waitcnt lgkmcnt(8)
buffer_load_dwordx4 v237, s[24:27], s65 offen offset:1024 sc1 lds
v_mfma_f32_16x16x32_bf16 v[88:91], v[172:175], v[136:139], 0
ds_read_b64 v[156:157], v233 offset:17408
s_add_u32 m0, s51, 49152
v_mfma_f32_16x16x32_bf16 v[92:95], v[172:175], v[140:143], 0
ds_read_b64 v[158:159], v233 offset:17920
s_add_u32 s65, s47, 5120
v_mfma_f32_16x16x32_bf16 v[96:99], v[172:175], v[144:147], 0
ds_read_b64 v[160:161], v233 offset:20480
buffer_load_dwordx4 v236, s[24:27], s65 offen offset:0 sc1 lds
v_mfma_f32_16x16x32_bf16 v[100:103], v[172:175], v[148:151], 0
ds_read_b64 v[162:163], v233 offset:20992
s_waitcnt lgkmcnt(10)
buffer_load_dwordx4 v237, s[24:27], s65 offen offset:1024 sc1 lds
v_mfma_f32_16x16x32_bf16 v[104:107], v[176:179], v[136:139], 0
ds_read_b64 v[164:165], v233 offset:21504
s_and_b32 s67, s43, 1
v_mfma_f32_16x16x32_bf16 v[108:111], v[176:179], v[140:143], 0
ds_read_b64 v[166:167], v233 offset:22016
s_lshl_b32 s67, s67, 16
v_mfma_f32_16x16x32_bf16 v[112:115], v[176:179], v[144:147], 0
ds_read_b64_tr_b16 v[188:189], v225 offset:16384
s_sub_u32 s67, 0x20000, s67
v_mfma_f32_16x16x32_bf16 v[116:119], v[176:179], v[148:151], 0
ds_read_b64_tr_b16 v[190:191], v225 offset:20480
s_waitcnt lgkmcnt(12)
v_mfma_f32_16x16x32_bf16 v[120:123], v[180:183], v[136:139], 0
ds_read_b64_tr_b16 v[192:193], v226 offset:16384
v_subrev_u32 v231, s67, v233
v_mfma_f32_16x16x32_bf16 v[124:127], v[180:183], v[140:143], 0
ds_read_b64_tr_b16 v[194:195], v226 offset:20480
v_subrev_u32 v216, s67, v224
v_mfma_f32_16x16x32_bf16 v[128:131], v[180:183], v[144:147], 0
ds_read_b64_tr_b16 v[196:197], v227 offset:16384
v_subrev_u32 v217, s67, v225
v_mfma_f32_16x16x32_bf16 v[132:135], v[180:183], v[148:151], 0
ds_read_b64_tr_b16 v[198:199], v227 offset:20480
s_waitcnt lgkmcnt(6)
v_subrev_u32 v218, s67, v226
v_subrev_u32 v219, s67, v227
v_subrev_u32 v228, s67, v230
v_xor_b32 v232, 0x10000, v231
v_xor_b32 v229, 0x10000, v228
v_xor_b32 v220, 0x10000, v216
v_xor_b32 v221, 0x10000, v217
v_xor_b32 v222, 0x10000, v218
v_xor_b32 v223, 0x10000, v219
s_add_u32 m0, s51, 51200
s_add_u32 s66, s49, 163840
buffer_load_dwordx4 v238, s[8:11], s66 offen offset:0 lds
buffer_load_dwordx4 v239, s[8:11], s66 offen offset:1024 lds
s_add_u32 m0, s52, 2048
s_add_u32 s66, s49, 196608
buffer_load_dwordx4 v238, s[8:11], s66 offen offset:0 lds
buffer_load_dwordx4 v239, s[8:11], s66 offen offset:1024 lds
v_mfma_f32_16x16x32_bf16 v[72:75], v[184:187], v[152:155], v[72:75]
ds_read_b64_tr_b16 v[168:169], v216 offset:0
s_add_u32 m0, s52, 32768
v_mfma_f32_16x16x32_bf16 v[76:79], v[184:187], v[156:159], v[76:79]
ds_read_b64_tr_b16 v[170:171], v216 offset:4096
s_add_u32 s65, s47, 8192
v_mfma_f32_16x16x32_bf16 v[80:83], v[184:187], v[160:163], v[80:83]
ds_read_b64 v[136:137], v231 offset:0
buffer_load_dwordx4 v236, s[24:27], s65 offen offset:0 sc1 lds
v_mfma_f32_16x16x32_bf16 v[84:87], v[184:187], v[164:167], v[84:87]
ds_read_b64 v[138:139], v231 offset:512
s_waitcnt lgkmcnt(8)
buffer_load_dwordx4 v237, s[24:27], s65 offen offset:1024 sc1 lds
v_mfma_f32_16x16x32_bf16 v[88:91], v[188:191], v[152:155], v[88:91]
ds_read_b64 v[140:141], v231 offset:1024
s_add_u32 m0, s52, 16384
v_mfma_f32_16x16x32_bf16 v[92:95], v[188:191], v[156:159], v[92:95]
ds_read_b64 v[142:143], v231 offset:1536
s_add_u32 s65, s47, 7168
v_mfma_f32_16x16x32_bf16 v[96:99], v[188:191], v[160:163], v[96:99]
ds_read_b64 v[144:145], v231 offset:4096
buffer_load_dwordx4 v236, s[24:27], s65 offen offset:0 sc1 lds
v_mfma_f32_16x16x32_bf16 v[100:103], v[188:191], v[164:167], v[100:103]
ds_read_b64 v[146:147], v231 offset:4608
s_waitcnt lgkmcnt(10)
buffer_load_dwordx4 v237, s[24:27], s65 offen offset:1024 sc1 lds
v_mfma_f32_16x16x32_bf16 v[104:107], v[192:195], v[152:155], v[104:107]
ds_read_b64 v[148:149], v231 offset:5120
s_add_u32 m0, s52, 18432
v_mfma_f32_16x16x32_bf16 v[108:111], v[192:195], v[156:159], v[108:111]
ds_read_b64 v[150:151], v231 offset:5632
s_add_u32 s66, s49, 229376
v_mfma_f32_16x16x32_bf16 v[112:115], v[192:195], v[160:163], v[112:115]
ds_read_b64_tr_b16 v[172:173], v217 offset:0
buffer_load_dwordx4 v238, s[8:11], s66 offen offset:0 lds
v_mfma_f32_16x16x32_bf16 v[116:119], v[192:195], v[164:167], v[116:119]
ds_read_b64_tr_b16 v[174:175], v217 offset:4096
s_waitcnt lgkmcnt(12)
buffer_load_dwordx4 v239, s[8:11], s66 offen offset:1024 lds
v_mfma_f32_16x16x32_bf16 v[120:123], v[196:199], v[152:155], v[120:123]
ds_read_b64_tr_b16 v[176:177], v218 offset:0
s_add_u32 m0, s52, 34816
v_mfma_f32_16x16x32_bf16 v[124:127], v[196:199], v[156:159], v[124:127]
ds_read_b64_tr_b16 v[178:179], v218 offset:4096
s_add_u32 s66, s49, 262144
v_mfma_f32_16x16x32_bf16 v[128:131], v[196:199], v[160:163], v[128:131]
ds_read_b64_tr_b16 v[180:181], v219 offset:0
buffer_load_dwordx4 v238, s[8:11], s66 offen offset:0 lds
v_mfma_f32_16x16x32_bf16 v[132:135], v[196:199], v[164:167], v[132:135]
ds_read_b64_tr_b16 v[182:183], v219 offset:4096
s_waitcnt lgkmcnt(6)
buffer_load_dwordx4 v239, s[8:11], s66 offen offset:1024 lds
s_barrier
v_mfma_f32_16x16x32_bf16 v[72:75], v[168:171], v[136:139], v[72:75]
ds_read_b64_tr_b16 v[184:185], v216 offset:16384
s_lshl_b32 s67, s43, 2
v_mfma_f32_16x16x32_bf16 v[76:79], v[168:171], v[140:143], v[76:79]
ds_read_b64_tr_b16 v[186:187], v216 offset:20480
s_lshr_b32 s68, s44, 3
v_mfma_f32_16x16x32_bf16 v[80:83], v[168:171], v[144:147], v[80:83]
ds_read_b64 v[152:153], v231 offset:16384
s_add_u32 s67, s67, s68
v_mfma_f32_16x16x32_bf16 v[84:87], v[168:171], v[148:151], v[84:87]
ds_read_b64 v[154:155], v231 offset:16896
s_waitcnt lgkmcnt(8)
v_mfma_f32_16x16x32_bf16 v[88:91], v[172:175], v[136:139], v[88:91]
ds_read_b64 v[156:157], v231 offset:17408
s_lshl_b32 s67, s67, 2
v_mfma_f32_16x16x32_bf16 v[92:95], v[172:175], v[140:143], v[92:95]
ds_read_b64 v[158:159], v231 offset:17920
s_add_u32 s67, s67, s40
v_mfma_f32_16x16x32_bf16 v[96:99], v[172:175], v[144:147], v[96:99]
ds_read_b64 v[160:161], v231 offset:20480
s_add_u32 s67, s67, 312
v_mfma_f32_16x16x32_bf16 v[100:103], v[172:175], v[148:151], v[100:103]
ds_read_b64 v[162:163], v231 offset:20992
s_waitcnt lgkmcnt(10)
v_mfma_f32_16x16x32_bf16 v[104:107], v[176:179], v[136:139], v[104:107]
ds_read_b64 v[164:165], v231 offset:21504
s_lshl_b32 s67, s67, 7
v_mfma_f32_16x16x32_bf16 v[108:111], v[176:179], v[140:143], v[108:111]
ds_read_b64 v[166:167], v231 offset:22016
s_waitcnt vmcnt(16)
v_mfma_f32_16x16x32_bf16 v[112:115], v[176:179], v[144:147], v[112:115]
ds_read_b64_tr_b16 v[188:189], v217 offset:16384
buffer_atomic_add v6, v5, s[32:35], s67 offen sc1
v_mfma_f32_16x16x32_bf16 v[116:119], v[176:179], v[148:151], v[116:119]
ds_read_b64_tr_b16 v[190:191], v217 offset:20480
s_waitcnt lgkmcnt(12)
v_mfma_f32_16x16x32_bf16 v[120:123], v[180:183], v[136:139], v[120:123]
ds_read_b64_tr_b16 v[192:193], v218 offset:16384
s_add_u32 m0, s41, 131072
v_mfma_f32_16x16x32_bf16 v[124:127], v[180:183], v[140:143], v[124:127]
ds_read_b64_tr_b16 v[194:195], v218 offset:20480
s_add_u32 s65, s47, 10240
v_mfma_f32_16x16x32_bf16 v[128:131], v[180:183], v[144:147], v[128:131]
ds_read_b64_tr_b16 v[196:197], v219 offset:16384
buffer_load_dwordx4 v236, s[24:27], s65 offen offset:0 sc1 lds
v_mfma_f32_16x16x32_bf16 v[132:135], v[180:183], v[148:151], v[132:135]
ds_read_b64_tr_b16 v[198:199], v219 offset:20480
s_waitcnt lgkmcnt(6)
buffer_load_dwordx4 v237, s[24:27], s65 offen offset:1024 sc1 lds
s_add_u32 m0, s52, 49152
s_add_u32 s65, s47, 9216
buffer_load_dwordx4 v236, s[24:27], s65 offen offset:0 sc1 lds
buffer_load_dwordx4 v237, s[24:27], s65 offen offset:1024 sc1 lds
s_add_u32 m0, s52, 51200
s_add_u32 s66, s49, 294912
buffer_load_dwordx4 v238, s[8:11], s66 offen offset:0 lds
buffer_load_dwordx4 v239, s[8:11], s66 offen offset:1024 lds
s_add_u32 m0, s41, 133120
s_add_u32 s66, s49, 327680
buffer_load_dwordx4 v238, s[8:11], s66 offen offset:0 lds
buffer_load_dwordx4 v239, s[8:11], s66 offen offset:1024 lds
v_mfma_f32_16x16x32_bf16 v[72:75], v[184:187], v[152:155], v[72:75]
ds_read_b64_tr_b16 v[168:169], v216 offset:32768
s_add_u32 m0, s41, 149504
v_mfma_f32_16x16x32_bf16 v[76:79], v[184:187], v[156:159], v[76:79]
ds_read_b64_tr_b16 v[170:171], v216 offset:36864
s_add_u32 s66, s50, 0
v_mfma_f32_16x16x32_bf16 v[80:83], v[184:187], v[160:163], v[80:83]
ds_read_b64 v[136:137], v231 offset:32768
buffer_load_dwordx4 v238, s[4:7], s66 offen offset:0 lds
v_mfma_f32_16x16x32_bf16 v[84:87], v[184:187], v[164:167], v[84:87]
ds_read_b64 v[138:139], v231 offset:33280
s_waitcnt lgkmcnt(8)
v_mfma_f32_16x16x32_bf16 v[88:91], v[188:191], v[152:155], v[88:91]
ds_read_b64 v[140:141], v231 offset:33792
v_mfma_f32_16x16x32_bf16 v[92:95], v[188:191], v[156:159], v[92:95]
ds_read_b64 v[142:143], v231 offset:34304
v_mfma_f32_16x16x32_bf16 v[96:99], v[188:191], v[160:163], v[96:99]
ds_read_b64 v[144:145], v231 offset:36864
v_mfma_f32_16x16x32_bf16 v[100:103], v[188:191], v[164:167], v[100:103]
ds_read_b64 v[146:147], v231 offset:37376
s_waitcnt lgkmcnt(10)
v_mfma_f32_16x16x32_bf16 v[104:107], v[192:195], v[152:155], v[104:107]
ds_read_b64 v[148:149], v231 offset:37888
v_mfma_f32_16x16x32_bf16 v[108:111], v[192:195], v[156:159], v[108:111]
ds_read_b64 v[150:151], v231 offset:38400
v_mfma_f32_16x16x32_bf16 v[112:115], v[192:195], v[160:163], v[112:115]
ds_read_b64_tr_b16 v[172:173], v217 offset:32768
buffer_load_dwordx4 v239, s[4:7], s66 offen offset:1024 lds
v_mfma_f32_16x16x32_bf16 v[116:119], v[192:195], v[164:167], v[116:119]
ds_read_b64_tr_b16 v[174:175], v217 offset:36864
s_waitcnt lgkmcnt(12)
v_mfma_f32_16x16x32_bf16 v[120:123], v[196:199], v[152:155], v[120:123]
ds_read_b64_tr_b16 v[176:177], v218 offset:32768
v_mfma_f32_16x16x32_bf16 v[124:127], v[196:199], v[156:159], v[124:127]
ds_read_b64_tr_b16 v[178:179], v218 offset:36864
v_mfma_f32_16x16x32_bf16 v[128:131], v[196:199], v[160:163], v[128:131]
ds_read_b64_tr_b16 v[180:181], v219 offset:32768
v_mfma_f32_16x16x32_bf16 v[132:135], v[196:199], v[164:167], v[132:135]
ds_read_b64_tr_b16 v[182:183], v219 offset:36864
s_waitcnt lgkmcnt(6)
s_waitcnt vmcnt(19)
s_barrier
v_mfma_f32_16x16x32_bf16 v[72:75], v[168:171], v[136:139], v[72:75]
ds_read_b64_tr_b16 v[184:185], v216 offset:49152
s_add_u32 m0, s51, 2048
v_mfma_f32_16x16x32_bf16 v[76:79], v[168:171], v[140:143], v[76:79]
ds_read_b64_tr_b16 v[186:187], v216 offset:53248
s_add_u32 s66, s50, 32768
v_mfma_f32_16x16x32_bf16 v[80:83], v[168:171], v[144:147], v[80:83]
ds_read_b64 v[152:153], v231 offset:49152
buffer_load_dwordx4 v238, s[4:7], s66 offen offset:0 lds
v_mfma_f32_16x16x32_bf16 v[84:87], v[168:171], v[148:151], v[84:87]
ds_read_b64 v[154:155], v231 offset:49664
s_waitcnt lgkmcnt(8)
v_mfma_f32_16x16x32_bf16 v[88:91], v[172:175], v[136:139], v[88:91]
ds_read_b64 v[156:157], v231 offset:50176
v_mfma_f32_16x16x32_bf16 v[92:95], v[172:175], v[140:143], v[92:95]
ds_read_b64 v[158:159], v231 offset:50688
v_mfma_f32_16x16x32_bf16 v[96:99], v[172:175], v[144:147], v[96:99]
ds_read_b64 v[160:161], v231 offset:53248
buffer_load_dwordx4 v239, s[4:7], s66 offen offset:1024 lds
v_mfma_f32_16x16x32_bf16 v[100:103], v[172:175], v[148:151], v[100:103]
ds_read_b64 v[162:163], v231 offset:53760
s_waitcnt lgkmcnt(10)
v_mfma_f32_16x16x32_bf16 v[104:107], v[176:179], v[136:139], v[104:107]
ds_read_b64 v[164:165], v231 offset:54272
s_add_u32 m0, s51, 18432
v_mfma_f32_16x16x32_bf16 v[108:111], v[176:179], v[140:143], v[108:111]
ds_read_b64 v[166:167], v231 offset:54784
s_add_u32 s66, s50, 65536
v_mfma_f32_16x16x32_bf16 v[112:115], v[176:179], v[144:147], v[112:115]
ds_read_b64_tr_b16 v[188:189], v217 offset:49152
buffer_load_dwordx4 v238, s[4:7], s66 offen offset:0 lds
v_mfma_f32_16x16x32_bf16 v[116:119], v[176:179], v[148:151], v[116:119]
ds_read_b64_tr_b16 v[190:191], v217 offset:53248
s_waitcnt lgkmcnt(12)
v_mfma_f32_16x16x32_bf16 v[120:123], v[180:183], v[136:139], v[120:123]
ds_read_b64_tr_b16 v[192:193], v218 offset:49152
v_mfma_f32_16x16x32_bf16 v[124:127], v[180:183], v[140:143], v[124:127]
ds_read_b64_tr_b16 v[194:195], v218 offset:53248
v_mfma_f32_16x16x32_bf16 v[128:131], v[180:183], v[144:147], v[128:131]
ds_read_b64_tr_b16 v[196:197], v219 offset:49152
buffer_load_dwordx4 v239, s[4:7], s66 offen offset:1024 lds
v_mfma_f32_16x16x32_bf16 v[132:135], v[180:183], v[148:151], v[132:135]
ds_read_b64_tr_b16 v[198:199], v219 offset:53248
s_waitcnt lgkmcnt(6)
v_mfma_f32_16x16x32_bf16 v[72:75], v[184:187], v[152:155], v[72:75]
ds_read_b64_tr_b16 v[168:169], v220 offset:0
v_mfma_f32_16x16x32_bf16 v[76:79], v[184:187], v[156:159], v[76:79]
ds_read_b64_tr_b16 v[170:171], v220 offset:4096
v_mfma_f32_16x16x32_bf16 v[80:83], v[184:187], v[160:163], v[80:83]
ds_read_b64 v[136:137], v232 offset:0
v_mfma_f32_16x16x32_bf16 v[84:87], v[184:187], v[164:167], v[84:87]
ds_read_b64 v[138:139], v232 offset:512
s_waitcnt lgkmcnt(8)
v_mfma_f32_16x16x32_bf16 v[88:91], v[188:191], v[152:155], v[88:91]
ds_read_b64 v[140:141], v232 offset:1024
v_mfma_f32_16x16x32_bf16 v[92:95], v[188:191], v[156:159], v[92:95]
ds_read_b64 v[142:143], v232 offset:1536
v_mfma_f32_16x16x32_bf16 v[96:99], v[188:191], v[160:163], v[96:99]
ds_read_b64 v[144:145], v232 offset:4096
v_mfma_f32_16x16x32_bf16 v[100:103], v[188:191], v[164:167], v[100:103]
ds_read_b64 v[146:147], v232 offset:4608
s_waitcnt lgkmcnt(10)
v_mfma_f32_16x16x32_bf16 v[104:107], v[192:195], v[152:155], v[104:107]
ds_read_b64 v[148:149], v232 offset:5120
v_mfma_f32_16x16x32_bf16 v[108:111], v[192:195], v[156:159], v[108:111]
ds_read_b64 v[150:151], v232 offset:5632
v_mfma_f32_16x16x32_bf16 v[112:115], v[192:195], v[160:163], v[112:115]
ds_read_b64_tr_b16 v[172:173], v221 offset:0
v_mfma_f32_16x16x32_bf16 v[116:119], v[192:195], v[164:167], v[116:119]
ds_read_b64_tr_b16 v[174:175], v221 offset:4096
s_waitcnt lgkmcnt(12)
v_mfma_f32_16x16x32_bf16 v[120:123], v[196:199], v[152:155], v[120:123]
ds_read_b64_tr_b16 v[176:177], v222 offset:0
v_mfma_f32_16x16x32_bf16 v[124:127], v[196:199], v[156:159], v[124:127]
ds_read_b64_tr_b16 v[178:179], v222 offset:4096
v_mfma_f32_16x16x32_bf16 v[128:131], v[196:199], v[160:163], v[128:131]
ds_read_b64_tr_b16 v[180:181], v223 offset:0
v_mfma_f32_16x16x32_bf16 v[132:135], v[196:199], v[164:167], v[132:135]
ds_read_b64_tr_b16 v[182:183], v223 offset:4096
s_waitcnt lgkmcnt(6)
s_waitcnt vmcnt(15)
s_barrier
v_mfma_f32_16x16x32_bf16 v[72:75], v[168:171], v[136:139], v[72:75]
ds_read_b64_tr_b16 v[184:185], v220 offset:16384
s_add_u32 m0, s51, 34816
v_mfma_f32_16x16x32_bf16 v[76:79], v[168:171], v[140:143], v[76:79]
ds_read_b64_tr_b16 v[186:187], v220 offset:20480
s_add_u32 s66, s50, 98304
v_mfma_f32_16x16x32_bf16 v[80:83], v[168:171], v[144:147], v[80:83]
ds_read_b64 v[152:153], v232 offset:16384
buffer_load_dwordx4 v238, s[4:7], s66 offen offset:0 lds
v_mfma_f32_16x16x32_bf16 v[84:87], v[168:171], v[148:151], v[84:87]
ds_read_b64 v[154:155], v232 offset:16896
s_waitcnt lgkmcnt(8)
buffer_load_dwordx4 v239, s[4:7], s66 offen offset:1024 lds
v_mfma_f32_16x16x32_bf16 v[88:91], v[172:175], v[136:139], v[88:91]
ds_read_b64 v[156:157], v232 offset:17408
s_add_u32 m0, s51, 51200
v_mfma_f32_16x16x32_bf16 v[92:95], v[172:175], v[140:143], v[92:95]
ds_read_b64 v[158:159], v232 offset:17920
s_add_u32 s66, s50, 131072
v_mfma_f32_16x16x32_bf16 v[96:99], v[172:175], v[144:147], v[96:99]
ds_read_b64 v[160:161], v232 offset:20480
buffer_load_dwordx4 v238, s[4:7], s66 offen offset:0 lds
v_mfma_f32_16x16x32_bf16 v[100:103], v[172:175], v[148:151], v[100:103]
ds_read_b64 v[162:163], v232 offset:20992
s_waitcnt lgkmcnt(10)
v_mfma_f32_16x16x32_bf16 v[104:107], v[176:179], v[136:139], v[104:107]
ds_read_b64 v[164:165], v232 offset:21504
buffer_load_dwordx4 v239, s[4:7], s66 offen offset:1024 lds
v_mfma_f32_16x16x32_bf16 v[108:111], v[176:179], v[140:143], v[108:111]
ds_read_b64 v[166:167], v232 offset:22016
v_and_b32 v245, 3, v1
v_mfma_f32_16x16x32_bf16 v[112:115], v[176:179], v[144:147], v[112:115]
ds_read_b64_tr_b16 v[188:189], v221 offset:16384
v_lshlrev_b32 v245, 7, v245
v_mfma_f32_16x16x32_bf16 v[116:119], v[176:179], v[148:151], v[116:119]
ds_read_b64_tr_b16 v[190:191], v221 offset:20480
s_waitcnt lgkmcnt(12)
v_mfma_f32_16x16x32_bf16 v[120:123], v[180:183], v[136:139], v[120:123]
ds_read_b64_tr_b16 v[192:193], v222 offset:16384
s_sub_u32 s69, 15, s55
v_mfma_f32_16x16x32_bf16 v[124:127], v[180:183], v[140:143], v[124:127]
ds_read_b64_tr_b16 v[194:195], v222 offset:20480
s_min_u32 s69, s69, s55
v_mfma_f32_16x16x32_bf16 v[128:131], v[180:183], v[144:147], v[128:131]
ds_read_b64_tr_b16 v[196:197], v223 offset:16384
s_lshl_b32 s69, s69, 2
v_mfma_f32_16x16x32_bf16 v[132:135], v[180:183], v[148:151], v[132:135]
ds_read_b64_tr_b16 v[198:199], v223 offset:20480
s_waitcnt lgkmcnt(6)
s_add_u32 s69, s69, s53
s_lshl_b32 s69, s69, 2
s_add_u32 s69, s69, 312
s_lshl_b32 s69, s69, 7
buffer_load_dword v244, v245, s[32:35], s69 offen sc1
v_mfma_f32_16x16x32_bf16 v[72:75], v[184:187], v[152:155], v[72:75]
ds_read_b64_tr_b16 v[168:169], v220 offset:32768
v_mfma_f32_16x16x32_bf16 v[76:79], v[184:187], v[156:159], v[76:79]
ds_read_b64_tr_b16 v[170:171], v220 offset:36864
v_mfma_f32_16x16x32_bf16 v[80:83], v[184:187], v[160:163], v[80:83]
ds_read_b64 v[136:137], v232 offset:32768
v_mfma_f32_16x16x32_bf16 v[84:87], v[184:187], v[164:167], v[84:87]
ds_read_b64 v[138:139], v232 offset:33280
s_waitcnt lgkmcnt(8)
v_mfma_f32_16x16x32_bf16 v[88:91], v[188:191], v[152:155], v[88:91]
ds_read_b64 v[140:141], v232 offset:33792
v_mfma_f32_16x16x32_bf16 v[92:95], v[188:191], v[156:159], v[92:95]
ds_read_b64 v[142:143], v232 offset:34304
v_mfma_f32_16x16x32_bf16 v[96:99], v[188:191], v[160:163], v[96:99]
ds_read_b64 v[144:145], v232 offset:36864
v_mfma_f32_16x16x32_bf16 v[100:103], v[188:191], v[164:167], v[100:103]
ds_read_b64 v[146:147], v232 offset:37376
s_waitcnt lgkmcnt(10)
v_mfma_f32_16x16x32_bf16 v[104:107], v[192:195], v[152:155], v[104:107]
ds_read_b64 v[148:149], v232 offset:37888
v_mfma_f32_16x16x32_bf16 v[108:111], v[192:195], v[156:159], v[108:111]
ds_read_b64 v[150:151], v232 offset:38400
v_mfma_f32_16x16x32_bf16 v[112:115], v[192:195], v[160:163], v[112:115]
ds_read_b64_tr_b16 v[172:173], v221 offset:32768
v_mfma_f32_16x16x32_bf16 v[116:119], v[192:195], v[164:167], v[116:119]
ds_read_b64_tr_b16 v[174:175], v221 offset:36864
s_waitcnt lgkmcnt(12)
v_mfma_f32_16x16x32_bf16 v[120:123], v[196:199], v[152:155], v[120:123]
ds_read_b64_tr_b16 v[176:177], v222 offset:32768
v_mfma_f32_16x16x32_bf16 v[124:127], v[196:199], v[156:159], v[124:127]
ds_read_b64_tr_b16 v[178:179], v222 offset:36864
v_mfma_f32_16x16x32_bf16 v[128:131], v[196:199], v[160:163], v[128:131]
ds_read_b64_tr_b16 v[180:181], v223 offset:32768
v_mfma_f32_16x16x32_bf16 v[132:135], v[196:199], v[164:167], v[132:135]
ds_read_b64_tr_b16 v[182:183], v223 offset:36864
s_waitcnt lgkmcnt(6)
s_waitcnt vmcnt(11)
s_barrier
v_mfma_f32_16x16x32_bf16 v[72:75], v[168:171], v[136:139], v[72:75]
ds_read_b64_tr_b16 v[184:185], v220 offset:49152
s_waitcnt vmcnt(0)
v_cmp_le_u32 vcc, 8, v244
s_cmp_eq_u64 vcc, exec
s_cbranch_scc0 KF_c_spin
KF_c_back:
v_mfma_f32_16x16x32_bf16 v[76:79], v[168:171], v[140:143], v[76:79]
ds_read_b64_tr_b16 v[186:187], v220 offset:53248
s_add_u32 m0, s51, 0
v_mfma_f32_16x16x32_bf16 v[80:83], v[168:171], v[144:147], v[80:83]
ds_read_b64 v[152:153], v232 offset:49152
s_add_u32 s65, s48, 1024
v_mfma_f32_16x16x32_bf16 v[84:87], v[168:171], v[148:151], v[84:87]
ds_read_b64 v[154:155], v232 offset:49664
s_waitcnt lgkmcnt(8)
buffer_load_dwordx4 v234, s[28:31], s65 offen offset:0 sc1 lds
v_mfma_f32_16x16x32_bf16 v[88:91], v[172:175], v[136:139], v[88:91]
ds_read_b64 v[156:157], v232 offset:50176
buffer_load_dwordx4 v235, s[28:31], s65 offen offset:1024 sc1 lds
v_mfma_f32_16x16x32_bf16 v[92:95], v[172:175], v[140:143], v[92:95]
ds_read_b64 v[158:159], v232 offset:50688
s_add_u32 m0, s41, 147456
v_mfma_f32_16x16x32_bf16 v[96:99], v[172:175], v[144:147], v[96:99]
ds_read_b64 v[160:161], v232 offset:53248
s_add_u32 s65, s48, 0
v_mfma_f32_16x16x32_bf16 v[100:103], v[172:175], v[148:151], v[100:103]
ds_read_b64 v[162:163], v232 offset:53760
s_waitcnt lgkmcnt(10)
buffer_load_dwordx4 v234, s[28:31], s65 offen offset:0 sc1 lds
v_mfma_f32_16x16x32_bf16 v[104:107], v[176:179], v[136:139], v[104:107]
ds_read_b64 v[164:165], v232 offset:54272
buffer_load_dwordx4 v235, s[28:31], s65 offen offset:1024 sc1 lds
v_mfma_f32_16x16x32_bf16 v[108:111], v[176:179], v[140:143], v[108:111]
ds_read_b64 v[166:167], v232 offset:54784
s_add_u32 m0, s52, 2048
v_mfma_f32_16x16x32_bf16 v[112:115], v[176:179], v[144:147], v[112:115]
ds_read_b64_tr_b16 v[188:189], v221 offset:49152
s_add_u32 s66, s50, 163840
v_mfma_f32_16x16x32_bf16 v[116:119], v[176:179], v[148:151], v[116:119]
ds_read_b64_tr_b16 v[190:191], v221 offset:53248
s_waitcnt lgkmcnt(12)
buffer_load_dwordx4 v238, s[4:7], s66 offen offset:0 lds
v_mfma_f32_16x16x32_bf16 v[120:123], v[180:183], v[136:139], v[120:123]
ds_read_b64_tr_b16 v[192:193], v222 offset:49152
buffer_load_dwordx4 v239, s[4:7], s66 offen offset:1024 lds
v_mfma_f32_16x16x32_bf16 v[124:127], v[180:183], v[140:143], v[124:127]
ds_read_b64_tr_b16 v[194:195], v222 offset:53248
s_add_u32 m0, s52, 18432
v_mfma_f32_16x16x32_bf16 v[128:131], v[180:183], v[144:147], v[128:131]
ds_read_b64_tr_b16 v[196:197], v223 offset:49152
s_add_u32 s66, s50, 196608
v_mfma_f32_16x16x32_bf16 v[132:135], v[180:183], v[148:151], v[132:135]
ds_read_b64_tr_b16 v[198:199], v223 offset:53248
s_waitcnt lgkmcnt(6)
buffer_load_dwordx4 v238, s[4:7], s66 offen offset:0 lds
buffer_load_dwordx4 v239, s[4:7], s66 offen offset:1024 lds
v_mfma_f32_16x16x32_bf16 v[72:75], v[184:187], v[152:155], v[72:75]
ds_read_b64_tr_b16 v[168:169], v224 offset:0
s_add_u32 m0, s51, 32768
v_mfma_f32_16x16x32_bf16 v[76:79], v[184:187], v[156:159], v[76:79]
ds_read_b64_tr_b16 v[170:171], v224 offset:4096
s_add_u32 s65, s48, 3072
v_mfma_f32_16x16x32_bf16 v[80:83], v[184:187], v[160:163], v[80:83]
ds_read_b64 v[136:137], v233 offset:0
buffer_load_dwordx4 v234, s[28:31], s65 offen offset:0 sc1 lds
v_mfma_f32_16x16x32_bf16 v[84:87], v[184:187], v[164:167], v[84:87]
ds_read_b64 v[138:139], v233 offset:512
s_waitcnt lgkmcnt(8)
v_mfma_f32_16x16x32_bf16 v[88:91], v[188:191], v[152:155], v[88:91]
ds_read_b64 v[140:141], v233 offset:1024
v_mfma_f32_16x16x32_bf16 v[92:95], v[188:191], v[156:159], v[92:95]
ds_read_b64 v[142:143], v233 offset:1536
v_mfma_f32_16x16x32_bf16 v[96:99], v[188:191], v[160:163], v[96:99]
ds_read_b64 v[144:145], v233 offset:4096
buffer_load_dwordx4 v235, s[28:31], s65 offen offset:1024 sc1 lds
v_mfma_f32_16x16x32_bf16 v[100:103], v[188:191], v[164:167], v[100:103]
ds_read_b64 v[146:147], v233 offset:4608
s_waitcnt lgkmcnt(10)
v_mfma_f32_16x16x32_bf16 v[104:107], v[192:195], v[152:155], v[104:107]
ds_read_b64 v[148:149], v233 offset:5120
s_add_u32 m0, s51, 16384
v_mfma_f32_16x16x32_bf16 v[108:111], v[192:195], v[156:159], v[108:111]
ds_read_b64 v[150:151], v233 offset:5632
s_add_u32 s65, s48, 2048
v_mfma_f32_16x16x32_bf16 v[112:115], v[192:195], v[160:163], v[112:115]
ds_read_b64_tr_b16 v[172:173], v225 offset:0
buffer_load_dwordx4 v234, s[28:31], s65 offen offset:0 sc1 lds
v_mfma_f32_16x16x32_bf16 v[116:119], v[192:195], v[164:167], v[116:119]
ds_read_b64_tr_b16 v[174:175], v225 offset:4096
s_waitcnt lgkmcnt(12)
v_mfma_f32_16x16x32_bf16 v[120:123], v[196:199], v[152:155], v[120:123]
ds_read_b64_tr_b16 v[176:177], v226 offset:0
v_mfma_f32_16x16x32_bf16 v[124:127], v[196:199], v[156:159], v[124:127]
ds_read_b64_tr_b16 v[178:179], v226 offset:4096
v_mfma_f32_16x16x32_bf16 v[128:131], v[196:199], v[160:163], v[128:131]
ds_read_b64_tr_b16 v[180:181], v227 offset:0
buffer_load_dwordx4 v235, s[28:31], s65 offen offset:1024 sc1 lds
v_mfma_f32_16x16x32_bf16 v[132:135], v[196:199], v[164:167], v[132:135]
ds_read_b64_tr_b16 v[182:183], v227 offset:4096
s_waitcnt lgkmcnt(6)
s_waitcnt vmcnt(8)
s_barrier
v_mfma_f32_16x16x32_bf16 v[72:75], v[168:171], v[136:139], v[72:75]
ds_read_b64_tr_b16 v[184:185], v224 offset:16384
s_add_u32 m0, s52, 0
v_mfma_f32_16x16x32_bf16 v[76:79], v[168:171], v[140:143], v[76:79]
ds_read_b64_tr_b16 v[186:187], v224 offset:20480
s_add_u32 s65, s48, 5120
v_mfma_f32_16x16x32_bf16 v[80:83], v[168:171], v[144:147], v[80:83]
ds_read_b128 v[152:155], v230 offset:16384
buffer_load_dwordx4 v234, s[28:31], s65 offen offset:0 sc1 lds
v_mfma_f32_16x16x32_bf16 v[84:87], v[168:171], v[148:151], v[84:87]
ds_read_b128 v[156:159], v230 offset:17408
s_waitcnt lgkmcnt(8)
buffer_load_dwordx4 v235, s[28:31], s65 offen offset:1024 sc1 lds
v_mfma_f32_16x16x32_bf16 v[88:91], v[172:175], v[136:139], v[88:91]
ds_read_b128 v[160:163], v230 offset:20480
s_add_u32 m0, s51, 49152
v_mfma_f32_16x16x32_bf16 v[92:95], v[172:175], v[140:143], v[92:95]
ds_read_b128 v[164:167], v230 offset:21504
s_add_u32 s65, s48, 4096
v_mfma_f32_16x16x32_bf16 v[96:99], v[172:175], v[144:147], v[96:99]
ds_read_b64_tr_b16 v[188:189], v225 offset:16384
buffer_load_dwordx4 v234, s[28:31], s65 offen offset:0 sc1 lds
v_mfma_f32_16x16x32_bf16 v[100:103], v[172:175], v[148:151], v[100:103]
ds_read_b64_tr_b16 v[190:191], v225 offset:20480
s_waitcnt lgkmcnt(10)
buffer_load_dwordx4 v235, s[28:31], s65 offen offset:1024 sc1 lds
v_mfma_f32_16x16x32_bf16 v[104:107], v[176:179], v[136:139], v[104:107]
ds_read_b64_tr_b16 v[192:193], v226 offset:16384
s_add_u32 m0, s52, 34816
v_mfma_f32_16x16x32_bf16 v[108:111], v[176:179], v[140:143], v[108:111]
ds_read_b64_tr_b16 v[194:195], v226 offset:20480
s_add_u32 s66, s50, 229376
v_mfma_f32_16x16x32_bf16 v[112:115], v[176:179], v[144:147], v[112:115]
ds_read_b64_tr_b16 v[196:197], v227 offset:16384
buffer_load_dwordx4 v238, s[4:7], s66 offen offset:0 lds
v_mfma_f32_16x16x32_bf16 v[116:119], v[176:179], v[148:151], v[116:119]
ds_read_b64_tr_b16 v[198:199], v227 offset:20480
s_waitcnt lgkmcnt(12)
buffer_load_dwordx4 v239, s[4:7], s66 offen offset:1024 lds
v_mfma_f32_16x16x32_bf16 v[120:123], v[180:183], v[136:139], v[120:123]
s_add_u32 m0, s52, 51200
s_add_u32 s66, s50, 262144
v_mfma_f32_16x16x32_bf16 v[124:127], v[180:183], v[140:143], v[124:127]
buffer_load_dwordx4 v238, s[4:7], s66 offen offset:0 lds
v_mfma_f32_16x16x32_bf16 v[128:131], v[180:183], v[144:147], v[128:131]
buffer_load_dwordx4 v239, s[4:7], s66 offen offset:1024 lds
v_mfma_f32_16x16x32_bf16 v[132:135], v[180:183], v[148:151], v[132:135]
s_waitcnt lgkmcnt(6)
v_mfma_f32_16x16x32_bf16 v[72:75], v[184:187], v[152:155], v[72:75]
ds_read_b64_tr_b16 v[168:169], v216 offset:0
s_add_u32 m0, s52, 32768
v_mfma_f32_16x16x32_bf16 v[76:79], v[184:187], v[156:159], v[76:79]
ds_read_b64_tr_b16 v[170:171], v216 offset:4096
s_add_u32 s65, s48, 7168
v_mfma_f32_16x16x32_bf16 v[80:83], v[184:187], v[160:163], v[80:83]
ds_read_b128 v[136:139], v228 offset:0
buffer_load_dwordx4 v234, s[28:31], s65 offen offset:0 sc1 lds
v_mfma_f32_16x16x32_bf16 v[84:87], v[184:187], v[164:167], v[84:87]
ds_read_b128 v[140:143], v228 offset:1024
s_waitcnt lgkmcnt(8)
v_mfma_f32_16x16x32_bf16 v[88:91], v[188:191], v[152:155], v[88:91]
ds_read_b128 v[144:147], v228 offset:4096
v_mfma_f32_16x16x32_bf16 v[92:95], v[188:191], v[156:159], v[92:95]
ds_read_b128 v[148:151], v228 offset:5120
v_mfma_f32_16x16x32_bf16 v[96:99], v[188:191], v[160:163], v[96:99]
ds_read_b64_tr_b16 v[172:173], v217 offset:0
buffer_load_dwordx4 v235, s[28:31], s65 offen offset:1024 sc1 lds
v_mfma_f32_16x16x32_bf16 v[100:103], v[188:191], v[164:167], v[100:103]
ds_read_b64_tr_b16 v[174:175], v217 offset:4096
s_waitcnt lgkmcnt(10)
v_mfma_f32_16x16x32_bf16 v[104:107], v[192:195], v[152:155], v[104:107]
ds_read_b64_tr_b16 v[176:177], v218 offset:0
s_add_u32 m0, s52, 16384
v_mfma_f32_16x16x32_bf16 v[108:111], v[192:195], v[156:159], v[108:111]
ds_read_b64_tr_b16 v[178:179], v218 offset:4096
s_add_u32 s65, s48, 6144
v_mfma_f32_16x16x32_bf16 v[112:115], v[192:195], v[160:163], v[112:115]
ds_read_b64_tr_b16 v[180:181], v219 offset:0
buffer_load_dwordx4 v234, s[28:31], s65 offen offset:0 sc1 lds
v_mfma_f32_16x16x32_bf16 v[116:119], v[192:195], v[164:167], v[116:119]
ds_read_b64_tr_b16 v[182:183], v219 offset:4096
s_waitcnt lgkmcnt(12)
v_mfma_f32_16x16x32_bf16 v[120:123], v[196:199], v[152:155], v[120:123]
v_mfma_f32_16x16x32_bf16 v[124:127], v[196:199], v[156:159], v[124:127]
v_mfma_f32_16x16x32_bf16 v[128:131], v[196:199], v[160:163], v[128:131]
buffer_load_dwordx4 v235, s[28:31], s65 offen offset:1024 sc1 lds
v_mfma_f32_16x16x32_bf16 v[132:135], v[196:199], v[164:167], v[132:135]
s_waitcnt lgkmcnt(6)
s_waitcnt vmcnt(12)
s_barrier
v_mfma_f32_16x16x32_bf16 v[72:75], v[168:171], v[136:139], v[72:75]
ds_read_b64_tr_b16 v[184:185], v216 offset:16384
s_add_u32 m0, s41, 131072
v_mfma_f32_16x16x32_bf16 v[76:79], v[168:171], v[140:143], v[76:79]
ds_read_b64_tr_b16 v[186:187], v216 offset:20480
s_add_u32 s65, s48, 9216
v_mfma_f32_16x16x32_bf16 v[80:83], v[168:171], v[144:147], v[80:83]
ds_read_b128 v[152:155], v228 offset:16384
buffer_load_dwordx4 v234, s[28:31], s65 offen offset:0 sc1 lds
v_mfma_f32_16x16x32_bf16 v[84:87], v[168:171], v[148:151], v[84:87]
ds_read_b128 v[156:159], v228 offset:17408
s_waitcnt lgkmcnt(8)
buffer_load_dwordx4 v235, s[28:31], s65 offen offset:1024 sc1 lds
v_mfma_f32_16x16x32_bf16 v[88:91], v[172:175], v[136:139], v[88:91]
ds_read_b128 v[160:163], v228 offset:20480
s_add_u32 m0, s52, 49152
v_mfma_f32_16x16x32_bf16 v[92:95], v[172:175], v[140:143], v[92:95]
ds_read_b128 v[164:167], v228 offset:21504
s_add_u32 s65, s48, 8192
v_mfma_f32_16x16x32_bf16 v[96:99], v[172:175], v[144:147], v[96:99]
ds_read_b64_tr_b16 v[188:189], v217 offset:16384
buffer_load_dwordx4 v234, s[28:31], s65 offen offset:0 sc1 lds
v_mfma_f32_16x16x32_bf16 v[100:103], v[172:175], v[148:151], v[100:103]
ds_read_b64_tr_b16 v[190:191], v217 offset:20480
s_waitcnt lgkmcnt(10)
buffer_load_dwordx4 v235, s[28:31], s65 offen offset:1024 sc1 lds
v_mfma_f32_16x16x32_bf16 v[104:107], v[176:179], v[136:139], v[104:107]
ds_read_b64_tr_b16 v[192:193], v218 offset:16384
s_add_u32 m0, s41, 133120
v_mfma_f32_16x16x32_bf16 v[108:111], v[176:179], v[140:143], v[108:111]
ds_read_b64_tr_b16 v[194:195], v218 offset:20480
s_add_u32 s66, s50, 294912
v_mfma_f32_16x16x32_bf16 v[112:115], v[176:179], v[144:147], v[112:115]
ds_read_b64_tr_b16 v[196:197], v219 offset:16384
buffer_load_dwordx4 v238, s[4:7], s66 offen offset:0 lds
v_mfma_f32_16x16x32_bf16 v[116:119], v[176:179], v[148:151], v[116:119]
ds_read_b64_tr_b16 v[198:199], v219 offset:20480
s_waitcnt lgkmcnt(12)
buffer_load_dwordx4 v239, s[4:7], s66 offen offset:1024 lds
v_mfma_f32_16x16x32_bf16 v[120:123], v[180:183], v[136:139], v[120:123]
s_add_u32 m0, s41, 149504
s_add_u32 s66, s50, 327680
v_mfma_f32_16x16x32_bf16 v[124:127], v[180:183], v[140:143], v[124:127]
buffer_load_dwordx4 v238, s[4:7], s66 offen offset:0 lds
v_mfma_f32_16x16x32_bf16 v[128:131], v[180:183], v[144:147], v[128:131]
buffer_load_dwordx4 v239, s[4:7], s66 offen offset:1024 lds
v_mfma_f32_16x16x32_bf16 v[132:135], v[180:183], v[148:151], v[132:135]
s_waitcnt lgkmcnt(6)
v_mfma_f32_16x16x32_bf16 v[72:75], v[184:187], v[152:155], v[72:75]
ds_read_b64_tr_b16 v[168:169], v216 offset:32768
s_add_u32 m0, s41, 147456
v_mfma_f32_16x16x32_bf16 v[76:79], v[184:187], v[156:159], v[76:79]
ds_read_b64_tr_b16 v[170:171], v216 offset:36864
s_add_u32 s65, s48, 10240
v_mfma_f32_16x16x32_bf16 v[80:83], v[184:187], v[160:163], v[80:83]
ds_read_b128 v[136:139], v228 offset:32768
buffer_load_dwordx4 v234, s[28:31], s65 offen offset:0 sc1 lds
v_mfma_f32_16x16x32_bf16 v[84:87], v[184:187], v[164:167], v[84:87]
ds_read_b128 v[140:143], v228 offset:33792
s_waitcnt lgkmcnt(8)
v_mfma_f32_16x16x32_bf16 v[88:91], v[188:191], v[152:155], v[88:91]
ds_read_b128 v[144:147], v228 offset:36864
v_mfma_f32_16x16x32_bf16 v[92:95], v[188:191], v[156:159], v[92:95]
ds_read_b128 v[148:151], v228 offset:37888
v_mfma_f32_16x16x32_bf16 v[96:99], v[188:191], v[160:163], v[96:99]
ds_read_b64_tr_b16 v[172:173], v217 offset:32768
v_mfma_f32_16x16x32_bf16 v[100:103], v[188:191], v[164:167], v[100:103]
ds_read_b64_tr_b16 v[174:175], v217 offset:36864
s_waitcnt lgkmcnt(10)
v_mfma_f32_16x16x32_bf16 v[104:107], v[192:195], v[152:155], v[104:107]
ds_read_b64_tr_b16 v[176:177], v218 offset:32768
v_mfma_f32_16x16x32_bf16 v[108:111], v[192:195], v[156:159], v[108:111]
ds_read_b64_tr_b16 v[178:179], v218 offset:36864
v_mfma_f32_16x16x32_bf16 v[112:115], v[192:195], v[160:163], v[112:115]
ds_read_b64_tr_b16 v[180:181], v219 offset:32768
buffer_load_dwordx4 v235, s[28:31], s65 offen offset:1024 sc1 lds
v_mfma_f32_16x16x32_bf16 v[116:119], v[192:195], v[164:167], v[116:119]
ds_read_b64_tr_b16 v[182:183], v219 offset:36864
s_waitcnt lgkmcnt(12)
v_mfma_f32_16x16x32_bf16 v[120:123], v[196:199], v[152:155], v[120:123]
v_mfma_f32_16x16x32_bf16 v[124:127], v[196:199], v[156:159], v[124:127]
v_mfma_f32_16x16x32_bf16 v[128:131], v[196:199], v[160:163], v[128:131]
v_mfma_f32_16x16x32_bf16 v[132:135], v[196:199], v[164:167], v[132:135]
s_waitcnt lgkmcnt(6)
s_waitcnt vmcnt(18)
s_barrier
v_mfma_f32_16x16x32_bf16 v[72:75], v[168:171], v[136:139], v[72:75]
ds_read_b64_tr_b16 v[184:185], v216 offset:49152
s_add_u32 m0, s51, 16384
v_mfma_f32_16x16x32_bf16 v[76:79], v[168:171], v[140:143], v[76:79]
ds_read_b64_tr_b16 v[186:187], v216 offset:53248
s_add_u32 s65, s48, 12288
v_mfma_f32_16x16x32_bf16 v[80:83], v[168:171], v[144:147], v[80:83]
ds_read_b128 v[152:155], v228 offset:49152
buffer_load_dwordx4 v234, s[28:31], s65 offen offset:0 sc1 lds
v_mfma_f32_16x16x32_bf16 v[84:87], v[168:171], v[148:151], v[84:87]
ds_read_b128 v[156:159], v228 offset:50176
s_waitcnt lgkmcnt(8)
buffer_load_dwordx4 v235, s[28:31], s65 offen offset:1024 sc1 lds
v_mfma_f32_16x16x32_bf16 v[88:91], v[172:175], v[136:139], v[88:91]
ds_read_b128 v[160:163], v228 offset:53248
s_add_u32 m0, s51, 0
v_mfma_f32_16x16x32_bf16 v[92:95], v[172:175], v[140:143], v[92:95]
ds_read_b128 v[164:167], v228 offset:54272
s_add_u32 s65, s48, 11264
v_mfma_f32_16x16x32_bf16 v[96:99], v[172:175], v[144:147], v[96:99]
ds_read_b64_tr_b16 v[188:189], v217 offset:49152
buffer_load_dwordx4 v234, s[28:31], s65 offen offset:0 sc1 lds
v_mfma_f32_16x16x32_bf16 v[100:103], v[172:175], v[148:151], v[100:103]
ds_read_b64_tr_b16 v[190:191], v217 offset:53248
s_waitcnt lgkmcnt(10)
buffer_load_dwordx4 v235, s[28:31], s65 offen offset:1024 sc1 lds
v_mfma_f32_16x16x32_bf16 v[104:107], v[176:179], v[136:139], v[104:107]
ds_read_b64_tr_b16 v[192:193], v218 offset:49152
s_add_u32 m0, s51, 2048
v_mfma_f32_16x16x32_bf16 v[108:111], v[176:179], v[140:143], v[108:111]
ds_read_b64_tr_b16 v[194:195], v218 offset:53248
s_add_u32 s66, s50, 360448
v_mfma_f32_16x16x32_bf16 v[112:115], v[176:179], v[144:147], v[112:115]
ds_read_b64_tr_b16 v[196:197], v219 offset:49152
buffer_load_dwordx4 v238, s[4:7], s66 offen offset:0 lds
v_mfma_f32_16x16x32_bf16 v[116:119], v[176:179], v[148:151], v[116:119]
ds_read_b64_tr_b16 v[198:199], v219 offset:53248
s_waitcnt lgkmcnt(12)
buffer_load_dwordx4 v239, s[4:7], s66 offen offset:1024 lds
v_mfma_f32_16x16x32_bf16 v[120:123], v[180:183], v[136:139], v[120:123]
s_add_u32 m0, s51, 18432
s_add_u32 s66, s50, 393216
v_mfma_f32_16x16x32_bf16 v[124:127], v[180:183], v[140:143], v[124:127]
buffer_load_dwordx4 v238, s[4:7], s66 offen offset:0 lds
v_mfma_f32_16x16x32_bf16 v[128:131], v[180:183], v[144:147], v[128:131]
buffer_load_dwordx4 v239, s[4:7], s66 offen offset:1024 lds
v_mfma_f32_16x16x32_bf16 v[132:135], v[180:183], v[148:151], v[132:135]
s_waitcnt lgkmcnt(6)
v_mfma_f32_16x16x32_bf16 v[72:75], v[184:187], v[152:155], v[72:75]
ds_read_b64_tr_b16 v[168:169], v220 offset:0
v_mfma_f32_16x16x32_bf16 v[76:79], v[184:187], v[156:159], v[76:79]
ds_read_b64_tr_b16 v[170:171], v220 offset:4096
v_mfma_f32_16x16x32_bf16 v[80:83], v[184:187], v[160:163], v[80:83]
ds_read_b128 v[136:139], v229 offset:0
v_mfma_f32_16x16x32_bf16 v[84:87], v[184:187], v[164:167], v[84:87]
ds_read_b128 v[140:143], v229 offset:1024
s_waitcnt lgkmcnt(8)
v_mfma_f32_16x16x32_bf16 v[88:91], v[188:191], v[152:155], v[88:91]
ds_read_b128 v[144:147], v229 offset:4096
v_mfma_f32_16x16x32_bf16 v[92:95], v[188:191], v[156:159], v[92:95]
ds_read_b128 v[148:151], v229 offset:5120
v_mfma_f32_16x16x32_bf16 v[96:99], v[188:191], v[160:163], v[96:99]
ds_read_b64_tr_b16 v[172:173], v221 offset:0
v_mfma_f32_16x16x32_bf16 v[100:103], v[188:191], v[164:167], v[100:103]
ds_read_b64_tr_b16 v[174:175], v221 offset:4096
s_waitcnt lgkmcnt(10)
v_mfma_f32_16x16x32_bf16 v[104:107], v[192:195], v[152:155], v[104:107]
ds_read_b64_tr_b16 v[176:177], v222 offset:0
v_mfma_f32_16x16x32_bf16 v[108:111], v[192:195], v[156:159], v[108:111]
ds_read_b64_tr_b16 v[178:179], v222 offset:4096
v_mfma_f32_16x16x32_bf16 v[112:115], v[192:195], v[160:163], v[112:115]
ds_read_b64_tr_b16 v[180:181], v223 offset:0
v_mfma_f32_16x16x32_bf16 v[116:119], v[192:195], v[164:167], v[116:119]
ds_read_b64_tr_b16 v[182:183], v223 offset:4096
s_waitcnt lgkmcnt(12)
v_mfma_f32_16x16x32_bf16 v[120:123], v[196:199], v[152:155], v[120:123]
v_mfma_f32_16x16x32_bf16 v[124:127], v[196:199], v[156:159], v[124:127]
v_mfma_f32_16x16x32_bf16 v[128:131], v[196:199], v[160:163], v[128:131]
v_mfma_f32_16x16x32_bf16 v[132:135], v[196:199], v[164:167], v[132:135]
s_waitcnt lgkmcnt(6)
s_waitcnt vmcnt(18)
s_barrier
v_mfma_f32_16x16x32_bf16 v[72:75], v[168:171], v[136:139], v[72:75]
ds_read_b64_tr_b16 v[184:185], v220 offset:16384
s_add_u32 m0, s51, 49152
v_mfma_f32_16x16x32_bf16 v[76:79], v[168:171], v[140:143], v[76:79]
ds_read_b64_tr_b16 v[186:187], v220 offset:20480
s_add_u32 s65, s48, 14336
v_mfma_f32_16x16x32_bf16 v[80:83], v[168:171], v[144:147], v[80:83]
ds_read_b128 v[152:155], v229 offset:16384
buffer_load_dwordx4 v234, s[28:31], s65 offen offset:0 sc1 lds
v_mfma_f32_16x16x32_bf16 v[84:87], v[168:171], v[148:151], v[84:87]
ds_read_b128 v[156:159], v229 offset:17408
s_waitcnt lgkmcnt(8)
buffer_load_dwordx4 v235, s[28:31], s65 offen offset:1024 sc1 lds
v_mfma_f32_16x16x32_bf16 v[88:91], v[172:175], v[136:139], v[88:91]
ds_read_b128 v[160:163], v229 offset:20480
s_add_u32 m0, s51, 32768
v_mfma_f32_16x16x32_bf16 v[92:95], v[172:175], v[140:143], v[92:95]
ds_read_b128 v[164:167], v229 offset:21504
s_add_u32 s65, s48, 13312
v_mfma_f32_16x16x32_bf16 v[96:99], v[172:175], v[144:147], v[96:99]
ds_read_b64_tr_b16 v[188:189], v221 offset:16384
buffer_load_dwordx4 v234, s[28:31], s65 offen offset:0 sc1 lds
v_mfma_f32_16x16x32_bf16 v[100:103], v[172:175], v[148:151], v[100:103]
ds_read_b64_tr_b16 v[190:191], v221 offset:20480
s_waitcnt lgkmcnt(10)
buffer_load_dwordx4 v235, s[28:31], s65 offen offset:1024 sc1 lds
v_mfma_f32_16x16x32_bf16 v[104:107], v[176:179], v[136:139], v[104:107]
ds_read_b64_tr_b16 v[192:193], v222 offset:16384
s_add_u32 m0, s51, 34816
v_mfma_f32_16x16x32_bf16 v[108:111], v[176:179], v[140:143], v[108:111]
ds_read_b64_tr_b16 v[194:195], v222 offset:20480
s_add_u32 s66, s50, 425984
v_mfma_f32_16x16x32_bf16 v[112:115], v[176:179], v[144:147], v[112:115]
ds_read_b64_tr_b16 v[196:197], v223 offset:16384
buffer_load_dwordx4 v238, s[4:7], s66 offen offset:0 lds
v_mfma_f32_16x16x32_bf16 v[116:119], v[176:179], v[148:151], v[116:119]
ds_read_b64_tr_b16 v[198:199], v223 offset:20480
s_waitcnt lgkmcnt(12)
buffer_load_dwordx4 v239, s[4:7], s66 offen offset:1024 lds
v_mfma_f32_16x16x32_bf16 v[120:123], v[180:183], v[136:139], v[120:123]
s_add_u32 m0, s51, 51200
s_add_u32 s66, s50, 458752
v_mfma_f32_16x16x32_bf16 v[124:127], v[180:183], v[140:143], v[124:127]
buffer_load_dwordx4 v238, s[4:7], s66 offen offset:0 lds
v_mfma_f32_16x16x32_bf16 v[128:131], v[180:183], v[144:147], v[128:131]
buffer_load_dwordx4 v239, s[4:7], s66 offen offset:1024 lds
v_mfma_f32_16x16x32_bf16 v[132:135], v[180:183], v[148:151], v[132:135]
s_waitcnt lgkmcnt(6)
v_mfma_f32_16x16x32_bf16 v[72:75], v[184:187], v[152:155], v[72:75]
ds_read_b64_tr_b16 v[168:169], v220 offset:32768
v_mfma_f32_16x16x32_bf16 v[76:79], v[184:187], v[156:159], v[76:79]
ds_read_b64_tr_b16 v[170:171], v220 offset:36864
v_mfma_f32_16x16x32_bf16 v[80:83], v[184:187], v[160:163], v[80:83]
ds_read_b128 v[136:139], v229 offset:32768
v_mfma_f32_16x16x32_bf16 v[84:87], v[184:187], v[164:167], v[84:87]
ds_read_b128 v[140:143], v229 offset:33792
s_waitcnt lgkmcnt(8)
v_mfma_f32_16x16x32_bf16 v[88:91], v[188:191], v[152:155], v[88:91]
ds_read_b128 v[144:147], v229 offset:36864
v_mfma_f32_16x16x32_bf16 v[92:95], v[188:191], v[156:159], v[92:95]
ds_read_b128 v[148:151], v229 offset:37888
v_mfma_f32_16x16x32_bf16 v[96:99], v[188:191], v[160:163], v[96:99]
ds_read_b64_tr_b16 v[172:173], v221 offset:32768
v_mfma_f32_16x16x32_bf16 v[100:103], v[188:191], v[164:167], v[100:103]
ds_read_b64_tr_b16 v[174:175], v221 offset:36864
s_waitcnt lgkmcnt(10)
v_mfma_f32_16x16x32_bf16 v[104:107], v[192:195], v[152:155], v[104:107]
ds_read_b64_tr_b16 v[176:177], v222 offset:32768
v_mfma_f32_16x16x32_bf16 v[108:111], v[192:195], v[156:159], v[108:111]
ds_read_b64_tr_b16 v[178:179], v222 offset:36864
v_mfma_f32_16x16x32_bf16 v[112:115], v[192:195], v[160:163], v[112:115]
ds_read_b64_tr_b16 v[180:181], v223 offset:32768
v_mfma_f32_16x16x32_bf16 v[116:119], v[192:195], v[164:167], v[116:119]
ds_read_b64_tr_b16 v[182:183], v223 offset:36864
s_waitcnt lgkmcnt(12)
v_mfma_f32_16x16x32_bf16 v[120:123], v[196:199], v[152:155], v[120:123]
v_mfma_f32_16x16x32_bf16 v[124:127], v[196:199], v[156:159], v[124:127]
v_mfma_f32_16x16x32_bf16 v[128:131], v[196:199], v[160:163], v[128:131]
v_mfma_f32_16x16x32_bf16 v[132:135], v[196:199], v[164:167], v[132:135]
s_waitcnt lgkmcnt(6)
s_waitcnt vmcnt(20)
s_barrier
v_mfma_f32_16x16x32_bf16 v[72:75], v[168:171], v[136:139], v[72:75]
ds_read_b64_tr_b16 v[184:185], v220 offset:49152
s_add_u32 m0, s52, 16384
v_mfma_f32_16x16x32_bf16 v[76:79], v[168:171], v[140:143], v[76:79]
ds_read_b64_tr_b16 v[186:187], v220 offset:53248
s_add_u32 s65, s48, 16384
v_mfma_f32_16x16x32_bf16 v[80:83], v[168:171], v[144:147], v[80:83]
ds_read_b128 v[152:155], v229 offset:49152
buffer_load_dwordx4 v234, s[28:31], s65 offen offset:0 sc1 lds
v_mfma_f32_16x16x32_bf16 v[84:87], v[168:171], v[148:151], v[84:87]
ds_read_b128 v[156:159], v229 offset:50176
s_waitcnt lgkmcnt(8)
buffer_load_dwordx4 v235, s[28:31], s65 offen offset:1024 sc1 lds
v_mfma_f32_16x16x32_bf16 v[88:91], v[172:175], v[136:139], v[88:91]
ds_read_b128 v[160:163], v229 offset:53248
s_add_u32 m0, s52, 0
v_mfma_f32_16x16x32_bf16 v[92:95], v[172:175], v[140:143], v[92:95]
ds_read_b128 v[164:167], v229 offset:54272
s_add_u32 s65, s48, 15360
v_mfma_f32_16x16x32_bf16 v[96:99], v[172:175], v[144:147], v[96:99]
ds_read_b64_tr_b16 v[188:189], v221 offset:49152
buffer_load_dwordx4 v234, s[28:31], s65 offen offset:0 sc1 lds
v_mfma_f32_16x16x32_bf16 v[100:103], v[172:175], v[148:151], v[100:103]
ds_read_b64_tr_b16 v[190:191], v221 offset:53248
s_waitcnt lgkmcnt(10)
buffer_load_dwordx4 v235, s[28:31], s65 offen offset:1024 sc1 lds
v_mfma_f32_16x16x32_bf16 v[104:107], v[176:179], v[136:139], v[104:107]
ds_read_b64_tr_b16 v[192:193], v222 offset:49152
s_add_u32 m0, s52, 2048
v_mfma_f32_16x16x32_bf16 v[108:111], v[176:179], v[140:143], v[108:111]
ds_read_b64_tr_b16 v[194:195], v222 offset:53248
s_add_u32 s66, s50, 491520
v_mfma_f32_16x16x32_bf16 v[112:115], v[176:179], v[144:147], v[112:115]
ds_read_b64_tr_b16 v[196:197], v223 offset:49152
buffer_load_dwordx4 v238, s[4:7], s66 offen offset:0 lds
v_mfma_f32_16x16x32_bf16 v[116:119], v[176:179], v[148:151], v[116:119]
ds_read_b64_tr_b16 v[198:199], v223 offset:53248
s_waitcnt lgkmcnt(12)
buffer_load_dwordx4 v239, s[4:7], s66 offen offset:1024 lds
v_mfma_f32_16x16x32_bf16 v[120:123], v[180:183], v[136:139], v[120:123]
s_add_u32 m0, s52, 18432
s_add_u32 s66, s50, 524288
v_mfma_f32_16x16x32_bf16 v[124:127], v[180:183], v[140:143], v[124:127]
buffer_load_dwordx4 v238, s[4:7], s66 offen offset:0 lds
v_mfma_f32_16x16x32_bf16 v[128:131], v[180:183], v[144:147], v[128:131]
buffer_load_dwordx4 v239, s[4:7], s66 offen offset:1024 lds
v_mfma_f32_16x16x32_bf16 v[132:135], v[180:183], v[148:151], v[132:135]
s_waitcnt lgkmcnt(6)
v_mfma_f32_16x16x32_bf16 v[72:75], v[184:187], v[152:155], v[72:75]
ds_read_b64_tr_b16 v[168:169], v224 offset:0
v_mfma_f32_16x16x32_bf16 v[76:79], v[184:187], v[156:159], v[76:79]
ds_read_b64_tr_b16 v[170:171], v224 offset:4096
v_mfma_f32_16x16x32_bf16 v[80:83], v[184:187], v[160:163], v[80:83]
ds_read_b128 v[136:139], v230 offset:0
v_mfma_f32_16x16x32_bf16 v[84:87], v[184:187], v[164:167], v[84:87]
ds_read_b128 v[140:143], v230 offset:1024
s_waitcnt lgkmcnt(8)
v_mfma_f32_16x16x32_bf16 v[88:91], v[188:191], v[152:155], v[88:91]
ds_read_b128 v[144:147], v230 offset:4096
v_mfma_f32_16x16x32_bf16 v[92:95], v[188:191], v[156:159], v[92:95]
ds_read_b128 v[148:151], v230 offset:5120
v_mfma_f32_16x16x32_bf16 v[96:99], v[188:191], v[160:163], v[96:99]
ds_read_b64_tr_b16 v[172:173], v225 offset:0
v_mfma_f32_16x16x32_bf16 v[100:103], v[188:191], v[164:167], v[100:103]
ds_read_b64_tr_b16 v[174:175], v225 offset:4096
s_waitcnt lgkmcnt(10)
v_mfma_f32_16x16x32_bf16 v[104:107], v[192:195], v[152:155], v[104:107]
ds_read_b64_tr_b16 v[176:177], v226 offset:0
v_mfma_f32_16x16x32_bf16 v[108:111], v[192:195], v[156:159], v[108:111]
ds_read_b64_tr_b16 v[178:179], v226 offset:4096
v_mfma_f32_16x16x32_bf16 v[112:115], v[192:195], v[160:163], v[112:115]
ds_read_b64_tr_b16 v[180:181], v227 offset:0
v_mfma_f32_16x16x32_bf16 v[116:119], v[192:195], v[164:167], v[116:119]
ds_read_b64_tr_b16 v[182:183], v227 offset:4096
s_waitcnt lgkmcnt(12)
v_mfma_f32_16x16x32_bf16 v[120:123], v[196:199], v[152:155], v[120:123]
v_mfma_f32_16x16x32_bf16 v[124:127], v[196:199], v[156:159], v[124:127]
v_mfma_f32_16x16x32_bf16 v[128:131], v[196:199], v[160:163], v[128:131]
v_mfma_f32_16x16x32_bf16 v[132:135], v[196:199], v[164:167], v[132:135]
s_waitcnt lgkmcnt(6)
s_waitcnt vmcnt(18)
s_barrier
v_mfma_f32_16x16x32_bf16 v[72:75], v[168:171], v[136:139], v[72:75]
ds_read_b64_tr_b16 v[184:185], v224 offset:16384
s_add_u32 m0, s52, 49152
v_mfma_f32_16x16x32_bf16 v[76:79], v[168:171], v[140:143], v[76:79]
ds_read_b64_tr_b16 v[186:187], v224 offset:20480
s_add_u32 s65, s48, 18432
v_mfma_f32_16x16x32_bf16 v[80:83], v[168:171], v[144:147], v[80:83]
ds_read_b128 v[152:155], v230 offset:16384
buffer_load_dwordx4 v234, s[28:31], s65 offen offset:0 sc1 lds
v_mfma_f32_16x16x32_bf16 v[84:87], v[168:171], v[148:151], v[84:87]
ds_read_b128 v[156:159], v230 offset:17408
s_waitcnt lgkmcnt(8)
buffer_load_dwordx4 v235, s[28:31], s65 offen offset:1024 sc1 lds
v_mfma_f32_16x16x32_bf16 v[88:91], v[172:175], v[136:139], v[88:91]
ds_read_b128 v[160:163], v230 offset:20480
s_add_u32 m0, s52, 32768
v_mfma_f32_16x16x32_bf16 v[92:95], v[172:175], v[140:143], v[92:95]
ds_read_b128 v[164:167], v230 offset:21504
s_add_u32 s65, s48, 17408
v_mfma_f32_16x16x32_bf16 v[96:99], v[172:175], v[144:147], v[96:99]
ds_read_b64_tr_b16 v[188:189], v225 offset:16384
buffer_load_dwordx4 v234, s[28:31], s65 offen offset:0 sc1 lds
v_mfma_f32_16x16x32_bf16 v[100:103], v[172:175], v[148:151], v[100:103]
ds_read_b64_tr_b16 v[190:191], v225 offset:20480
s_waitcnt lgkmcnt(10)
buffer_load_dwordx4 v235, s[28:31], s65 offen offset:1024 sc1 lds
v_mfma_f32_16x16x32_bf16 v[104:107], v[176:179], v[136:139], v[104:107]
ds_read_b64_tr_b16 v[192:193], v226 offset:16384
s_add_u32 m0, s52, 34816
v_mfma_f32_16x16x32_bf16 v[108:111], v[176:179], v[140:143], v[108:111]
ds_read_b64_tr_b16 v[194:195], v226 offset:20480
s_add_u32 s66, s50, 557056
v_mfma_f32_16x16x32_bf16 v[112:115], v[176:179], v[144:147], v[112:115]
ds_read_b64_tr_b16 v[196:197], v227 offset:16384
buffer_load_dwordx4 v238, s[4:7], s66 offen offset:0 lds
v_mfma_f32_16x16x32_bf16 v[116:119], v[176:179], v[148:151], v[116:119]
ds_read_b64_tr_b16 v[198:199], v227 offset:20480
s_waitcnt lgkmcnt(12)
buffer_load_dwordx4 v239, s[4:7], s66 offen offset:1024 lds
v_mfma_f32_16x16x32_bf16 v[120:123], v[180:183], v[136:139], v[120:123]
s_add_u32 m0, s52, 51200
s_add_u32 s66, s50, 589824
v_mfma_f32_16x16x32_bf16 v[124:127], v[180:183], v[140:143], v[124:127]
buffer_load_dwordx4 v238, s[4:7], s66 offen offset:0 lds
v_mfma_f32_16x16x32_bf16 v[128:131], v[180:183], v[144:147], v[128:131]
buffer_load_dwordx4 v239, s[4:7], s66 offen offset:1024 lds
v_mfma_f32_16x16x32_bf16 v[132:135], v[180:183], v[148:151], v[132:135]
s_waitcnt lgkmcnt(6)
v_mfma_f32_16x16x32_bf16 v[72:75], v[184:187], v[152:155], v[72:75]
ds_read_b64_tr_b16 v[168:169], v216 offset:0
s_mov_b32 s20, s98
v_mfma_f32_16x16x32_bf16 v[76:79], v[184:187], v[156:159], v[76:79]
ds_read_b64_tr_b16 v[170:171], v216 offset:4096
s_mov_b32 s21, s99
v_mfma_f32_16x16x32_bf16 v[80:83], v[184:187], v[160:163], v[80:83]
ds_read_b128 v[136:139], v228 offset:0
s_mov_b32 s22, 0x200000
v_mfma_f32_16x16x32_bf16 v[84:87], v[184:187], v[164:167], v[84:87]
ds_read_b128 v[140:143], v228 offset:1024
s_waitcnt lgkmcnt(8)
v_mfma_f32_16x16x32_bf16 v[88:91], v[188:191], v[152:155], v[88:91]
ds_read_b128 v[144:147], v228 offset:4096
s_mov_b32 s23, 0x20000
v_mfma_f32_16x16x32_bf16 v[92:95], v[188:191], v[156:159], v[92:95]
ds_read_b128 v[148:151], v228 offset:5120
s_mov_b32 s16, s94
v_mfma_f32_16x16x32_bf16 v[96:99], v[188:191], v[160:163], v[96:99]
ds_read_b64_tr_b16 v[172:173], v217 offset:0
s_mov_b32 s17, s95
v_mfma_f32_16x16x32_bf16 v[100:103], v[188:191], v[164:167], v[100:103]
ds_read_b64_tr_b16 v[174:175], v217 offset:4096
s_waitcnt lgkmcnt(10)
v_mfma_f32_16x16x32_bf16 v[104:107], v[192:195], v[152:155], v[104:107]
ds_read_b64_tr_b16 v[176:177], v218 offset:0
s_mov_b32 s18, 0x200000
v_mfma_f32_16x16x32_bf16 v[108:111], v[192:195], v[156:159], v[108:111]
ds_read_b64_tr_b16 v[178:179], v218 offset:4096
s_mov_b32 s19, 0x20000
v_mfma_f32_16x16x32_bf16 v[112:115], v[192:195], v[160:163], v[112:115]
ds_read_b64_tr_b16 v[180:181], v219 offset:0
v_mfma_f32_16x16x32_bf16 v[116:119], v[192:195], v[164:167], v[116:119]
ds_read_b64_tr_b16 v[182:183], v219 offset:4096
s_waitcnt lgkmcnt(12)
v_mfma_f32_16x16x32_bf16 v[120:123], v[196:199], v[152:155], v[120:123]
v_mfma_f32_16x16x32_bf16 v[124:127], v[196:199], v[156:159], v[124:127]
v_mfma_f32_16x16x32_bf16 v[128:131], v[196:199], v[160:163], v[128:131]
v_mfma_f32_16x16x32_bf16 v[132:135], v[196:199], v[164:167], v[132:135]
s_waitcnt lgkmcnt(6)
s_waitcnt vmcnt(18)
s_barrier
v_mfma_f32_16x16x32_bf16 v[72:75], v[168:171], v[136:139], v[72:75]
ds_read_b64_tr_b16 v[184:185], v216 offset:16384
s_add_u32 m0, s41, 147456
v_mfma_f32_16x16x32_bf16 v[76:79], v[168:171], v[140:143], v[76:79]
ds_read_b64_tr_b16 v[186:187], v216 offset:20480
s_add_u32 s65, s48, 20480
v_mfma_f32_16x16x32_bf16 v[80:83], v[168:171], v[144:147], v[80:83]
ds_read_b128 v[152:155], v228 offset:16384
buffer_load_dwordx4 v234, s[28:31], s65 offen offset:0 sc1 lds
v_mfma_f32_16x16x32_bf16 v[84:87], v[168:171], v[148:151], v[84:87]
ds_read_b128 v[156:159], v228 offset:17408
s_waitcnt lgkmcnt(8)
buffer_load_dwordx4 v235, s[28:31], s65 offen offset:1024 sc1 lds
v_mfma_f32_16x16x32_bf16 v[88:91], v[172:175], v[136:139], v[88:91]
ds_read_b128 v[160:163], v228 offset:20480
s_add_u32 m0, s41, 131072
v_mfma_f32_16x16x32_bf16 v[92:95], v[172:175], v[140:143], v[92:95]
ds_read_b128 v[164:167], v228 offset:21504
s_add_u32 s65, s48, 19456
v_mfma_f32_16x16x32_bf16 v[96:99], v[172:175], v[144:147], v[96:99]
ds_read_b64_tr_b16 v[188:189], v217 offset:16384
buffer_load_dwordx4 v234, s[28:31], s65 offen offset:0 sc1 lds
v_mfma_f32_16x16x32_bf16 v[100:103], v[172:175], v[148:151], v[100:103]
ds_read_b64_tr_b16 v[190:191], v217 offset:20480
s_waitcnt lgkmcnt(10)
buffer_load_dwordx4 v235, s[28:31], s65 offen offset:1024 sc1 lds
v_mfma_f32_16x16x32_bf16 v[104:107], v[176:179], v[136:139], v[104:107]
ds_read_b64_tr_b16 v[192:193], v218 offset:16384
s_add_u32 m0, s41, 133120
v_mfma_f32_16x16x32_bf16 v[108:111], v[176:179], v[140:143], v[108:111]
ds_read_b64_tr_b16 v[194:195], v218 offset:20480
s_add_u32 s66, s50, 622592
v_mfma_f32_16x16x32_bf16 v[112:115], v[176:179], v[144:147], v[112:115]
ds_read_b64_tr_b16 v[196:197], v219 offset:16384
buffer_load_dwordx4 v238, s[4:7], s66 offen offset:0 lds
v_mfma_f32_16x16x32_bf16 v[116:119], v[176:179], v[148:151], v[116:119]
ds_read_b64_tr_b16 v[198:199], v219 offset:20480
s_waitcnt lgkmcnt(12)
buffer_load_dwordx4 v239, s[4:7], s66 offen offset:1024 lds
v_mfma_f32_16x16x32_bf16 v[120:123], v[180:183], v[136:139], v[120:123]
s_add_u32 m0, s41, 149504
s_add_u32 s66, s50, 655360
v_mfma_f32_16x16x32_bf16 v[124:127], v[180:183], v[140:143], v[124:127]
buffer_load_dwordx4 v238, s[4:7], s66 offen offset:0 lds
v_mfma_f32_16x16x32_bf16 v[128:131], v[180:183], v[144:147], v[128:131]
buffer_load_dwordx4 v239, s[4:7], s66 offen offset:1024 lds
v_mfma_f32_16x16x32_bf16 v[132:135], v[180:183], v[148:151], v[132:135]
s_waitcnt lgkmcnt(6)
v_mfma_f32_16x16x32_bf16 v[72:75], v[184:187], v[152:155], v[72:75]
ds_read_b64_tr_b16 v[168:169], v216 offset:32768
v_mfma_f32_16x16x32_bf16 v[76:79], v[184:187], v[156:159], v[76:79]
ds_read_b64_tr_b16 v[170:171], v216 offset:36864
v_mfma_f32_16x16x32_bf16 v[80:83], v[184:187], v[160:163], v[80:83]
ds_read_b128 v[136:139], v228 offset:32768
v_mfma_f32_16x16x32_bf16 v[84:87], v[184:187], v[164:167], v[84:87]
ds_read_b128 v[140:143], v228 offset:33792
s_waitcnt lgkmcnt(8)
v_mfma_f32_16x16x32_bf16 v[88:91], v[188:191], v[152:155], v[88:91]
ds_read_b128 v[144:147], v228 offset:36864
v_mfma_f32_16x16x32_bf16 v[92:95], v[188:191], v[156:159], v[92:95]
ds_read_b128 v[148:151], v228 offset:37888
v_mfma_f32_16x16x32_bf16 v[96:99], v[188:191], v[160:163], v[96:99]
ds_read_b64_tr_b16 v[172:173], v217 offset:32768
v_mfma_f32_16x16x32_bf16 v[100:103], v[188:191], v[164:167], v[100:103]
ds_read_b64_tr_b16 v[174:175], v217 offset:36864
s_waitcnt lgkmcnt(10)
v_mfma_f32_16x16x32_bf16 v[104:107], v[192:195], v[152:155], v[104:107]
ds_read_b64_tr_b16 v[176:177], v218 offset:32768
v_mfma_f32_16x16x32_bf16 v[108:111], v[192:195], v[156:159], v[108:111]
ds_read_b64_tr_b16 v[178:179], v218 offset:36864
v_mfma_f32_16x16x32_bf16 v[112:115], v[192:195], v[160:163], v[112:115]
ds_read_b64_tr_b16 v[180:181], v219 offset:32768
v_mfma_f32_16x16x32_bf16 v[116:119], v[192:195], v[164:167], v[116:119]
ds_read_b64_tr_b16 v[182:183], v219 offset:36864
s_waitcnt lgkmcnt(12)
v_mfma_f32_16x16x32_bf16 v[120:123], v[196:199], v[152:155], v[120:123]
v_mfma_f32_16x16x32_bf16 v[124:127], v[196:199], v[156:159], v[124:127]
v_mfma_f32_16x16x32_bf16 v[128:131], v[196:199], v[160:163], v[128:131]
v_mfma_f32_16x16x32_bf16 v[132:135], v[196:199], v[164:167], v[132:135]
s_waitcnt lgkmcnt(6)
s_waitcnt vmcnt(18)
s_barrier
v_mfma_f32_16x16x32_bf16 v[72:75], v[168:171], v[136:139], v[72:75]
ds_read_b64_tr_b16 v[184:185], v216 offset:49152
s_add_u32 m0, s51, 16384
v_mfma_f32_16x16x32_bf16 v[76:79], v[168:171], v[140:143], v[76:79]
ds_read_b64_tr_b16 v[186:187], v216 offset:53248
s_add_u32 s65, s48, 22528
v_mfma_f32_16x16x32_bf16 v[80:83], v[168:171], v[144:147], v[80:83]
ds_read_b128 v[152:155], v228 offset:49152
buffer_load_dwordx4 v234, s[28:31], s65 offen offset:0 sc1 lds
v_mfma_f32_16x16x32_bf16 v[84:87], v[168:171], v[148:151], v[84:87]
ds_read_b128 v[156:159], v228 offset:50176
s_waitcnt lgkmcnt(8)
buffer_load_dwordx4 v235, s[28:31], s65 offen offset:1024 sc1 lds
v_mfma_f32_16x16x32_bf16 v[88:91], v[172:175], v[136:139], v[88:91]
ds_read_b128 v[160:163], v228 offset:53248
s_add_u32 m0, s51, 0
v_mfma_f32_16x16x32_bf16 v[92:95], v[172:175], v[140:143], v[92:95]
ds_read_b128 v[164:167], v228 offset:54272
s_add_u32 s65, s48, 21504
v_mfma_f32_16x16x32_bf16 v[96:99], v[172:175], v[144:147], v[96:99]
ds_read_b64_tr_b16 v[188:189], v217 offset:49152
buffer_load_dwordx4 v234, s[28:31], s65 offen offset:0 sc1 lds
v_mfma_f32_16x16x32_bf16 v[100:103], v[172:175], v[148:151], v[100:103]
ds_read_b64_tr_b16 v[190:191], v217 offset:53248
s_waitcnt lgkmcnt(10)
buffer_load_dwordx4 v235, s[28:31], s65 offen offset:1024 sc1 lds
v_mfma_f32_16x16x32_bf16 v[104:107], v[176:179], v[136:139], v[104:107]
ds_read_b64_tr_b16 v[192:193], v218 offset:49152
s_add_u32 m0, s51, 2048
v_mfma_f32_16x16x32_bf16 v[108:111], v[176:179], v[140:143], v[108:111]
ds_read_b64_tr_b16 v[194:195], v218 offset:53248
s_add_u32 s66, s50, 688128
v_mfma_f32_16x16x32_bf16 v[112:115], v[176:179], v[144:147], v[112:115]
ds_read_b64_tr_b16 v[196:197], v219 offset:49152
buffer_load_dwordx4 v238, s[4:7], s66 offen offset:0 lds
v_mfma_f32_16x16x32_bf16 v[116:119], v[176:179], v[148:151], v[116:119]
ds_read_b64_tr_b16 v[198:199], v219 offset:53248
s_waitcnt lgkmcnt(12)
buffer_load_dwordx4 v239, s[4:7], s66 offen offset:1024 lds
v_mfma_f32_16x16x32_bf16 v[120:123], v[180:183], v[136:139], v[120:123]
s_add_u32 m0, s51, 18432
s_add_u32 s66, s50, 720896
v_mfma_f32_16x16x32_bf16 v[124:127], v[180:183], v[140:143], v[124:127]
buffer_load_dwordx4 v238, s[4:7], s66 offen offset:0 lds
v_mfma_f32_16x16x32_bf16 v[128:131], v[180:183], v[144:147], v[128:131]
buffer_load_dwordx4 v239, s[4:7], s66 offen offset:1024 lds
v_mfma_f32_16x16x32_bf16 v[132:135], v[180:183], v[148:151], v[132:135]
s_waitcnt lgkmcnt(6)
v_mfma_f32_16x16x32_bf16 v[72:75], v[184:187], v[152:155], v[72:75]
ds_read_b64_tr_b16 v[168:169], v220 offset:0
v_mfma_f32_16x16x32_bf16 v[76:79], v[184:187], v[156:159], v[76:79]
ds_read_b64_tr_b16 v[170:171], v220 offset:4096
v_mfma_f32_16x16x32_bf16 v[80:83], v[184:187], v[160:163], v[80:83]
ds_read_b128 v[136:139], v229 offset:0
v_mfma_f32_16x16x32_bf16 v[84:87], v[184:187], v[164:167], v[84:87]
ds_read_b128 v[140:143], v229 offset:1024
s_waitcnt lgkmcnt(8)
v_mfma_f32_16x16x32_bf16 v[88:91], v[188:191], v[152:155], v[88:91]
ds_read_b128 v[144:147], v229 offset:4096
v_mfma_f32_16x16x32_bf16 v[92:95], v[188:191], v[156:159], v[92:95]
ds_read_b128 v[148:151], v229 offset:5120
v_mfma_f32_16x16x32_bf16 v[96:99], v[188:191], v[160:163], v[96:99]
ds_read_b64_tr_b16 v[172:173], v221 offset:0
v_mfma_f32_16x16x32_bf16 v[100:103], v[188:191], v[164:167], v[100:103]
ds_read_b64_tr_b16 v[174:175], v221 offset:4096
s_waitcnt lgkmcnt(10)
v_mfma_f32_16x16x32_bf16 v[104:107], v[192:195], v[152:155], v[104:107]
ds_read_b64_tr_b16 v[176:177], v222 offset:0
v_mfma_f32_16x16x32_bf16 v[108:111], v[192:195], v[156:159], v[108:111]
ds_read_b64_tr_b16 v[178:179], v222 offset:4096
v_mfma_f32_16x16x32_bf16 v[112:115], v[192:195], v[160:163], v[112:115]
ds_read_b64_tr_b16 v[180:181], v223 offset:0
v_mfma_f32_16x16x32_bf16 v[116:119], v[192:195], v[164:167], v[116:119]
ds_read_b64_tr_b16 v[182:183], v223 offset:4096
s_waitcnt lgkmcnt(12)
v_mfma_f32_16x16x32_bf16 v[120:123], v[196:199], v[152:155], v[120:123]
v_mfma_f32_16x16x32_bf16 v[124:127], v[196:199], v[156:159], v[124:127]
v_mfma_f32_16x16x32_bf16 v[128:131], v[196:199], v[160:163], v[128:131]
v_mfma_f32_16x16x32_bf16 v[132:135], v[196:199], v[164:167], v[132:135]
s_waitcnt lgkmcnt(6)
s_waitcnt vmcnt(18)
s_barrier
v_mfma_f32_16x16x32_bf16 v[72:75], v[168:171], v[136:139], v[72:75]
ds_read_b64_tr_b16 v[184:185], v220 offset:16384
s_add_u32 m0, s51, 49152
v_mfma_f32_16x16x32_bf16 v[76:79], v[168:171], v[140:143], v[76:79]
ds_read_b64_tr_b16 v[186:187], v220 offset:20480
s_add_u32 s65, s48, 24576
v_mfma_f32_16x16x32_bf16 v[80:83], v[168:171], v[144:147], v[80:83]
ds_read_b128 v[152:155], v229 offset:16384
buffer_load_dwordx4 v234, s[28:31], s65 offen offset:0 sc1 lds
v_mfma_f32_16x16x32_bf16 v[84:87], v[168:171], v[148:151], v[84:87]
ds_read_b128 v[156:159], v229 offset:17408
s_waitcnt lgkmcnt(8)
buffer_load_dwordx4 v235, s[28:31], s65 offen offset:1024 sc1 lds
v_mfma_f32_16x16x32_bf16 v[88:91], v[172:175], v[136:139], v[88:91]
ds_read_b128 v[160:163], v229 offset:20480
s_add_u32 m0, s51, 32768
v_mfma_f32_16x16x32_bf16 v[92:95], v[172:175], v[140:143], v[92:95]
ds_read_b128 v[164:167], v229 offset:21504
s_add_u32 s65, s48, 23552
v_mfma_f32_16x16x32_bf16 v[96:99], v[172:175], v[144:147], v[96:99]
ds_read_b64_tr_b16 v[188:189], v221 offset:16384
buffer_load_dwordx4 v234, s[28:31], s65 offen offset:0 sc1 lds
v_mfma_f32_16x16x32_bf16 v[100:103], v[172:175], v[148:151], v[100:103]
ds_read_b64_tr_b16 v[190:191], v221 offset:20480
s_waitcnt lgkmcnt(10)
buffer_load_dwordx4 v235, s[28:31], s65 offen offset:1024 sc1 lds
v_mfma_f32_16x16x32_bf16 v[104:107], v[176:179], v[136:139], v[104:107]
ds_read_b64_tr_b16 v[192:193], v222 offset:16384
s_add_u32 m0, s51, 34816
v_mfma_f32_16x16x32_bf16 v[108:111], v[176:179], v[140:143], v[108:111]
ds_read_b64_tr_b16 v[194:195], v222 offset:20480
s_add_u32 s66, s50, 753664
v_mfma_f32_16x16x32_bf16 v[112:115], v[176:179], v[144:147], v[112:115]
ds_read_b64_tr_b16 v[196:197], v223 offset:16384
buffer_load_dwordx4 v238, s[4:7], s66 offen offset:0 lds
v_mfma_f32_16x16x32_bf16 v[116:119], v[176:179], v[148:151], v[116:119]
ds_read_b64_tr_b16 v[198:199], v223 offset:20480
s_waitcnt lgkmcnt(12)
buffer_load_dwordx4 v239, s[4:7], s66 offen offset:1024 lds
v_mfma_f32_16x16x32_bf16 v[120:123], v[180:183], v[136:139], v[120:123]
s_add_u32 m0, s51, 51200
s_add_u32 s66, s50, 786432
v_mfma_f32_16x16x32_bf16 v[124:127], v[180:183], v[140:143], v[124:127]
buffer_load_dwordx4 v238, s[4:7], s66 offen offset:0 lds
v_mfma_f32_16x16x32_bf16 v[128:131], v[180:183], v[144:147], v[128:131]
buffer_load_dwordx4 v239, s[4:7], s66 offen offset:1024 lds
v_mfma_f32_16x16x32_bf16 v[132:135], v[180:183], v[148:151], v[132:135]
s_waitcnt lgkmcnt(6)
v_mfma_f32_16x16x32_bf16 v[72:75], v[184:187], v[152:155], v[72:75]
ds_read_b64_tr_b16 v[168:169], v220 offset:32768
v_mfma_f32_16x16x32_bf16 v[76:79], v[184:187], v[156:159], v[76:79]
ds_read_b64_tr_b16 v[170:171], v220 offset:36864
v_mfma_f32_16x16x32_bf16 v[80:83], v[184:187], v[160:163], v[80:83]
ds_read_b128 v[136:139], v229 offset:32768
v_mfma_f32_16x16x32_bf16 v[84:87], v[184:187], v[164:167], v[84:87]
ds_read_b128 v[140:143], v229 offset:33792
s_waitcnt lgkmcnt(8)
v_mfma_f32_16x16x32_bf16 v[88:91], v[188:191], v[152:155], v[88:91]
ds_read_b128 v[144:147], v229 offset:36864
v_mfma_f32_16x16x32_bf16 v[92:95], v[188:191], v[156:159], v[92:95]
ds_read_b128 v[148:151], v229 offset:37888
v_mfma_f32_16x16x32_bf16 v[96:99], v[188:191], v[160:163], v[96:99]
ds_read_b64_tr_b16 v[172:173], v221 offset:32768
v_mfma_f32_16x16x32_bf16 v[100:103], v[188:191], v[164:167], v[100:103]
ds_read_b64_tr_b16 v[174:175], v221 offset:36864
s_waitcnt lgkmcnt(10)
v_mfma_f32_16x16x32_bf16 v[104:107], v[192:195], v[152:155], v[104:107]
ds_read_b64_tr_b16 v[176:177], v222 offset:32768
v_mfma_f32_16x16x32_bf16 v[108:111], v[192:195], v[156:159], v[108:111]
ds_read_b64_tr_b16 v[178:179], v222 offset:36864
v_mfma_f32_16x16x32_bf16 v[112:115], v[192:195], v[160:163], v[112:115]
ds_read_b64_tr_b16 v[180:181], v223 offset:32768
v_mfma_f32_16x16x32_bf16 v[116:119], v[192:195], v[164:167], v[116:119]
ds_read_b64_tr_b16 v[182:183], v223 offset:36864
s_waitcnt lgkmcnt(12)
v_mfma_f32_16x16x32_bf16 v[120:123], v[196:199], v[152:155], v[120:123]
v_mfma_f32_16x16x32_bf16 v[124:127], v[196:199], v[156:159], v[124:127]
v_mfma_f32_16x16x32_bf16 v[128:131], v[196:199], v[160:163], v[128:131]
v_mfma_f32_16x16x32_bf16 v[132:135], v[196:199], v[164:167], v[132:135]
s_waitcnt lgkmcnt(6)
s_waitcnt vmcnt(18)
s_barrier
v_mfma_f32_16x16x32_bf16 v[72:75], v[168:171], v[136:139], v[72:75]
ds_read_b64_tr_b16 v[184:185], v220 offset:49152
s_add_u32 m0, s52, 16384
v_mfma_f32_16x16x32_bf16 v[76:79], v[168:171], v[140:143], v[76:79]
ds_read_b64_tr_b16 v[186:187], v220 offset:53248
s_add_u32 s65, s48, 26624
v_mfma_f32_16x16x32_bf16 v[80:83], v[168:171], v[144:147], v[80:83]
ds_read_b128 v[152:155], v229 offset:49152
buffer_load_dwordx4 v234, s[28:31], s65 offen offset:0 sc1 lds
v_mfma_f32_16x16x32_bf16 v[84:87], v[168:171], v[148:151], v[84:87]
ds_read_b128 v[156:159], v229 offset:50176
s_waitcnt lgkmcnt(8)
buffer_load_dwordx4 v235, s[28:31], s65 offen offset:1024 sc1 lds
v_mfma_f32_16x16x32_bf16 v[88:91], v[172:175], v[136:139], v[88:91]
ds_read_b128 v[160:163], v229 offset:53248
s_add_u32 m0, s52, 0
v_mfma_f32_16x16x32_bf16 v[92:95], v[172:175], v[140:143], v[92:95]
ds_read_b128 v[164:167], v229 offset:54272
s_add_u32 s65, s48, 25600
v_mfma_f32_16x16x32_bf16 v[96:99], v[172:175], v[144:147], v[96:99]
ds_read_b64_tr_b16 v[188:189], v221 offset:49152
buffer_load_dwordx4 v234, s[28:31], s65 offen offset:0 sc1 lds
v_mfma_f32_16x16x32_bf16 v[100:103], v[172:175], v[148:151], v[100:103]
ds_read_b64_tr_b16 v[190:191], v221 offset:53248
s_waitcnt lgkmcnt(10)
buffer_load_dwordx4 v235, s[28:31], s65 offen offset:1024 sc1 lds
v_mfma_f32_16x16x32_bf16 v[104:107], v[176:179], v[136:139], v[104:107]
ds_read_b64_tr_b16 v[192:193], v222 offset:49152
s_add_u32 m0, s52, 2048
v_mfma_f32_16x16x32_bf16 v[108:111], v[176:179], v[140:143], v[108:111]
ds_read_b64_tr_b16 v[194:195], v222 offset:53248
s_add_u32 s66, s50, 819200
v_mfma_f32_16x16x32_bf16 v[112:115], v[176:179], v[144:147], v[112:115]
ds_read_b64_tr_b16 v[196:197], v223 offset:49152
buffer_load_dwordx4 v238, s[4:7], s66 offen offset:0 lds
v_mfma_f32_16x16x32_bf16 v[116:119], v[176:179], v[148:151], v[116:119]
ds_read_b64_tr_b16 v[198:199], v223 offset:53248
s_waitcnt lgkmcnt(12)
buffer_load_dwordx4 v239, s[4:7], s66 offen offset:1024 lds
v_mfma_f32_16x16x32_bf16 v[120:123], v[180:183], v[136:139], v[120:123]
s_add_u32 m0, s52, 18432
s_add_u32 s66, s50, 851968
v_mfma_f32_16x16x32_bf16 v[124:127], v[180:183], v[140:143], v[124:127]
buffer_load_dwordx4 v238, s[4:7], s66 offen offset:0 lds
v_mfma_f32_16x16x32_bf16 v[128:131], v[180:183], v[144:147], v[128:131]
buffer_load_dwordx4 v239, s[4:7], s66 offen offset:1024 lds
v_mfma_f32_16x16x32_bf16 v[132:135], v[180:183], v[148:151], v[132:135]
s_waitcnt lgkmcnt(6)
v_mfma_f32_16x16x32_bf16 v[72:75], v[184:187], v[152:155], v[72:75]
ds_read_b64_tr_b16 v[168:169], v224 offset:0
v_mfma_f32_16x16x32_bf16 v[76:79], v[184:187], v[156:159], v[76:79]
ds_read_b64_tr_b16 v[170:171], v224 offset:4096
v_mfma_f32_16x16x32_bf16 v[80:83], v[184:187], v[160:163], v[80:83]
ds_read_b128 v[136:139], v230 offset:0
v_mfma_f32_16x16x32_bf16 v[84:87], v[184:187], v[164:167], v[84:87]
ds_read_b128 v[140:143], v230 offset:1024
s_waitcnt lgkmcnt(8)
v_mfma_f32_16x16x32_bf16 v[88:91], v[188:191], v[152:155], v[88:91]
ds_read_b128 v[144:147], v230 offset:4096
v_mfma_f32_16x16x32_bf16 v[92:95], v[188:191], v[156:159], v[92:95]
ds_read_b128 v[148:151], v230 offset:5120
v_mfma_f32_16x16x32_bf16 v[96:99], v[188:191], v[160:163], v[96:99]
ds_read_b64_tr_b16 v[172:173], v225 offset:0
v_mfma_f32_16x16x32_bf16 v[100:103], v[188:191], v[164:167], v[100:103]
ds_read_b64_tr_b16 v[174:175], v225 offset:4096
s_waitcnt lgkmcnt(10)
v_mfma_f32_16x16x32_bf16 v[104:107], v[192:195], v[152:155], v[104:107]
ds_read_b64_tr_b16 v[176:177], v226 offset:0
v_mfma_f32_16x16x32_bf16 v[108:111], v[192:195], v[156:159], v[108:111]
ds_read_b64_tr_b16 v[178:179], v226 offset:4096
v_mfma_f32_16x16x32_bf16 v[112:115], v[192:195], v[160:163], v[112:115]
ds_read_b64_tr_b16 v[180:181], v227 offset:0
v_mfma_f32_16x16x32_bf16 v[116:119], v[192:195], v[164:167], v[116:119]
ds_read_b64_tr_b16 v[182:183], v227 offset:4096
s_waitcnt lgkmcnt(12)
v_mfma_f32_16x16x32_bf16 v[120:123], v[196:199], v[152:155], v[120:123]
v_mfma_f32_16x16x32_bf16 v[124:127], v[196:199], v[156:159], v[124:127]
v_mfma_f32_16x16x32_bf16 v[128:131], v[196:199], v[160:163], v[128:131]
v_mfma_f32_16x16x32_bf16 v[132:135], v[196:199], v[164:167], v[132:135]
s_waitcnt lgkmcnt(6)
s_waitcnt vmcnt(18)
s_barrier
v_mfma_f32_16x16x32_bf16 v[72:75], v[168:171], v[136:139], v[72:75]
ds_read_b64_tr_b16 v[184:185], v224 offset:16384
s_add_u32 m0, s52, 49152
v_mfma_f32_16x16x32_bf16 v[76:79], v[168:171], v[140:143], v[76:79]
ds_read_b64_tr_b16 v[186:187], v224 offset:20480
s_add_u32 s65, s48, 28672
v_mfma_f32_16x16x32_bf16 v[80:83], v[168:171], v[144:147], v[80:83]
ds_read_b128 v[152:155], v230 offset:16384
buffer_load_dwordx4 v234, s[28:31], s65 offen offset:0 sc1 lds
v_mfma_f32_16x16x32_bf16 v[84:87], v[168:171], v[148:151], v[84:87]
ds_read_b128 v[156:159], v230 offset:17408
s_waitcnt lgkmcnt(8)
buffer_load_dwordx4 v235, s[28:31], s65 offen offset:1024 sc1 lds
v_mfma_f32_16x16x32_bf16 v[88:91], v[172:175], v[136:139], v[88:91]
ds_read_b128 v[160:163], v230 offset:20480
s_add_u32 m0, s52, 32768
v_mfma_f32_16x16x32_bf16 v[92:95], v[172:175], v[140:143], v[92:95]
ds_read_b128 v[164:167], v230 offset:21504
s_add_u32 s65, s48, 27648
v_mfma_f32_16x16x32_bf16 v[96:99], v[172:175], v[144:147], v[96:99]
ds_read_b64_tr_b16 v[188:189], v225 offset:16384
buffer_load_dwordx4 v234, s[28:31], s65 offen offset:0 sc1 lds
v_mfma_f32_16x16x32_bf16 v[100:103], v[172:175], v[148:151], v[100:103]
ds_read_b64_tr_b16 v[190:191], v225 offset:20480
s_waitcnt lgkmcnt(10)
buffer_load_dwordx4 v235, s[28:31], s65 offen offset:1024 sc1 lds
v_mfma_f32_16x16x32_bf16 v[104:107], v[176:179], v[136:139], v[104:107]
ds_read_b64_tr_b16 v[192:193], v226 offset:16384
s_add_u32 m0, s52, 34816
v_mfma_f32_16x16x32_bf16 v[108:111], v[176:179], v[140:143], v[108:111]
ds_read_b64_tr_b16 v[194:195], v226 offset:20480
s_add_u32 s66, s50, 884736
v_mfma_f32_16x16x32_bf16 v[112:115], v[176:179], v[144:147], v[112:115]
ds_read_b64_tr_b16 v[196:197], v227 offset:16384
buffer_load_dwordx4 v238, s[4:7], s66 offen offset:0 lds
v_mfma_f32_16x16x32_bf16 v[116:119], v[176:179], v[148:151], v[116:119]
ds_read_b64_tr_b16 v[198:199], v227 offset:20480
s_waitcnt lgkmcnt(12)
buffer_load_dwordx4 v239, s[4:7], s66 offen offset:1024 lds
v_mfma_f32_16x16x32_bf16 v[120:123], v[180:183], v[136:139], v[120:123]
s_add_u32 m0, s52, 51200
s_add_u32 s66, s50, 917504
v_mfma_f32_16x16x32_bf16 v[124:127], v[180:183], v[140:143], v[124:127]
buffer_load_dwordx4 v238, s[4:7], s66 offen offset:0 lds
v_mfma_f32_16x16x32_bf16 v[128:131], v[180:183], v[144:147], v[128:131]
buffer_load_dwordx4 v239, s[4:7], s66 offen offset:1024 lds
s_lshr_b32 s67, s53, 1
v_mfma_f32_16x16x32_bf16 v[132:135], v[180:183], v[148:151], v[132:135]
s_waitcnt lgkmcnt(6)
s_lshl_b32 s67, s67, 2
s_add_u32 s67, s67, s40
s_lshl_b32 s67, s67, 14
s_lshl_b32 s57, s55, 17
s_add_u32 s57, s57, s67
s_lshl_b32 s67, s56, 8
s_add_u32 s57, s57, s67
s_and_b32 s67, s53, 1
s_lshl_b32 s67, s67, 7
s_add_u32 s57, s57, s67
v_and_b32 v246, 15, v1
v_lshlrev_b32 v246, 10, v246
v_bfe_u32 v247, v1, 4, 1
v_lshl_add_u32 v246, v247, 5, v246
v_lshrrev_b32 v247, 5, v1
v_lshl_add_u32 v248, v247, 4, v246
buffer_load_dwordx4 v[8:11], v248, s[20:23], s57 offen
buffer_load_dwordx4 v[12:15], v248, s[20:23], s57 offen offset:64
v_mfma_f32_16x16x32_bf16 v[72:75], v[184:187], v[152:155], v[72:75]
ds_read_b64_tr_b16 v[168:169], v216 offset:0
v_mfma_f32_16x16x32_bf16 v[76:79], v[184:187], v[156:159], v[76:79]
ds_read_b64_tr_b16 v[170:171], v216 offset:4096
v_mfma_f32_16x16x32_bf16 v[80:83], v[184:187], v[160:163], v[80:83]
ds_read_b128 v[136:139], v228 offset:0
v_mfma_f32_16x16x32_bf16 v[84:87], v[184:187], v[164:167], v[84:87]
ds_read_b128 v[140:143], v228 offset:1024
s_waitcnt lgkmcnt(8)
v_mfma_f32_16x16x32_bf16 v[88:91], v[188:191], v[152:155], v[88:91]
ds_read_b128 v[144:147], v228 offset:4096
v_mfma_f32_16x16x32_bf16 v[92:95], v[188:191], v[156:159], v[92:95]
ds_read_b128 v[148:151], v228 offset:5120
v_mfma_f32_16x16x32_bf16 v[96:99], v[188:191], v[160:163], v[96:99]
ds_read_b64_tr_b16 v[172:173], v217 offset:0
v_mfma_f32_16x16x32_bf16 v[100:103], v[188:191], v[164:167], v[100:103]
ds_read_b64_tr_b16 v[174:175], v217 offset:4096
s_waitcnt lgkmcnt(10)
v_mfma_f32_16x16x32_bf16 v[104:107], v[192:195], v[152:155], v[104:107]
ds_read_b64_tr_b16 v[176:177], v218 offset:0
v_mfma_f32_16x16x32_bf16 v[108:111], v[192:195], v[156:159], v[108:111]
ds_read_b64_tr_b16 v[178:179], v218 offset:4096
v_mfma_f32_16x16x32_bf16 v[112:115], v[192:195], v[160:163], v[112:115]
ds_read_b64_tr_b16 v[180:181], v219 offset:0
v_mfma_f32_16x16x32_bf16 v[116:119], v[192:195], v[164:167], v[116:119]
ds_read_b64_tr_b16 v[182:183], v219 offset:4096
s_waitcnt lgkmcnt(12)
v_mfma_f32_16x16x32_bf16 v[120:123], v[196:199], v[152:155], v[120:123]
v_mfma_f32_16x16x32_bf16 v[124:127], v[196:199], v[156:159], v[124:127]
v_mfma_f32_16x16x32_bf16 v[128:131], v[196:199], v[160:163], v[128:131]
v_mfma_f32_16x16x32_bf16 v[132:135], v[196:199], v[164:167], v[132:135]
s_waitcnt lgkmcnt(6)
s_waitcnt vmcnt(20)
s_barrier
v_mfma_f32_16x16x32_bf16 v[72:75], v[168:171], v[136:139], v[72:75]
ds_read_b64_tr_b16 v[184:185], v216 offset:16384
s_add_u32 m0, s41, 147456
v_mfma_f32_16x16x32_bf16 v[76:79], v[168:171], v[140:143], v[76:79]
ds_read_b64_tr_b16 v[186:187], v216 offset:20480
s_add_u32 s65, s48, 30720
v_mfma_f32_16x16x32_bf16 v[80:83], v[168:171], v[144:147], v[80:83]
ds_read_b128 v[152:155], v228 offset:16384
buffer_load_dwordx4 v234, s[28:31], s65 offen offset:0 sc1 lds
v_mfma_f32_16x16x32_bf16 v[84:87], v[168:171], v[148:151], v[84:87]
ds_read_b128 v[156:159], v228 offset:17408
s_waitcnt lgkmcnt(8)
buffer_load_dwordx4 v235, s[28:31], s65 offen offset:1024 sc1 lds
v_mfma_f32_16x16x32_bf16 v[88:91], v[172:175], v[136:139], v[88:91]
ds_read_b128 v[160:163], v228 offset:20480
s_add_u32 m0, s41, 131072
v_mfma_f32_16x16x32_bf16 v[92:95], v[172:175], v[140:143], v[92:95]
ds_read_b128 v[164:167], v228 offset:21504
s_add_u32 s65, s48, 29696
v_mfma_f32_16x16x32_bf16 v[96:99], v[172:175], v[144:147], v[96:99]
ds_read_b64_tr_b16 v[188:189], v217 offset:16384
buffer_load_dwordx4 v234, s[28:31], s65 offen offset:0 sc1 lds
v_mfma_f32_16x16x32_bf16 v[100:103], v[172:175], v[148:151], v[100:103]
ds_read_b64_tr_b16 v[190:191], v217 offset:20480
s_waitcnt lgkmcnt(10)
buffer_load_dwordx4 v235, s[28:31], s65 offen offset:1024 sc1 lds
v_mfma_f32_16x16x32_bf16 v[104:107], v[176:179], v[136:139], v[104:107]
ds_read_b64_tr_b16 v[192:193], v218 offset:16384
s_add_u32 m0, s41, 133120
v_mfma_f32_16x16x32_bf16 v[108:111], v[176:179], v[140:143], v[108:111]
ds_read_b64_tr_b16 v[194:195], v218 offset:20480
s_add_u32 s66, s50, 950272
v_mfma_f32_16x16x32_bf16 v[112:115], v[176:179], v[144:147], v[112:115]
ds_read_b64_tr_b16 v[196:197], v219 offset:16384
buffer_load_dwordx4 v238, s[4:7], s66 offen offset:0 lds
v_mfma_f32_16x16x32_bf16 v[116:119], v[176:179], v[148:151], v[116:119]
ds_read_b64_tr_b16 v[198:199], v219 offset:20480
s_waitcnt lgkmcnt(12)
buffer_load_dwordx4 v239, s[4:7], s66 offen offset:1024 lds
v_mfma_f32_16x16x32_bf16 v[120:123], v[180:183], v[136:139], v[120:123]
s_add_u32 m0, s41, 149504
s_add_u32 s66, s50, 983040
v_mfma_f32_16x16x32_bf16 v[124:127], v[180:183], v[140:143], v[124:127]
buffer_load_dwordx4 v238, s[4:7], s66 offen offset:0 lds
v_mfma_f32_16x16x32_bf16 v[128:131], v[180:183], v[144:147], v[128:131]
buffer_load_dwordx4 v239, s[4:7], s66 offen offset:1024 lds
v_mfma_f32_16x16x32_bf16 v[132:135], v[180:183], v[148:151], v[132:135]
s_waitcnt lgkmcnt(6)
v_mfma_f32_16x16x32_bf16 v[72:75], v[184:187], v[152:155], v[72:75]
ds_read_b64_tr_b16 v[168:169], v216 offset:32768
v_mfma_f32_16x16x32_bf16 v[76:79], v[184:187], v[156:159], v[76:79]
ds_read_b64_tr_b16 v[170:171], v216 offset:36864
v_mfma_f32_16x16x32_bf16 v[80:83], v[184:187], v[160:163], v[80:83]
ds_read_b128 v[136:139], v228 offset:32768
v_mfma_f32_16x16x32_bf16 v[84:87], v[184:187], v[164:167], v[84:87]
ds_read_b128 v[140:143], v228 offset:33792
s_waitcnt lgkmcnt(8)
v_mfma_f32_16x16x32_bf16 v[88:91], v[188:191], v[152:155], v[88:91]
ds_read_b128 v[144:147], v228 offset:36864
v_mfma_f32_16x16x32_bf16 v[92:95], v[188:191], v[156:159], v[92:95]
ds_read_b128 v[148:151], v228 offset:37888
v_mfma_f32_16x16x32_bf16 v[96:99], v[188:191], v[160:163], v[96:99]
ds_read_b64_tr_b16 v[172:173], v217 offset:32768
v_mfma_f32_16x16x32_bf16 v[100:103], v[188:191], v[164:167], v[100:103]
ds_read_b64_tr_b16 v[174:175], v217 offset:36864
s_waitcnt lgkmcnt(10)
v_mfma_f32_16x16x32_bf16 v[104:107], v[192:195], v[152:155], v[104:107]
ds_read_b64_tr_b16 v[176:177], v218 offset:32768
v_mfma_f32_16x16x32_bf16 v[108:111], v[192:195], v[156:159], v[108:111]
ds_read_b64_tr_b16 v[178:179], v218 offset:36864
v_mfma_f32_16x16x32_bf16 v[112:115], v[192:195], v[160:163], v[112:115]
ds_read_b64_tr_b16 v[180:181], v219 offset:32768
v_mfma_f32_16x16x32_bf16 v[116:119], v[192:195], v[164:167], v[116:119]
ds_read_b64_tr_b16 v[182:183], v219 offset:36864
s_waitcnt lgkmcnt(12)
v_mfma_f32_16x16x32_bf16 v[120:123], v[196:199], v[152:155], v[120:123]
v_mfma_f32_16x16x32_bf16 v[124:127], v[196:199], v[156:159], v[124:127]
v_mfma_f32_16x16x32_bf16 v[128:131], v[196:199], v[160:163], v[128:131]
v_mfma_f32_16x16x32_bf16 v[132:135], v[196:199], v[164:167], v[132:135]
s_waitcnt lgkmcnt(6)
s_waitcnt vmcnt(20)
s_barrier
v_mfma_f32_16x16x32_bf16 v[72:75], v[168:171], v[136:139], v[72:75]
ds_read_b64_tr_b16 v[184:185], v216 offset:49152
s_add_u32 m0, s51, 0
v_mfma_f32_16x16x32_bf16 v[76:79], v[168:171], v[140:143], v[76:79]
ds_read_b64_tr_b16 v[186:187], v216 offset:53248
s_add_u32 s65, s48, 31744
v_mfma_f32_16x16x32_bf16 v[80:83], v[168:171], v[144:147], v[80:83]
ds_read_b128 v[152:155], v228 offset:49152
buffer_load_dwordx4 v234, s[28:31], s65 offen offset:0 sc1 lds
v_mfma_f32_16x16x32_bf16 v[84:87], v[168:171], v[148:151], v[84:87]
ds_read_b128 v[156:159], v228 offset:50176
s_waitcnt lgkmcnt(8)
v_mfma_f32_16x16x32_bf16 v[88:91], v[172:175], v[136:139], v[88:91]
ds_read_b128 v[160:163], v228 offset:53248
v_mfma_f32_16x16x32_bf16 v[92:95], v[172:175], v[140:143], v[92:95]
ds_read_b128 v[164:167], v228 offset:54272
v_mfma_f32_16x16x32_bf16 v[96:99], v[172:175], v[144:147], v[96:99]
ds_read_b64_tr_b16 v[188:189], v217 offset:49152
buffer_load_dwordx4 v235, s[28:31], s65 offen offset:1024 sc1 lds
v_mfma_f32_16x16x32_bf16 v[100:103], v[172:175], v[148:151], v[100:103]
ds_read_b64_tr_b16 v[190:191], v217 offset:53248
s_waitcnt lgkmcnt(10)
v_mfma_f32_16x16x32_bf16 v[104:107], v[176:179], v[136:139], v[104:107]
ds_read_b64_tr_b16 v[192:193], v218 offset:49152
s_add_u32 m0, s51, 2048
v_mfma_f32_16x16x32_bf16 v[108:111], v[176:179], v[140:143], v[108:111]
ds_read_b64_tr_b16 v[194:195], v218 offset:53248
s_add_u32 s66, s50, 1015808
v_mfma_f32_16x16x32_bf16 v[112:115], v[176:179], v[144:147], v[112:115]
ds_read_b64_tr_b16 v[196:197], v219 offset:49152
buffer_load_dwordx4 v238, s[4:7], s66 offen offset:0 lds
v_mfma_f32_16x16x32_bf16 v[116:119], v[176:179], v[148:151], v[116:119]
ds_read_b64_tr_b16 v[198:199], v219 offset:53248
s_waitcnt lgkmcnt(12)
v_mfma_f32_16x16x32_bf16 v[120:123], v[180:183], v[136:139], v[120:123]
v_mfma_f32_16x16x32_bf16 v[124:127], v[180:183], v[140:143], v[124:127]
v_mfma_f32_16x16x32_bf16 v[128:131], v[180:183], v[144:147], v[128:131]
buffer_load_dwordx4 v239, s[4:7], s66 offen offset:1024 lds
v_mfma_f32_16x16x32_bf16 v[132:135], v[180:183], v[148:151], v[132:135]
s_waitcnt lgkmcnt(6)
v_mfma_f32_16x16x32_bf16 v[72:75], v[184:187], v[152:155], v[72:75]
ds_read_b64_tr_b16 v[168:169], v220 offset:0
v_mfma_f32_16x16x32_bf16 v[76:79], v[184:187], v[156:159], v[76:79]
ds_read_b64_tr_b16 v[170:171], v220 offset:4096
v_mfma_f32_16x16x32_bf16 v[80:83], v[184:187], v[160:163], v[80:83]
ds_read_b128 v[136:139], v229 offset:0
v_mfma_f32_16x16x32_bf16 v[84:87], v[184:187], v[164:167], v[84:87]
ds_read_b128 v[140:143], v229 offset:1024
s_waitcnt lgkmcnt(8)
v_mfma_f32_16x16x32_bf16 v[88:91], v[188:191], v[152:155], v[88:91]
ds_read_b128 v[144:147], v229 offset:4096
v_mfma_f32_16x16x32_bf16 v[92:95], v[188:191], v[156:159], v[92:95]
ds_read_b128 v[148:151], v229 offset:5120
v_mfma_f32_16x16x32_bf16 v[96:99], v[188:191], v[160:163], v[96:99]
ds_read_b64_tr_b16 v[172:173], v221 offset:0
v_mfma_f32_16x16x32_bf16 v[100:103], v[188:191], v[164:167], v[100:103]
ds_read_b64_tr_b16 v[174:175], v221 offset:4096
s_waitcnt lgkmcnt(10)
v_mfma_f32_16x16x32_bf16 v[104:107], v[192:195], v[152:155], v[104:107]
ds_read_b64_tr_b16 v[176:177], v222 offset:0
v_mfma_f32_16x16x32_bf16 v[108:111], v[192:195], v[156:159], v[108:111]
ds_read_b64_tr_b16 v[178:179], v222 offset:4096
v_mfma_f32_16x16x32_bf16 v[112:115], v[192:195], v[160:163], v[112:115]
ds_read_b64_tr_b16 v[180:181], v223 offset:0
v_mfma_f32_16x16x32_bf16 v[116:119], v[192:195], v[164:167], v[116:119]
ds_read_b64_tr_b16 v[182:183], v223 offset:4096
s_waitcnt lgkmcnt(12)
v_mfma_f32_16x16x32_bf16 v[120:123], v[196:199], v[152:155], v[120:123]
v_mfma_f32_16x16x32_bf16 v[124:127], v[196:199], v[156:159], v[124:127]
v_mfma_f32_16x16x32_bf16 v[128:131], v[196:199], v[160:163], v[128:131]
v_mfma_f32_16x16x32_bf16 v[132:135], v[196:199], v[164:167], v[132:135]
s_waitcnt lgkmcnt(6)
s_waitcnt vmcnt(16)
s_barrier
v_mfma_f32_16x16x32_bf16 v[72:75], v[168:171], v[136:139], v[72:75]
ds_read_b64_tr_b16 v[184:185], v220 offset:16384
v_mfma_f32_16x16x32_bf16 v[76:79], v[168:171], v[140:143], v[76:79]
ds_read_b64_tr_b16 v[186:187], v220 offset:20480
v_mfma_f32_16x16x32_bf16 v[80:83], v[168:171], v[144:147], v[80:83]
ds_read_b128 v[152:155], v229 offset:16384
v_mfma_f32_16x16x32_bf16 v[84:87], v[168:171], v[148:151], v[84:87]
ds_read_b128 v[156:159], v229 offset:17408
s_waitcnt lgkmcnt(8)
v_mfma_f32_16x16x32_bf16 v[88:91], v[172:175], v[136:139], v[88:91]
ds_read_b128 v[160:163], v229 offset:20480
v_mfma_f32_16x16x32_bf16 v[92:95], v[172:175], v[140:143], v[92:95]
ds_read_b128 v[164:167], v229 offset:21504
v_mfma_f32_16x16x32_bf16 v[96:99], v[172:175], v[144:147], v[96:99]
ds_read_b64_tr_b16 v[188:189], v221 offset:16384
v_mfma_f32_16x16x32_bf16 v[100:103], v[172:175], v[148:151], v[100:103]
ds_read_b64_tr_b16 v[190:191], v221 offset:20480
s_waitcnt lgkmcnt(10)
v_mfma_f32_16x16x32_bf16 v[104:107], v[176:179], v[136:139], v[104:107]
ds_read_b64_tr_b16 v[192:193], v222 offset:16384
v_mfma_f32_16x16x32_bf16 v[108:111], v[176:179], v[140:143], v[108:111]
ds_read_b64_tr_b16 v[194:195], v222 offset:20480
v_mfma_f32_16x16x32_bf16 v[112:115], v[176:179], v[144:147], v[112:115]
ds_read_b64_tr_b16 v[196:197], v223 offset:16384
v_mfma_f32_16x16x32_bf16 v[116:119], v[176:179], v[148:151], v[116:119]
ds_read_b64_tr_b16 v[198:199], v223 offset:20480
s_waitcnt lgkmcnt(12)
v_mfma_f32_16x16x32_bf16 v[120:123], v[180:183], v[136:139], v[120:123]
v_mfma_f32_16x16x32_bf16 v[124:127], v[180:183], v[140:143], v[124:127]
v_mfma_f32_16x16x32_bf16 v[128:131], v[180:183], v[144:147], v[128:131]
v_mfma_f32_16x16x32_bf16 v[132:135], v[180:183], v[148:151], v[132:135]
s_waitcnt lgkmcnt(6)
v_mfma_f32_16x16x32_bf16 v[72:75], v[184:187], v[152:155], v[72:75]
ds_read_b64_tr_b16 v[168:169], v220 offset:32768
v_mfma_f32_16x16x32_bf16 v[76:79], v[184:187], v[156:159], v[76:79]
ds_read_b64_tr_b16 v[170:171], v220 offset:36864
v_mfma_f32_16x16x32_bf16 v[80:83], v[184:187], v[160:163], v[80:83]
ds_read_b128 v[136:139], v229 offset:32768
v_mfma_f32_16x16x32_bf16 v[84:87], v[184:187], v[164:167], v[84:87]
ds_read_b128 v[140:143], v229 offset:33792
s_waitcnt lgkmcnt(8)
v_mfma_f32_16x16x32_bf16 v[88:91], v[188:191], v[152:155], v[88:91]
ds_read_b128 v[144:147], v229 offset:36864
v_mfma_f32_16x16x32_bf16 v[92:95], v[188:191], v[156:159], v[92:95]
ds_read_b128 v[148:151], v229 offset:37888
v_mfma_f32_16x16x32_bf16 v[96:99], v[188:191], v[160:163], v[96:99]
ds_read_b64_tr_b16 v[172:173], v221 offset:32768
v_mfma_f32_16x16x32_bf16 v[100:103], v[188:191], v[164:167], v[100:103]
ds_read_b64_tr_b16 v[174:175], v221 offset:36864
s_waitcnt lgkmcnt(10)
v_mfma_f32_16x16x32_bf16 v[104:107], v[192:195], v[152:155], v[104:107]
ds_read_b64_tr_b16 v[176:177], v222 offset:32768
v_mfma_f32_16x16x32_bf16 v[108:111], v[192:195], v[156:159], v[108:111]
ds_read_b64_tr_b16 v[178:179], v222 offset:36864
v_mfma_f32_16x16x32_bf16 v[112:115], v[192:195], v[160:163], v[112:115]
ds_read_b64_tr_b16 v[180:181], v223 offset:32768
v_mfma_f32_16x16x32_bf16 v[116:119], v[192:195], v[164:167], v[116:119]
ds_read_b64_tr_b16 v[182:183], v223 offset:36864
s_waitcnt lgkmcnt(12)
v_mfma_f32_16x16x32_bf16 v[120:123], v[196:199], v[152:155], v[120:123]
v_mfma_f32_16x16x32_bf16 v[124:127], v[196:199], v[156:159], v[124:127]
v_mfma_f32_16x16x32_bf16 v[128:131], v[196:199], v[160:163], v[128:131]
v_mfma_f32_16x16x32_bf16 v[132:135], v[196:199], v[164:167], v[132:135]
s_waitcnt lgkmcnt(6)
s_waitcnt vmcnt(6)
s_barrier
v_mfma_f32_16x16x32_bf16 v[72:75], v[168:171], v[136:139], v[72:75]
ds_read_b64_tr_b16 v[184:185], v220 offset:49152
v_mfma_f32_16x16x32_bf16 v[76:79], v[168:171], v[140:143], v[76:79]
ds_read_b64_tr_b16 v[186:187], v220 offset:53248
v_mfma_f32_16x16x32_bf16 v[80:83], v[168:171], v[144:147], v[80:83]
ds_read_b128 v[152:155], v229 offset:49152
v_mfma_f32_16x16x32_bf16 v[84:87], v[168:171], v[148:151], v[84:87]
ds_read_b128 v[156:159], v229 offset:50176
s_waitcnt lgkmcnt(8)
v_mfma_f32_16x16x32_bf16 v[88:91], v[172:175], v[136:139], v[88:91]
ds_read_b128 v[160:163], v229 offset:53248
v_mfma_f32_16x16x32_bf16 v[92:95], v[172:175], v[140:143], v[92:95]
ds_read_b128 v[164:167], v229 offset:54272
v_mfma_f32_16x16x32_bf16 v[96:99], v[172:175], v[144:147], v[96:99]
ds_read_b64_tr_b16 v[188:189], v221 offset:49152
v_mfma_f32_16x16x32_bf16 v[100:103], v[172:175], v[148:151], v[100:103]
ds_read_b64_tr_b16 v[190:191], v221 offset:53248
s_waitcnt lgkmcnt(10)
v_mfma_f32_16x16x32_bf16 v[104:107], v[176:179], v[136:139], v[104:107]
ds_read_b64_tr_b16 v[192:193], v222 offset:49152
v_mfma_f32_16x16x32_bf16 v[108:111], v[176:179], v[140:143], v[108:111]
ds_read_b64_tr_b16 v[194:195], v222 offset:53248
v_mfma_f32_16x16x32_bf16 v[112:115], v[176:179], v[144:147], v[112:115]
ds_read_b64_tr_b16 v[196:197], v223 offset:49152
v_mfma_f32_16x16x32_bf16 v[116:119], v[176:179], v[148:151], v[116:119]
ds_read_b64_tr_b16 v[198:199], v223 offset:53248
s_waitcnt lgkmcnt(12)
v_mfma_f32_16x16x32_bf16 v[120:123], v[180:183], v[136:139], v[120:123]
v_mfma_f32_16x16x32_bf16 v[124:127], v[180:183], v[140:143], v[124:127]
v_mfma_f32_16x16x32_bf16 v[128:131], v[180:183], v[144:147], v[128:131]
v_mfma_f32_16x16x32_bf16 v[132:135], v[180:183], v[148:151], v[132:135]
s_waitcnt lgkmcnt(6)
v_mfma_f32_16x16x32_bf16 v[72:75], v[184:187], v[152:155], v[72:75]
ds_read_b64_tr_b16 v[168:169], v224 offset:0
v_mfma_f32_16x16x32_bf16 v[76:79], v[184:187], v[156:159], v[76:79]
ds_read_b64_tr_b16 v[170:171], v224 offset:4096
v_mfma_f32_16x16x32_bf16 v[80:83], v[184:187], v[160:163], v[80:83]
ds_read_b128 v[136:139], v230 offset:0
v_mfma_f32_16x16x32_bf16 v[84:87], v[184:187], v[164:167], v[84:87]
ds_read_b128 v[140:143], v230 offset:1024
s_waitcnt lgkmcnt(8)
v_mfma_f32_16x16x32_bf16 v[88:91], v[188:191], v[152:155], v[88:91]
ds_read_b128 v[144:147], v230 offset:4096
v_mfma_f32_16x16x32_bf16 v[92:95], v[188:191], v[156:159], v[92:95]
ds_read_b128 v[148:151], v230 offset:5120
v_mfma_f32_16x16x32_bf16 v[96:99], v[188:191], v[160:163], v[96:99]
ds_read_b64_tr_b16 v[172:173], v225 offset:0
v_mfma_f32_16x16x32_bf16 v[100:103], v[188:191], v[164:167], v[100:103]
ds_read_b64_tr_b16 v[174:175], v225 offset:4096
s_waitcnt lgkmcnt(10)
v_mfma_f32_16x16x32_bf16 v[104:107], v[192:195], v[152:155], v[104:107]
ds_read_b64_tr_b16 v[176:177], v226 offset:0
v_mfma_f32_16x16x32_bf16 v[108:111], v[192:195], v[156:159], v[108:111]
ds_read_b64_tr_b16 v[178:179], v226 offset:4096
v_mfma_f32_16x16x32_bf16 v[112:115], v[192:195], v[160:163], v[112:115]
ds_read_b64_tr_b16 v[180:181], v227 offset:0
v_mfma_f32_16x16x32_bf16 v[116:119], v[192:195], v[164:167], v[116:119]
ds_read_b64_tr_b16 v[182:183], v227 offset:4096
s_waitcnt lgkmcnt(12)
v_mfma_f32_16x16x32_bf16 v[120:123], v[196:199], v[152:155], v[120:123]
v_mfma_f32_16x16x32_bf16 v[124:127], v[196:199], v[156:159], v[124:127]
v_mfma_f32_16x16x32_bf16 v[128:131], v[196:199], v[160:163], v[128:131]
v_mfma_f32_16x16x32_bf16 v[132:135], v[196:199], v[164:167], v[132:135]
s_waitcnt lgkmcnt(6)
s_waitcnt vmcnt(0)
s_barrier
v_mfma_f32_16x16x32_bf16 v[72:75], v[168:171], v[136:139], v[72:75]
ds_read_b64_tr_b16 v[184:185], v224 offset:16384
v_mfma_f32_16x16x32_bf16 v[76:79], v[168:171], v[140:143], v[76:79]
ds_read_b64_tr_b16 v[186:187], v224 offset:20480
v_mfma_f32_16x16x32_bf16 v[80:83], v[168:171], v[144:147], v[80:83]
ds_read_b128 v[152:155], v230 offset:16384
v_mfma_f32_16x16x32_bf16 v[84:87], v[168:171], v[148:151], v[84:87]
ds_read_b128 v[156:159], v230 offset:17408
s_waitcnt lgkmcnt(8)
v_mfma_f32_16x16x32_bf16 v[88:91], v[172:175], v[136:139], v[88:91]
ds_read_b128 v[160:163], v230 offset:20480
v_mfma_f32_16x16x32_bf16 v[92:95], v[172:175], v[140:143], v[92:95]
ds_read_b128 v[164:167], v230 offset:21504
v_mfma_f32_16x16x32_bf16 v[96:99], v[172:175], v[144:147], v[96:99]
ds_read_b64_tr_b16 v[188:189], v225 offset:16384
v_mfma_f32_16x16x32_bf16 v[100:103], v[172:175], v[148:151], v[100:103]
ds_read_b64_tr_b16 v[190:191], v225 offset:20480
s_waitcnt lgkmcnt(10)
v_mfma_f32_16x16x32_bf16 v[104:107], v[176:179], v[136:139], v[104:107]
ds_read_b64_tr_b16 v[192:193], v226 offset:16384
v_mfma_f32_16x16x32_bf16 v[108:111], v[176:179], v[140:143], v[108:111]
ds_read_b64_tr_b16 v[194:195], v226 offset:20480
v_mfma_f32_16x16x32_bf16 v[112:115], v[176:179], v[144:147], v[112:115]
ds_read_b64_tr_b16 v[196:197], v227 offset:16384
v_mfma_f32_16x16x32_bf16 v[116:119], v[176:179], v[148:151], v[116:119]
ds_read_b64_tr_b16 v[198:199], v227 offset:20480
s_waitcnt lgkmcnt(12)
v_mfma_f32_16x16x32_bf16 v[120:123], v[180:183], v[136:139], v[120:123]
v_mfma_f32_16x16x32_bf16 v[124:127], v[180:183], v[140:143], v[124:127]
v_mfma_f32_16x16x32_bf16 v[128:131], v[180:183], v[144:147], v[128:131]
v_mfma_f32_16x16x32_bf16 v[132:135], v[180:183], v[148:151], v[132:135]
s_waitcnt lgkmcnt(6)
v_mfma_f32_16x16x32_bf16 v[72:75], v[184:187], v[152:155], v[72:75]
ds_read_b64_tr_b16 v[168:169], v216 offset:0
v_mfma_f32_16x16x32_bf16 v[76:79], v[184:187], v[156:159], v[76:79]
ds_read_b64_tr_b16 v[170:171], v216 offset:4096
v_mfma_f32_16x16x32_bf16 v[80:83], v[184:187], v[160:163], v[80:83]
ds_read_b128 v[136:139], v228 offset:0
v_mfma_f32_16x16x32_bf16 v[84:87], v[184:187], v[164:167], v[84:87]
ds_read_b128 v[140:143], v228 offset:1024
s_waitcnt lgkmcnt(8)
v_mfma_f32_16x16x32_bf16 v[88:91], v[188:191], v[152:155], v[88:91]
ds_read_b128 v[144:147], v228 offset:4096
v_mfma_f32_16x16x32_bf16 v[92:95], v[188:191], v[156:159], v[92:95]
ds_read_b128 v[148:151], v228 offset:5120
v_mfma_f32_16x16x32_bf16 v[96:99], v[188:191], v[160:163], v[96:99]
ds_read_b64_tr_b16 v[172:173], v217 offset:0
v_mfma_f32_16x16x32_bf16 v[100:103], v[188:191], v[164:167], v[100:103]
ds_read_b64_tr_b16 v[174:175], v217 offset:4096
s_waitcnt lgkmcnt(10)
v_mfma_f32_16x16x32_bf16 v[104:107], v[192:195], v[152:155], v[104:107]
ds_read_b64_tr_b16 v[176:177], v218 offset:0
v_mfma_f32_16x16x32_bf16 v[108:111], v[192:195], v[156:159], v[108:111]
ds_read_b64_tr_b16 v[178:179], v218 offset:4096
v_mfma_f32_16x16x32_bf16 v[112:115], v[192:195], v[160:163], v[112:115]
ds_read_b64_tr_b16 v[180:181], v219 offset:0
v_mfma_f32_16x16x32_bf16 v[116:119], v[192:195], v[164:167], v[116:119]
ds_read_b64_tr_b16 v[182:183], v219 offset:4096
s_waitcnt lgkmcnt(12)
v_mfma_f32_16x16x32_bf16 v[120:123], v[196:199], v[152:155], v[120:123]
v_mfma_f32_16x16x32_bf16 v[124:127], v[196:199], v[156:159], v[124:127]
v_mfma_f32_16x16x32_bf16 v[128:131], v[196:199], v[160:163], v[128:131]
v_mfma_f32_16x16x32_bf16 v[132:135], v[196:199], v[164:167], v[132:135]
s_waitcnt lgkmcnt(6)
v_mfma_f32_16x16x32_bf16 v[72:75], v[168:171], v[136:139], v[72:75]
v_mfma_f32_16x16x32_bf16 v[76:79], v[168:171], v[140:143], v[76:79]
v_mfma_f32_16x16x32_bf16 v[80:83], v[168:171], v[144:147], v[80:83]
v_mfma_f32_16x16x32_bf16 v[84:87], v[168:171], v[148:151], v[84:87]
s_waitcnt lgkmcnt(4)
v_mfma_f32_16x16x32_bf16 v[88:91], v[172:175], v[136:139], v[88:91]
v_mfma_f32_16x16x32_bf16 v[92:95], v[172:175], v[140:143], v[92:95]
v_mfma_f32_16x16x32_bf16 v[96:99], v[172:175], v[144:147], v[96:99]
v_mfma_f32_16x16x32_bf16 v[100:103], v[172:175], v[148:151], v[100:103]
s_waitcnt lgkmcnt(2)
v_mfma_f32_16x16x32_bf16 v[104:107], v[176:179], v[136:139], v[104:107]
v_mfma_f32_16x16x32_bf16 v[108:111], v[176:179], v[140:143], v[108:111]
v_mfma_f32_16x16x32_bf16 v[112:115], v[176:179], v[144:147], v[112:115]
v_mfma_f32_16x16x32_bf16 v[116:119], v[176:179], v[148:151], v[116:119]
s_waitcnt lgkmcnt(0)
v_mfma_f32_16x16x32_bf16 v[120:123], v[180:183], v[136:139], v[120:123]
v_mfma_f32_16x16x32_bf16 v[124:127], v[180:183], v[140:143], v[124:127]
v_mfma_f32_16x16x32_bf16 v[128:131], v[180:183], v[144:147], v[128:131]
v_mfma_f32_16x16x32_bf16 v[132:135], v[180:183], v[148:151], v[132:135]
s_lshl_b32 s65, s54, 2
s_add_u32 s66, s65, s40
s_lshl_b32 s67, s66, 2
s_add_u32 s67, s67, s53
s_lshl_b32 s67, s67, 13
s_lshl_b32 s66, s66, 7
s_add_u32 s65, s65, s53
s_lshl_b32 s69, s65, 7
s_sub_u32 s68, s51, s41
v_add_u32 v246, s68, v2
s_cmp_eq_u32 s40, s53
s_cbranch_scc1 KF_own
v_cvt_pk_bf16_f32 v136, v72, v73
v_cvt_pk_bf16_f32 v137, v74, v75
v_cvt_pk_bf16_f32 v138, v88, v89
v_cvt_pk_bf16_f32 v139, v90, v91
buffer_store_dwordx4 v[136:139], v2, s[12:15], s67 offen offset:0 sc1
v_cvt_pk_bf16_f32 v140, v104, v105
v_cvt_pk_bf16_f32 v141, v106, v107
v_cvt_pk_bf16_f32 v142, v120, v121
v_cvt_pk_bf16_f32 v143, v122, v123
buffer_store_dwordx4 v[140:143], v2, s[12:15], s67 offen offset:1024 sc1
v_cvt_pk_bf16_f32 v144, v76, v77
v_cvt_pk_bf16_f32 v145, v78, v79
v_cvt_pk_bf16_f32 v146, v92, v93
v_cvt_pk_bf16_f32 v147, v94, v95
buffer_store_dwordx4 v[144:147], v2, s[12:15], s67 offen offset:2048 sc1
v_cvt_pk_bf16_f32 v148, v108, v109
v_cvt_pk_bf16_f32 v149, v110, v111
v_cvt_pk_bf16_f32 v150, v124, v125
v_cvt_pk_bf16_f32 v151, v126, v127
buffer_store_dwordx4 v[148:151], v2, s[12:15], s67 offen offset:3072 sc1
s_add_u32 s67, s67, 4096
v_cvt_pk_bf16_f32 v152, v80, v81
v_cvt_pk_bf16_f32 v153, v82, v83
v_cvt_pk_bf16_f32 v154, v96, v97
v_cvt_pk_bf16_f32 v155, v98, v99
buffer_store_dwordx4 v[152:155], v2, s[12:15], s67 offen offset:0 sc1
v_cvt_pk_bf16_f32 v156, v112, v113
v_cvt_pk_bf16_f32 v157, v114, v115
v_cvt_pk_bf16_f32 v158, v128, v129
v_cvt_pk_bf16_f32 v159, v130, v131
buffer_store_dwordx4 v[156:159], v2, s[12:15], s67 offen offset:1024 sc1
v_cvt_pk_bf16_f32 v160, v84, v85
v_cvt_pk_bf16_f32 v161, v86, v87
v_cvt_pk_bf16_f32 v162, v100, v101
v_cvt_pk_bf16_f32 v163, v102, v103
buffer_store_dwordx4 v[160:163], v2, s[12:15], s67 offen offset:2048 sc1
v_cvt_pk_bf16_f32 v164, v116, v117
v_cvt_pk_bf16_f32 v165, v118, v119
v_cvt_pk_bf16_f32 v166, v132, v133
v_cvt_pk_bf16_f32 v167, v134, v135
buffer_store_dwordx4 v[164:167], v2, s[12:15], s67 offen offset:3072 sc1
s_branch KF_sent
KF_own:
ds_write_b128 v246, v[72:75] offset:32768
ds_write_b128 v246, v[88:91] offset:33792
ds_write_b128 v246, v[104:107] offset:34816
ds_write_b128 v246, v[120:123] offset:35840
ds_write_b128 v246, v[76:79] offset:36864
ds_write_b128 v246, v[92:95] offset:37888
ds_write_b128 v246, v[108:111] offset:38912
ds_write_b128 v246, v[124:127] offset:39936
ds_write_b128 v246, v[80:83] offset:40960
ds_write_b128 v246, v[96:99] offset:41984
ds_write_b128 v246, v[112:115] offset:43008
ds_write_b128 v246, v[128:131] offset:44032
ds_write_b128 v246, v[84:87] offset:45056
ds_write_b128 v246, v[100:103] offset:46080
ds_write_b128 v246, v[116:119] offset:47104
ds_write_b128 v246, v[132:135] offset:48128
s_waitcnt lgkmcnt(0)
KF_sent:
s_lshl_b32 s65, s65, 15
s_lshl_b32 s66, s40, 11
s_add_u32 s65, s65, s66
s_add_u32 s66, s53, 1
s_and_b32 s66, s66, 3
s_lshl_b32 s66, s66, 13
s_add_u32 s66, s66, s65
s_add_u32 s67, s53, 2
s_and_b32 s67, s67, 3
s_lshl_b32 s67, s67, 13
s_add_u32 s67, s67, s65
s_add_u32 s68, s53, 3
s_and_b32 s68, s68, 3
s_lshl_b32 s68, s68, 13
s_add_u32 s68, s68, s65
s_barrier
v_add_u32 v246, s41, v246
ds_read_b128 v[72:75], v246 offset:32768
ds_read_b128 v[76:79], v246 offset:33792
ds_read_b128 v[80:83], v246 offset:34816
ds_read_b128 v[84:87], v246 offset:35840
s_mov_b32 s100, 0
KF_xloop:
buffer_load_dwordx4 v[88:91], v2, s[12:15], s66 offen offset:0 sc1
buffer_load_dwordx4 v[92:95], v2, s[12:15], s66 offen offset:1024 sc1
buffer_load_dwordx4 v[96:99], v2, s[12:15], s67 offen offset:0 sc1
buffer_load_dwordx4 v[100:103], v2, s[12:15], s67 offen offset:1024 sc1
buffer_load_dwordx4 v[104:107], v2, s[12:15], s68 offen offset:0 sc1
buffer_load_dwordx4 v[108:111], v2, s[12:15], s68 offen offset:1024 sc1
v_lshlrev_b32 v16, 16, v8
v_and_b32 v17, 0xffff0000, v8
v_lshlrev_b32 v18, 16, v9
v_and_b32 v19, 0xffff0000, v9
v_lshlrev_b32 v20, 16, v10
v_and_b32 v21, 0xffff0000, v10
v_lshlrev_b32 v22, 16, v11
v_and_b32 v23, 0xffff0000, v11
v_lshlrev_b32 v24, 16, v12
v_and_b32 v25, 0xffff0000, v12
v_lshlrev_b32 v26, 16, v13
v_and_b32 v27, 0xffff0000, v13
v_lshlrev_b32 v28, 16, v14
v_and_b32 v29, 0xffff0000, v14
v_lshlrev_b32 v30, 16, v15
v_and_b32 v31, 0xffff0000, v15
s_waitcnt vmcnt(5)
v_max3_u32 v120, v88, v89, v90
s_waitcnt vmcnt(4)
v_max3_u32 v120, v120, v91, v92
v_max3_u32 v120, v120, v93, v94
s_waitcnt vmcnt(3)
v_max3_u32 v120, v120, v95, v96
v_max3_u32 v120, v120, v97, v98
s_waitcnt vmcnt(2)
v_max3_u32 v120, v120, v99, v100
v_max3_u32 v120, v120, v101, v102
s_waitcnt vmcnt(1)
v_max3_u32 v120, v120, v103, v104
v_max3_u32 v120, v120, v105, v106
s_waitcnt vmcnt(0)
v_max3_u32 v120, v120, v107, v108
v_max3_u32 v120, v120, v109, v110
v_max_u32 v120, v120, v111
v_cmp_ne_u32 vcc, -1, v120
s_cmp_eq_u64 vcc, exec
s_cbranch_scc1 KF_xok
s_add_u32 s100, s100, 1
s_cmp_lt_u32 s100, 0x10000
s_cbranch_scc1 KF_xloop
KF_xok:
v_lshlrev_b32 v120, 16, v88
v_and_b32 v88, 0xffff0000, v88
s_waitcnt lgkmcnt(3)
v_add_f32 v72, v72, v120
v_add_f32 v73, v73, v88
v_lshlrev_b32 v121, 16, v89
v_and_b32 v89, 0xffff0000, v89
v_add_f32 v74, v74, v121
v_add_f32 v75, v75, v89
v_lshlrev_b32 v120, 16, v90
v_and_b32 v90, 0xffff0000, v90
s_waitcnt lgkmcnt(2)
v_add_f32 v76, v76, v120
v_add_f32 v77, v77, v90
v_lshlrev_b32 v121, 16, v91
v_and_b32 v91, 0xffff0000, v91
v_add_f32 v78, v78, v121
v_add_f32 v79, v79, v91
v_lshlrev_b32 v120, 16, v92
v_and_b32 v92, 0xffff0000, v92
s_waitcnt lgkmcnt(1)
v_add_f32 v80, v80, v120
v_add_f32 v81, v81, v92
v_lshlrev_b32 v121, 16, v93
v_and_b32 v93, 0xffff0000, v93
v_add_f32 v82, v82, v121
v_add_f32 v83, v83, v93
v_lshlrev_b32 v120, 16, v94
v_and_b32 v94, 0xffff0000, v94
s_waitcnt lgkmcnt(0)
v_add_f32 v84, v84, v120
v_add_f32 v85, v85, v94
v_lshlrev_b32 v121, 16, v95
v_and_b32 v95, 0xffff0000, v95
v_add_f32 v86, v86, v121
v_add_f32 v87, v87, v95
v_lshlrev_b32 v120, 16, v96
v_and_b32 v96, 0xffff0000, v96
v_add_f32 v72, v72, v120
v_add_f32 v73, v73, v96
v_lshlrev_b32 v121, 16, v97
v_and_b32 v97, 0xffff0000, v97
v_add_f32 v74, v74, v121
v_add_f32 v75, v75, v97
v_lshlrev_b32 v120, 16, v98
v_and_b32 v98, 0xffff0000, v98
v_add_f32 v76, v76, v120
v_add_f32 v77, v77, v98
v_lshlrev_b32 v121, 16, v99
v_and_b32 v99, 0xffff0000, v99
v_add_f32 v78, v78, v121
v_add_f32 v79, v79, v99
v_lshlrev_b32 v120, 16, v100
v_and_b32 v100, 0xffff0000, v100
v_add_f32 v80, v80, v120
v_add_f32 v81, v81, v100
v_lshlrev_b32 v121, 16, v101
v_and_b32 v101, 0xffff0000, v101
v_add_f32 v82, v82, v121
v_add_f32 v83, v83, v101
v_lshlrev_b32 v120, 16, v102
v_and_b32 v102, 0xffff0000, v102
v_add_f32 v84, v84, v120
v_add_f32 v85, v85, v102
v_lshlrev_b32 v121, 16, v103
v_and_b32 v103, 0xffff0000, v103
v_add_f32 v86, v86, v121
v_add_f32 v87, v87, v103
v_lshlrev_b32 v120, 16, v104
v_and_b32 v104, 0xffff0000, v104
v_add_f32 v72, v72, v120
v_add_f32 v73, v73, v104
v_lshlrev_b32 v121, 16, v105
v_and_b32 v105, 0xffff0000, v105
v_add_f32 v74, v74, v121
v_add_f32 v75, v75, v105
v_lshlrev_b32 v120, 16, v106
v_and_b32 v106, 0xffff0000, v106
v_add_f32 v76, v76, v120
v_add_f32 v77, v77, v106
v_lshlrev_b32 v121, 16, v107
v_and_b32 v107, 0xffff0000, v107
v_add_f32 v78, v78, v121
v_add_f32 v79, v79, v107
v_lshlrev_b32 v120, 16, v108
v_and_b32 v108, 0xffff0000, v108
v_add_f32 v80, v80, v120
v_add_f32 v81, v81, v108
v_lshlrev_b32 v121, 16, v109
v_and_b32 v109, 0xffff0000, v109
v_add_f32 v82, v82, v121
v_add_f32 v83, v83, v109
v_lshlrev_b32 v120, 16, v110
v_and_b32 v110, 0xffff0000, v110
v_add_f32 v84, v84, v120
v_add_f32 v85, v85, v110
v_lshlrev_b32 v121, 16, v111
v_and_b32 v111, 0xffff0000, v111
v_add_f32 v86, v86, v121
v_add_f32 v87, v87, v111
v_permlane16_swap_b32 v72, v76
v_permlane16_swap_b32 v73, v77
v_permlane16_swap_b32 v74, v78
v_permlane16_swap_b32 v75, v79
v_permlane16_swap_b32 v80, v84
v_permlane16_swap_b32 v81, v85
v_permlane16_swap_b32 v82, v86
v_permlane16_swap_b32 v83, v87
v_add_f32 v72, v72, v16
v_add_f32 v73, v73, v17
v_add_f32 v74, v74, v18
v_add_f32 v75, v75, v19
v_add_f32 v76, v76, v20
v_add_f32 v77, v77, v21
v_add_f32 v78, v78, v22
v_add_f32 v79, v79, v23
v_cvt_pk_bf16_f32 v8, v72, v73
v_cvt_pk_bf16_f32 v9, v74, v75
v_cvt_pk_bf16_f32 v10, v76, v77
v_cvt_pk_bf16_f32 v11, v78, v79
buffer_store_dwordx4 v[8:11], v248, s[16:19], s57 offen offset:0 sc1
v_add_f32 v80, v80, v24
v_add_f32 v81, v81, v25
v_add_f32 v82, v82, v26
v_add_f32 v83, v83, v27
v_add_f32 v84, v84, v28
v_add_f32 v85, v85, v29
v_add_f32 v86, v86, v30
v_add_f32 v87, v87, v31
v_cvt_pk_bf16_f32 v12, v80, v81
v_cvt_pk_bf16_f32 v13, v82, v83
v_cvt_pk_bf16_f32 v14, v84, v85
v_cvt_pk_bf16_f32 v15, v86, v87
buffer_store_dwordx4 v[12:15], v248, s[16:19], s57 offen offset:64 sc1
s_endpgm
KF_wd:
s_lshr_b32 s67, s2, 3
s_lshl_b32 s67, s67, 2
s_add_u32 s67, s67, s40
v_lshlrev_b32 v249, 7, v1
s_lshl_b32 s65, s67, 13
s_add_u32 s65, s65, s50
s_and_b32 s65, s65, 0xfffffc00
s_waitcnt vmcnt(10)
buffer_load_dword v242, v249, s[4:7], s65 offen
v_min_u32 v250, 2688, v249
s_mul_i32 s65, s67, 2816
s_add_u32 s65, s65, s49
s_and_b32 s65, s65, 0xffffff00
s_lshl_b32 s66, s56, 8
s_sub_u32 s65, s65, s66
s_waitcnt vmcnt(10)
buffer_load_dword v243, v250, s[8:11], s65 offen
s_lshr_b32 s100, s2, 3
s_lshl_b32 s100, s100, 2
s_add_u32 s100, s100, s40
s_mul_i32 s100, s100, 384
s_add_u32 s100, s100, KF_tails-KF_cw1
s_min_i32 s100, s100, KF_codeend-KF_cw1-384
v_min_u32 v249, 2, v1
v_lshlrev_b32 v249, 7, v249
s_getpc_b64 s[78:79]
KF_cw1:
s_ashr_i32 s101, s100, 31
s_add_u32 s78, s78, s100
s_addc_u32 s79, s79, s101
global_load_dword v250, v249, s[78:79]
s_mov_b32 s84, -1
s_branch KF_wd_back
KF_g0_spin:
s_mov_b32 s100, 0
KF_g0_loop:
buffer_load_dword v70, v71, s[36:39], 0 offen sc1
s_waitcnt vmcnt(0)
v_cmp_le_u32 vcc, 64, v70
s_cmp_eq_u64 vcc, exec
s_cbranch_scc1 KF_g0_back
s_add_u32 s100, s100, 1
s_cmp_lt_u32 s100, 0x10000
s_cbranch_scc1 KF_g0_loop
s_branch KF_g0_back
KF_x0_spin:
s_mov_b32 s100, 0
KF_x0_loop:
buffer_load_dword v70, v71, s[32:35], s69 offen sc1
s_waitcnt vmcnt(0)
v_cmp_le_u32 vcc, 32, v70
s_cmp_eq_u64 vcc, exec
s_cbranch_scc1 KF_x0_back
s_add_u32 s100, s100, 1
s_cmp_lt_u32 s100, 0x10000
s_cbranch_scc1 KF_x0_loop
s_branch KF_x0_back
KF_k_spin:
s_mov_b32 s100, 0
KF_k_loop:
buffer_load_dword v240, off, s[32:35], s69 sc1
s_waitcnt vmcnt(0)
v_cmp_le_u32 vcc, 16, v240
s_cmp_eq_u64 vcc, exec
s_cbranch_scc1 KF_k_back
s_add_u32 s100, s100, 1
s_cmp_lt_u32 s100, 0x10000
s_cbranch_scc1 KF_k_loop
s_branch KF_k_back
KF_g1_spin:
s_mov_b32 s100, 0
KF_g1_loop:
buffer_load_dword v70, v71, s[36:39], 0 offen sc1
s_waitcnt vmcnt(0)
v_cmp_le_u32 vcc, 64, v70
s_cmp_eq_u64 vcc, exec
s_cbranch_scc1 KF_g1_back
s_add_u32 s100, s100, 1
s_cmp_lt_u32 s100, 0x10000
s_cbranch_scc1 KF_g1_loop
s_branch KF_g1_back
KF_x1_spin:
s_mov_b32 s100, 0
KF_x1_loop:
buffer_load_dword v70, v71, s[32:35], s69 offen sc1
s_waitcnt vmcnt(0)
v_cmp_le_u32 vcc, 32, v70
s_cmp_eq_u64 vcc, exec
s_cbranch_scc1 KF_x1_back
s_add_u32 s100, s100, 1
s_cmp_lt_u32 s100, 0x10000
s_cbranch_scc1 KF_x1_loop
s_branch KF_x1_back
KF_h_spin:
s_mov_b32 s100, 0
KF_h_loop:
buffer_load_dword v244, v245, s[32:35], s69 offen sc1
s_waitcnt vmcnt(0)
v_cmp_le_u32 vcc, 32, v244
s_cmp_eq_u64 vcc, exec
s_cbranch_scc1 KF_h_back
s_add_u32 s100, s100, 1
s_cmp_lt_u32 s100, 0x10000
s_cbranch_scc1 KF_h_loop
s_branch KF_h_back
KF_h2_spin:
s_mov_b32 s100, 0
KF_h2_loop:
buffer_load_dword v244, v245, s[32:35], s69 offen sc1
s_waitcnt vmcnt(0)
v_cmp_le_u32 vcc, 32, v244
s_cmp_eq_u64 vcc, exec
s_cbranch_scc1 KF_h2_back
s_add_u32 s100, s100, 1
s_cmp_lt_u32 s100, 0x10000
s_cbranch_scc1 KF_h2_loop
s_branch KF_h2_back
KF_c_spin:
s_mov_b32 s100, 0
KF_c_loop:
buffer_load_dword v244, v245, s[32:35], s69 offen sc1
s_waitcnt vmcnt(0)
v_cmp_le_u32 vcc, 8, v244
s_cmp_eq_u64 vcc, exec
s_cbranch_scc1 KF_c_back
s_add_u32 s100, s100, 1
s_cmp_lt_u32 s100, 0x10000
s_cbranch_scc1 KF_c_loop
s_branch KF_c_back
KF_end:
s_endpgm
KF_codeend:
.section .rodata,"a"
.p2align 6
.amdhsa_kernel parallel_sum__compressed_kv_cla__geglu_ffn__prompt_kernel
  .amdhsa_next_free_vgpr 512
  .amdhsa_next_free_sgpr 102
  .amdhsa_accum_offset 256
  .amdhsa_group_segment_fixed_size 0
  .amdhsa_kernarg_size 104
  .amdhsa_user_sgpr_count 2
  .amdhsa_user_sgpr_kernarg_segment_ptr 1
  .amdhsa_system_sgpr_workgroup_id_x 1
  .amdhsa_float_denorm_mode_32 3
.end_amdhsa_kernel
.text
```
